```python
import torch

def _softmax(x, axis=-1):
    return torch.softmax(x, dim=axis)

def _gelu(x):
    return torch.nn.functional.gelu(x, approximate='tanh')

def _silu(x):
    return torch.nn.functional.silu(x)

def _sigmoid(x):
    return torch.sigmoid(x)

def _layernorm(x, axis=-1, eps=1e-05):
    m = x.mean(dim=axis, keepdim=True)
    v = x.var(dim=axis, keepdim=True, unbiased=False)
    return (x - m) / torch.sqrt(v + eps)

def _scatter_add(tgt, idx, src, axis=0):
    return tgt.clone().index_add_(axis, idx, src)

def _segment_sum(src, seg, n):
    out = torch.zeros((n,) + src.shape[1:], dtype=src.dtype)
    return out.index_add_(0, seg, src)

def _pad(x, pw):
    flat = tuple((v for pair in reversed(pw) for v in pair))
    return torch.nn.functional.pad(x, flat)
kernel_name = 'parallel_sum__memory_aug_recurrent_mem_tr__glu_gated_swiglu__prompt'

def setup_inputs():

    _w = lambda a: (lambda t: t.to(torch.bfloat16) if t.is_floating_point() else t)(torch.as_tensor(a))

    def _A_setup():
        B, S, Dm = (1, 2048, 512)
        H, Dh = (32, 128)
        M, seg = (8, 32)
        seg = min(seg, S)
        S = S // seg * seg
        return {'x': _w((lambda *s: torch.randn(*s, dtype=torch.bfloat16) * 0.05)(B, S, Dm)), 'mem0': _w((lambda *s: torch.randn(*s, dtype=torch.bfloat16) * 0.2)(B, M, Dm)), 'Wq': _w((lambda *s: torch.randn(*s, dtype=torch.bfloat16) * 1.6)(Dm, H, Dh) * Dm ** (-0.5)), 'Wk': _w((lambda *s: torch.randn(*s, dtype=torch.bfloat16) * 1.6)(Dm, H, Dh) * Dm ** (-0.5)), 'Wv': _w((lambda *s: torch.randn(*s, dtype=torch.bfloat16) * 0.2)(Dm, H, Dh) * Dm ** (-0.5)), 'Wo': _w((lambda *s: torch.randn(*s, dtype=torch.bfloat16) * 0.2)(H, Dh, Dm) * (H * Dh) ** (-0.5)), 'seg_len': seg}
    _A_in = _A_setup()

    def _B_setup():
        B, S, D, F = (1, 2048, 512, 1376)
        return {'x': _w((lambda *s: torch.randn(*s, dtype=torch.bfloat16) * 0.05)(B, S, D)), 'w1': _w((lambda *s: torch.randn(*s, dtype=torch.bfloat16) * 0.2)(D, F) * (2.0 / D) ** 0.5), 'w3': _w((lambda *s: torch.randn(*s, dtype=torch.bfloat16) * 0.2)(D, F) * (2.0 / D) ** 0.5), 'w2': _w((lambda *s: torch.randn(*s, dtype=torch.bfloat16) * 0.2)(F, D) * (2.0 / F) ** 0.5)}
    _B_in = _B_setup()
    return {'A_x': _A_in['x'], 'A_mem0': _A_in['mem0'], 'A_Wq': _A_in['Wq'], 'A_Wk': _A_in['Wk'], 'A_Wv': _A_in['Wv'], 'A_Wo': _A_in['Wo'], 'A_seg_len': _A_in['seg_len'], 'B_x': _B_in['x'], 'B_w1': _B_in['w1'], 'B_w3': _B_in['w3'], 'B_w2': _B_in['w2']}

def reference(A_x, A_mem0, A_Wq, A_Wk, A_Wv, A_Wo, A_seg_len, B_x, B_w1, B_w3, B_w2):

    def _A_ref(x, mem0, Wq, Wk, Wv, Wo, seg_len):
        B, S, Dm = x.shape
        H, Dh = (Wq.shape[1], Wq.shape[2])
        M = mem0.shape[1]
        scale = Dh ** (-0.5)
        n_seg = S // seg_len
        L = M + seg_len
        idx = torch.arange(L)
        mask = (idx[:, None] < M) | (idx[:, None] >= idx[None, :])
        mem = mem0
        outs = []
        for s in range(n_seg):
            xs = x[:, s * seg_len:(s + 1) * seg_len, :].clone()
            h = torch.concatenate([mem, xs], axis=1)
            q = torch.einsum('btd,dhe->bhte', h, Wq)
            k = torch.einsum('btd,dhe->bhte', h, Wk)
            v = torch.einsum('btd,dhe->bhte', h, Wv)
            scores = torch.einsum('bhqe,bhke->bhqk', q, k) * scale
            scores = torch.where(mask[None, None], scores, -1000000000.0)
            p = _softmax(scores, axis=-1)
            o = torch.einsum('bhqk,bhke->bhqe', p, v)
            o = torch.einsum('bhte,hed->btd', o, Wo)
            mem = o[:, :M, :].clone()
            outs.append(o[:, M:, :])
        return torch.concatenate(outs, axis=1)

    def _B_ref(x, w1, w3, w2):
        gate = torch.einsum('bsd,df->bsf', x, w1)
        up = torch.einsum('bsd,df->bsf', x, w3)
        h = _silu(gate) * up
        out = torch.einsum('bsf,fd->bsd', h, w2)
        return out
    x = A_x
    xn = _layernorm(x, axis=-1)
    return x + _A_ref(xn, A_mem0, A_Wq, A_Wk, A_Wv, A_Wo, A_seg_len) + _B_ref(xn, B_w1, B_w3, B_w2)
```

```asm
; @launch grid=(256,1,1) block=(256,1,1) lds=163840
.amdgcn_target "amdgcn-amd-amdhsa--gfx950"
.text
.globl parallel_sum__memory_aug_recurrent_mem_tr__glu_gated_swiglu__prompt_kernel
.p2align 8
.type parallel_sum__memory_aug_recurrent_mem_tr__glu_gated_swiglu__prompt_kernel,@function
parallel_sum__memory_aug_recurrent_mem_tr__glu_gated_swiglu__prompt_kernel:
    s_cmp_ge_u32 s2, 256
    s_cbranch_scc1 L_END
    s_load_dwordx4 s[60:63], s[0:1], 96
    s_load_dwordx16 s[36:51], s[0:1], 0
    s_load_dwordx8 s[52:59], s[0:1], 64
    s_getreg_b32 s3, hwreg(HW_REG_XCC_ID)
    s_and_b32 s3, s3, 7
    s_lshl_b32 s3, s3, 2
    s_lshr_b32 s3, 0x43216507, s3
    s_and_b32 s3, s3, 7
    v_lshrrev_b32 v1, 6, v0
    v_and_b32 v0, 63, v0
    v_readfirstlane_b32 s25, v1
    v_mov_b32 v4, 32000
    v_lshlrev_b32 v12, 7, v0
    s_lshr_b32 s13, s2, 3
    s_cmp_lg_u32 s25, 3
    s_cbranch_scc1 L_NOPF
    s_getpc_b64 s[14:15]
L_PC:
    s_and_b32 s12, s13, 15
    s_lshl_b32 s12, s12, 13
    v_add_u32 v13, s12, v12
    v_min_u32 v13, L_LAST-L_PC, v13
    global_load_dword v127, v13, s[14:15]
L_NOPF:
    s_waitcnt lgkmcnt(0)
    s_mov_b32 s4, s62
    s_mov_b32 s5, s63
    s_mov_b32 s6, 0x10000000
    s_mov_b32 s7, 0x20000
    s_cmp_lg_u32 s25, 0
    s_cbranch_scc1 L_NOTK
    s_lshl_b32 s8, s3, 5
    s_mov_b32 s9, 1
    s_atomic_add s9, s[60:61], s8 glc
L_NOTK:
    s_mov_b32 s18, 0x400000
    s_mov_b32 s19, 0x20000
    s_lshr_b32 s11, s25, 1
    s_lshl_b32 s11, s11, 7
    s_add_u32 s11, s11, s13
    s_lshl_b32 s11, s11, 13
    s_and_b32 s12, s25, 1
    v_lshlrev_b32 v13, 4, v0
    s_cmp_lg_u32 s3, 0
    s_cbranch_scc1 L_PWQ
    s_mov_b32 s16, s42
    s_mov_b32 s17, s43
    s_lshl_b32 s12, s12, 12
    s_add_u32 s11, s11, s12
    v_add_u32 v13, s11, v13
    s_mov_b32 s12, 0
    buffer_load_dwordx4 v[124:127], v13, s[16:19], s12 offen offset:0
    buffer_load_dwordx4 v[124:127], v13, s[16:19], s12 offen offset:1024
    buffer_load_dwordx4 v[124:127], v13, s[16:19], s12 offen offset:2048
    buffer_load_dwordx4 v[124:127], v13, s[16:19], s12 offen offset:3072
    s_branch L_NOPW
L_PWQ:
    s_cmp_ge_u32 s3, 5
    s_cbranch_scc1 L_PWO
    s_lshl_b32 s12, s12, 10
    s_add_u32 s11, s11, s12
    s_sub_u32 s12, s3, 1
    s_lshl_b32 s12, s12, 11
    s_add_u32 s11, s11, s12
    v_add_u32 v13, s11, v13
    s_mov_b32 s16, s42
    s_mov_b32 s17, s43
    s_mov_b32 s12, 0
    buffer_load_dwordx4 v[124:127], v13, s[16:19], s12 offen
    s_mov_b32 s12, 2097152
    buffer_load_dwordx4 v[124:127], v13, s[16:19], s12 offen
    s_mov_b32 s12, 262144
    buffer_load_dwordx4 v[124:127], v13, s[16:19], s12 offen
    s_mov_b32 s12, 2359296
    buffer_load_dwordx4 v[124:127], v13, s[16:19], s12 offen
    s_mov_b32 s12, 524288
    buffer_load_dwordx4 v[124:127], v13, s[16:19], s12 offen
    s_mov_b32 s12, 2621440
    buffer_load_dwordx4 v[124:127], v13, s[16:19], s12 offen
    s_mov_b32 s12, 786432
    buffer_load_dwordx4 v[124:127], v13, s[16:19], s12 offen
    s_mov_b32 s12, 2883584
    buffer_load_dwordx4 v[124:127], v13, s[16:19], s12 offen
    s_branch L_NOPW
L_PWO:
L_NOPW:
    s_cmp_lg_u32 s25, 0
    s_cbranch_scc1 L_RANKED
    s_waitcnt lgkmcnt(0)
    v_mov_b32 v3, s9
    ds_write_b32 v4, v3
    s_waitcnt lgkmcnt(0)
L_RANKED:
    s_barrier
    ds_read_b32 v3, v4
    s_waitcnt lgkmcnt(0)
    v_readfirstlane_b32 s24, v3
    s_barrier
    s_cmp_ge_u32 s24, 32
    s_cbranch_scc1 L_OVER
L_ROLE:
    s_cmp_eq_u32 s3, 0
    s_cbranch_scc1 ROLE_R
    s_cmp_eq_u32 s3, 7
    s_cbranch_scc1 ROLE_H
    s_cmp_ge_u32 s3, 5
    s_cbranch_scc1 ROLE_F
ROLE_QA:
    s_mov_b32 s8, s42
    s_mov_b32 s9, s43
    s_mov_b32 s10, 0x400000
    s_mov_b32 s11, 0x20000
    s_mov_b32 s12, s44
    s_mov_b32 s13, s45
    s_mov_b32 s14, 0x400000
    s_mov_b32 s15, 0x20000
    s_mov_b32 s16, s40
    s_mov_b32 s17, s41
    s_mov_b32 s18, 0x400000
    s_mov_b32 s19, 0x20000
    v_mov_b32 v31, v13
    s_waitcnt vmcnt(0)
    s_waitcnt vmcnt(4)
    s_mov_b32 s67, 0
    buffer_load_dwordx4 v[124:127], v31, s[12:15], s67 offen
    s_waitcnt vmcnt(4)
    s_mov_b32 s67, 2097152
    buffer_load_dwordx4 v[124:127], v31, s[12:15], s67 offen
    s_waitcnt vmcnt(4)
    s_mov_b32 s67, 262144
    buffer_load_dwordx4 v[124:127], v31, s[12:15], s67 offen
    s_waitcnt vmcnt(4)
    s_mov_b32 s67, 2359296
    buffer_load_dwordx4 v[124:127], v31, s[12:15], s67 offen
    s_waitcnt vmcnt(4)
    s_mov_b32 s67, 524288
    buffer_load_dwordx4 v[124:127], v31, s[12:15], s67 offen
    s_waitcnt vmcnt(4)
    s_mov_b32 s67, 2621440
    buffer_load_dwordx4 v[124:127], v31, s[12:15], s67 offen
    s_waitcnt vmcnt(4)
    s_mov_b32 s67, 786432
    buffer_load_dwordx4 v[124:127], v31, s[12:15], s67 offen
    s_waitcnt vmcnt(4)
    s_mov_b32 s67, 2883584
    buffer_load_dwordx4 v[124:127], v31, s[12:15], s67 offen
    s_waitcnt vmcnt(0)
    s_waitcnt vmcnt(4)
    s_mov_b32 s67, 0
    buffer_load_dwordx4 v[124:127], v31, s[16:19], s67 offen
    s_waitcnt vmcnt(4)
    s_mov_b32 s67, 2097152
    buffer_load_dwordx4 v[124:127], v31, s[16:19], s67 offen
    s_waitcnt vmcnt(4)
    s_mov_b32 s67, 262144
    buffer_load_dwordx4 v[124:127], v31, s[16:19], s67 offen
    s_waitcnt vmcnt(4)
    s_mov_b32 s67, 2359296
    buffer_load_dwordx4 v[124:127], v31, s[16:19], s67 offen
    s_waitcnt vmcnt(4)
    s_mov_b32 s67, 524288
    buffer_load_dwordx4 v[124:127], v31, s[16:19], s67 offen
    s_waitcnt vmcnt(4)
    s_mov_b32 s67, 2621440
    buffer_load_dwordx4 v[124:127], v31, s[16:19], s67 offen
    s_waitcnt vmcnt(4)
    s_mov_b32 s67, 786432
    buffer_load_dwordx4 v[124:127], v31, s[16:19], s67 offen
    s_waitcnt vmcnt(4)
    s_mov_b32 s67, 2883584
    buffer_load_dwordx4 v[124:127], v31, s[16:19], s67 offen
QA_nopf:
    s_cmp_ge_u32 s24, 24
    s_cbranch_scc1 ROLE_FU
    s_sub_u32 s26, s3, 1
    s_lshl_b32 s26, s26, 3
    s_and_b32 s67, s24, 7
    s_add_u32 s26, s26, s67
    s_lshr_b32 s27, s24, 3
    v_lshlrev_b32 v1, 4, v0
    v_lshrrev_b32 v2, 5, v0
    v_and_b32 v3, 31, v0
    v_lshlrev_b32 v4, 8, v2
    v_bfe_u32 v5, v3, 3, 1
    v_lshl_add_u32 v5, v5, 10, v4
    v_lshrrev_b32 v6, 4, v3
    v_lshl_add_u32 v5, v6, 7, v5
    v_and_b32 v7, 7, v3
    v_lshl_add_u32 v12, v7, 4, v5
    v_and_b32 v8, 15, v3
    v_lshl_add_u32 v5, v8, 4, v4
    v_lshl_add_u32 v13, v6, 10, v5
    v_mul_u32_u24 v6, 196608, v6
    v_add_u32 v14, v5, v6
    v_bfe_u32 v5, v0, 3, 1
    v_lshl_add_u32 v5, v5, 7, v4
    v_bfe_u32 v6, v0, 1, 1
    v_lshl_add_u32 v5, v6, 6, v5
    v_and_b32 v6, 1, v0
    v_lshl_add_u32 v5, v6, 4, v5
    v_add_u32 v5, 139264, v5
    v_lshrrev_b32 v6, 2, v0
    v_xor_b32 v6, v6, v0
    v_and_b32 v6, 4, v6
    v_mov_b32 v9, 155680
    v_cmp_eq_u32 vcc, 0, v6
    s_lshl_b32 s67, s25, 10
    s_add_u32 s67, s67, 151552
    v_cndmask_b32 v15, v9, v5, vcc
    v_bfe_u32 v5, v0, 2, 1
    v_lshlrev_b32 v5, 8, v5
    v_bfe_u32 v6, v0, 4, 1
    v_lshl_add_u32 v5, v6, 7, v5
    v_bfe_u32 v6, v0, 3, 1
    v_lshl_add_u32 v5, v6, 6, v5
    v_and_b32 v6, 3, v0
    v_lshl_add_u32 v5, v6, 4, v5
    v_lshl_add_u32 v5, v2, 3, v5
    v_add_u32 v18, s67, v5
    v_lshlrev_b32 v5, 7, v2
    v_lshl_add_u32 v5, v7, 4, v5
    v_add_u32 v19, s67, v5
    v_add_u32 v16, 139264, v1
    v_mov_b32 v17, 1
    v_lshlrev_b32 v2, 2, v2
    v_sub_u32 v2, v3, v2
    v_mov_b32 v3, 0xf149f2ca
    v_cmp_gt_i32 vcc, 0, v2
    s_nop 1
    v_cndmask_b32 v32, 0, v3, vcc
    v_cmp_gt_i32 vcc, 1, v2
    s_nop 1
    v_cndmask_b32 v33, 0, v3, vcc
    v_cmp_gt_i32 vcc, 2, v2
    s_nop 1
    v_cndmask_b32 v34, 0, v3, vcc
    v_cmp_gt_i32 vcc, 3, v2
    s_nop 1
    v_cndmask_b32 v35, 0, v3, vcc
    v_cmp_gt_i32 vcc, 8, v2
    s_nop 1
    v_cndmask_b32 v36, 0, v3, vcc
    v_cmp_gt_i32 vcc, 9, v2
    s_nop 1
    v_cndmask_b32 v37, 0, v3, vcc
    v_cmp_gt_i32 vcc, 10, v2
    s_nop 1
    v_cndmask_b32 v38, 0, v3, vcc
    v_cmp_gt_i32 vcc, 11, v2
    s_nop 1
    v_cndmask_b32 v39, 0, v3, vcc
    v_cmp_gt_i32 vcc, 16, v2
    s_nop 1
    v_cndmask_b32 v40, 0, v3, vcc
    v_cmp_gt_i32 vcc, 17, v2
    s_nop 1
    v_cndmask_b32 v41, 0, v3, vcc
    v_cmp_gt_i32 vcc, 18, v2
    s_nop 1
    v_cndmask_b32 v42, 0, v3, vcc
    v_cmp_gt_i32 vcc, 19, v2
    s_nop 1
    v_cndmask_b32 v43, 0, v3, vcc
    v_cmp_gt_i32 vcc, 24, v2
    s_nop 1
    v_cndmask_b32 v44, 0, v3, vcc
    v_cmp_gt_i32 vcc, 25, v2
    s_nop 1
    v_cndmask_b32 v45, 0, v3, vcc
    v_cmp_gt_i32 vcc, 26, v2
    s_nop 1
    v_cndmask_b32 v46, 0, v3, vcc
    v_cmp_gt_i32 vcc, 27, v2
    s_nop 1
    v_cndmask_b32 v47, 0, v3, vcc
    ds_write_b128 v16, v[32:35] offset:8192
    ds_write_b128 v16, v[36:39] offset:9216
    ds_write_b128 v16, v[40:43] offset:10240
    ds_write_b128 v16, v[44:47] offset:11264
    v_mov_b64 v[4:5], 0
    v_mov_b64 v[6:7], 0
    ds_write_b128 v16, v[4:7] offset:16384
    ds_write_b128 v16, v[4:7] offset:17408
    ds_write_b128 v16, v[4:7] offset:18432
    ds_write_b128 v16, v[4:7] offset:19456
    ds_write_b128 v16, v[4:7] offset:20480
    ds_write_b128 v16, v[4:7] offset:21504
    ds_write_b128 v16, v[4:7] offset:22528
    ds_write_b128 v16, v[4:7] offset:23552
    s_mul_i32 s34, s26, 1064960
    s_lshl_b32 s67, s27, 14
    s_lshl_b32 s68, s25, 11
    s_add_u32 s34, s34, s67
    s_add_u32 s34, s34, s68
    s_add_u32 s34, s34, 16777216
    s_lshl_b32 s70, s27, 13
    s_add_u32 s70, s70, s68
    s_add_u32 s70, s70, 3145728
    s_lshl_b32 s64, s26, 10
    s_lshl_b32 s67, s27, 4
    s_add_u32 s64, s64, s67
    s_lshl_b32 s67, s25, 2
    s_add_u32 s64, s64, s67
    s_add_u32 s65, s64, 32768
    s_add_u32 s64, s64, 0
    s_mul_i32 s66, s27, 393216
    s_lshl_b32 s67, s26, 12
    s_lshl_b32 s68, s25, 10
    s_add_u32 s66, s66, s67
    s_add_u32 s66, s66, s68
    s_add_u32 s66, s66, 52428800
    s_mov_b32 s71, 0x3e0293ee
    s_mov_b32 s74, s71
    s_mov_b32 s75, s71
    s_mov_b32 s28, s27
    s_mov_b32 s29, s27
    s_mov_b32 s32, 65536
    s_mov_b32 s33, 65536
    s_mov_b32 s30, 0
    s_mov_b32 s31, s27
    s_add_u32 s72, s64, 0x18000
    s_lshl_b32 s73, s26, 8
    v_mov_b32 v8, 136
    v_lshrrev_b32 v2, 4, v0
    v_and_b32 v3, 15, v0
    v_lshlrev_b32 v4, 2, v2
    v_xor_b32 v4, v4, v3
    v_lshlrev_b32 v4, 4, v4
    s_lshl_b32 s67, s25, 4
    v_add_u32 v5, s67, v2
    v_mul_u32_u24 v5, 8192, v5
    v_add_u32 v4, v4, v5
    v_add_u32 v4, s73, v4
    v_bfe_u32 v5, v0, 2, 2
    v_lshrrev_b32 v6, 5, v0
    v_lshl_add_u32 v6, v6, 3, v5
    v_lshlrev_b32 v6, 8, v6
    v_xor_b32 v5, s25, v5
    v_lshl_add_u32 v6, v5, 6, v6
    v_bfe_u32 v5, v0, 4, 1
    v_lshl_add_u32 v6, v5, 5, v6
    v_and_b32 v5, 3, v0
    v_lshl_add_u32 v6, v5, 3, v6
    v_add_u32 v7, 0x10000, v6
    s_lshl_b32 s69, s25, 12
    s_add_u32 m0, s69, 32768
    s_mov_b32 s67, 0
    buffer_load_dwordx4 v4, s[8:11], s67 offen lds
    s_add_u32 m0, s69, 33792
    s_mov_b32 s67, 32768
    buffer_load_dwordx4 v4, s[8:11], s67 offen lds
    s_add_u32 m0, s69, 34816
    s_mov_b32 s67, 65536
    buffer_load_dwordx4 v4, s[8:11], s67 offen lds
    s_add_u32 m0, s69, 35840
    s_mov_b32 s67, 98304
    buffer_load_dwordx4 v4, s[8:11], s67 offen lds
    s_add_u32 m0, s69, 49152
    s_mov_b32 s67, 524288
    buffer_load_dwordx4 v4, s[8:11], s67 offen lds
    s_add_u32 m0, s69, 50176
    s_mov_b32 s67, 557056
    buffer_load_dwordx4 v4, s[8:11], s67 offen lds
    s_add_u32 m0, s69, 51200
    s_mov_b32 s67, 589824
    buffer_load_dwordx4 v4, s[8:11], s67 offen lds
    s_add_u32 m0, s69, 52224
    s_mov_b32 s67, 622592
    buffer_load_dwordx4 v4, s[8:11], s67 offen lds
    s_add_u32 m0, s69, 65536
    s_mov_b32 s67, 1048576
    buffer_load_dwordx4 v4, s[8:11], s67 offen lds
    s_add_u32 m0, s69, 66560
    s_mov_b32 s67, 1081344
    buffer_load_dwordx4 v4, s[8:11], s67 offen lds
    s_add_u32 m0, s69, 67584
    s_mov_b32 s67, 1114112
    buffer_load_dwordx4 v4, s[8:11], s67 offen lds
    s_add_u32 m0, s69, 68608
    s_mov_b32 s67, 1146880
    buffer_load_dwordx4 v4, s[8:11], s67 offen lds
    s_add_u32 m0, s69, 81920
    s_mov_b32 s67, 1572864
    buffer_load_dwordx4 v4, s[8:11], s67 offen lds
    s_add_u32 m0, s69, 82944
    s_mov_b32 s67, 1605632
    buffer_load_dwordx4 v4, s[8:11], s67 offen lds
    s_add_u32 m0, s69, 83968
    s_mov_b32 s67, 1638400
    buffer_load_dwordx4 v4, s[8:11], s67 offen lds
    s_add_u32 m0, s69, 84992
    s_mov_b32 s67, 1671168
    buffer_load_dwordx4 v4, s[8:11], s67 offen lds
    s_add_u32 m0, s69, 98304
    s_mov_b32 s67, 2097152
    buffer_load_dwordx4 v4, s[8:11], s67 offen lds
    s_add_u32 m0, s69, 99328
    s_mov_b32 s67, 2129920
    buffer_load_dwordx4 v4, s[8:11], s67 offen lds
    s_add_u32 m0, s69, 100352
    s_mov_b32 s67, 2162688
    buffer_load_dwordx4 v4, s[8:11], s67 offen lds
    s_add_u32 m0, s69, 101376
    s_mov_b32 s67, 2195456
    buffer_load_dwordx4 v4, s[8:11], s67 offen lds
    s_add_u32 m0, s69, 114688
    s_mov_b32 s67, 2621440
    buffer_load_dwordx4 v4, s[8:11], s67 offen lds
    s_add_u32 m0, s69, 115712
    s_mov_b32 s67, 2654208
    buffer_load_dwordx4 v4, s[8:11], s67 offen lds
    s_add_u32 m0, s69, 116736
    s_mov_b32 s67, 2686976
    buffer_load_dwordx4 v4, s[8:11], s67 offen lds
    s_add_u32 m0, s69, 117760
    s_mov_b32 s67, 2719744
    buffer_load_dwordx4 v4, s[8:11], s67 offen lds
    s_waitcnt vmcnt(20)
    s_barrier
    ds_read_b64_tr_b16 a[0:1], v6 offset:32768
    ds_read_b64_tr_b16 a[2:3], v6 offset:33792
    ds_read_b64_tr_b16 a[4:5], v6 offset:36864
    ds_read_b64_tr_b16 a[6:7], v6 offset:37888
    ds_read_b64_tr_b16 a[8:9], v6 offset:40960
    ds_read_b64_tr_b16 a[10:11], v6 offset:41984
    ds_read_b64_tr_b16 a[12:13], v6 offset:45056
    ds_read_b64_tr_b16 a[14:15], v6 offset:46080
    s_waitcnt lgkmcnt(0)
    s_waitcnt vmcnt(16)
    s_barrier
    s_add_u32 m0, s69, 32768
    s_mov_b32 s67, 3145728
    buffer_load_dwordx4 v4, s[8:11], s67 offen lds
    s_add_u32 m0, s69, 33792
    s_mov_b32 s67, 3178496
    buffer_load_dwordx4 v4, s[8:11], s67 offen lds
    s_add_u32 m0, s69, 34816
    s_mov_b32 s67, 3211264
    buffer_load_dwordx4 v4, s[8:11], s67 offen lds
    s_add_u32 m0, s69, 35840
    s_mov_b32 s67, 3244032
    buffer_load_dwordx4 v4, s[8:11], s67 offen lds
    ds_read_b64_tr_b16 a[16:17], v6 offset:49152
    ds_read_b64_tr_b16 a[18:19], v6 offset:50176
    ds_read_b64_tr_b16 a[20:21], v6 offset:53248
    ds_read_b64_tr_b16 a[22:23], v6 offset:54272
    ds_read_b64_tr_b16 a[24:25], v6 offset:57344
    ds_read_b64_tr_b16 a[26:27], v6 offset:58368
    ds_read_b64_tr_b16 a[28:29], v6 offset:61440
    ds_read_b64_tr_b16 a[30:31], v6 offset:62464
    s_waitcnt lgkmcnt(0)
    s_waitcnt vmcnt(16)
    s_barrier
    s_add_u32 m0, s69, 49152
    s_mov_b32 s67, 3670016
    buffer_load_dwordx4 v4, s[8:11], s67 offen lds
    s_add_u32 m0, s69, 50176
    s_mov_b32 s67, 3702784
    buffer_load_dwordx4 v4, s[8:11], s67 offen lds
    s_add_u32 m0, s69, 51200
    s_mov_b32 s67, 3735552
    buffer_load_dwordx4 v4, s[8:11], s67 offen lds
    s_add_u32 m0, s69, 52224
    s_mov_b32 s67, 3768320
    buffer_load_dwordx4 v4, s[8:11], s67 offen lds
    ds_read_b64_tr_b16 a[32:33], v7 offset:0
    ds_read_b64_tr_b16 a[34:35], v7 offset:1024
    ds_read_b64_tr_b16 a[36:37], v7 offset:4096
    ds_read_b64_tr_b16 a[38:39], v7 offset:5120
    ds_read_b64_tr_b16 a[40:41], v7 offset:8192
    ds_read_b64_tr_b16 a[42:43], v7 offset:9216
    ds_read_b64_tr_b16 a[44:45], v7 offset:12288
    ds_read_b64_tr_b16 a[46:47], v7 offset:13312
    s_waitcnt lgkmcnt(0)
    s_waitcnt vmcnt(16)
    s_barrier
    s_add_u32 m0, s69, 65536
    s_mov_b32 s67, 0
    buffer_load_dwordx4 v4, s[12:15], s67 offen lds
    s_add_u32 m0, s69, 66560
    s_mov_b32 s67, 32768
    buffer_load_dwordx4 v4, s[12:15], s67 offen lds
    s_add_u32 m0, s69, 67584
    s_mov_b32 s67, 65536
    buffer_load_dwordx4 v4, s[12:15], s67 offen lds
    s_add_u32 m0, s69, 68608
    s_mov_b32 s67, 98304
    buffer_load_dwordx4 v4, s[12:15], s67 offen lds
    ds_read_b64_tr_b16 a[48:49], v7 offset:16384
    ds_read_b64_tr_b16 a[50:51], v7 offset:17408
    ds_read_b64_tr_b16 a[52:53], v7 offset:20480
    ds_read_b64_tr_b16 a[54:55], v7 offset:21504
    ds_read_b64_tr_b16 a[56:57], v7 offset:24576
    ds_read_b64_tr_b16 a[58:59], v7 offset:25600
    ds_read_b64_tr_b16 a[60:61], v7 offset:28672
    ds_read_b64_tr_b16 a[62:63], v7 offset:29696
    s_waitcnt lgkmcnt(0)
    s_waitcnt vmcnt(16)
    s_barrier
    s_add_u32 m0, s69, 81920
    s_mov_b32 s67, 524288
    buffer_load_dwordx4 v4, s[12:15], s67 offen lds
    s_add_u32 m0, s69, 82944
    s_mov_b32 s67, 557056
    buffer_load_dwordx4 v4, s[12:15], s67 offen lds
    s_add_u32 m0, s69, 83968
    s_mov_b32 s67, 589824
    buffer_load_dwordx4 v4, s[12:15], s67 offen lds
    s_add_u32 m0, s69, 84992
    s_mov_b32 s67, 622592
    buffer_load_dwordx4 v4, s[12:15], s67 offen lds
    global_load_dword v9, v8, s[60:61] sc1
    ds_read_b64_tr_b16 a[64:65], v7 offset:32768
    ds_read_b64_tr_b16 a[66:67], v7 offset:33792
    ds_read_b64_tr_b16 a[68:69], v7 offset:36864
    ds_read_b64_tr_b16 a[70:71], v7 offset:37888
    ds_read_b64_tr_b16 a[72:73], v7 offset:40960
    ds_read_b64_tr_b16 a[74:75], v7 offset:41984
    ds_read_b64_tr_b16 a[76:77], v7 offset:45056
    ds_read_b64_tr_b16 a[78:79], v7 offset:46080
    s_waitcnt lgkmcnt(0)
    s_waitcnt vmcnt(17)
    s_barrier
    s_add_u32 m0, s69, 98304
    s_mov_b32 s67, 1048576
    buffer_load_dwordx4 v4, s[12:15], s67 offen lds
    s_add_u32 m0, s69, 99328
    s_mov_b32 s67, 1081344
    buffer_load_dwordx4 v4, s[12:15], s67 offen lds
    s_add_u32 m0, s69, 100352
    s_mov_b32 s67, 1114112
    buffer_load_dwordx4 v4, s[12:15], s67 offen lds
    s_add_u32 m0, s69, 101376
    s_mov_b32 s67, 1146880
    buffer_load_dwordx4 v4, s[12:15], s67 offen lds
    ds_read_b64_tr_b16 a[80:81], v7 offset:49152
    ds_read_b64_tr_b16 a[82:83], v7 offset:50176
    ds_read_b64_tr_b16 a[84:85], v7 offset:53248
    ds_read_b64_tr_b16 a[86:87], v7 offset:54272
    ds_read_b64_tr_b16 a[88:89], v7 offset:57344
    ds_read_b64_tr_b16 a[90:91], v7 offset:58368
    ds_read_b64_tr_b16 a[92:93], v7 offset:61440
    ds_read_b64_tr_b16 a[94:95], v7 offset:62464
    s_waitcnt lgkmcnt(0)
    s_waitcnt vmcnt(17)
    s_barrier
    s_add_u32 m0, s69, 114688
    s_mov_b32 s67, 1572864
    buffer_load_dwordx4 v4, s[12:15], s67 offen lds
    s_add_u32 m0, s69, 115712
    s_mov_b32 s67, 1605632
    buffer_load_dwordx4 v4, s[12:15], s67 offen lds
    s_add_u32 m0, s69, 116736
    s_mov_b32 s67, 1638400
    buffer_load_dwordx4 v4, s[12:15], s67 offen lds
    s_add_u32 m0, s69, 117760
    s_mov_b32 s67, 1671168
    buffer_load_dwordx4 v4, s[12:15], s67 offen lds
    ds_read_b64_tr_b16 a[96:97], v6 offset:32768
    ds_read_b64_tr_b16 a[98:99], v6 offset:33792
    ds_read_b64_tr_b16 a[100:101], v6 offset:36864
    ds_read_b64_tr_b16 a[102:103], v6 offset:37888
    ds_read_b64_tr_b16 a[104:105], v6 offset:40960
    ds_read_b64_tr_b16 a[106:107], v6 offset:41984
    ds_read_b64_tr_b16 a[108:109], v6 offset:45056
    ds_read_b64_tr_b16 a[110:111], v6 offset:46080
    s_waitcnt lgkmcnt(0)
    s_waitcnt vmcnt(17)
    s_barrier
    s_add_u32 m0, s69, 32768
    s_mov_b32 s67, 2097152
    buffer_load_dwordx4 v4, s[12:15], s67 offen lds
    s_add_u32 m0, s69, 33792
    s_mov_b32 s67, 2129920
    buffer_load_dwordx4 v4, s[12:15], s67 offen lds
    s_add_u32 m0, s69, 34816
    s_mov_b32 s67, 2162688
    buffer_load_dwordx4 v4, s[12:15], s67 offen lds
    s_add_u32 m0, s69, 35840
    s_mov_b32 s67, 2195456
    buffer_load_dwordx4 v4, s[12:15], s67 offen lds
    ds_read_b64_tr_b16 a[112:113], v6 offset:49152
    ds_read_b64_tr_b16 a[114:115], v6 offset:50176
    ds_read_b64_tr_b16 a[116:117], v6 offset:53248
    ds_read_b64_tr_b16 a[118:119], v6 offset:54272
    ds_read_b64_tr_b16 a[120:121], v6 offset:57344
    ds_read_b64_tr_b16 a[122:123], v6 offset:58368
    ds_read_b64_tr_b16 a[124:125], v6 offset:61440
    ds_read_b64_tr_b16 a[126:127], v6 offset:62464
    s_waitcnt lgkmcnt(0)
    s_waitcnt vmcnt(17)
    s_barrier
    s_add_u32 m0, s69, 49152
    s_mov_b32 s67, 2621440
    buffer_load_dwordx4 v4, s[12:15], s67 offen lds
    s_add_u32 m0, s69, 50176
    s_mov_b32 s67, 2654208
    buffer_load_dwordx4 v4, s[12:15], s67 offen lds
    s_add_u32 m0, s69, 51200
    s_mov_b32 s67, 2686976
    buffer_load_dwordx4 v4, s[12:15], s67 offen lds
    s_add_u32 m0, s69, 52224
    s_mov_b32 s67, 2719744
    buffer_load_dwordx4 v4, s[12:15], s67 offen lds
    ds_read_b64_tr_b16 a[128:129], v7 offset:0
    ds_read_b64_tr_b16 a[130:131], v7 offset:1024
    ds_read_b64_tr_b16 a[132:133], v7 offset:4096
    ds_read_b64_tr_b16 a[134:135], v7 offset:5120
    ds_read_b64_tr_b16 a[136:137], v7 offset:8192
    ds_read_b64_tr_b16 a[138:139], v7 offset:9216
    ds_read_b64_tr_b16 a[140:141], v7 offset:12288
    ds_read_b64_tr_b16 a[142:143], v7 offset:13312
    s_waitcnt lgkmcnt(0)
    s_waitcnt vmcnt(17)
    s_barrier
    s_add_u32 m0, s69, 65536
    s_mov_b32 s67, 3145728
    buffer_load_dwordx4 v4, s[12:15], s67 offen lds
    s_add_u32 m0, s69, 66560
    s_mov_b32 s67, 3178496
    buffer_load_dwordx4 v4, s[12:15], s67 offen lds
    s_add_u32 m0, s69, 67584
    s_mov_b32 s67, 3211264
    buffer_load_dwordx4 v4, s[12:15], s67 offen lds
    s_add_u32 m0, s69, 68608
    s_mov_b32 s67, 3244032
    buffer_load_dwordx4 v4, s[12:15], s67 offen lds
    ds_read_b64_tr_b16 a[144:145], v7 offset:16384
    ds_read_b64_tr_b16 a[146:147], v7 offset:17408
    ds_read_b64_tr_b16 a[148:149], v7 offset:20480
    ds_read_b64_tr_b16 a[150:151], v7 offset:21504
    ds_read_b64_tr_b16 a[152:153], v7 offset:24576
    ds_read_b64_tr_b16 a[154:155], v7 offset:25600
    ds_read_b64_tr_b16 a[156:157], v7 offset:28672
    ds_read_b64_tr_b16 a[158:159], v7 offset:29696
    s_waitcnt lgkmcnt(0)
    s_waitcnt vmcnt(16)
    s_barrier
    s_add_u32 m0, s69, 81920
    s_mov_b32 s67, 3670016
    buffer_load_dwordx4 v4, s[12:15], s67 offen lds
    s_add_u32 m0, s69, 82944
    s_mov_b32 s67, 3702784
    buffer_load_dwordx4 v4, s[12:15], s67 offen lds
    s_add_u32 m0, s69, 83968
    s_mov_b32 s67, 3735552
    buffer_load_dwordx4 v4, s[12:15], s67 offen lds
    s_add_u32 m0, s69, 84992
    s_mov_b32 s67, 3768320
    buffer_load_dwordx4 v4, s[12:15], s67 offen lds
    v_cmp_eq_u32 vcc, 0, v9
    s_cbranch_vccnz QA_go
QA_gook:
    s_lshl_b32 s67, s31, 15
    s_lshl_b32 s68, s25, 13
    s_add_u32 s67, s67, s68
    s_add_u32 s67, s67, 1048576
    s_add_u32 s68, s68, s30
    s_mov_b32 m0, s68
    s_nop 0
    buffer_load_dwordx4 v1, s[4:7], s67 offen offset:0 sc1 lds
    buffer_load_dwordx4 v1, s[4:7], s67 offen offset:1024 sc1 lds
    buffer_load_dwordx4 v1, s[4:7], s67 offen offset:2048 sc1 lds
    buffer_load_dwordx4 v1, s[4:7], s67 offen offset:3072 sc1 lds
    s_add_u32 s67, s67, 0x1000
    s_add_u32 s68, s68, 0x1000
    s_mov_b32 m0, s68
    s_nop 0
    buffer_load_dwordx4 v1, s[4:7], s67 offen offset:0 sc1 lds
    buffer_load_dwordx4 v1, s[4:7], s67 offen offset:1024 sc1 lds
    buffer_load_dwordx4 v1, s[4:7], s67 offen offset:2048 sc1 lds
    buffer_load_dwordx4 v1, s[4:7], s67 offen offset:3072 sc1 lds
    ds_read_b64_tr_b16 a[160:161], v7 offset:32768
    ds_read_b64_tr_b16 a[162:163], v7 offset:33792
    ds_read_b64_tr_b16 a[164:165], v7 offset:36864
    ds_read_b64_tr_b16 a[166:167], v7 offset:37888
    ds_read_b64_tr_b16 a[168:169], v7 offset:40960
    ds_read_b64_tr_b16 a[170:171], v7 offset:41984
    ds_read_b64_tr_b16 a[172:173], v7 offset:45056
    ds_read_b64_tr_b16 a[174:175], v7 offset:46080
    s_waitcnt lgkmcnt(0)
    s_waitcnt vmcnt(24)
    s_barrier
    s_add_u32 m0, s69, 98304
    s_mov_b32 s67, 0
    buffer_load_dwordx4 v4, s[16:19], s67 offen lds
    s_add_u32 m0, s69, 99328
    s_mov_b32 s67, 32768
    buffer_load_dwordx4 v4, s[16:19], s67 offen lds
    s_add_u32 m0, s69, 100352
    s_mov_b32 s67, 65536
    buffer_load_dwordx4 v4, s[16:19], s67 offen lds
    s_add_u32 m0, s69, 101376
    s_mov_b32 s67, 98304
    buffer_load_dwordx4 v4, s[16:19], s67 offen lds
    ds_read_b64_tr_b16 a[176:177], v7 offset:49152
    ds_read_b64_tr_b16 a[178:179], v7 offset:50176
    ds_read_b64_tr_b16 a[180:181], v7 offset:53248
    ds_read_b64_tr_b16 a[182:183], v7 offset:54272
    ds_read_b64_tr_b16 a[184:185], v7 offset:57344
    ds_read_b64_tr_b16 a[186:187], v7 offset:58368
    ds_read_b64_tr_b16 a[188:189], v7 offset:61440
    ds_read_b64_tr_b16 a[190:191], v7 offset:62464
    s_waitcnt lgkmcnt(0)
    s_waitcnt vmcnt(24)
    s_barrier
    s_add_u32 m0, s69, 114688
    s_mov_b32 s67, 524288
    buffer_load_dwordx4 v4, s[16:19], s67 offen lds
    s_add_u32 m0, s69, 115712
    s_mov_b32 s67, 557056
    buffer_load_dwordx4 v4, s[16:19], s67 offen lds
    s_add_u32 m0, s69, 116736
    s_mov_b32 s67, 589824
    buffer_load_dwordx4 v4, s[16:19], s67 offen lds
    s_add_u32 m0, s69, 117760
    s_mov_b32 s67, 622592
    buffer_load_dwordx4 v4, s[16:19], s67 offen lds
    ds_read_b64_tr_b16 a[192:193], v6 offset:32768
    ds_read_b64_tr_b16 a[194:195], v6 offset:33792
    ds_read_b64_tr_b16 a[196:197], v6 offset:36864
    ds_read_b64_tr_b16 a[198:199], v6 offset:37888
    ds_read_b64_tr_b16 a[200:201], v6 offset:40960
    ds_read_b64_tr_b16 a[202:203], v6 offset:41984
    ds_read_b64_tr_b16 a[204:205], v6 offset:45056
    ds_read_b64_tr_b16 a[206:207], v6 offset:46080
    s_waitcnt lgkmcnt(0)
    s_waitcnt vmcnt(24)
    s_barrier
    s_add_u32 m0, s69, 32768
    s_mov_b32 s67, 1048576
    buffer_load_dwordx4 v4, s[16:19], s67 offen lds
    s_add_u32 m0, s69, 33792
    s_mov_b32 s67, 1081344
    buffer_load_dwordx4 v4, s[16:19], s67 offen lds
    s_add_u32 m0, s69, 34816
    s_mov_b32 s67, 1114112
    buffer_load_dwordx4 v4, s[16:19], s67 offen lds
    s_add_u32 m0, s69, 35840
    s_mov_b32 s67, 1146880
    buffer_load_dwordx4 v4, s[16:19], s67 offen lds
    ds_read_b64_tr_b16 a[208:209], v6 offset:49152
    ds_read_b64_tr_b16 a[210:211], v6 offset:50176
    ds_read_b64_tr_b16 a[212:213], v6 offset:53248
    ds_read_b64_tr_b16 a[214:215], v6 offset:54272
    ds_read_b64_tr_b16 a[216:217], v6 offset:57344
    ds_read_b64_tr_b16 a[218:219], v6 offset:58368
    ds_read_b64_tr_b16 a[220:221], v6 offset:61440
    ds_read_b64_tr_b16 a[222:223], v6 offset:62464
    s_waitcnt lgkmcnt(0)
    s_waitcnt vmcnt(24)
    s_barrier
    s_add_u32 m0, s69, 49152
    s_mov_b32 s67, 1572864
    buffer_load_dwordx4 v4, s[16:19], s67 offen lds
    s_add_u32 m0, s69, 50176
    s_mov_b32 s67, 1605632
    buffer_load_dwordx4 v4, s[16:19], s67 offen lds
    s_add_u32 m0, s69, 51200
    s_mov_b32 s67, 1638400
    buffer_load_dwordx4 v4, s[16:19], s67 offen lds
    s_add_u32 m0, s69, 52224
    s_mov_b32 s67, 1671168
    buffer_load_dwordx4 v4, s[16:19], s67 offen lds
    ds_read_b64_tr_b16 a[224:225], v7 offset:0
    ds_read_b64_tr_b16 a[226:227], v7 offset:1024
    ds_read_b64_tr_b16 a[228:229], v7 offset:4096
    ds_read_b64_tr_b16 a[230:231], v7 offset:5120
    ds_read_b64_tr_b16 a[232:233], v7 offset:8192
    ds_read_b64_tr_b16 a[234:235], v7 offset:9216
    ds_read_b64_tr_b16 a[236:237], v7 offset:12288
    ds_read_b64_tr_b16 a[238:239], v7 offset:13312
    s_waitcnt lgkmcnt(0)
    s_waitcnt vmcnt(24)
    s_barrier
    s_add_u32 m0, s69, 65536
    s_mov_b32 s67, 2097152
    buffer_load_dwordx4 v4, s[16:19], s67 offen lds
    s_add_u32 m0, s69, 66560
    s_mov_b32 s67, 2129920
    buffer_load_dwordx4 v4, s[16:19], s67 offen lds
    s_add_u32 m0, s69, 67584
    s_mov_b32 s67, 2162688
    buffer_load_dwordx4 v4, s[16:19], s67 offen lds
    s_add_u32 m0, s69, 68608
    s_mov_b32 s67, 2195456
    buffer_load_dwordx4 v4, s[16:19], s67 offen lds
    ds_read_b64_tr_b16 a[240:241], v7 offset:16384
    ds_read_b64_tr_b16 a[242:243], v7 offset:17408
    ds_read_b64_tr_b16 a[244:245], v7 offset:20480
    ds_read_b64_tr_b16 a[246:247], v7 offset:21504
    ds_read_b64_tr_b16 a[248:249], v7 offset:24576
    ds_read_b64_tr_b16 a[250:251], v7 offset:25600
    ds_read_b64_tr_b16 a[252:253], v7 offset:28672
    ds_read_b64_tr_b16 a[254:255], v7 offset:29696
    s_waitcnt lgkmcnt(0)
    s_waitcnt vmcnt(20)
    s_barrier
    v_add_u32 v10, s30, v1
    s_xor_b32 s30, s30, 0x8000
    s_add_u32 s31, s31, 3
    s_min_u32 s31, s31, 63
    ds_read_b128 v[80:83], v10 offset:0
    ds_read_b128 v[84:87], v10 offset:1024
    ds_read_b128 v[88:91], v10 offset:2048
    s_waitcnt lgkmcnt(2)
    v_mfma_f32_32x32x16_bf16 v[32:47], a[0:3], v[80:83], 0
    ds_read_b128 v[92:95], v10 offset:3072
    v_mfma_f32_32x32x16_bf16 v[48:63], v[80:83], a[128:131], 0
    s_waitcnt lgkmcnt(2)
    v_mfma_f32_32x32x16_bf16 v[32:47], a[4:7], v[84:87], v[32:47]
    ds_read_b128 v[80:83], v10 offset:4096
    v_mfma_f32_32x32x16_bf16 v[48:63], v[84:87], a[132:135], v[48:63]
    s_waitcnt lgkmcnt(2)
    v_mfma_f32_32x32x16_bf16 v[32:47], a[8:11], v[88:91], v[32:47]
    ds_read_b128 v[84:87], v10 offset:5120
    v_mfma_f32_32x32x16_bf16 v[48:63], v[88:91], a[136:139], v[48:63]
    s_waitcnt lgkmcnt(2)
    v_mfma_f32_32x32x16_bf16 v[32:47], a[12:15], v[92:95], v[32:47]
    ds_read_b128 v[88:91], v10 offset:6144
    v_mfma_f32_32x32x16_bf16 v[48:63], v[92:95], a[140:143], v[48:63]
    s_waitcnt lgkmcnt(2)
    v_mfma_f32_32x32x16_bf16 v[32:47], a[16:19], v[80:83], v[32:47]
    ds_read_b128 v[92:95], v10 offset:7168
    v_mfma_f32_32x32x16_bf16 v[48:63], v[80:83], a[144:147], v[48:63]
    s_waitcnt lgkmcnt(2)
    v_mfma_f32_32x32x16_bf16 v[32:47], a[20:23], v[84:87], v[32:47]
    ds_read_b128 v[80:83], v10 offset:8192
    v_mfma_f32_32x32x16_bf16 v[48:63], v[84:87], a[148:151], v[48:63]
    s_waitcnt lgkmcnt(2)
    v_mfma_f32_32x32x16_bf16 v[32:47], a[24:27], v[88:91], v[32:47]
    ds_read_b128 v[84:87], v10 offset:9216
    v_mfma_f32_32x32x16_bf16 v[48:63], v[88:91], a[152:155], v[48:63]
    s_waitcnt lgkmcnt(2)
    v_mfma_f32_32x32x16_bf16 v[32:47], a[28:31], v[92:95], v[32:47]
    ds_read_b128 v[88:91], v10 offset:10240
    v_mfma_f32_32x32x16_bf16 v[48:63], v[92:95], a[156:159], v[48:63]
    s_waitcnt lgkmcnt(2)
    v_mfma_f32_32x32x16_bf16 v[32:47], a[32:35], v[80:83], v[32:47]
    ds_read_b128 v[92:95], v10 offset:11264
    v_mfma_f32_32x32x16_bf16 v[48:63], v[80:83], a[160:163], v[48:63]
    s_waitcnt lgkmcnt(2)
    v_mfma_f32_32x32x16_bf16 v[32:47], a[36:39], v[84:87], v[32:47]
    ds_read_b128 v[80:83], v10 offset:12288
    v_mfma_f32_32x32x16_bf16 v[48:63], v[84:87], a[164:167], v[48:63]
    s_waitcnt lgkmcnt(2)
    v_mfma_f32_32x32x16_bf16 v[32:47], a[40:43], v[88:91], v[32:47]
    ds_read_b128 v[84:87], v10 offset:13312
    v_mfma_f32_32x32x16_bf16 v[48:63], v[88:91], a[168:171], v[48:63]
    s_waitcnt lgkmcnt(2)
    v_mfma_f32_32x32x16_bf16 v[32:47], a[44:47], v[92:95], v[32:47]
    ds_read_b128 v[88:91], v10 offset:14336
    v_mfma_f32_32x32x16_bf16 v[48:63], v[92:95], a[172:175], v[48:63]
    s_waitcnt lgkmcnt(2)
    v_mfma_f32_32x32x16_bf16 v[32:47], a[48:51], v[80:83], v[32:47]
    ds_read_b128 v[92:95], v10 offset:15360
    v_mfma_f32_32x32x16_bf16 v[48:63], v[80:83], a[176:179], v[48:63]
    s_waitcnt lgkmcnt(2)
    v_mfma_f32_32x32x16_bf16 v[32:47], a[52:55], v[84:87], v[32:47]
    ds_read_b128 v[80:83], v10 offset:16384
    v_mfma_f32_32x32x16_bf16 v[48:63], v[84:87], a[180:183], v[48:63]
    s_waitcnt lgkmcnt(2)
    v_mfma_f32_32x32x16_bf16 v[32:47], a[56:59], v[88:91], v[32:47]
    ds_read_b128 v[84:87], v10 offset:17408
    v_mfma_f32_32x32x16_bf16 v[48:63], v[88:91], a[184:187], v[48:63]
    s_waitcnt lgkmcnt(2)
    v_mfma_f32_32x32x16_bf16 v[32:47], a[60:63], v[92:95], v[32:47]
    ds_read_b128 v[88:91], v10 offset:18432
    v_mfma_f32_32x32x16_bf16 v[48:63], v[92:95], a[188:191], v[48:63]
    s_waitcnt lgkmcnt(2)
    v_mfma_f32_32x32x16_bf16 v[32:47], a[64:67], v[80:83], v[32:47]
    ds_read_b128 v[92:95], v10 offset:19456
    v_mfma_f32_32x32x16_bf16 v[48:63], v[80:83], a[192:195], v[48:63]
    s_waitcnt lgkmcnt(2)
    v_mfma_f32_32x32x16_bf16 v[32:47], a[68:71], v[84:87], v[32:47]
    ds_read_b128 v[80:83], v10 offset:20480
    v_mfma_f32_32x32x16_bf16 v[48:63], v[84:87], a[196:199], v[48:63]
    s_waitcnt lgkmcnt(2)
    v_mfma_f32_32x32x16_bf16 v[32:47], a[72:75], v[88:91], v[32:47]
    ds_read_b128 v[84:87], v10 offset:21504
    v_mfma_f32_32x32x16_bf16 v[48:63], v[88:91], a[200:203], v[48:63]
    s_waitcnt lgkmcnt(2)
    v_mfma_f32_32x32x16_bf16 v[32:47], a[76:79], v[92:95], v[32:47]
    ds_read_b128 v[88:91], v10 offset:22528
    v_mfma_f32_32x32x16_bf16 v[48:63], v[92:95], a[204:207], v[48:63]
    s_waitcnt lgkmcnt(2)
    v_mfma_f32_32x32x16_bf16 v[32:47], a[80:83], v[80:83], v[32:47]
    ds_read_b128 v[92:95], v10 offset:23552
    v_mfma_f32_32x32x16_bf16 v[48:63], v[80:83], a[208:211], v[48:63]
    s_waitcnt lgkmcnt(2)
    v_mfma_f32_32x32x16_bf16 v[32:47], a[84:87], v[84:87], v[32:47]
    ds_read_b128 v[80:83], v10 offset:24576
    v_mfma_f32_32x32x16_bf16 v[48:63], v[84:87], a[212:215], v[48:63]
    s_waitcnt lgkmcnt(2)
    v_mfma_f32_32x32x16_bf16 v[32:47], a[88:91], v[88:91], v[32:47]
    ds_read_b128 v[84:87], v10 offset:25600
    v_mfma_f32_32x32x16_bf16 v[48:63], v[88:91], a[216:219], v[48:63]
    s_waitcnt lgkmcnt(2)
    v_mfma_f32_32x32x16_bf16 v[32:47], a[92:95], v[92:95], v[32:47]
    ds_read_b128 v[88:91], v10 offset:26624
    v_mfma_f32_32x32x16_bf16 v[48:63], v[92:95], a[220:223], v[48:63]
    s_waitcnt lgkmcnt(2)
    v_mfma_f32_32x32x16_bf16 v[32:47], a[96:99], v[80:83], v[32:47]
    ds_read_b128 v[92:95], v10 offset:27648
    v_mfma_f32_32x32x16_bf16 v[48:63], v[80:83], a[224:227], v[48:63]
    s_waitcnt lgkmcnt(2)
    v_mfma_f32_32x32x16_bf16 v[32:47], a[100:103], v[84:87], v[32:47]
    ds_read_b128 v[80:83], v10 offset:28672
    v_mfma_f32_32x32x16_bf16 v[48:63], v[84:87], a[228:231], v[48:63]
    s_waitcnt lgkmcnt(2)
    v_mfma_f32_32x32x16_bf16 v[32:47], a[104:107], v[88:91], v[32:47]
    ds_read_b128 v[84:87], v10 offset:29696
    v_mfma_f32_32x32x16_bf16 v[48:63], v[88:91], a[232:235], v[48:63]
    s_waitcnt lgkmcnt(2)
    v_mfma_f32_32x32x16_bf16 v[32:47], a[108:111], v[92:95], v[32:47]
    ds_read_b128 v[88:91], v10 offset:30720
    v_mfma_f32_32x32x16_bf16 v[48:63], v[92:95], a[236:239], v[48:63]
    s_waitcnt lgkmcnt(2)
    v_mfma_f32_32x32x16_bf16 v[32:47], a[112:115], v[80:83], v[32:47]
    ds_read_b128 v[92:95], v10 offset:31744
    v_mfma_f32_32x32x16_bf16 v[48:63], v[80:83], a[240:243], v[48:63]
    s_waitcnt lgkmcnt(2)
    v_mfma_f32_32x32x16_bf16 v[32:47], a[116:119], v[84:87], v[32:47]
    v_mfma_f32_32x32x16_bf16 v[48:63], v[84:87], a[244:247], v[48:63]
    s_waitcnt lgkmcnt(1)
    v_mfma_f32_32x32x16_bf16 v[32:47], a[120:123], v[88:91], v[32:47]
    v_mfma_f32_32x32x16_bf16 v[48:63], v[88:91], a[248:251], v[48:63]
    s_waitcnt lgkmcnt(0)
    v_mfma_f32_32x32x16_bf16 v[32:47], a[124:127], v[92:95], v[32:47]
    v_mfma_f32_32x32x16_bf16 v[48:63], v[92:95], a[252:255], v[48:63]
    s_add_u32 s68, s34, 0x2000
    s_mov_b32 s72, s64
    s_nop 2
    v_cvt_pk_bf16_f32 v96, v32, v33
    v_cvt_pk_bf16_f32 v97, v34, v35
    v_cvt_pk_bf16_f32 v98, v36, v37
    v_cvt_pk_bf16_f32 v99, v38, v39
    v_cvt_pk_bf16_f32 v100, v40, v41
    v_cvt_pk_bf16_f32 v101, v42, v43
    v_cvt_pk_bf16_f32 v102, v44, v45
    v_cvt_pk_bf16_f32 v103, v46, v47
    buffer_store_dwordx4 v[96:99], v12, s[4:7], s34 offen offset:0 sc1
    buffer_store_dwordx4 v[100:103], v12, s[4:7], s34 offen offset:512 sc1
    v_cvt_pk_bf16_f32 v104, v48, v49
    v_cvt_pk_bf16_f32 v105, v50, v51
    v_cvt_pk_bf16_f32 v106, v52, v53
    v_cvt_pk_bf16_f32 v107, v54, v55
    v_cvt_pk_bf16_f32 v108, v56, v57
    v_cvt_pk_bf16_f32 v109, v58, v59
    v_cvt_pk_bf16_f32 v110, v60, v61
    v_cvt_pk_bf16_f32 v111, v62, v63
    buffer_store_dwordx4 v[104:107], v13, s[4:7], s68 offen offset:0 sc1
    buffer_store_dwordx4 v[108:111], v13, s[4:7], s68 offen offset:512 sc1
    s_waitcnt vmcnt(20)
    s_barrier
    s_add_u32 m0, s69, 81920
    s_mov_b32 s67, 2621440
    buffer_load_dwordx4 v4, s[16:19], s67 offen lds
    s_add_u32 m0, s69, 82944
    s_mov_b32 s67, 2654208
    buffer_load_dwordx4 v4, s[16:19], s67 offen lds
    s_add_u32 m0, s69, 83968
    s_mov_b32 s67, 2686976
    buffer_load_dwordx4 v4, s[16:19], s67 offen lds
    s_add_u32 m0, s69, 84992
    s_mov_b32 s67, 2719744
    buffer_load_dwordx4 v4, s[16:19], s67 offen lds
    ds_read_b64_tr_b16 v[128:129], v7 offset:32768
    ds_read_b64_tr_b16 v[130:131], v7 offset:33792
    ds_read_b64_tr_b16 v[132:133], v7 offset:36864
    ds_read_b64_tr_b16 v[134:135], v7 offset:37888
    ds_read_b64_tr_b16 v[136:137], v7 offset:40960
    ds_read_b64_tr_b16 v[138:139], v7 offset:41984
    ds_read_b64_tr_b16 v[140:141], v7 offset:45056
    ds_read_b64_tr_b16 v[142:143], v7 offset:46080
    s_waitcnt lgkmcnt(0)
    s_waitcnt vmcnt(20)
    s_barrier
    s_add_u32 m0, s69, 98304
    s_mov_b32 s67, 3145728
    buffer_load_dwordx4 v4, s[16:19], s67 offen lds
    s_add_u32 m0, s69, 99328
    s_mov_b32 s67, 3178496
    buffer_load_dwordx4 v4, s[16:19], s67 offen lds
    s_add_u32 m0, s69, 100352
    s_mov_b32 s67, 3211264
    buffer_load_dwordx4 v4, s[16:19], s67 offen lds
    s_add_u32 m0, s69, 101376
    s_mov_b32 s67, 3244032
    buffer_load_dwordx4 v4, s[16:19], s67 offen lds
    ds_read_b64_tr_b16 v[144:145], v7 offset:49152
    ds_read_b64_tr_b16 v[146:147], v7 offset:50176
    ds_read_b64_tr_b16 v[148:149], v7 offset:53248
    ds_read_b64_tr_b16 v[150:151], v7 offset:54272
    ds_read_b64_tr_b16 v[152:153], v7 offset:57344
    ds_read_b64_tr_b16 v[154:155], v7 offset:58368
    ds_read_b64_tr_b16 v[156:157], v7 offset:61440
    ds_read_b64_tr_b16 v[158:159], v7 offset:62464
    s_waitcnt lgkmcnt(0)
    s_waitcnt vmcnt(20)
    s_barrier
    s_add_u32 m0, s69, 114688
    s_mov_b32 s67, 3670016
    buffer_load_dwordx4 v4, s[16:19], s67 offen lds
    s_add_u32 m0, s69, 115712
    s_mov_b32 s67, 3702784
    buffer_load_dwordx4 v4, s[16:19], s67 offen lds
    s_add_u32 m0, s69, 116736
    s_mov_b32 s67, 3735552
    buffer_load_dwordx4 v4, s[16:19], s67 offen lds
    s_add_u32 m0, s69, 117760
    s_mov_b32 s67, 3768320
    buffer_load_dwordx4 v4, s[16:19], s67 offen lds
    ds_read_b64_tr_b16 v[160:161], v6 offset:32768
    ds_read_b64_tr_b16 v[162:163], v6 offset:33792
    ds_read_b64_tr_b16 v[164:165], v6 offset:36864
    ds_read_b64_tr_b16 v[166:167], v6 offset:37888
    ds_read_b64_tr_b16 v[168:169], v6 offset:40960
    ds_read_b64_tr_b16 v[170:171], v6 offset:41984
    ds_read_b64_tr_b16 v[172:173], v6 offset:45056
    ds_read_b64_tr_b16 v[174:175], v6 offset:46080
    s_waitcnt lgkmcnt(0)
    s_waitcnt vmcnt(20)
    s_barrier
    ds_read_b64_tr_b16 v[176:177], v6 offset:49152
    ds_read_b64_tr_b16 v[178:179], v6 offset:50176
    ds_read_b64_tr_b16 v[180:181], v6 offset:53248
    ds_read_b64_tr_b16 v[182:183], v6 offset:54272
    ds_read_b64_tr_b16 v[184:185], v6 offset:57344
    ds_read_b64_tr_b16 v[186:187], v6 offset:58368
    ds_read_b64_tr_b16 v[188:189], v6 offset:61440
    ds_read_b64_tr_b16 v[190:191], v6 offset:62464
    s_waitcnt lgkmcnt(0)
    s_waitcnt vmcnt(16)
    s_barrier
    ds_read_b64_tr_b16 v[192:193], v7 offset:0
    ds_read_b64_tr_b16 v[194:195], v7 offset:1024
    ds_read_b64_tr_b16 v[196:197], v7 offset:4096
    ds_read_b64_tr_b16 v[198:199], v7 offset:5120
    ds_read_b64_tr_b16 v[200:201], v7 offset:8192
    ds_read_b64_tr_b16 v[202:203], v7 offset:9216
    ds_read_b64_tr_b16 v[204:205], v7 offset:12288
    ds_read_b64_tr_b16 v[206:207], v7 offset:13312
    s_waitcnt lgkmcnt(0)
    s_waitcnt vmcnt(8)
    s_barrier
    ds_read_b64_tr_b16 v[208:209], v7 offset:16384
    ds_read_b64_tr_b16 v[210:211], v7 offset:17408
    ds_read_b64_tr_b16 v[212:213], v7 offset:20480
    ds_read_b64_tr_b16 v[214:215], v7 offset:21504
    ds_read_b64_tr_b16 v[216:217], v7 offset:24576
    ds_read_b64_tr_b16 v[218:219], v7 offset:25600
    ds_read_b64_tr_b16 v[220:221], v7 offset:28672
    ds_read_b64_tr_b16 v[222:223], v7 offset:29696
    s_waitcnt lgkmcnt(0)
    s_waitcnt vmcnt(4)
    s_barrier
    ds_read_b64_tr_b16 v[224:225], v7 offset:32768
    ds_read_b64_tr_b16 v[226:227], v7 offset:33792
    ds_read_b64_tr_b16 v[228:229], v7 offset:36864
    ds_read_b64_tr_b16 v[230:231], v7 offset:37888
    ds_read_b64_tr_b16 v[232:233], v7 offset:40960
    ds_read_b64_tr_b16 v[234:235], v7 offset:41984
    ds_read_b64_tr_b16 v[236:237], v7 offset:45056
    ds_read_b64_tr_b16 v[238:239], v7 offset:46080
    s_waitcnt lgkmcnt(0)
    s_waitcnt vmcnt(0)
    s_barrier
    ds_read_b64_tr_b16 v[240:241], v7 offset:49152
    ds_read_b64_tr_b16 v[242:243], v7 offset:50176
    ds_read_b64_tr_b16 v[244:245], v7 offset:53248
    ds_read_b64_tr_b16 v[246:247], v7 offset:54272
    ds_read_b64_tr_b16 v[248:249], v7 offset:57344
    ds_read_b64_tr_b16 v[250:251], v7 offset:58368
    ds_read_b64_tr_b16 v[252:253], v7 offset:61440
    ds_read_b64_tr_b16 v[254:255], v7 offset:62464
    s_waitcnt lgkmcnt(0)
    s_barrier
    s_mov_b64 exec, 1
    buffer_store_dword v17, off, s[4:7], s72 sc1
    s_mov_b64 exec, -1
    ds_read_b128 v[80:83], v10 offset:0
    ds_read_b128 v[84:87], v10 offset:1024
    ds_read_b128 v[88:91], v10 offset:2048
    s_waitcnt lgkmcnt(2)
    v_mfma_f32_32x32x16_bf16 v[64:79], v[128:131], v[80:83], 0
    ds_read_b128 v[92:95], v10 offset:3072
    s_waitcnt lgkmcnt(2)
    v_mfma_f32_32x32x16_bf16 v[64:79], v[132:135], v[84:87], v[64:79]
    ds_read_b128 v[80:83], v10 offset:4096
    s_lshl_b32 s67, s31, 15
    s_lshl_b32 s68, s25, 13
    s_add_u32 s67, s67, s68
    s_add_u32 s67, s67, 1048576
    s_add_u32 s68, s68, s30
    s_waitcnt lgkmcnt(2)
    v_mfma_f32_32x32x16_bf16 v[64:79], v[136:139], v[88:91], v[64:79]
    ds_read_b128 v[84:87], v10 offset:5120
    s_mov_b32 m0, s68
    s_nop 0
    buffer_load_dwordx4 v1, s[4:7], s67 offen offset:0 sc1 lds
    s_waitcnt lgkmcnt(2)
    v_mfma_f32_32x32x16_bf16 v[64:79], v[140:143], v[92:95], v[64:79]
    ds_read_b128 v[88:91], v10 offset:6144
    buffer_load_dwordx4 v1, s[4:7], s67 offen offset:1024 sc1 lds
    s_waitcnt lgkmcnt(2)
    v_mfma_f32_32x32x16_bf16 v[64:79], v[144:147], v[80:83], v[64:79]
    ds_read_b128 v[92:95], v10 offset:7168
    buffer_load_dwordx4 v1, s[4:7], s67 offen offset:2048 sc1 lds
    s_waitcnt lgkmcnt(2)
    v_mfma_f32_32x32x16_bf16 v[64:79], v[148:151], v[84:87], v[64:79]
    ds_read_b128 v[80:83], v10 offset:8192
    buffer_load_dwordx4 v1, s[4:7], s67 offen offset:3072 sc1 lds
    s_waitcnt lgkmcnt(2)
    v_mfma_f32_32x32x16_bf16 v[64:79], v[152:155], v[88:91], v[64:79]
    ds_read_b128 v[84:87], v10 offset:9216
    s_add_u32 s67, s67, 0x1000
    s_add_u32 s68, s68, 0x1000
    s_waitcnt lgkmcnt(2)
    v_mfma_f32_32x32x16_bf16 v[64:79], v[156:159], v[92:95], v[64:79]
    ds_read_b128 v[88:91], v10 offset:10240
    s_mov_b32 m0, s68
    s_nop 0
    buffer_load_dwordx4 v1, s[4:7], s67 offen offset:0 sc1 lds
    s_waitcnt lgkmcnt(2)
    v_mfma_f32_32x32x16_bf16 v[64:79], v[160:163], v[80:83], v[64:79]
    ds_read_b128 v[92:95], v10 offset:11264
    buffer_load_dwordx4 v1, s[4:7], s67 offen offset:1024 sc1 lds
    s_waitcnt lgkmcnt(2)
    v_mfma_f32_32x32x16_bf16 v[64:79], v[164:167], v[84:87], v[64:79]
    ds_read_b128 v[80:83], v10 offset:12288
    buffer_load_dwordx4 v1, s[4:7], s67 offen offset:2048 sc1 lds
    s_waitcnt lgkmcnt(2)
    v_mfma_f32_32x32x16_bf16 v[64:79], v[168:171], v[88:91], v[64:79]
    ds_read_b128 v[84:87], v10 offset:13312
    buffer_load_dwordx4 v1, s[4:7], s67 offen offset:3072 sc1 lds
    s_waitcnt lgkmcnt(2)
    v_mfma_f32_32x32x16_bf16 v[64:79], v[172:175], v[92:95], v[64:79]
    ds_read_b128 v[88:91], v10 offset:14336
    s_waitcnt lgkmcnt(2)
    v_mfma_f32_32x32x16_bf16 v[64:79], v[176:179], v[80:83], v[64:79]
    ds_read_b128 v[92:95], v10 offset:15360
    s_waitcnt lgkmcnt(2)
    v_mfma_f32_32x32x16_bf16 v[64:79], v[180:183], v[84:87], v[64:79]
    ds_read_b128 v[80:83], v10 offset:16384
    s_waitcnt lgkmcnt(2)
    v_mfma_f32_32x32x16_bf16 v[64:79], v[184:187], v[88:91], v[64:79]
    ds_read_b128 v[84:87], v10 offset:17408
    s_waitcnt lgkmcnt(2)
    v_mfma_f32_32x32x16_bf16 v[64:79], v[188:191], v[92:95], v[64:79]
    ds_read_b128 v[88:91], v10 offset:18432
    s_waitcnt lgkmcnt(2)
    v_mfma_f32_32x32x16_bf16 v[64:79], v[192:195], v[80:83], v[64:79]
    ds_read_b128 v[92:95], v10 offset:19456
    s_waitcnt lgkmcnt(2)
    v_mfma_f32_32x32x16_bf16 v[64:79], v[196:199], v[84:87], v[64:79]
    ds_read_b128 v[80:83], v10 offset:20480
    s_waitcnt lgkmcnt(2)
    v_mfma_f32_32x32x16_bf16 v[64:79], v[200:203], v[88:91], v[64:79]
    ds_read_b128 v[84:87], v10 offset:21504
    s_waitcnt lgkmcnt(2)
    v_mfma_f32_32x32x16_bf16 v[64:79], v[204:207], v[92:95], v[64:79]
    ds_read_b128 v[88:91], v10 offset:22528
    s_waitcnt lgkmcnt(2)
    v_mfma_f32_32x32x16_bf16 v[64:79], v[208:211], v[80:83], v[64:79]
    ds_read_b128 v[92:95], v10 offset:23552
    s_waitcnt lgkmcnt(2)
    v_mfma_f32_32x32x16_bf16 v[64:79], v[212:215], v[84:87], v[64:79]
    ds_read_b128 v[80:83], v10 offset:24576
    s_waitcnt lgkmcnt(2)
    v_mfma_f32_32x32x16_bf16 v[64:79], v[216:219], v[88:91], v[64:79]
    ds_read_b128 v[84:87], v10 offset:25600
    s_waitcnt lgkmcnt(2)
    v_mfma_f32_32x32x16_bf16 v[64:79], v[220:223], v[92:95], v[64:79]
    ds_read_b128 v[88:91], v10 offset:26624
    s_waitcnt lgkmcnt(2)
    v_mfma_f32_32x32x16_bf16 v[64:79], v[224:227], v[80:83], v[64:79]
    ds_read_b128 v[92:95], v10 offset:27648
    s_waitcnt lgkmcnt(2)
    v_mfma_f32_32x32x16_bf16 v[64:79], v[228:231], v[84:87], v[64:79]
    ds_read_b128 v[80:83], v10 offset:28672
    s_waitcnt lgkmcnt(2)
    v_mfma_f32_32x32x16_bf16 v[64:79], v[232:235], v[88:91], v[64:79]
    ds_read_b128 v[84:87], v10 offset:29696
    s_waitcnt lgkmcnt(2)
    v_mfma_f32_32x32x16_bf16 v[64:79], v[236:239], v[92:95], v[64:79]
    ds_read_b128 v[88:91], v10 offset:30720
    s_waitcnt lgkmcnt(2)
    v_mfma_f32_32x32x16_bf16 v[64:79], v[240:243], v[80:83], v[64:79]
    ds_read_b128 v[92:95], v10 offset:31744
    s_waitcnt lgkmcnt(2)
    v_mfma_f32_32x32x16_bf16 v[64:79], v[244:247], v[84:87], v[64:79]
    s_waitcnt lgkmcnt(1)
    v_mfma_f32_32x32x16_bf16 v[64:79], v[248:251], v[88:91], v[64:79]
    s_waitcnt lgkmcnt(0)
    v_mfma_f32_32x32x16_bf16 v[64:79], v[252:255], v[92:95], v[64:79]
    s_lshl_b32 s67, s25, 11
    s_add_u32 s67, s67, s32
    v_add_u32 v11, s67, v1
    ds_write_b128 v11, v[96:99] offset:0
    ds_write_b128 v11, v[100:103] offset:1024
    ds_write_b128 v11, v[104:107] offset:8192
    ds_write_b128 v11, v[108:111] offset:9216
    s_waitcnt vmcnt(0)
    s_nop 3
    s_branch QA_A2
QA_A:
    v_add_u32 v10, s30, v1
    s_xor_b32 s30, s30, 0x8000
    s_add_u32 s31, s31, 3
    s_min_u32 s31, s31, 63
    ds_read_b128 v[80:83], v10 offset:0
    ds_read_b128 v[84:87], v10 offset:1024
    ds_read_b128 v[88:91], v10 offset:2048
    s_waitcnt lgkmcnt(2)
    v_mfma_f32_32x32x16_bf16 v[32:47], a[0:3], v[80:83], 0
    ds_read_b128 v[92:95], v10 offset:3072
    s_waitcnt lgkmcnt(2)
    v_mfma_f32_32x32x16_bf16 v[32:47], a[4:7], v[84:87], v[32:47]
    ds_read_b128 v[80:83], v10 offset:4096
    s_lshl_b32 s67, s25, 11
    s_add_u32 s67, s67, s32
    v_add_u32 v11, s67, v1
    s_waitcnt lgkmcnt(2)
    v_mfma_f32_32x32x16_bf16 v[32:47], a[8:11], v[88:91], v[32:47]
    ds_read_b128 v[84:87], v10 offset:5120
    s_waitcnt lgkmcnt(2)
    v_mfma_f32_32x32x16_bf16 v[32:47], a[12:15], v[92:95], v[32:47]
    ds_read_b128 v[88:91], v10 offset:6144
    s_waitcnt lgkmcnt(2)
    v_mfma_f32_32x32x16_bf16 v[32:47], a[16:19], v[80:83], v[32:47]
    ds_read_b128 v[92:95], v10 offset:7168
    s_waitcnt lgkmcnt(2)
    v_mfma_f32_32x32x16_bf16 v[32:47], a[20:23], v[84:87], v[32:47]
    ds_read_b128 v[80:83], v10 offset:8192
    s_waitcnt lgkmcnt(2)
    v_mfma_f32_32x32x16_bf16 v[32:47], a[24:27], v[88:91], v[32:47]
    ds_read_b128 v[84:87], v10 offset:9216
    s_waitcnt lgkmcnt(2)
    v_mfma_f32_32x32x16_bf16 v[32:47], a[28:31], v[92:95], v[32:47]
    ds_read_b128 v[88:91], v10 offset:10240
    s_waitcnt lgkmcnt(2)
    v_mfma_f32_32x32x16_bf16 v[32:47], a[32:35], v[80:83], v[32:47]
    ds_read_b128 v[92:95], v10 offset:11264
    s_waitcnt lgkmcnt(2)
    v_mfma_f32_32x32x16_bf16 v[32:47], a[36:39], v[84:87], v[32:47]
    ds_read_b128 v[80:83], v10 offset:12288
    s_waitcnt lgkmcnt(2)
    v_mfma_f32_32x32x16_bf16 v[32:47], a[40:43], v[88:91], v[32:47]
    ds_read_b128 v[84:87], v10 offset:13312
    s_waitcnt lgkmcnt(2)
    v_mfma_f32_32x32x16_bf16 v[32:47], a[44:47], v[92:95], v[32:47]
    ds_read_b128 v[88:91], v10 offset:14336
    s_waitcnt lgkmcnt(2)
    v_mfma_f32_32x32x16_bf16 v[32:47], a[48:51], v[80:83], v[32:47]
    ds_read_b128 v[92:95], v10 offset:15360
    s_waitcnt lgkmcnt(2)
    v_mfma_f32_32x32x16_bf16 v[32:47], a[52:55], v[84:87], v[32:47]
    ds_read_b128 v[80:83], v10 offset:16384
    s_waitcnt lgkmcnt(2)
    v_mfma_f32_32x32x16_bf16 v[32:47], a[56:59], v[88:91], v[32:47]
    ds_read_b128 v[84:87], v10 offset:17408
    s_waitcnt lgkmcnt(2)
    v_mfma_f32_32x32x16_bf16 v[32:47], a[60:63], v[92:95], v[32:47]
    ds_read_b128 v[88:91], v10 offset:18432
    s_waitcnt lgkmcnt(2)
    v_mfma_f32_32x32x16_bf16 v[32:47], a[64:67], v[80:83], v[32:47]
    ds_read_b128 v[92:95], v10 offset:19456
    s_waitcnt lgkmcnt(2)
    v_mfma_f32_32x32x16_bf16 v[32:47], a[68:71], v[84:87], v[32:47]
    ds_read_b128 v[80:83], v10 offset:20480
    s_waitcnt lgkmcnt(2)
    v_mfma_f32_32x32x16_bf16 v[32:47], a[72:75], v[88:91], v[32:47]
    ds_read_b128 v[84:87], v10 offset:21504
    s_waitcnt lgkmcnt(2)
    v_mfma_f32_32x32x16_bf16 v[32:47], a[76:79], v[92:95], v[32:47]
    ds_read_b128 v[88:91], v10 offset:22528
    s_waitcnt lgkmcnt(2)
    v_mfma_f32_32x32x16_bf16 v[32:47], a[80:83], v[80:83], v[32:47]
    ds_read_b128 v[92:95], v10 offset:23552
    s_waitcnt lgkmcnt(2)
    v_mfma_f32_32x32x16_bf16 v[32:47], a[84:87], v[84:87], v[32:47]
    ds_read_b128 v[80:83], v10 offset:24576
    s_waitcnt lgkmcnt(2)
    v_mfma_f32_32x32x16_bf16 v[32:47], a[88:91], v[88:91], v[32:47]
    ds_read_b128 v[84:87], v10 offset:25600
    s_waitcnt lgkmcnt(2)
    v_mfma_f32_32x32x16_bf16 v[32:47], a[92:95], v[92:95], v[32:47]
    ds_read_b128 v[88:91], v10 offset:26624
    s_waitcnt lgkmcnt(2)
    v_mfma_f32_32x32x16_bf16 v[32:47], a[96:99], v[80:83], v[32:47]
    ds_read_b128 v[92:95], v10 offset:27648
    s_waitcnt vmcnt(0)
    s_mov_b64 exec, 1
    buffer_store_dword v17, off, s[4:7], s72 sc1
    s_mov_b64 exec, -1
    s_mov_b32 s72, s64
    s_waitcnt lgkmcnt(2)
    v_mfma_f32_32x32x16_bf16 v[32:47], a[100:103], v[84:87], v[32:47]
    ds_read_b128 v[80:83], v10 offset:28672
    s_lshl_b32 s67, s31, 15
    s_lshl_b32 s68, s25, 13
    s_add_u32 s67, s67, s68
    s_add_u32 s67, s67, 1048576
    s_add_u32 s68, s68, s30
    s_waitcnt lgkmcnt(2)
    v_mfma_f32_32x32x16_bf16 v[32:47], a[104:107], v[88:91], v[32:47]
    ds_read_b128 v[84:87], v10 offset:29696
    s_mov_b32 m0, s68
    s_nop 0
    buffer_load_dwordx4 v1, s[4:7], s67 offen offset:0 sc1 lds
    s_waitcnt lgkmcnt(2)
    v_mfma_f32_32x32x16_bf16 v[32:47], a[108:111], v[92:95], v[32:47]
    ds_read_b128 v[88:91], v10 offset:30720
    s_waitcnt lgkmcnt(2)
    v_mfma_f32_32x32x16_bf16 v[32:47], a[112:115], v[80:83], v[32:47]
    ds_read_b128 v[92:95], v10 offset:31744
    buffer_load_dwordx4 v1, s[4:7], s67 offen offset:1024 sc1 lds
    s_waitcnt lgkmcnt(2)
    v_mfma_f32_32x32x16_bf16 v[32:47], a[116:119], v[84:87], v[32:47]
    ds_read_b128 v[80:83], v10 offset:0
    s_waitcnt lgkmcnt(2)
    v_mfma_f32_32x32x16_bf16 v[32:47], a[120:123], v[88:91], v[32:47]
    ds_read_b128 v[84:87], v10 offset:1024
    buffer_load_dwordx4 v1, s[4:7], s67 offen offset:2048 sc1 lds
    s_waitcnt lgkmcnt(2)
    v_mfma_f32_32x32x16_bf16 v[32:47], a[124:127], v[92:95], v[32:47]
    ds_read_b128 v[88:91], v10 offset:2048
    s_waitcnt lgkmcnt(2)
    v_mfma_f32_32x32x16_bf16 v[48:63], v[80:83], a[128:131], 0
    ds_read_b128 v[92:95], v10 offset:3072
    buffer_load_dwordx4 v1, s[4:7], s67 offen offset:3072 sc1 lds
    s_waitcnt lgkmcnt(2)
    v_mfma_f32_32x32x16_bf16 v[48:63], v[84:87], a[132:135], v[48:63]
    ds_read_b128 v[80:83], v10 offset:4096
    s_waitcnt lgkmcnt(2)
    v_mfma_f32_32x32x16_bf16 v[48:63], v[88:91], a[136:139], v[48:63]
    ds_read_b128 v[84:87], v10 offset:5120
    s_add_u32 s67, s67, 0x1000
    s_add_u32 s68, s68, 0x1000
    s_waitcnt lgkmcnt(2)
    v_mfma_f32_32x32x16_bf16 v[48:63], v[92:95], a[140:143], v[48:63]
    ds_read_b128 v[88:91], v10 offset:6144
    s_mov_b32 m0, s68
    s_nop 0
    buffer_load_dwordx4 v1, s[4:7], s67 offen offset:0 sc1 lds
    s_waitcnt lgkmcnt(2)
    v_mfma_f32_32x32x16_bf16 v[48:63], v[80:83], a[144:147], v[48:63]
    ds_read_b128 v[92:95], v10 offset:7168
    s_waitcnt lgkmcnt(2)
    v_mfma_f32_32x32x16_bf16 v[48:63], v[84:87], a[148:151], v[48:63]
    ds_read_b128 v[80:83], v10 offset:8192
    buffer_load_dwordx4 v1, s[4:7], s67 offen offset:1024 sc1 lds
    s_waitcnt lgkmcnt(2)
    v_mfma_f32_32x32x16_bf16 v[48:63], v[88:91], a[152:155], v[48:63]
    ds_read_b128 v[84:87], v10 offset:9216
    s_waitcnt lgkmcnt(2)
    v_mfma_f32_32x32x16_bf16 v[48:63], v[92:95], a[156:159], v[48:63]
    ds_read_b128 v[88:91], v10 offset:10240
    buffer_load_dwordx4 v1, s[4:7], s67 offen offset:2048 sc1 lds
    s_waitcnt lgkmcnt(2)
    v_mfma_f32_32x32x16_bf16 v[48:63], v[80:83], a[160:163], v[48:63]
    ds_read_b128 v[92:95], v10 offset:11264
    s_waitcnt lgkmcnt(2)
    v_mfma_f32_32x32x16_bf16 v[48:63], v[84:87], a[164:167], v[48:63]
    ds_read_b128 v[80:83], v10 offset:12288
    buffer_load_dwordx4 v1, s[4:7], s67 offen offset:3072 sc1 lds
    s_waitcnt lgkmcnt(2)
    v_mfma_f32_32x32x16_bf16 v[48:63], v[88:91], a[168:171], v[48:63]
    ds_read_b128 v[84:87], v10 offset:13312
    s_waitcnt lgkmcnt(2)
    v_mfma_f32_32x32x16_bf16 v[48:63], v[92:95], a[172:175], v[48:63]
    ds_read_b128 v[88:91], v10 offset:14336
    s_waitcnt lgkmcnt(2)
    v_mfma_f32_32x32x16_bf16 v[48:63], v[80:83], a[176:179], v[48:63]
    ds_read_b128 v[92:95], v10 offset:15360
    s_waitcnt lgkmcnt(2)
    v_mfma_f32_32x32x16_bf16 v[48:63], v[84:87], a[180:183], v[48:63]
    ds_read_b128 v[80:83], v10 offset:16384
    s_waitcnt lgkmcnt(2)
    v_mfma_f32_32x32x16_bf16 v[48:63], v[88:91], a[184:187], v[48:63]
    ds_read_b128 v[84:87], v10 offset:17408
    v_cvt_pk_bf16_f32 v96, v32, v33
    v_cvt_pk_bf16_f32 v97, v34, v35
    v_cvt_pk_bf16_f32 v98, v36, v37
    s_waitcnt lgkmcnt(2)
    v_mfma_f32_32x32x16_bf16 v[48:63], v[92:95], a[188:191], v[48:63]
    ds_read_b128 v[88:91], v10 offset:18432
    v_cvt_pk_bf16_f32 v99, v38, v39
    v_cvt_pk_bf16_f32 v100, v40, v41
    v_cvt_pk_bf16_f32 v101, v42, v43
    s_waitcnt lgkmcnt(2)
    v_mfma_f32_32x32x16_bf16 v[48:63], v[80:83], a[192:195], v[48:63]
    ds_read_b128 v[92:95], v10 offset:19456
    v_cvt_pk_bf16_f32 v102, v44, v45
    v_cvt_pk_bf16_f32 v103, v46, v47
    s_waitcnt lgkmcnt(2)
    v_mfma_f32_32x32x16_bf16 v[48:63], v[84:87], a[196:199], v[48:63]
    ds_read_b128 v[80:83], v10 offset:20480
    buffer_store_dwordx4 v[96:99], v12, s[4:7], s34 offen offset:0 sc1
    s_waitcnt lgkmcnt(2)
    v_mfma_f32_32x32x16_bf16 v[48:63], v[88:91], a[200:203], v[48:63]
    ds_read_b128 v[84:87], v10 offset:21504
    s_waitcnt lgkmcnt(2)
    v_mfma_f32_32x32x16_bf16 v[48:63], v[92:95], a[204:207], v[48:63]
    ds_read_b128 v[88:91], v10 offset:22528
    buffer_store_dwordx4 v[100:103], v12, s[4:7], s34 offen offset:512 sc1
    s_waitcnt lgkmcnt(2)
    v_mfma_f32_32x32x16_bf16 v[48:63], v[80:83], a[208:211], v[48:63]
    ds_read_b128 v[92:95], v10 offset:23552
    s_waitcnt lgkmcnt(2)
    v_mfma_f32_32x32x16_bf16 v[48:63], v[84:87], a[212:215], v[48:63]
    ds_read_b128 v[80:83], v10 offset:24576
    ds_write_b128 v11, v[96:99] offset:0
    s_waitcnt lgkmcnt(3)
    v_mfma_f32_32x32x16_bf16 v[48:63], v[88:91], a[216:219], v[48:63]
    ds_read_b128 v[84:87], v10 offset:25600
    s_waitcnt lgkmcnt(3)
    v_mfma_f32_32x32x16_bf16 v[48:63], v[92:95], a[220:223], v[48:63]
    ds_read_b128 v[88:91], v10 offset:26624
    ds_write_b128 v11, v[100:103] offset:1024
    s_waitcnt lgkmcnt(4)
    v_mfma_f32_32x32x16_bf16 v[48:63], v[80:83], a[224:227], v[48:63]
    ds_read_b128 v[92:95], v10 offset:27648
    s_waitcnt lgkmcnt(3)
    v_mfma_f32_32x32x16_bf16 v[48:63], v[84:87], a[228:231], v[48:63]
    ds_read_b128 v[80:83], v10 offset:28672
    s_waitcnt lgkmcnt(3)
    v_mfma_f32_32x32x16_bf16 v[48:63], v[88:91], a[232:235], v[48:63]
    ds_read_b128 v[84:87], v10 offset:29696
    s_waitcnt lgkmcnt(2)
    v_mfma_f32_32x32x16_bf16 v[48:63], v[92:95], a[236:239], v[48:63]
    ds_read_b128 v[88:91], v10 offset:30720
    s_waitcnt lgkmcnt(2)
    v_mfma_f32_32x32x16_bf16 v[48:63], v[80:83], a[240:243], v[48:63]
    ds_read_b128 v[92:95], v10 offset:31744
    s_add_u32 s68, s34, 0x2000
    s_waitcnt lgkmcnt(2)
    v_mfma_f32_32x32x16_bf16 v[48:63], v[84:87], a[244:247], v[48:63]
    ds_read_b128 v[80:83], v10 offset:0
    s_waitcnt lgkmcnt(2)
    v_mfma_f32_32x32x16_bf16 v[48:63], v[88:91], a[248:251], v[48:63]
    ds_read_b128 v[84:87], v10 offset:1024
    s_waitcnt lgkmcnt(2)
    v_mfma_f32_32x32x16_bf16 v[48:63], v[92:95], a[252:255], v[48:63]
    ds_read_b128 v[88:91], v10 offset:2048
    s_waitcnt lgkmcnt(2)
    v_mfma_f32_32x32x16_bf16 v[64:79], v[128:131], v[80:83], 0
    ds_read_b128 v[92:95], v10 offset:3072
    s_waitcnt lgkmcnt(2)
    v_mfma_f32_32x32x16_bf16 v[64:79], v[132:135], v[84:87], v[64:79]
    ds_read_b128 v[80:83], v10 offset:4096
    s_waitcnt lgkmcnt(2)
    v_mfma_f32_32x32x16_bf16 v[64:79], v[136:139], v[88:91], v[64:79]
    ds_read_b128 v[84:87], v10 offset:5120
    v_cvt_pk_bf16_f32 v104, v48, v49
    v_cvt_pk_bf16_f32 v105, v50, v51
    v_cvt_pk_bf16_f32 v106, v52, v53
    s_waitcnt lgkmcnt(2)
    v_mfma_f32_32x32x16_bf16 v[64:79], v[140:143], v[92:95], v[64:79]
    ds_read_b128 v[88:91], v10 offset:6144
    v_cvt_pk_bf16_f32 v107, v54, v55
    v_cvt_pk_bf16_f32 v108, v56, v57
    v_cvt_pk_bf16_f32 v109, v58, v59
    s_waitcnt lgkmcnt(2)
    v_mfma_f32_32x32x16_bf16 v[64:79], v[144:147], v[80:83], v[64:79]
    ds_read_b128 v[92:95], v10 offset:7168
    v_cvt_pk_bf16_f32 v110, v60, v61
    v_cvt_pk_bf16_f32 v111, v62, v63
    s_waitcnt lgkmcnt(2)
    v_mfma_f32_32x32x16_bf16 v[64:79], v[148:151], v[84:87], v[64:79]
    ds_read_b128 v[80:83], v10 offset:8192
    buffer_store_dwordx4 v[104:107], v13, s[4:7], s68 offen offset:0 sc1
    s_waitcnt lgkmcnt(2)
    v_mfma_f32_32x32x16_bf16 v[64:79], v[152:155], v[88:91], v[64:79]
    ds_read_b128 v[84:87], v10 offset:9216
    s_waitcnt lgkmcnt(2)
    v_mfma_f32_32x32x16_bf16 v[64:79], v[156:159], v[92:95], v[64:79]
    ds_read_b128 v[88:91], v10 offset:10240
    buffer_store_dwordx4 v[108:111], v13, s[4:7], s68 offen offset:512 sc1
    s_waitcnt lgkmcnt(2)
    v_mfma_f32_32x32x16_bf16 v[64:79], v[160:163], v[80:83], v[64:79]
    ds_read_b128 v[92:95], v10 offset:11264
    s_waitcnt lgkmcnt(2)
    v_mfma_f32_32x32x16_bf16 v[64:79], v[164:167], v[84:87], v[64:79]
    ds_read_b128 v[80:83], v10 offset:12288
    ds_write_b128 v11, v[104:107] offset:8192
    s_waitcnt lgkmcnt(3)
    v_mfma_f32_32x32x16_bf16 v[64:79], v[168:171], v[88:91], v[64:79]
    ds_read_b128 v[84:87], v10 offset:13312
    s_waitcnt lgkmcnt(3)
    v_mfma_f32_32x32x16_bf16 v[64:79], v[172:175], v[92:95], v[64:79]
    ds_read_b128 v[88:91], v10 offset:14336
    ds_write_b128 v11, v[108:111] offset:9216
    s_waitcnt lgkmcnt(4)
    v_mfma_f32_32x32x16_bf16 v[64:79], v[176:179], v[80:83], v[64:79]
    ds_read_b128 v[92:95], v10 offset:15360
    s_waitcnt lgkmcnt(3)
    v_mfma_f32_32x32x16_bf16 v[64:79], v[180:183], v[84:87], v[64:79]
    ds_read_b128 v[80:83], v10 offset:16384
    s_waitcnt lgkmcnt(3)
    v_mfma_f32_32x32x16_bf16 v[64:79], v[184:187], v[88:91], v[64:79]
    ds_read_b128 v[84:87], v10 offset:17408
    s_waitcnt lgkmcnt(2)
    v_mfma_f32_32x32x16_bf16 v[64:79], v[188:191], v[92:95], v[64:79]
    ds_read_b128 v[88:91], v10 offset:18432
    s_waitcnt lgkmcnt(2)
    v_mfma_f32_32x32x16_bf16 v[64:79], v[192:195], v[80:83], v[64:79]
    ds_read_b128 v[92:95], v10 offset:19456
    s_waitcnt lgkmcnt(2)
    v_mfma_f32_32x32x16_bf16 v[64:79], v[196:199], v[84:87], v[64:79]
    ds_read_b128 v[80:83], v10 offset:20480
    s_waitcnt lgkmcnt(2)
    v_mfma_f32_32x32x16_bf16 v[64:79], v[200:203], v[88:91], v[64:79]
    ds_read_b128 v[84:87], v10 offset:21504
    s_waitcnt lgkmcnt(2)
    v_mfma_f32_32x32x16_bf16 v[64:79], v[204:207], v[92:95], v[64:79]
    ds_read_b128 v[88:91], v10 offset:22528
    s_waitcnt lgkmcnt(2)
    v_mfma_f32_32x32x16_bf16 v[64:79], v[208:211], v[80:83], v[64:79]
    ds_read_b128 v[92:95], v10 offset:23552
    s_waitcnt lgkmcnt(2)
    v_mfma_f32_32x32x16_bf16 v[64:79], v[212:215], v[84:87], v[64:79]
    ds_read_b128 v[80:83], v10 offset:24576
    s_waitcnt lgkmcnt(2)
    v_mfma_f32_32x32x16_bf16 v[64:79], v[216:219], v[88:91], v[64:79]
    ds_read_b128 v[84:87], v10 offset:25600
    s_waitcnt lgkmcnt(2)
    v_mfma_f32_32x32x16_bf16 v[64:79], v[220:223], v[92:95], v[64:79]
    ds_read_b128 v[88:91], v10 offset:26624
    s_waitcnt lgkmcnt(2)
    v_mfma_f32_32x32x16_bf16 v[64:79], v[224:227], v[80:83], v[64:79]
    ds_read_b128 v[92:95], v10 offset:27648
    s_waitcnt lgkmcnt(2)
    v_mfma_f32_32x32x16_bf16 v[64:79], v[228:231], v[84:87], v[64:79]
    ds_read_b128 v[80:83], v10 offset:28672
    s_waitcnt lgkmcnt(2)
    v_mfma_f32_32x32x16_bf16 v[64:79], v[232:235], v[88:91], v[64:79]
    ds_read_b128 v[84:87], v10 offset:29696
    s_waitcnt lgkmcnt(2)
    v_mfma_f32_32x32x16_bf16 v[64:79], v[236:239], v[92:95], v[64:79]
    ds_read_b128 v[88:91], v10 offset:30720
    s_waitcnt lgkmcnt(2)
    v_mfma_f32_32x32x16_bf16 v[64:79], v[240:243], v[80:83], v[64:79]
    ds_read_b128 v[92:95], v10 offset:31744
    buffer_load_dwordx4 v[120:123], v1, s[4:7], s70 offen sc1
    s_waitcnt lgkmcnt(2)
    v_mfma_f32_32x32x16_bf16 v[64:79], v[244:247], v[84:87], v[64:79]
    s_waitcnt lgkmcnt(1)
    v_mfma_f32_32x32x16_bf16 v[64:79], v[248:251], v[88:91], v[64:79]
    buffer_load_dwordx4 v[124:127], v1, s[4:7], s70 offen offset:1024 sc1
    s_waitcnt lgkmcnt(0)
    v_mfma_f32_32x32x16_bf16 v[64:79], v[252:255], v[92:95], v[64:79]
    s_waitcnt vmcnt(6)
    s_nop 7
    s_nop 2
QA_A2:
    v_cvt_pk_bf16_f32 v112, v64, v65
    v_cvt_pk_bf16_f32 v113, v66, v67
    v_cvt_pk_bf16_f32 v114, v68, v69
    v_cvt_pk_bf16_f32 v115, v70, v71
    v_cvt_pk_bf16_f32 v116, v72, v73
    v_cvt_pk_bf16_f32 v117, v74, v75
    v_cvt_pk_bf16_f32 v118, v76, v77
    v_cvt_pk_bf16_f32 v119, v78, v79
    ds_write_b128 v11, v[112:115] offset:16384
    ds_write_b128 v11, v[116:119] offset:17408
    s_add_u32 s34, s34, 49152
    s_add_u32 s28, s28, 3
    s_add_u32 s64, s64, 48
    s_add_u32 s32, s32, 24576
    s_cmp_eq_u32 s32, 139264
    s_cselect_b32 s32, 65536, s32
    s_waitcnt lgkmcnt(0)
    s_barrier
    s_cmp_lt_u32 s28, 9
    s_cbranch_scc1 QA_A
QA_B:
    v_add_u32 v11, s33, v1
    s_lshl_b32 s67, s25, 11
    v_add_u32 v2, s67, v11
    v_add_u32 v3, s67, v16
    ds_read_b128 v[32:35], v16 offset:8192
    ds_read_b128 v[36:39], v16 offset:9216
    ds_read_b128 v[40:43], v16 offset:10240
    ds_read_b128 v[44:47], v16 offset:11264
    ds_read_b128 v[48:51], v11 offset:0
    ds_read_b128 v[52:55], v11 offset:16384
    ds_read_b128 v[56:59], v11 offset:1024
    ds_read_b128 v[60:63], v11 offset:17408
    ds_read_b128 v[64:67], v11 offset:2048
    ds_read_b128 v[68:71], v11 offset:18432
    s_waitcnt lgkmcnt(4)
    v_mfma_f32_32x32x16_bf16 v[32:47], v[48:51], v[52:55], v[32:47]
    ds_read_b128 v[72:75], v11 offset:3072
    ds_read_b128 v[76:79], v11 offset:19456
    s_waitcnt lgkmcnt(4)
    v_mfma_f32_32x32x16_bf16 v[32:47], v[56:59], v[60:63], v[32:47]
    ds_read_b128 v[48:51], v11 offset:4096
    ds_read_b128 v[52:55], v11 offset:20480
    s_waitcnt lgkmcnt(4)
    v_mfma_f32_32x32x16_bf16 v[32:47], v[64:67], v[68:71], v[32:47]
    ds_read_b128 v[56:59], v11 offset:5120
    ds_read_b128 v[60:63], v11 offset:21504
    s_waitcnt lgkmcnt(4)
    v_mfma_f32_32x32x16_bf16 v[32:47], v[72:75], v[76:79], v[32:47]
    ds_read_b128 v[64:67], v11 offset:6144
    ds_read_b128 v[68:71], v11 offset:22528
    s_waitcnt lgkmcnt(4)
    v_mfma_f32_32x32x16_bf16 v[32:47], v[48:51], v[52:55], v[32:47]
    ds_read_b128 v[72:75], v11 offset:7168
    ds_read_b128 v[76:79], v11 offset:23552
    s_waitcnt lgkmcnt(4)
    v_mfma_f32_32x32x16_bf16 v[32:47], v[56:59], v[60:63], v[32:47]
    s_waitcnt lgkmcnt(2)
    v_mfma_f32_32x32x16_bf16 v[32:47], v[64:67], v[68:71], v[32:47]
    s_waitcnt lgkmcnt(0)
    v_mfma_f32_32x32x16_bf16 v[32:47], v[72:75], v[76:79], v[32:47]
    ds_read_b128 v[96:99], v2 offset:16384
    ds_read_b128 v[100:103], v2 offset:17408
    ds_read_b128 v[104:107], v2 offset:8192
    ds_read_b128 v[108:111], v2 offset:9216
    s_lshl_b32 s67, s25, 10
    v_add_u32 v2, s67, v16
    s_nop 5
    v_max3_f32 v4, v32, v33, v34
    v_max3_f32 v4, v4, v35, v36
    v_max3_f32 v4, v4, v37, v38
    v_max3_f32 v4, v4, v39, v40
    v_max3_f32 v4, v4, v41, v42
    v_max3_f32 v4, v4, v43, v44
    v_max3_f32 v4, v4, v45, v46
    v_max_f32 v5, v4, v47
    v_max_f32 v4, v4, v47
    s_nop 1
    v_permlane32_swap_b32 v4, v5
    v_max_f32 v4, v4, v5
    v_mul_f32 v6, s71, v4
    v_pk_fma_f32 v[32:33], v[32:33], s[74:75], v[6:7] op_sel_hi:[1,1,0] neg_lo:[0,0,1] neg_hi:[0,0,1]
    v_pk_fma_f32 v[34:35], v[34:35], s[74:75], v[6:7] op_sel_hi:[1,1,0] neg_lo:[0,0,1] neg_hi:[0,0,1]
    v_pk_fma_f32 v[36:37], v[36:37], s[74:75], v[6:7] op_sel_hi:[1,1,0] neg_lo:[0,0,1] neg_hi:[0,0,1]
    v_pk_fma_f32 v[38:39], v[38:39], s[74:75], v[6:7] op_sel_hi:[1,1,0] neg_lo:[0,0,1] neg_hi:[0,0,1]
    v_pk_fma_f32 v[40:41], v[40:41], s[74:75], v[6:7] op_sel_hi:[1,1,0] neg_lo:[0,0,1] neg_hi:[0,0,1]
    v_pk_fma_f32 v[42:43], v[42:43], s[74:75], v[6:7] op_sel_hi:[1,1,0] neg_lo:[0,0,1] neg_hi:[0,0,1]
    v_pk_fma_f32 v[44:45], v[44:45], s[74:75], v[6:7] op_sel_hi:[1,1,0] neg_lo:[0,0,1] neg_hi:[0,0,1]
    v_pk_fma_f32 v[46:47], v[46:47], s[74:75], v[6:7] op_sel_hi:[1,1,0] neg_lo:[0,0,1] neg_hi:[0,0,1]
    v_exp_f32 v32, v32
    v_exp_f32 v33, v33
    v_exp_f32 v34, v34
    v_exp_f32 v35, v35
    v_exp_f32 v36, v36
    v_exp_f32 v37, v37
    v_exp_f32 v38, v38
    v_exp_f32 v39, v39
    v_exp_f32 v40, v40
    v_exp_f32 v41, v41
    v_exp_f32 v42, v42
    v_exp_f32 v43, v43
    v_exp_f32 v44, v44
    v_exp_f32 v45, v45
    v_exp_f32 v46, v46
    v_exp_f32 v47, v47
    v_cvt_pk_bf16_f32 v20, v32, v33
    v_cvt_pk_bf16_f32 v21, v34, v35
    v_cvt_pk_bf16_f32 v22, v36, v37
    v_cvt_pk_bf16_f32 v23, v38, v39
    v_cvt_pk_bf16_f32 v24, v40, v41
    v_cvt_pk_bf16_f32 v25, v42, v43
    v_cvt_pk_bf16_f32 v26, v44, v45
    v_cvt_pk_bf16_f32 v27, v46, v47
    v_pk_add_f32 v[32:33], v[32:33], v[40:41]
    v_pk_add_f32 v[34:35], v[34:35], v[42:43]
    v_pk_add_f32 v[36:37], v[36:37], v[44:45]
    v_pk_add_f32 v[38:39], v[38:39], v[46:47]
    v_pk_add_f32 v[32:33], v[32:33], v[36:37]
    v_pk_add_f32 v[34:35], v[34:35], v[38:39]
    v_pk_add_f32 v[32:33], v[32:33], v[34:35]
    v_add_f32 v7, v32, v33
    s_waitcnt lgkmcnt(0)
    v_mfma_f32_32x32x16_bf16 v[48:63], v[104:107], v[20:23], 0
    v_mfma_f32_32x32x16_bf16 v[48:63], v[108:111], v[24:27], v[48:63]
    s_waitcnt vmcnt(0)
    s_mov_b64 exec, 1
    buffer_store_dword v17, off, s[4:7], s72 sc1
    s_mov_b64 exec, -1
    v_max3_u32 v4, v120, v121, v122
    v_max3_u32 v5, v123, v124, v125
    v_max3_u32 v4, v4, v126, v127
    v_max_u32 v4, v4, v5
    v_cmp_eq_u32 vcc, -1, v4
    s_mov_b32 s72, s65
    s_cbranch_vccz QA_m_ok
    s_mov_b32 s35, 0
QA_m:
    buffer_load_dwordx4 v[120:123], v1, s[4:7], s70 offen sc1
    buffer_load_dwordx4 v[124:127], v1, s[4:7], s70 offen offset:1024 sc1
    s_waitcnt vmcnt(0)
    v_max3_u32 v4, v120, v121, v122
    v_max3_u32 v5, v123, v124, v125
    v_max3_u32 v4, v4, v126, v127
    v_max_u32 v4, v4, v5
    v_cmp_eq_u32 vcc, -1, v4
    s_cbranch_vccz QA_m_ok
    s_sleep 1
    s_add_u32 s35, s35, 1
    s_cmp_lt_u32 s35, 131072
    s_cbranch_scc1 QA_m
    s_branch L_END
QA_m_ok:
    ds_write_b128 v3, v[120:123]
    ds_write_b128 v3, v[124:127] offset:1024
    s_waitcnt lgkmcnt(0)
    s_barrier
    ds_read_b128 v[80:83], v15 offset:0
    ds_read_b128 v[84:87], v15 offset:32
    ds_read_b128 v[88:91], v15 offset:2048
    ds_read_b128 v[92:95], v15 offset:2080
    ds_read_b128 v[104:107], v15 offset:4096
    s_waitcnt lgkmcnt(4)
    v_mfma_f32_16x16x32_bf16 v[64:67], a[0:3], v[80:83], 0
    ds_read_b128 v[108:111], v15 offset:4128
    v_mfma_f32_16x16x32_bf16 v[68:71], v[80:83], a[128:131], 0
    s_waitcnt lgkmcnt(4)
    v_mfma_f32_16x16x32_bf16 v[64:67], a[4:7], v[84:87], v[64:67]
    ds_read_b128 v[80:83], v15 offset:6144
    s_waitcnt lgkmcnt(4)
    v_mfma_f32_16x16x32_bf16 v[64:67], a[8:11], v[88:91], v[64:67]
    ds_read_b128 v[84:87], v15 offset:6176
    s_waitcnt lgkmcnt(4)
    v_mfma_f32_16x16x32_bf16 v[64:67], a[12:15], v[92:95], v[64:67]
    ds_read_b128 v[88:91], v15 offset:512
    v_mfma_f32_16x16x32_bf16 v[68:71], v[92:95], a[140:143], v[68:71]
    s_waitcnt lgkmcnt(4)
    v_mfma_f32_16x16x32_bf16 v[64:67], a[16:19], v[104:107], v[64:67]
    ds_read_b128 v[92:95], v15 offset:544
    s_waitcnt lgkmcnt(4)
    v_mfma_f32_16x16x32_bf16 v[64:67], a[20:23], v[108:111], v[64:67]
    ds_read_b128 v[104:107], v15 offset:2560
    s_waitcnt lgkmcnt(4)
    v_mfma_f32_16x16x32_bf16 v[64:67], a[24:27], v[80:83], v[64:67]
    ds_read_b128 v[108:111], v15 offset:2592
    v_mfma_f32_16x16x32_bf16 v[68:71], v[80:83], a[152:155], v[68:71]
    s_waitcnt lgkmcnt(4)
    v_mfma_f32_16x16x32_bf16 v[64:67], a[28:31], v[84:87], v[64:67]
    ds_read_b128 v[80:83], v15 offset:4608
    s_waitcnt lgkmcnt(4)
    v_mfma_f32_16x16x32_bf16 v[64:67], a[32:35], v[88:91], v[64:67]
    ds_read_b128 v[84:87], v15 offset:4640
    v_mfma_f32_16x16x32_bf16 v[68:71], v[88:91], a[160:163], v[68:71]
    s_waitcnt lgkmcnt(4)
    v_mfma_f32_16x16x32_bf16 v[64:67], a[36:39], v[92:95], v[64:67]
    ds_read_b128 v[88:91], v15 offset:6656
    s_waitcnt lgkmcnt(4)
    v_mfma_f32_16x16x32_bf16 v[64:67], a[40:43], v[104:107], v[64:67]
    ds_read_b128 v[92:95], v15 offset:6688
    s_waitcnt lgkmcnt(4)
    v_mfma_f32_16x16x32_bf16 v[64:67], a[44:47], v[108:111], v[64:67]
    ds_read_b128 v[104:107], v15 offset:1024
    v_mfma_f32_16x16x32_bf16 v[68:71], v[108:111], a[172:175], v[68:71]
    s_waitcnt lgkmcnt(4)
    v_mfma_f32_16x16x32_bf16 v[64:67], a[48:51], v[80:83], v[64:67]
    ds_read_b128 v[108:111], v15 offset:1056
    s_waitcnt lgkmcnt(4)
    v_mfma_f32_16x16x32_bf16 v[64:67], a[52:55], v[84:87], v[64:67]
    ds_read_b128 v[80:83], v15 offset:3072
    s_waitcnt lgkmcnt(4)
    v_mfma_f32_16x16x32_bf16 v[64:67], a[56:59], v[88:91], v[64:67]
    ds_read_b128 v[84:87], v15 offset:3104
    v_mfma_f32_16x16x32_bf16 v[68:71], v[88:91], a[184:187], v[68:71]
    s_waitcnt lgkmcnt(4)
    v_mfma_f32_16x16x32_bf16 v[64:67], a[60:63], v[92:95], v[64:67]
    ds_read_b128 v[88:91], v15 offset:5120
    s_waitcnt lgkmcnt(4)
    v_mfma_f32_16x16x32_bf16 v[64:67], a[64:67], v[104:107], v[64:67]
    ds_read_b128 v[92:95], v15 offset:5152
    v_mfma_f32_16x16x32_bf16 v[68:71], v[104:107], a[192:195], v[68:71]
    s_waitcnt lgkmcnt(4)
    v_mfma_f32_16x16x32_bf16 v[64:67], a[68:71], v[108:111], v[64:67]
    ds_read_b128 v[104:107], v15 offset:7168
    s_waitcnt lgkmcnt(4)
    v_mfma_f32_16x16x32_bf16 v[64:67], a[72:75], v[80:83], v[64:67]
    ds_read_b128 v[108:111], v15 offset:7200
    s_waitcnt lgkmcnt(4)
    v_mfma_f32_16x16x32_bf16 v[64:67], a[76:79], v[84:87], v[64:67]
    ds_read_b128 v[80:83], v15 offset:1536
    v_mfma_f32_16x16x32_bf16 v[68:71], v[84:87], a[204:207], v[68:71]
    s_waitcnt lgkmcnt(4)
    v_mfma_f32_16x16x32_bf16 v[64:67], a[80:83], v[88:91], v[64:67]
    ds_read_b128 v[84:87], v15 offset:1568
    s_waitcnt lgkmcnt(4)
    v_mfma_f32_16x16x32_bf16 v[64:67], a[84:87], v[92:95], v[64:67]
    ds_read_b128 v[88:91], v15 offset:3584
    s_waitcnt lgkmcnt(4)
    v_mfma_f32_16x16x32_bf16 v[64:67], a[88:91], v[104:107], v[64:67]
    ds_read_b128 v[92:95], v15 offset:3616
    v_mfma_f32_16x16x32_bf16 v[68:71], v[104:107], a[216:219], v[68:71]
    s_waitcnt lgkmcnt(4)
    v_mfma_f32_16x16x32_bf16 v[64:67], a[92:95], v[108:111], v[64:67]
    ds_read_b128 v[104:107], v15 offset:5632
    s_waitcnt lgkmcnt(4)
    v_mfma_f32_16x16x32_bf16 v[64:67], a[96:99], v[80:83], v[64:67]
    ds_read_b128 v[108:111], v15 offset:5664
    v_mfma_f32_16x16x32_bf16 v[68:71], v[80:83], a[224:227], v[68:71]
    s_waitcnt lgkmcnt(4)
    v_mfma_f32_16x16x32_bf16 v[64:67], a[100:103], v[84:87], v[64:67]
    ds_read_b128 v[80:83], v15 offset:7680
    s_waitcnt lgkmcnt(4)
    v_mfma_f32_16x16x32_bf16 v[64:67], a[104:107], v[88:91], v[64:67]
    ds_read_b128 v[84:87], v15 offset:7712
    s_waitcnt lgkmcnt(4)
    v_mfma_f32_16x16x32_bf16 v[64:67], a[108:111], v[92:95], v[64:67]
    ds_read_b128 v[88:91], v15 offset:32
    v_mfma_f32_16x16x32_bf16 v[68:71], v[92:95], a[236:239], v[68:71]
    s_waitcnt lgkmcnt(4)
    v_mfma_f32_16x16x32_bf16 v[64:67], a[112:115], v[104:107], v[64:67]
    ds_read_b128 v[92:95], v15 offset:2048
    s_waitcnt lgkmcnt(4)
    v_mfma_f32_16x16x32_bf16 v[64:67], a[116:119], v[108:111], v[64:67]
    ds_read_b128 v[104:107], v15 offset:4096
    s_waitcnt lgkmcnt(4)
    v_mfma_f32_16x16x32_bf16 v[64:67], a[120:123], v[80:83], v[64:67]
    ds_read_b128 v[108:111], v15 offset:4128
    v_mfma_f32_16x16x32_bf16 v[68:71], v[80:83], a[248:251], v[68:71]
    s_waitcnt lgkmcnt(4)
    v_mfma_f32_16x16x32_bf16 v[64:67], a[124:127], v[84:87], v[64:67]
    ds_read_b128 v[80:83], v15 offset:6176
    s_waitcnt lgkmcnt(4)
    v_mfma_f32_16x16x32_bf16 v[68:71], v[88:91], a[132:135], v[68:71]
    ds_read_b128 v[84:87], v15 offset:544
    s_waitcnt lgkmcnt(4)
    v_mfma_f32_16x16x32_bf16 v[68:71], v[92:95], a[136:139], v[68:71]
    ds_read_b128 v[88:91], v15 offset:2560
    v_cvt_pk_bf16_f32 v64, v64, v65
    v_cvt_pk_bf16_f32 v65, v66, v67
    ds_write_b64 v18, v[64:65]
    ds_read_b128 v[72:75], v19 offset:0
    ds_read_b128 v[76:79], v19 offset:256
    s_waitcnt lgkmcnt(7)
    v_mfma_f32_16x16x32_bf16 v[68:71], v[104:107], a[144:147], v[68:71]
    ds_read_b128 v[92:95], v15 offset:4608
    s_waitcnt lgkmcnt(7)
    v_mfma_f32_16x16x32_bf16 v[68:71], v[108:111], a[148:151], v[68:71]
    ds_read_b128 v[104:107], v15 offset:4640
    s_waitcnt lgkmcnt(7)
    v_mfma_f32_16x16x32_bf16 v[68:71], v[80:83], a[156:159], v[68:71]
    ds_read_b128 v[108:111], v15 offset:6688
    s_waitcnt lgkmcnt(7)
    v_mfma_f32_16x16x32_bf16 v[68:71], v[84:87], a[164:167], v[68:71]
    ds_read_b128 v[80:83], v15 offset:1056
    s_waitcnt lgkmcnt(7)
    v_mfma_f32_16x16x32_bf16 v[68:71], v[88:91], a[168:171], v[68:71]
    ds_read_b128 v[84:87], v15 offset:3072
    s_waitcnt lgkmcnt(5)
    v_mfma_f32_32x32x16_bf16 v[32:47], v[72:75], v[96:99], 0
    v_mfma_f32_32x32x16_bf16 v[32:47], v[76:79], v[100:103], v[32:47]
    s_waitcnt lgkmcnt(4)
    v_mfma_f32_16x16x32_bf16 v[68:71], v[92:95], a[176:179], v[68:71]
    ds_read_b128 v[88:91], v15 offset:5120
    s_waitcnt lgkmcnt(4)
    v_mfma_f32_16x16x32_bf16 v[68:71], v[104:107], a[180:183], v[68:71]
    ds_read_b128 v[92:95], v15 offset:5152
    s_waitcnt lgkmcnt(4)
    v_mfma_f32_16x16x32_bf16 v[68:71], v[108:111], a[188:191], v[68:71]
    ds_read_b128 v[104:107], v15 offset:7200
    ds_write_b128 v2, v[32:35] offset:12288
    s_waitcnt lgkmcnt(5)
    v_mfma_f32_16x16x32_bf16 v[68:71], v[80:83], a[196:199], v[68:71]
    ds_read_b128 v[108:111], v15 offset:1568
    s_waitcnt lgkmcnt(5)
    v_mfma_f32_16x16x32_bf16 v[68:71], v[84:87], a[200:203], v[68:71]
    ds_read_b128 v[80:83], v15 offset:3584
    s_waitcnt lgkmcnt(5)
    v_mfma_f32_16x16x32_bf16 v[68:71], v[88:91], a[208:211], v[68:71]
    ds_read_b128 v[84:87], v15 offset:5632
    s_waitcnt lgkmcnt(5)
    v_mfma_f32_16x16x32_bf16 v[68:71], v[92:95], a[212:215], v[68:71]
    ds_read_b128 v[88:91], v15 offset:5664
    s_waitcnt lgkmcnt(4)
    s_barrier
    ds_read_b128 v[112:115], v16 offset:12288
    ds_read_b128 v[116:119], v16 offset:13312
    ds_read_b128 v[120:123], v16 offset:14336
    ds_read_b128 v[124:127], v16 offset:15360
    v_mfma_f32_16x16x32_bf16 v[68:71], v[104:107], a[220:223], v[68:71]
    ds_read_b128 v[92:95], v15 offset:7712
    s_add_u32 s70, s70, 24576
    s_add_u32 s29, s29, 3
    s_waitcnt lgkmcnt(8)
    v_mfma_f32_16x16x32_bf16 v[68:71], v[108:111], a[228:231], v[68:71]
    s_add_u32 s65, s65, 48
    s_add_u32 s33, s33, 24576
    s_waitcnt lgkmcnt(7)
    v_mfma_f32_16x16x32_bf16 v[68:71], v[80:83], a[232:235], v[68:71]
    s_cmp_eq_u32 s33, 139264
    s_cselect_b32 s33, 65536, s33
    s_waitcnt lgkmcnt(6)
    v_mfma_f32_16x16x32_bf16 v[68:71], v[84:87], a[240:243], v[68:71]
    s_waitcnt lgkmcnt(5)
    v_mfma_f32_16x16x32_bf16 v[68:71], v[88:91], a[244:247], v[68:71]
    s_waitcnt lgkmcnt(0)
    v_mfma_f32_16x16x32_bf16 v[68:71], v[92:95], a[252:255], v[68:71]
    v_pk_add_f32 v[112:113], v[112:113], v[116:117]
    v_pk_add_f32 v[114:115], v[114:115], v[118:119]
    v_pk_add_f32 v[120:121], v[120:121], v[124:125]
    v_pk_add_f32 v[122:123], v[122:123], v[126:127]
    v_pk_add_f32 v[112:113], v[112:113], v[120:121]
    v_pk_add_f32 v[114:115], v[114:115], v[122:123]
    v_max_f32 v4, v112, v113
    v_max3_f32 v5, v4, v114, v115
    v_max3_f32 v4, v4, v114, v115
    v_cvt_pk_bf16_f32 v30, v68, v69
    v_cvt_pk_bf16_f32 v31, v70, v71
    v_permlane32_swap_b32 v4, v5
    v_max_f32 v4, v4, v5
    v_mul_f32 v4, s71, v4
    v_max_f32 v4, v4, v6
    v_sub_f32 v6, v6, v4
    v_pk_fma_f32 v[112:113], v[112:113], s[74:75], v[4:5] op_sel_hi:[1,1,0] neg_lo:[0,0,1] neg_hi:[0,0,1]
    v_pk_fma_f32 v[114:115], v[114:115], s[74:75], v[4:5] op_sel_hi:[1,1,0] neg_lo:[0,0,1] neg_hi:[0,0,1]
    v_exp_f32 v6, v6
    v_exp_f32 v112, v112
    v_exp_f32 v113, v113
    v_exp_f32 v114, v114
    v_exp_f32 v115, v115
    v_fma_f32 v7, v7, v6, v112
    v_cvt_pk_bf16_f32 v28, v112, v113
    v_cvt_pk_bf16_f32 v29, v114, v115
    v_add_f32 v7, v7, v113
    v_add_f32 v5, v114, v115
    v_mfma_f32_32x32x8_bf16 v[32:47], v[30:31], v[28:29], 0
    v_add_f32 v4, v7, v5
    v_add_f32 v5, v7, v5
    s_nop 1
    v_permlane32_swap_b32 v4, v5
    v_add_f32 v4, v4, v5
    v_rcp_f32 v4, v4
    s_nop 3
    v_pk_fma_f32 v[48:49], v[48:49], v[6:7], v[32:33] op_sel_hi:[1,0,1]
    v_pk_fma_f32 v[50:51], v[50:51], v[6:7], v[34:35] op_sel_hi:[1,0,1]
    v_pk_fma_f32 v[52:53], v[52:53], v[6:7], v[36:37] op_sel_hi:[1,0,1]
    v_pk_fma_f32 v[54:55], v[54:55], v[6:7], v[38:39] op_sel_hi:[1,0,1]
    v_pk_mul_f32 v[48:49], v[48:49], v[4:5] op_sel_hi:[1,0]
    v_pk_mul_f32 v[50:51], v[50:51], v[4:5] op_sel_hi:[1,0]
    v_pk_mul_f32 v[52:53], v[52:53], v[4:5] op_sel_hi:[1,0]
    v_pk_mul_f32 v[54:55], v[54:55], v[4:5] op_sel_hi:[1,0]
    v_cvt_pk_bf16_f32 v20, v48, v49
    v_cvt_pk_bf16_f32 v21, v50, v51
    v_cvt_pk_bf16_f32 v22, v52, v53
    v_cvt_pk_bf16_f32 v23, v54, v55
    buffer_store_dwordx4 v[20:23], v14, s[4:7], s66 offen offset:0 sc1
    v_pk_fma_f32 v[56:57], v[56:57], v[6:7], v[40:41] op_sel_hi:[1,0,1]
    v_pk_fma_f32 v[58:59], v[58:59], v[6:7], v[42:43] op_sel_hi:[1,0,1]
    v_pk_fma_f32 v[60:61], v[60:61], v[6:7], v[44:45] op_sel_hi:[1,0,1]
    v_pk_fma_f32 v[62:63], v[62:63], v[6:7], v[46:47] op_sel_hi:[1,0,1]
    v_pk_mul_f32 v[56:57], v[56:57], v[4:5] op_sel_hi:[1,0]
    v_pk_mul_f32 v[58:59], v[58:59], v[4:5] op_sel_hi:[1,0]
    v_pk_mul_f32 v[60:61], v[60:61], v[4:5] op_sel_hi:[1,0]
    v_pk_mul_f32 v[62:63], v[62:63], v[4:5] op_sel_hi:[1,0]
    v_cvt_pk_bf16_f32 v24, v56, v57
    v_cvt_pk_bf16_f32 v25, v58, v59
    v_cvt_pk_bf16_f32 v26, v60, v61
    v_cvt_pk_bf16_f32 v27, v62, v63
    buffer_store_dwordx4 v[24:27], v14, s[4:7], s66 offen offset:512 sc1
    s_add_u32 s66, s66, 1179648
    s_cmp_lt_u32 s28, 64
    s_cbranch_scc1 QA_A
    s_waitcnt vmcnt(0)
    s_barrier
    s_cmp_lg_u32 s25, 0
    s_cbranch_scc1 QA_one
    v_lshrrev_b32 v4, 2, v1
    s_mov_b64 exec, 15
    buffer_store_dword v17, v4, s[4:7], s72 offen sc1
    s_mov_b64 exec, -1
QA_one:
    s_add_u32 s72, s72, 0x10000
    v_mov_b32 v120, -1
    s_cmp_lt_u32 s29, 64
    s_cbranch_scc1 QA_B
    s_branch L_END
QA_go:
    s_mov_b32 s35, 0
QA_go2:
    global_load_dword v9, v8, s[60:61] sc1
    s_waitcnt vmcnt(0)
    v_cmp_eq_u32 vcc, 0, v9
    s_cbranch_vccz QA_go2_ok
    s_sleep 4
    s_add_u32 s35, s35, 1
    s_cmp_lt_u32 s35, 131072
    s_cbranch_scc1 QA_go2
    s_branch L_END
QA_go2_ok:
    s_branch QA_gook
ROLE_FU:
    s_sub_u32 s67, s24, 24
    s_and_b32 s27, s67, 1
    s_lshr_b32 s67, s67, 1
    s_lshl_b32 s67, s67, 2
    s_add_u32 s26, s67, s3
    s_sub_u32 s26, s26, 1
    s_cmp_ge_u32 s26, 11
    s_cbranch_scc1 L_END
    s_lshl_b32 s30, s26, 8
    v_lshlrev_b32 v1, 4, v0
    s_mov_b32 s8, s52
    s_mov_b32 s9, s53
    s_mov_b32 s10, 0x158000
    s_mov_b32 s11, 0x20000
    s_mov_b32 s12, s54
    s_mov_b32 s13, s55
    s_mov_b32 s14, 0x158000
    s_mov_b32 s15, 0x20000
    v_mov_b32 v3, 136
    s_mov_b32 s35, 0
FU_w:
    global_load_dword v4, v3, s[60:61] sc1
    s_waitcnt vmcnt(0)
    v_cmp_eq_u32 vcc, 0, v4
    s_cbranch_vccz FU_w_ok
    s_sleep 4
    s_add_u32 s35, s35, 1
    s_cmp_lt_u32 s35, 131072
    s_cbranch_scc1 FU_w
    s_branch L_END
FU_w_ok:
    v_lshrrev_b32 v2, 4, v0
    v_and_b32 v3, 15, v0
    v_lshlrev_b32 v4, 2, v2
    v_xor_b32 v4, v4, v3
    v_lshlrev_b32 v4, 4, v4
    s_lshl_b32 s67, s25, 4
    v_add_u32 v5, s67, v2
    v_mul_u32_u24 v5, 2752, v5
    v_add_u32 v4, v4, v5
    v_add_u32 v4, s30, v4
    v_bfe_u32 v5, v0, 2, 2
    v_lshrrev_b32 v6, 5, v0
    v_lshl_add_u32 v6, v6, 3, v5
    v_lshlrev_b32 v6, 8, v6
    v_xor_b32 v5, s25, v5
    v_lshl_add_u32 v6, v5, 6, v6
    v_bfe_u32 v5, v0, 4, 1
    v_lshl_add_u32 v6, v5, 5, v6
    v_and_b32 v5, 3, v0
    v_lshl_add_u32 v6, v5, 3, v6
    v_add_u32 v7, 0x10000, v6
    s_lshl_b32 s69, s25, 12
    s_add_u32 m0, s69, 0
    s_mov_b32 s67, 0
    buffer_load_dwordx4 v4, s[8:11], s67 offen lds
    s_add_u32 m0, s69, 1024
    s_mov_b32 s67, 11008
    buffer_load_dwordx4 v4, s[8:11], s67 offen lds
    s_add_u32 m0, s69, 2048
    s_mov_b32 s67, 22016
    buffer_load_dwordx4 v4, s[8:11], s67 offen lds
    s_add_u32 m0, s69, 3072
    s_mov_b32 s67, 33024
    buffer_load_dwordx4 v4, s[8:11], s67 offen lds
    s_add_u32 m0, s69, 16384
    s_mov_b32 s67, 176128
    buffer_load_dwordx4 v4, s[8:11], s67 offen lds
    s_add_u32 m0, s69, 17408
    s_mov_b32 s67, 187136
    buffer_load_dwordx4 v4, s[8:11], s67 offen lds
    s_add_u32 m0, s69, 18432
    s_mov_b32 s67, 198144
    buffer_load_dwordx4 v4, s[8:11], s67 offen lds
    s_add_u32 m0, s69, 19456
    s_mov_b32 s67, 209152
    buffer_load_dwordx4 v4, s[8:11], s67 offen lds
    s_add_u32 m0, s69, 32768
    s_mov_b32 s67, 352256
    buffer_load_dwordx4 v4, s[8:11], s67 offen lds
    s_add_u32 m0, s69, 33792
    s_mov_b32 s67, 363264
    buffer_load_dwordx4 v4, s[8:11], s67 offen lds
    s_add_u32 m0, s69, 34816
    s_mov_b32 s67, 374272
    buffer_load_dwordx4 v4, s[8:11], s67 offen lds
    s_add_u32 m0, s69, 35840
    s_mov_b32 s67, 385280
    buffer_load_dwordx4 v4, s[8:11], s67 offen lds
    s_add_u32 m0, s69, 49152
    s_mov_b32 s67, 528384
    buffer_load_dwordx4 v4, s[8:11], s67 offen lds
    s_add_u32 m0, s69, 50176
    s_mov_b32 s67, 539392
    buffer_load_dwordx4 v4, s[8:11], s67 offen lds
    s_add_u32 m0, s69, 51200
    s_mov_b32 s67, 550400
    buffer_load_dwordx4 v4, s[8:11], s67 offen lds
    s_add_u32 m0, s69, 52224
    s_mov_b32 s67, 561408
    buffer_load_dwordx4 v4, s[8:11], s67 offen lds
    s_add_u32 m0, s69, 65536
    s_mov_b32 s67, 704512
    buffer_load_dwordx4 v4, s[8:11], s67 offen lds
    s_add_u32 m0, s69, 66560
    s_mov_b32 s67, 715520
    buffer_load_dwordx4 v4, s[8:11], s67 offen lds
    s_add_u32 m0, s69, 67584
    s_mov_b32 s67, 726528
    buffer_load_dwordx4 v4, s[8:11], s67 offen lds
    s_add_u32 m0, s69, 68608
    s_mov_b32 s67, 737536
    buffer_load_dwordx4 v4, s[8:11], s67 offen lds
    s_add_u32 m0, s69, 81920
    s_mov_b32 s67, 880640
    buffer_load_dwordx4 v4, s[8:11], s67 offen lds
    s_add_u32 m0, s69, 82944
    s_mov_b32 s67, 891648
    buffer_load_dwordx4 v4, s[8:11], s67 offen lds
    s_add_u32 m0, s69, 83968
    s_mov_b32 s67, 902656
    buffer_load_dwordx4 v4, s[8:11], s67 offen lds
    s_add_u32 m0, s69, 84992
    s_mov_b32 s67, 913664
    buffer_load_dwordx4 v4, s[8:11], s67 offen lds
    s_add_u32 m0, s69, 98304
    s_mov_b32 s67, 1056768
    buffer_load_dwordx4 v4, s[8:11], s67 offen lds
    s_add_u32 m0, s69, 99328
    s_mov_b32 s67, 1067776
    buffer_load_dwordx4 v4, s[8:11], s67 offen lds
    s_add_u32 m0, s69, 100352
    s_mov_b32 s67, 1078784
    buffer_load_dwordx4 v4, s[8:11], s67 offen lds
    s_add_u32 m0, s69, 101376
    s_mov_b32 s67, 1089792
    buffer_load_dwordx4 v4, s[8:11], s67 offen lds
    s_add_u32 m0, s69, 114688
    s_mov_b32 s67, 1232896
    buffer_load_dwordx4 v4, s[8:11], s67 offen lds
    s_add_u32 m0, s69, 115712
    s_mov_b32 s67, 1243904
    buffer_load_dwordx4 v4, s[8:11], s67 offen lds
    s_add_u32 m0, s69, 116736
    s_mov_b32 s67, 1254912
    buffer_load_dwordx4 v4, s[8:11], s67 offen lds
    s_add_u32 m0, s69, 117760
    s_mov_b32 s67, 1265920
    buffer_load_dwordx4 v4, s[8:11], s67 offen lds
    s_waitcnt vmcnt(28)
    s_barrier
    ds_read_b64_tr_b16 a[0:1], v6 offset:0
    ds_read_b64_tr_b16 a[2:3], v6 offset:1024
    ds_read_b64_tr_b16 a[4:5], v6 offset:4096
    ds_read_b64_tr_b16 a[6:7], v6 offset:5120
    ds_read_b64_tr_b16 a[8:9], v6 offset:8192
    ds_read_b64_tr_b16 a[10:11], v6 offset:9216
    ds_read_b64_tr_b16 a[12:13], v6 offset:12288
    ds_read_b64_tr_b16 a[14:15], v6 offset:13312
    s_waitcnt lgkmcnt(0)
    s_waitcnt vmcnt(24)
    s_barrier
    s_add_u32 m0, s69, 0
    s_mov_b32 s67, 0
    buffer_load_dwordx4 v4, s[12:15], s67 offen lds
    s_add_u32 m0, s69, 1024
    s_mov_b32 s67, 11008
    buffer_load_dwordx4 v4, s[12:15], s67 offen lds
    s_add_u32 m0, s69, 2048
    s_mov_b32 s67, 22016
    buffer_load_dwordx4 v4, s[12:15], s67 offen lds
    s_add_u32 m0, s69, 3072
    s_mov_b32 s67, 33024
    buffer_load_dwordx4 v4, s[12:15], s67 offen lds
    ds_read_b64_tr_b16 a[16:17], v6 offset:16384
    ds_read_b64_tr_b16 a[18:19], v6 offset:17408
    ds_read_b64_tr_b16 a[20:21], v6 offset:20480
    ds_read_b64_tr_b16 a[22:23], v6 offset:21504
    ds_read_b64_tr_b16 a[24:25], v6 offset:24576
    ds_read_b64_tr_b16 a[26:27], v6 offset:25600
    ds_read_b64_tr_b16 a[28:29], v6 offset:28672
    ds_read_b64_tr_b16 a[30:31], v6 offset:29696
    s_waitcnt lgkmcnt(0)
    s_waitcnt vmcnt(24)
    s_barrier
    s_add_u32 m0, s69, 16384
    s_mov_b32 s67, 176128
    buffer_load_dwordx4 v4, s[12:15], s67 offen lds
    s_add_u32 m0, s69, 17408
    s_mov_b32 s67, 187136
    buffer_load_dwordx4 v4, s[12:15], s67 offen lds
    s_add_u32 m0, s69, 18432
    s_mov_b32 s67, 198144
    buffer_load_dwordx4 v4, s[12:15], s67 offen lds
    s_add_u32 m0, s69, 19456
    s_mov_b32 s67, 209152
    buffer_load_dwordx4 v4, s[12:15], s67 offen lds
    ds_read_b64_tr_b16 a[32:33], v6 offset:32768
    ds_read_b64_tr_b16 a[34:35], v6 offset:33792
    ds_read_b64_tr_b16 a[36:37], v6 offset:36864
    ds_read_b64_tr_b16 a[38:39], v6 offset:37888
    ds_read_b64_tr_b16 a[40:41], v6 offset:40960
    ds_read_b64_tr_b16 a[42:43], v6 offset:41984
    ds_read_b64_tr_b16 a[44:45], v6 offset:45056
    ds_read_b64_tr_b16 a[46:47], v6 offset:46080
    s_waitcnt lgkmcnt(0)
    s_waitcnt vmcnt(24)
    s_barrier
    s_add_u32 m0, s69, 32768
    s_mov_b32 s67, 352256
    buffer_load_dwordx4 v4, s[12:15], s67 offen lds
    s_add_u32 m0, s69, 33792
    s_mov_b32 s67, 363264
    buffer_load_dwordx4 v4, s[12:15], s67 offen lds
    s_add_u32 m0, s69, 34816
    s_mov_b32 s67, 374272
    buffer_load_dwordx4 v4, s[12:15], s67 offen lds
    s_add_u32 m0, s69, 35840
    s_mov_b32 s67, 385280
    buffer_load_dwordx4 v4, s[12:15], s67 offen lds
    ds_read_b64_tr_b16 a[48:49], v6 offset:49152
    ds_read_b64_tr_b16 a[50:51], v6 offset:50176
    ds_read_b64_tr_b16 a[52:53], v6 offset:53248
    ds_read_b64_tr_b16 a[54:55], v6 offset:54272
    ds_read_b64_tr_b16 a[56:57], v6 offset:57344
    ds_read_b64_tr_b16 a[58:59], v6 offset:58368
    ds_read_b64_tr_b16 a[60:61], v6 offset:61440
    ds_read_b64_tr_b16 a[62:63], v6 offset:62464
    s_waitcnt lgkmcnt(0)
    s_waitcnt vmcnt(24)
    s_barrier
    s_add_u32 m0, s69, 49152
    s_mov_b32 s67, 528384
    buffer_load_dwordx4 v4, s[12:15], s67 offen lds
    s_add_u32 m0, s69, 50176
    s_mov_b32 s67, 539392
    buffer_load_dwordx4 v4, s[12:15], s67 offen lds
    s_add_u32 m0, s69, 51200
    s_mov_b32 s67, 550400
    buffer_load_dwordx4 v4, s[12:15], s67 offen lds
    s_add_u32 m0, s69, 52224
    s_mov_b32 s67, 561408
    buffer_load_dwordx4 v4, s[12:15], s67 offen lds
    ds_read_b64_tr_b16 a[64:65], v7 offset:0
    ds_read_b64_tr_b16 a[66:67], v7 offset:1024
    ds_read_b64_tr_b16 a[68:69], v7 offset:4096
    ds_read_b64_tr_b16 a[70:71], v7 offset:5120
    ds_read_b64_tr_b16 a[72:73], v7 offset:8192
    ds_read_b64_tr_b16 a[74:75], v7 offset:9216
    ds_read_b64_tr_b16 a[76:77], v7 offset:12288
    ds_read_b64_tr_b16 a[78:79], v7 offset:13312
    s_waitcnt lgkmcnt(0)
    s_waitcnt vmcnt(24)
    s_barrier
    s_add_u32 m0, s69, 65536
    s_mov_b32 s67, 704512
    buffer_load_dwordx4 v4, s[12:15], s67 offen lds
    s_add_u32 m0, s69, 66560
    s_mov_b32 s67, 715520
    buffer_load_dwordx4 v4, s[12:15], s67 offen lds
    s_add_u32 m0, s69, 67584
    s_mov_b32 s67, 726528
    buffer_load_dwordx4 v4, s[12:15], s67 offen lds
    s_add_u32 m0, s69, 68608
    s_mov_b32 s67, 737536
    buffer_load_dwordx4 v4, s[12:15], s67 offen lds
    ds_read_b64_tr_b16 a[80:81], v7 offset:16384
    ds_read_b64_tr_b16 a[82:83], v7 offset:17408
    ds_read_b64_tr_b16 a[84:85], v7 offset:20480
    ds_read_b64_tr_b16 a[86:87], v7 offset:21504
    ds_read_b64_tr_b16 a[88:89], v7 offset:24576
    ds_read_b64_tr_b16 a[90:91], v7 offset:25600
    ds_read_b64_tr_b16 a[92:93], v7 offset:28672
    ds_read_b64_tr_b16 a[94:95], v7 offset:29696
    s_waitcnt lgkmcnt(0)
    s_waitcnt vmcnt(24)
    s_barrier
    s_add_u32 m0, s69, 81920
    s_mov_b32 s67, 880640
    buffer_load_dwordx4 v4, s[12:15], s67 offen lds
    s_add_u32 m0, s69, 82944
    s_mov_b32 s67, 891648
    buffer_load_dwordx4 v4, s[12:15], s67 offen lds
    s_add_u32 m0, s69, 83968
    s_mov_b32 s67, 902656
    buffer_load_dwordx4 v4, s[12:15], s67 offen lds
    s_add_u32 m0, s69, 84992
    s_mov_b32 s67, 913664
    buffer_load_dwordx4 v4, s[12:15], s67 offen lds
    ds_read_b64_tr_b16 a[96:97], v7 offset:32768
    ds_read_b64_tr_b16 a[98:99], v7 offset:33792
    ds_read_b64_tr_b16 a[100:101], v7 offset:36864
    ds_read_b64_tr_b16 a[102:103], v7 offset:37888
    ds_read_b64_tr_b16 a[104:105], v7 offset:40960
    ds_read_b64_tr_b16 a[106:107], v7 offset:41984
    ds_read_b64_tr_b16 a[108:109], v7 offset:45056
    ds_read_b64_tr_b16 a[110:111], v7 offset:46080
    s_waitcnt lgkmcnt(0)
    s_waitcnt vmcnt(24)
    s_barrier
    s_add_u32 m0, s69, 98304
    s_mov_b32 s67, 1056768
    buffer_load_dwordx4 v4, s[12:15], s67 offen lds
    s_add_u32 m0, s69, 99328
    s_mov_b32 s67, 1067776
    buffer_load_dwordx4 v4, s[12:15], s67 offen lds
    s_add_u32 m0, s69, 100352
    s_mov_b32 s67, 1078784
    buffer_load_dwordx4 v4, s[12:15], s67 offen lds
    s_add_u32 m0, s69, 101376
    s_mov_b32 s67, 1089792
    buffer_load_dwordx4 v4, s[12:15], s67 offen lds
    ds_read_b64_tr_b16 a[112:113], v7 offset:49152
    ds_read_b64_tr_b16 a[114:115], v7 offset:50176
    ds_read_b64_tr_b16 a[116:117], v7 offset:53248
    ds_read_b64_tr_b16 a[118:119], v7 offset:54272
    ds_read_b64_tr_b16 a[120:121], v7 offset:57344
    ds_read_b64_tr_b16 a[122:123], v7 offset:58368
    ds_read_b64_tr_b16 a[124:125], v7 offset:61440
    ds_read_b64_tr_b16 a[126:127], v7 offset:62464
    s_waitcnt lgkmcnt(0)
    s_waitcnt vmcnt(24)
    s_barrier
    s_add_u32 m0, s69, 114688
    s_mov_b32 s67, 1232896
    buffer_load_dwordx4 v4, s[12:15], s67 offen lds
    s_add_u32 m0, s69, 115712
    s_mov_b32 s67, 1243904
    buffer_load_dwordx4 v4, s[12:15], s67 offen lds
    s_add_u32 m0, s69, 116736
    s_mov_b32 s67, 1254912
    buffer_load_dwordx4 v4, s[12:15], s67 offen lds
    s_add_u32 m0, s69, 117760
    s_mov_b32 s67, 1265920
    buffer_load_dwordx4 v4, s[12:15], s67 offen lds
    ds_read_b64_tr_b16 a[128:129], v6 offset:0
    ds_read_b64_tr_b16 a[130:131], v6 offset:1024
    ds_read_b64_tr_b16 a[132:133], v6 offset:4096
    ds_read_b64_tr_b16 a[134:135], v6 offset:5120
    ds_read_b64_tr_b16 a[136:137], v6 offset:8192
    ds_read_b64_tr_b16 a[138:139], v6 offset:9216
    ds_read_b64_tr_b16 a[140:141], v6 offset:12288
    ds_read_b64_tr_b16 a[142:143], v6 offset:13312
    s_waitcnt lgkmcnt(0)
    s_waitcnt vmcnt(24)
    s_barrier
    ds_read_b64_tr_b16 a[144:145], v6 offset:16384
    ds_read_b64_tr_b16 a[146:147], v6 offset:17408
    ds_read_b64_tr_b16 a[148:149], v6 offset:20480
    ds_read_b64_tr_b16 a[150:151], v6 offset:21504
    ds_read_b64_tr_b16 a[152:153], v6 offset:24576
    ds_read_b64_tr_b16 a[154:155], v6 offset:25600
    ds_read_b64_tr_b16 a[156:157], v6 offset:28672
    ds_read_b64_tr_b16 a[158:159], v6 offset:29696
    s_waitcnt lgkmcnt(0)
    s_waitcnt vmcnt(20)
    s_barrier
    ds_read_b64_tr_b16 a[160:161], v6 offset:32768
    ds_read_b64_tr_b16 a[162:163], v6 offset:33792
    ds_read_b64_tr_b16 a[164:165], v6 offset:36864
    ds_read_b64_tr_b16 a[166:167], v6 offset:37888
    ds_read_b64_tr_b16 a[168:169], v6 offset:40960
    ds_read_b64_tr_b16 a[170:171], v6 offset:41984
    ds_read_b64_tr_b16 a[172:173], v6 offset:45056
    ds_read_b64_tr_b16 a[174:175], v6 offset:46080
    s_waitcnt lgkmcnt(0)
    s_waitcnt vmcnt(16)
    s_barrier
    ds_read_b64_tr_b16 a[176:177], v6 offset:49152
    ds_read_b64_tr_b16 a[178:179], v6 offset:50176
    ds_read_b64_tr_b16 a[180:181], v6 offset:53248
    ds_read_b64_tr_b16 a[182:183], v6 offset:54272
    ds_read_b64_tr_b16 a[184:185], v6 offset:57344
    ds_read_b64_tr_b16 a[186:187], v6 offset:58368
    ds_read_b64_tr_b16 a[188:189], v6 offset:61440
    ds_read_b64_tr_b16 a[190:191], v6 offset:62464
    s_waitcnt lgkmcnt(0)
    s_waitcnt vmcnt(12)
    s_barrier
    ds_read_b64_tr_b16 a[192:193], v7 offset:0
    ds_read_b64_tr_b16 a[194:195], v7 offset:1024
    ds_read_b64_tr_b16 a[196:197], v7 offset:4096
    ds_read_b64_tr_b16 a[198:199], v7 offset:5120
    ds_read_b64_tr_b16 a[200:201], v7 offset:8192
    ds_read_b64_tr_b16 a[202:203], v7 offset:9216
    ds_read_b64_tr_b16 a[204:205], v7 offset:12288
    ds_read_b64_tr_b16 a[206:207], v7 offset:13312
    s_waitcnt lgkmcnt(0)
    s_waitcnt vmcnt(8)
    s_barrier
    ds_read_b64_tr_b16 a[208:209], v7 offset:16384
    ds_read_b64_tr_b16 a[210:211], v7 offset:17408
    ds_read_b64_tr_b16 a[212:213], v7 offset:20480
    ds_read_b64_tr_b16 a[214:215], v7 offset:21504
    ds_read_b64_tr_b16 a[216:217], v7 offset:24576
    ds_read_b64_tr_b16 a[218:219], v7 offset:25600
    ds_read_b64_tr_b16 a[220:221], v7 offset:28672
    ds_read_b64_tr_b16 a[222:223], v7 offset:29696
    s_waitcnt lgkmcnt(0)
    s_waitcnt vmcnt(4)
    s_barrier
    ds_read_b64_tr_b16 a[224:225], v7 offset:32768
    ds_read_b64_tr_b16 a[226:227], v7 offset:33792
    ds_read_b64_tr_b16 a[228:229], v7 offset:36864
    ds_read_b64_tr_b16 a[230:231], v7 offset:37888
    ds_read_b64_tr_b16 a[232:233], v7 offset:40960
    ds_read_b64_tr_b16 a[234:235], v7 offset:41984
    ds_read_b64_tr_b16 a[236:237], v7 offset:45056
    ds_read_b64_tr_b16 a[238:239], v7 offset:46080
    s_waitcnt lgkmcnt(0)
    s_waitcnt vmcnt(0)
    s_barrier
    ds_read_b64_tr_b16 a[240:241], v7 offset:49152
    ds_read_b64_tr_b16 a[242:243], v7 offset:50176
    ds_read_b64_tr_b16 a[244:245], v7 offset:53248
    ds_read_b64_tr_b16 a[246:247], v7 offset:54272
    ds_read_b64_tr_b16 a[248:249], v7 offset:57344
    ds_read_b64_tr_b16 a[250:251], v7 offset:58368
    ds_read_b64_tr_b16 a[252:253], v7 offset:61440
    ds_read_b64_tr_b16 a[254:255], v7 offset:62464
    s_waitcnt lgkmcnt(0)
    s_barrier
    v_lshrrev_b32 v2, 5, v0
    v_lshlrev_b32 v4, 8, v2
    v_and_b32 v8, 15, v0
    v_lshl_add_u32 v5, v8, 4, v4
    v_bfe_u32 v6, v0, 4, 1
    v_mul_u32_u24 v6, 196608, v6
    v_add_u32 v11, v5, v6
    v_mov_b32 v12, 1
    s_lshl_b32 s67, s26, 2
    s_add_u32 s67, s67, s25
    s_lshl_b32 s33, s67, 2
    s_lshl_b32 s67, s67, 10
    s_mul_i32 s32, s27, 393216
    s_add_u32 s32, s32, s67
    s_add_u32 s32, s32, 52559872
    s_lshl_b32 s67, s27, 8
    s_add_u32 s33, s33, s67
    s_add_u32 s33, s33, 65536
    s_mov_b32 s34, 0xbfb8aa3b
    s_mov_b32 s28, 0
    s_mov_b32 s30, 0
    s_mov_b32 s31, s27
    s_lshl_b32 s29, s33, 4
    s_and_b32 s29, s29, 0x3fff
    s_add_u32 s29, s29, 0x14000
    s_lshl_b32 s67, s31, 15
    s_lshl_b32 s68, s25, 13
    s_add_u32 s67, s67, s68
    s_add_u32 s67, s67, 1048576
    s_add_u32 s68, s68, s30
    s_mov_b32 m0, s68
    s_nop 0
    buffer_load_dwordx4 v1, s[4:7], s67 offen offset:0 sc1 lds
    buffer_load_dwordx4 v1, s[4:7], s67 offen offset:1024 sc1 lds
    buffer_load_dwordx4 v1, s[4:7], s67 offen offset:2048 sc1 lds
    buffer_load_dwordx4 v1, s[4:7], s67 offen offset:3072 sc1 lds
    s_add_u32 s67, s67, 0x1000
    s_add_u32 s68, s68, 0x1000
    s_mov_b32 m0, s68
    s_nop 0
    buffer_load_dwordx4 v1, s[4:7], s67 offen offset:0 sc1 lds
    buffer_load_dwordx4 v1, s[4:7], s67 offen offset:1024 sc1 lds
    buffer_load_dwordx4 v1, s[4:7], s67 offen offset:2048 sc1 lds
    buffer_load_dwordx4 v1, s[4:7], s67 offen offset:3072 sc1 lds
    s_waitcnt vmcnt(0)
    s_barrier
FU_A:
    v_add_u32 v10, s30, v1
    s_xor_b32 s30, s30, 0x8000
    s_add_u32 s31, s31, 2
    s_min_u32 s31, s31, 63
    ds_read_b128 v[64:67], v10 offset:0
    ds_read_b128 v[68:71], v10 offset:1024
    ds_read_b128 v[72:75], v10 offset:2048
    s_waitcnt lgkmcnt(2)
    v_mfma_f32_32x32x16_bf16 v[32:47], a[0:3], v[64:67], 0
    ds_read_b128 v[76:79], v10 offset:3072
    v_mfma_f32_32x32x16_bf16 v[48:63], a[128:131], v[64:67], 0
    s_waitcnt lgkmcnt(2)
    v_mfma_f32_32x32x16_bf16 v[32:47], a[4:7], v[68:71], v[32:47]
    ds_read_b128 v[64:67], v10 offset:4096
    v_mfma_f32_32x32x16_bf16 v[48:63], a[132:135], v[68:71], v[48:63]
    s_waitcnt lgkmcnt(2)
    v_mfma_f32_32x32x16_bf16 v[32:47], a[8:11], v[72:75], v[32:47]
    ds_read_b128 v[68:71], v10 offset:5120
    v_mfma_f32_32x32x16_bf16 v[48:63], a[136:139], v[72:75], v[48:63]
    s_waitcnt lgkmcnt(2)
    v_mfma_f32_32x32x16_bf16 v[32:47], a[12:15], v[76:79], v[32:47]
    ds_read_b128 v[72:75], v10 offset:6144
    v_mfma_f32_32x32x16_bf16 v[48:63], a[140:143], v[76:79], v[48:63]
    s_waitcnt lgkmcnt(2)
    v_mfma_f32_32x32x16_bf16 v[32:47], a[16:19], v[64:67], v[32:47]
    ds_read_b128 v[76:79], v10 offset:7168
    v_mfma_f32_32x32x16_bf16 v[48:63], a[144:147], v[64:67], v[48:63]
    s_waitcnt lgkmcnt(2)
    v_mfma_f32_32x32x16_bf16 v[32:47], a[20:23], v[68:71], v[32:47]
    ds_read_b128 v[64:67], v10 offset:8192
    v_mfma_f32_32x32x16_bf16 v[48:63], a[148:151], v[68:71], v[48:63]
    s_waitcnt lgkmcnt(2)
    v_mfma_f32_32x32x16_bf16 v[32:47], a[24:27], v[72:75], v[32:47]
    ds_read_b128 v[68:71], v10 offset:9216
    v_mfma_f32_32x32x16_bf16 v[48:63], a[152:155], v[72:75], v[48:63]
    s_waitcnt lgkmcnt(2)
    v_mfma_f32_32x32x16_bf16 v[32:47], a[28:31], v[76:79], v[32:47]
    ds_read_b128 v[72:75], v10 offset:10240
    v_mfma_f32_32x32x16_bf16 v[48:63], a[156:159], v[76:79], v[48:63]
    s_waitcnt lgkmcnt(2)
    v_mfma_f32_32x32x16_bf16 v[32:47], a[32:35], v[64:67], v[32:47]
    ds_read_b128 v[76:79], v10 offset:11264
    v_mfma_f32_32x32x16_bf16 v[48:63], a[160:163], v[64:67], v[48:63]
    s_waitcnt lgkmcnt(2)
    v_mfma_f32_32x32x16_bf16 v[32:47], a[36:39], v[68:71], v[32:47]
    ds_read_b128 v[64:67], v10 offset:12288
    v_mfma_f32_32x32x16_bf16 v[48:63], a[164:167], v[68:71], v[48:63]
    s_waitcnt lgkmcnt(2)
    v_mfma_f32_32x32x16_bf16 v[32:47], a[40:43], v[72:75], v[32:47]
    ds_read_b128 v[68:71], v10 offset:13312
    v_mfma_f32_32x32x16_bf16 v[48:63], a[168:171], v[72:75], v[48:63]
    s_waitcnt lgkmcnt(2)
    v_mfma_f32_32x32x16_bf16 v[32:47], a[44:47], v[76:79], v[32:47]
    ds_read_b128 v[72:75], v10 offset:14336
    v_mfma_f32_32x32x16_bf16 v[48:63], a[172:175], v[76:79], v[48:63]
    s_waitcnt lgkmcnt(2)
    v_mfma_f32_32x32x16_bf16 v[32:47], a[48:51], v[64:67], v[32:47]
    ds_read_b128 v[76:79], v10 offset:15360
    s_lshl_b32 s67, s31, 15
    s_lshl_b32 s68, s25, 13
    s_add_u32 s67, s67, s68
    s_add_u32 s67, s67, 1048576
    s_add_u32 s68, s68, s30
    v_mfma_f32_32x32x16_bf16 v[48:63], a[176:179], v[64:67], v[48:63]
    s_mov_b32 m0, s68
    s_nop 0
    buffer_load_dwordx4 v1, s[4:7], s67 offen offset:0 sc1 lds
    s_waitcnt lgkmcnt(2)
    v_mfma_f32_32x32x16_bf16 v[32:47], a[52:55], v[68:71], v[32:47]
    ds_read_b128 v[64:67], v10 offset:16384
    v_mfma_f32_32x32x16_bf16 v[48:63], a[180:183], v[68:71], v[48:63]
    buffer_load_dwordx4 v1, s[4:7], s67 offen offset:1024 sc1 lds
    s_waitcnt lgkmcnt(2)
    v_mfma_f32_32x32x16_bf16 v[32:47], a[56:59], v[72:75], v[32:47]
    ds_read_b128 v[68:71], v10 offset:17408
    v_mfma_f32_32x32x16_bf16 v[48:63], a[184:187], v[72:75], v[48:63]
    buffer_load_dwordx4 v1, s[4:7], s67 offen offset:2048 sc1 lds
    s_waitcnt lgkmcnt(2)
    v_mfma_f32_32x32x16_bf16 v[32:47], a[60:63], v[76:79], v[32:47]
    ds_read_b128 v[72:75], v10 offset:18432
    v_mfma_f32_32x32x16_bf16 v[48:63], a[188:191], v[76:79], v[48:63]
    buffer_load_dwordx4 v1, s[4:7], s67 offen offset:3072 sc1 lds
    s_waitcnt lgkmcnt(2)
    v_mfma_f32_32x32x16_bf16 v[32:47], a[64:67], v[64:67], v[32:47]
    ds_read_b128 v[76:79], v10 offset:19456
    v_mfma_f32_32x32x16_bf16 v[48:63], a[192:195], v[64:67], v[48:63]
    s_add_u32 s67, s67, 0x1000
    s_add_u32 s68, s68, 0x1000
    s_waitcnt lgkmcnt(2)
    v_mfma_f32_32x32x16_bf16 v[32:47], a[68:71], v[68:71], v[32:47]
    ds_read_b128 v[64:67], v10 offset:20480
    s_mov_b32 m0, s68
    s_nop 0
    buffer_load_dwordx4 v1, s[4:7], s67 offen offset:0 sc1 lds
    v_mfma_f32_32x32x16_bf16 v[48:63], a[196:199], v[68:71], v[48:63]
    s_waitcnt lgkmcnt(2)
    v_mfma_f32_32x32x16_bf16 v[32:47], a[72:75], v[72:75], v[32:47]
    ds_read_b128 v[68:71], v10 offset:21504
    buffer_load_dwordx4 v1, s[4:7], s67 offen offset:1024 sc1 lds
    v_mfma_f32_32x32x16_bf16 v[48:63], a[200:203], v[72:75], v[48:63]
    s_waitcnt lgkmcnt(2)
    v_mfma_f32_32x32x16_bf16 v[32:47], a[76:79], v[76:79], v[32:47]
    ds_read_b128 v[72:75], v10 offset:22528
    buffer_load_dwordx4 v1, s[4:7], s67 offen offset:2048 sc1 lds
    v_mfma_f32_32x32x16_bf16 v[48:63], a[204:207], v[76:79], v[48:63]
    s_waitcnt lgkmcnt(2)
    v_mfma_f32_32x32x16_bf16 v[32:47], a[80:83], v[64:67], v[32:47]
    ds_read_b128 v[76:79], v10 offset:23552
    buffer_load_dwordx4 v1, s[4:7], s67 offen offset:3072 sc1 lds
    v_mfma_f32_32x32x16_bf16 v[48:63], a[208:211], v[64:67], v[48:63]
    s_waitcnt lgkmcnt(2)
    v_mfma_f32_32x32x16_bf16 v[32:47], a[84:87], v[68:71], v[32:47]
    ds_read_b128 v[64:67], v10 offset:24576
    v_mfma_f32_32x32x16_bf16 v[48:63], a[212:215], v[68:71], v[48:63]
    s_waitcnt lgkmcnt(2)
    v_mfma_f32_32x32x16_bf16 v[32:47], a[88:91], v[72:75], v[32:47]
    ds_read_b128 v[68:71], v10 offset:25600
    v_mfma_f32_32x32x16_bf16 v[48:63], a[216:219], v[72:75], v[48:63]
    s_waitcnt lgkmcnt(2)
    v_mfma_f32_32x32x16_bf16 v[32:47], a[92:95], v[76:79], v[32:47]
    ds_read_b128 v[72:75], v10 offset:26624
    v_mfma_f32_32x32x16_bf16 v[48:63], a[220:223], v[76:79], v[48:63]
    s_waitcnt lgkmcnt(2)
    v_mfma_f32_32x32x16_bf16 v[32:47], a[96:99], v[64:67], v[32:47]
    ds_read_b128 v[76:79], v10 offset:27648
    v_mfma_f32_32x32x16_bf16 v[48:63], a[224:227], v[64:67], v[48:63]
    s_waitcnt vmcnt(8)
    s_mov_b64 exec, 1
    buffer_store_dword v12, off, s[4:7], s29 sc1
    s_mov_b64 exec, -1
    s_waitcnt lgkmcnt(2)
    v_mfma_f32_32x32x16_bf16 v[32:47], a[100:103], v[68:71], v[32:47]
    ds_read_b128 v[64:67], v10 offset:28672
    v_mfma_f32_32x32x16_bf16 v[48:63], a[228:231], v[68:71], v[48:63]
    s_waitcnt lgkmcnt(2)
    v_mfma_f32_32x32x16_bf16 v[32:47], a[104:107], v[72:75], v[32:47]
    ds_read_b128 v[68:71], v10 offset:29696
    v_mfma_f32_32x32x16_bf16 v[48:63], a[232:235], v[72:75], v[48:63]
    s_waitcnt lgkmcnt(2)
    v_mfma_f32_32x32x16_bf16 v[32:47], a[108:111], v[76:79], v[32:47]
    ds_read_b128 v[72:75], v10 offset:30720
    v_mfma_f32_32x32x16_bf16 v[48:63], a[236:239], v[76:79], v[48:63]
    s_waitcnt lgkmcnt(2)
    v_mfma_f32_32x32x16_bf16 v[32:47], a[112:115], v[64:67], v[32:47]
    ds_read_b128 v[76:79], v10 offset:31744
    v_mfma_f32_32x32x16_bf16 v[48:63], a[240:243], v[64:67], v[48:63]
    s_waitcnt lgkmcnt(2)
    v_mfma_f32_32x32x16_bf16 v[32:47], a[116:119], v[68:71], v[32:47]
    v_mfma_f32_32x32x16_bf16 v[48:63], a[244:247], v[68:71], v[48:63]
    s_waitcnt lgkmcnt(1)
    v_mfma_f32_32x32x16_bf16 v[32:47], a[120:123], v[72:75], v[32:47]
    v_mfma_f32_32x32x16_bf16 v[48:63], a[248:251], v[72:75], v[48:63]
    s_waitcnt lgkmcnt(0)
    v_mfma_f32_32x32x16_bf16 v[32:47], a[124:127], v[76:79], v[32:47]
    v_mfma_f32_32x32x16_bf16 v[48:63], a[252:255], v[76:79], v[48:63]
    s_mov_b32 s29, s33
    s_add_u32 s33, s33, 512
    s_nop 1
    v_mul_f32 v96, s34, v32
    v_mul_f32 v97, s34, v33
    v_mul_f32 v98, s34, v34
    v_mul_f32 v99, s34, v35
    v_mul_f32 v100, s34, v36
    v_mul_f32 v101, s34, v37
    v_mul_f32 v102, s34, v38
    v_mul_f32 v103, s34, v39
    v_mul_f32 v104, s34, v40
    v_mul_f32 v105, s34, v41
    v_mul_f32 v106, s34, v42
    v_mul_f32 v107, s34, v43
    v_mul_f32 v108, s34, v44
    v_mul_f32 v109, s34, v45
    v_mul_f32 v110, s34, v46
    v_mul_f32 v111, s34, v47
    v_exp_f32 v96, v96
    v_exp_f32 v97, v97
    v_exp_f32 v98, v98
    v_exp_f32 v99, v99
    v_exp_f32 v100, v100
    v_exp_f32 v101, v101
    v_exp_f32 v102, v102
    v_exp_f32 v103, v103
    v_exp_f32 v104, v104
    v_exp_f32 v105, v105
    v_exp_f32 v106, v106
    v_exp_f32 v107, v107
    v_exp_f32 v108, v108
    v_exp_f32 v109, v109
    v_exp_f32 v110, v110
    v_exp_f32 v111, v111
    v_add_f32 v96, 1.0, v96
    v_add_f32 v97, 1.0, v97
    v_add_f32 v98, 1.0, v98
    v_add_f32 v99, 1.0, v99
    v_add_f32 v100, 1.0, v100
    v_add_f32 v101, 1.0, v101
    v_add_f32 v102, 1.0, v102
    v_add_f32 v103, 1.0, v103
    v_add_f32 v104, 1.0, v104
    v_add_f32 v105, 1.0, v105
    v_add_f32 v106, 1.0, v106
    v_add_f32 v107, 1.0, v107
    v_add_f32 v108, 1.0, v108
    v_add_f32 v109, 1.0, v109
    v_add_f32 v110, 1.0, v110
    v_add_f32 v111, 1.0, v111
    v_rcp_f32 v96, v96
    v_rcp_f32 v97, v97
    v_rcp_f32 v98, v98
    v_rcp_f32 v99, v99
    v_rcp_f32 v100, v100
    v_rcp_f32 v101, v101
    v_rcp_f32 v102, v102
    v_rcp_f32 v103, v103
    v_rcp_f32 v104, v104
    v_rcp_f32 v105, v105
    v_rcp_f32 v106, v106
    v_rcp_f32 v107, v107
    v_rcp_f32 v108, v108
    v_rcp_f32 v109, v109
    v_rcp_f32 v110, v110
    v_rcp_f32 v111, v111
    v_pk_mul_f32 v[32:33], v[32:33], v[96:97]
    v_pk_mul_f32 v[34:35], v[34:35], v[98:99]
    v_pk_mul_f32 v[36:37], v[36:37], v[100:101]
    v_pk_mul_f32 v[38:39], v[38:39], v[102:103]
    v_pk_mul_f32 v[40:41], v[40:41], v[104:105]
    v_pk_mul_f32 v[42:43], v[42:43], v[106:107]
    v_pk_mul_f32 v[44:45], v[44:45], v[108:109]
    v_pk_mul_f32 v[46:47], v[46:47], v[110:111]
    v_pk_mul_f32 v[32:33], v[32:33], v[48:49]
    v_pk_mul_f32 v[34:35], v[34:35], v[50:51]
    v_pk_mul_f32 v[36:37], v[36:37], v[52:53]
    v_pk_mul_f32 v[38:39], v[38:39], v[54:55]
    v_pk_mul_f32 v[40:41], v[40:41], v[56:57]
    v_pk_mul_f32 v[42:43], v[42:43], v[58:59]
    v_pk_mul_f32 v[44:45], v[44:45], v[60:61]
    v_pk_mul_f32 v[46:47], v[46:47], v[62:63]
    v_cvt_pk_bf16_f32 v80, v32, v33
    v_cvt_pk_bf16_f32 v81, v34, v35
    v_cvt_pk_bf16_f32 v82, v36, v37
    v_cvt_pk_bf16_f32 v83, v38, v39
    v_cvt_pk_bf16_f32 v84, v40, v41
    v_cvt_pk_bf16_f32 v85, v42, v43
    v_cvt_pk_bf16_f32 v86, v44, v45
    v_cvt_pk_bf16_f32 v87, v46, v47
    s_waitcnt vmcnt(1)
    s_barrier
    buffer_store_dwordx4 v[80:83], v11, s[4:7], s32 offen offset:0 sc1
    buffer_store_dwordx4 v[84:87], v11, s[4:7], s32 offen offset:512 sc1
    s_add_u32 s32, s32, 786432
    s_add_u32 s28, s28, 1
    s_cmp_lt_u32 s28, 32
    s_cbranch_scc1 FU_A
    s_waitcnt vmcnt(0)
    s_mov_b64 exec, 1
    buffer_store_dword v12, off, s[4:7], s29 sc1
    s_mov_b64 exec, -1
    s_branch L_END
ROLE_H:
    v_lshlrev_b32 v1, 4, v0
    v_mov_b64 v[4:5], 0
    v_mov_b64 v[6:7], 0
    v_mov_b64 v[8:9], -1
    v_mov_b64 v[10:11], -1
    s_lshl_b32 s67, s24, 2
    s_add_u32 s67, s67, s25
    s_lshl_b32 s67, s67, 10
    s_lshl_b32 s68, s67, 2
    s_add_u32 s68, s68, 3145728
    buffer_store_dwordx4 v[4:7], v1, s[4:7], s67 offen sc1
    buffer_store_dwordx4 v[8:11], v1, s[4:7], s68 offen offset:0 sc1
    buffer_store_dwordx4 v[8:11], v1, s[4:7], s68 offen offset:1024 sc1
    buffer_store_dwordx4 v[8:11], v1, s[4:7], s68 offen offset:2048 sc1
    buffer_store_dwordx4 v[8:11], v1, s[4:7], s68 offen offset:3072 sc1
    s_sub_u32 s68, s68, 2621440
    buffer_store_dwordx4 v[4:7], v1, s[4:7], s68 offen offset:0 sc1
    buffer_store_dwordx4 v[4:7], v1, s[4:7], s68 offen offset:1024 sc1
    buffer_store_dwordx4 v[4:7], v1, s[4:7], s68 offen offset:2048 sc1
    buffer_store_dwordx4 v[4:7], v1, s[4:7], s68 offen offset:3072 sc1
    v_lshlrev_b32 v2, 2, v0
    s_lshr_b32 s67, s67, 2
    s_add_u32 s67, s67, 131072
    buffer_store_dword v8, v2, s[4:7], s67 offen sc1
    s_waitcnt vmcnt(0)
    s_barrier
    s_cmp_lg_u32 s25, 1
    s_cbranch_scc1 H_clr
    s_mov_b32 s77, 1
    s_atomic_add s77, s[60:61], 72 glc
    s_waitcnt lgkmcnt(0)
    s_cmp_lg_u32 s77, 95
    s_cbranch_scc1 H_clr
    s_mov_b32 s77, 1
    s_atomic_add s77, s[60:61], 136
H_clr:
    s_mov_b32 s16, s46
    s_mov_b32 s17, s47
    s_mov_b32 s18, 0x400000
    s_mov_b32 s19, 0x20000
    s_lshl_b32 s67, s24, 17
    s_lshl_b32 s68, s25, 12
    s_add_u32 s67, s67, s68
    v_lshlrev_b32 v1, 4, v0
    s_barrier
    v_mov_b32 v3, 136
    s_mov_b32 s35, 0
H_x:
    global_load_dword v4, v3, s[60:61] sc1
    s_waitcnt vmcnt(0)
    v_cmp_eq_u32 vcc, 0, v4
    s_cbranch_vccz H_x_ok
    s_sleep 4
    s_add_u32 s35, s35, 1
    s_cmp_lt_u32 s35, 131072
    s_cbranch_scc1 H_x
    s_branch L_END
H_x_ok:
    buffer_load_dwordx4 v[124:127], v1, s[16:19], s67 offen offset:0
    buffer_load_dwordx4 v[124:127], v1, s[16:19], s67 offen offset:1024
    buffer_load_dwordx4 v[124:127], v1, s[16:19], s67 offen offset:2048
    buffer_load_dwordx4 v[124:127], v1, s[16:19], s67 offen offset:3072
    s_add_u32 s67, s67, 0x4000
    buffer_load_dwordx4 v[124:127], v1, s[16:19], s67 offen offset:0
    buffer_load_dwordx4 v[124:127], v1, s[16:19], s67 offen offset:1024
    buffer_load_dwordx4 v[124:127], v1, s[16:19], s67 offen offset:2048
    buffer_load_dwordx4 v[124:127], v1, s[16:19], s67 offen offset:3072
    s_add_u32 s67, s67, 0x4000
    buffer_load_dwordx4 v[124:127], v1, s[16:19], s67 offen offset:0
    buffer_load_dwordx4 v[124:127], v1, s[16:19], s67 offen offset:1024
    buffer_load_dwordx4 v[124:127], v1, s[16:19], s67 offen offset:2048
    buffer_load_dwordx4 v[124:127], v1, s[16:19], s67 offen offset:3072
    s_add_u32 s67, s67, 0x4000
    buffer_load_dwordx4 v[124:127], v1, s[16:19], s67 offen offset:0
    buffer_load_dwordx4 v[124:127], v1, s[16:19], s67 offen offset:1024
    buffer_load_dwordx4 v[124:127], v1, s[16:19], s67 offen offset:2048
    buffer_load_dwordx4 v[124:127], v1, s[16:19], s67 offen offset:3072
    s_add_u32 s67, s67, 0x4000
    buffer_load_dwordx4 v[124:127], v1, s[16:19], s67 offen offset:0
    buffer_load_dwordx4 v[124:127], v1, s[16:19], s67 offen offset:1024
    buffer_load_dwordx4 v[124:127], v1, s[16:19], s67 offen offset:2048
    buffer_load_dwordx4 v[124:127], v1, s[16:19], s67 offen offset:3072
    s_add_u32 s67, s67, 0x4000
    buffer_load_dwordx4 v[124:127], v1, s[16:19], s67 offen offset:0
    buffer_load_dwordx4 v[124:127], v1, s[16:19], s67 offen offset:1024
    buffer_load_dwordx4 v[124:127], v1, s[16:19], s67 offen offset:2048
    buffer_load_dwordx4 v[124:127], v1, s[16:19], s67 offen offset:3072
    s_add_u32 s67, s67, 0x4000
    buffer_load_dwordx4 v[124:127], v1, s[16:19], s67 offen offset:0
    buffer_load_dwordx4 v[124:127], v1, s[16:19], s67 offen offset:1024
    buffer_load_dwordx4 v[124:127], v1, s[16:19], s67 offen offset:2048
    buffer_load_dwordx4 v[124:127], v1, s[16:19], s67 offen offset:3072
    s_add_u32 s67, s67, 0x4000
    buffer_load_dwordx4 v[124:127], v1, s[16:19], s67 offen offset:0
    buffer_load_dwordx4 v[124:127], v1, s[16:19], s67 offen offset:1024
    buffer_load_dwordx4 v[124:127], v1, s[16:19], s67 offen offset:2048
    buffer_load_dwordx4 v[124:127], v1, s[16:19], s67 offen offset:3072
    s_add_u32 s67, s67, 0x4000
    s_branch L_END
ROLE_F:
    s_mov_b32 s8, s36
    s_mov_b32 s9, s37
    s_mov_b32 s10, 0x200000
    s_mov_b32 s11, 0x20000
    s_mov_b32 s12, s46
    s_mov_b32 s13, s47
    s_mov_b32 s14, 0x400000
    s_mov_b32 s15, 0x20000
    s_mov_b32 s16, s56
    s_mov_b32 s17, s57
    s_mov_b32 s18, 0x158000
    s_mov_b32 s19, 0x20000
    s_mov_b32 s20, s58
    s_mov_b32 s21, s59
    s_mov_b32 s22, 0x200000
    s_mov_b32 s23, 0x20000
    s_sub_u32 s26, s3, 5
    s_lshl_b32 s26, s26, 5
    s_add_u32 s26, s26, s24
    v_lshlrev_b32 v1, 4, v0
    v_and_b32 v2, 7, v0
    v_lshrrev_b32 v3, 3, v0
    s_lshl_b32 s67, s25, 3
    v_add_u32 v2, s67, v2
    v_lshlrev_b32 v4, 10, v2
    v_lshl_add_u32 v4, v3, 4, v4
    v_lshlrev_b32 v5, 9, v3
    v_lshl_add_u32 v5, v2, 4, v5
    s_lshl_b32 s67, s26, 15
    buffer_load_dwordx4 v[32:35], v4, s[8:11], s67 offen offset:0
    buffer_load_dwordx4 v[36:39], v4, s[8:11], s67 offen offset:128
    buffer_load_dwordx4 v[40:43], v4, s[8:11], s67 offen offset:256
    buffer_load_dwordx4 v[44:47], v4, s[8:11], s67 offen offset:384
    buffer_load_dwordx4 v[48:51], v4, s[8:11], s67 offen offset:512
    buffer_load_dwordx4 v[52:55], v4, s[8:11], s67 offen offset:640
    buffer_load_dwordx4 v[56:59], v4, s[8:11], s67 offen offset:768
    buffer_load_dwordx4 v[60:63], v4, s[8:11], s67 offen offset:896
    s_waitcnt vmcnt(0)
    v_lshlrev_b32 v64, 16, v32
    v_and_b32 v65, 0xffff0000, v32
    v_lshlrev_b32 v66, 16, v33
    v_and_b32 v67, 0xffff0000, v33
    v_lshlrev_b32 v68, 16, v34
    v_and_b32 v69, 0xffff0000, v34
    v_lshlrev_b32 v70, 16, v35
    v_and_b32 v71, 0xffff0000, v35
    v_lshlrev_b32 v72, 16, v36
    v_and_b32 v73, 0xffff0000, v36
    v_lshlrev_b32 v74, 16, v37
    v_and_b32 v75, 0xffff0000, v37
    v_lshlrev_b32 v76, 16, v38
    v_and_b32 v77, 0xffff0000, v38
    v_lshlrev_b32 v78, 16, v39
    v_and_b32 v79, 0xffff0000, v39
    v_lshlrev_b32 v80, 16, v40
    v_and_b32 v81, 0xffff0000, v40
    v_lshlrev_b32 v82, 16, v41
    v_and_b32 v83, 0xffff0000, v41
    v_lshlrev_b32 v84, 16, v42
    v_and_b32 v85, 0xffff0000, v42
    v_lshlrev_b32 v86, 16, v43
    v_and_b32 v87, 0xffff0000, v43
    v_lshlrev_b32 v88, 16, v44
    v_and_b32 v89, 0xffff0000, v44
    v_lshlrev_b32 v90, 16, v45
    v_and_b32 v91, 0xffff0000, v45
    v_lshlrev_b32 v92, 16, v46
    v_and_b32 v93, 0xffff0000, v46
    v_lshlrev_b32 v94, 16, v47
    v_and_b32 v95, 0xffff0000, v47
    v_lshlrev_b32 v96, 16, v48
    v_and_b32 v97, 0xffff0000, v48
    v_lshlrev_b32 v98, 16, v49
    v_and_b32 v99, 0xffff0000, v49
    v_lshlrev_b32 v100, 16, v50
    v_and_b32 v101, 0xffff0000, v50
    v_lshlrev_b32 v102, 16, v51
    v_and_b32 v103, 0xffff0000, v51
    v_lshlrev_b32 v104, 16, v52
    v_and_b32 v105, 0xffff0000, v52
    v_lshlrev_b32 v106, 16, v53
    v_and_b32 v107, 0xffff0000, v53
    v_lshlrev_b32 v108, 16, v54
    v_and_b32 v109, 0xffff0000, v54
    v_lshlrev_b32 v110, 16, v55
    v_and_b32 v111, 0xffff0000, v55
    v_lshlrev_b32 v112, 16, v56
    v_and_b32 v113, 0xffff0000, v56
    v_lshlrev_b32 v114, 16, v57
    v_and_b32 v115, 0xffff0000, v57
    v_lshlrev_b32 v116, 16, v58
    v_and_b32 v117, 0xffff0000, v58
    v_lshlrev_b32 v118, 16, v59
    v_and_b32 v119, 0xffff0000, v59
    v_lshlrev_b32 v120, 16, v60
    v_and_b32 v121, 0xffff0000, v60
    v_lshlrev_b32 v122, 16, v61
    v_and_b32 v123, 0xffff0000, v61
    v_lshlrev_b32 v124, 16, v62
    v_and_b32 v125, 0xffff0000, v62
    v_lshlrev_b32 v126, 16, v63
    v_and_b32 v127, 0xffff0000, v63
    v_add_f32 v6, v64, v68
    v_add_f32 v7, v65, v69
    v_add_f32 v8, v66, v70
    v_add_f32 v9, v67, v71
    v_add_f32 v6, v6, v72
    v_add_f32 v7, v7, v73
    v_add_f32 v8, v8, v74
    v_add_f32 v9, v9, v75
    v_add_f32 v6, v6, v76
    v_add_f32 v7, v7, v77
    v_add_f32 v8, v8, v78
    v_add_f32 v9, v9, v79
    v_add_f32 v6, v6, v80
    v_add_f32 v7, v7, v81
    v_add_f32 v8, v8, v82
    v_add_f32 v9, v9, v83
    v_add_f32 v6, v6, v84
    v_add_f32 v7, v7, v85
    v_add_f32 v8, v8, v86
    v_add_f32 v9, v9, v87
    v_add_f32 v6, v6, v88
    v_add_f32 v7, v7, v89
    v_add_f32 v8, v8, v90
    v_add_f32 v9, v9, v91
    v_add_f32 v6, v6, v92
    v_add_f32 v7, v7, v93
    v_add_f32 v8, v8, v94
    v_add_f32 v9, v9, v95
    v_add_f32 v6, v6, v96
    v_add_f32 v7, v7, v97
    v_add_f32 v8, v8, v98
    v_add_f32 v9, v9, v99
    v_add_f32 v6, v6, v100
    v_add_f32 v7, v7, v101
    v_add_f32 v8, v8, v102
    v_add_f32 v9, v9, v103
    v_add_f32 v6, v6, v104
    v_add_f32 v7, v7, v105
    v_add_f32 v8, v8, v106
    v_add_f32 v9, v9, v107
    v_add_f32 v6, v6, v108
    v_add_f32 v7, v7, v109
    v_add_f32 v8, v8, v110
    v_add_f32 v9, v9, v111
    v_add_f32 v6, v6, v112
    v_add_f32 v7, v7, v113
    v_add_f32 v8, v8, v114
    v_add_f32 v9, v9, v115
    v_add_f32 v6, v6, v116
    v_add_f32 v7, v7, v117
    v_add_f32 v8, v8, v118
    v_add_f32 v9, v9, v119
    v_add_f32 v6, v6, v120
    v_add_f32 v7, v7, v121
    v_add_f32 v8, v8, v122
    v_add_f32 v9, v9, v123
    v_add_f32 v6, v6, v124
    v_add_f32 v7, v7, v125
    v_add_f32 v8, v8, v126
    v_add_f32 v9, v9, v127
    v_add_f32 v6, v6, v7
    v_add_f32 v8, v8, v9
    v_add_f32 v6, v6, v8
    s_nop 1
    v_add_f32_dpp v6, v6, v6 row_ror:8 row_mask:0xf bank_mask:0xf
    v_mov_b32 v7, v6
    s_nop 1
    v_permlane16_swap_b32 v6, v7
    v_add_f32 v6, v6, v7
    v_mov_b32 v7, v6
    s_nop 1
    v_permlane32_swap_b32 v6, v7
    v_add_f32 v6, v6, v7
    v_mul_f32 v6, 0x3b000000, v6
    v_sub_f32 v12, v64, v6
    v_mul_f32 v8, v12, v12
    v_sub_f32 v13, v65, v6
    v_mul_f32 v9, v13, v13
    v_sub_f32 v14, v66, v6
    v_mul_f32 v10, v14, v14
    v_sub_f32 v15, v67, v6
    v_mul_f32 v11, v15, v15
    v_sub_f32 v12, v68, v6
    v_fmac_f32 v8, v12, v12
    v_sub_f32 v13, v69, v6
    v_fmac_f32 v9, v13, v13
    v_sub_f32 v14, v70, v6
    v_fmac_f32 v10, v14, v14
    v_sub_f32 v15, v71, v6
    v_fmac_f32 v11, v15, v15
    v_sub_f32 v12, v72, v6
    v_fmac_f32 v8, v12, v12
    v_sub_f32 v13, v73, v6
    v_fmac_f32 v9, v13, v13
    v_sub_f32 v14, v74, v6
    v_fmac_f32 v10, v14, v14
    v_sub_f32 v15, v75, v6
    v_fmac_f32 v11, v15, v15
    v_sub_f32 v12, v76, v6
    v_fmac_f32 v8, v12, v12
    v_sub_f32 v13, v77, v6
    v_fmac_f32 v9, v13, v13
    v_sub_f32 v14, v78, v6
    v_fmac_f32 v10, v14, v14
    v_sub_f32 v15, v79, v6
    v_fmac_f32 v11, v15, v15
    v_sub_f32 v12, v80, v6
    v_fmac_f32 v8, v12, v12
    v_sub_f32 v13, v81, v6
    v_fmac_f32 v9, v13, v13
    v_sub_f32 v14, v82, v6
    v_fmac_f32 v10, v14, v14
    v_sub_f32 v15, v83, v6
    v_fmac_f32 v11, v15, v15
    v_sub_f32 v12, v84, v6
    v_fmac_f32 v8, v12, v12
    v_sub_f32 v13, v85, v6
    v_fmac_f32 v9, v13, v13
    v_sub_f32 v14, v86, v6
    v_fmac_f32 v10, v14, v14
    v_sub_f32 v15, v87, v6
    v_fmac_f32 v11, v15, v15
    v_sub_f32 v12, v88, v6
    v_fmac_f32 v8, v12, v12
    v_sub_f32 v13, v89, v6
    v_fmac_f32 v9, v13, v13
    v_sub_f32 v14, v90, v6
    v_fmac_f32 v10, v14, v14
    v_sub_f32 v15, v91, v6
    v_fmac_f32 v11, v15, v15
    v_sub_f32 v12, v92, v6
    v_fmac_f32 v8, v12, v12
    v_sub_f32 v13, v93, v6
    v_fmac_f32 v9, v13, v13
    v_sub_f32 v14, v94, v6
    v_fmac_f32 v10, v14, v14
    v_sub_f32 v15, v95, v6
    v_fmac_f32 v11, v15, v15
    v_sub_f32 v12, v96, v6
    v_fmac_f32 v8, v12, v12
    v_sub_f32 v13, v97, v6
    v_fmac_f32 v9, v13, v13
    v_sub_f32 v14, v98, v6
    v_fmac_f32 v10, v14, v14
    v_sub_f32 v15, v99, v6
    v_fmac_f32 v11, v15, v15
    v_sub_f32 v12, v100, v6
    v_fmac_f32 v8, v12, v12
    v_sub_f32 v13, v101, v6
    v_fmac_f32 v9, v13, v13
    v_sub_f32 v14, v102, v6
    v_fmac_f32 v10, v14, v14
    v_sub_f32 v15, v103, v6
    v_fmac_f32 v11, v15, v15
    v_sub_f32 v12, v104, v6
    v_fmac_f32 v8, v12, v12
    v_sub_f32 v13, v105, v6
    v_fmac_f32 v9, v13, v13
    v_sub_f32 v14, v106, v6
    v_fmac_f32 v10, v14, v14
    v_sub_f32 v15, v107, v6
    v_fmac_f32 v11, v15, v15
    v_sub_f32 v12, v108, v6
    v_fmac_f32 v8, v12, v12
    v_sub_f32 v13, v109, v6
    v_fmac_f32 v9, v13, v13
    v_sub_f32 v14, v110, v6
    v_fmac_f32 v10, v14, v14
    v_sub_f32 v15, v111, v6
    v_fmac_f32 v11, v15, v15
    v_sub_f32 v12, v112, v6
    v_fmac_f32 v8, v12, v12
    v_sub_f32 v13, v113, v6
    v_fmac_f32 v9, v13, v13
    v_sub_f32 v14, v114, v6
    v_fmac_f32 v10, v14, v14
    v_sub_f32 v15, v115, v6
    v_fmac_f32 v11, v15, v15
    v_sub_f32 v12, v116, v6
    v_fmac_f32 v8, v12, v12
    v_sub_f32 v13, v117, v6
    v_fmac_f32 v9, v13, v13
    v_sub_f32 v14, v118, v6
    v_fmac_f32 v10, v14, v14
    v_sub_f32 v15, v119, v6
    v_fmac_f32 v11, v15, v15
    v_sub_f32 v12, v120, v6
    v_fmac_f32 v8, v12, v12
    v_sub_f32 v13, v121, v6
    v_fmac_f32 v9, v13, v13
    v_sub_f32 v14, v122, v6
    v_fmac_f32 v10, v14, v14
    v_sub_f32 v15, v123, v6
    v_fmac_f32 v11, v15, v15
    v_sub_f32 v12, v124, v6
    v_fmac_f32 v8, v12, v12
    v_sub_f32 v13, v125, v6
    v_fmac_f32 v9, v13, v13
    v_sub_f32 v14, v126, v6
    v_fmac_f32 v10, v14, v14
    v_sub_f32 v15, v127, v6
    v_fmac_f32 v11, v15, v15
    v_add_f32 v8, v8, v9
    v_add_f32 v10, v10, v11
    v_add_f32 v8, v8, v10
    s_nop 1
    v_add_f32_dpp v8, v8, v8 row_ror:8 row_mask:0xf bank_mask:0xf
    v_mov_b32 v9, v8
    s_nop 1
    v_permlane16_swap_b32 v8, v9
    v_add_f32 v8, v8, v9
    v_mov_b32 v9, v8
    s_nop 1
    v_permlane32_swap_b32 v8, v9
    v_add_f32 v8, v8, v9
    v_mul_f32 v8, 0x3b000000, v8
    v_cvt_pk_bf16_f32 v6, v6, v6
    v_lshlrev_b32 v6, 16, v6
    v_cvt_pk_bf16_f32 v8, v8, v8
    v_lshlrev_b32 v8, 16, v8
    v_add_f32 v8, 0x3727c5ac, v8
    v_cvt_pk_bf16_f32 v8, v8, v8
    v_lshlrev_b32 v8, 16, v8
    v_sqrt_f32 v8, v8
    s_nop 0
    v_cvt_pk_bf16_f32 v8, v8, v8
    v_lshlrev_b32 v8, 16, v8
    v_rcp_f32 v8, v8
    v_sub_f32 v64, v64, v6
    v_sub_f32 v65, v65, v6
    v_sub_f32 v66, v66, v6
    v_sub_f32 v67, v67, v6
    v_sub_f32 v68, v68, v6
    v_sub_f32 v69, v69, v6
    v_sub_f32 v70, v70, v6
    v_sub_f32 v71, v71, v6
    v_sub_f32 v72, v72, v6
    v_sub_f32 v73, v73, v6
    v_sub_f32 v74, v74, v6
    v_sub_f32 v75, v75, v6
    v_sub_f32 v76, v76, v6
    v_sub_f32 v77, v77, v6
    v_sub_f32 v78, v78, v6
    v_sub_f32 v79, v79, v6
    v_sub_f32 v80, v80, v6
    v_sub_f32 v81, v81, v6
    v_sub_f32 v82, v82, v6
    v_sub_f32 v83, v83, v6
    v_sub_f32 v84, v84, v6
    v_sub_f32 v85, v85, v6
    v_sub_f32 v86, v86, v6
    v_sub_f32 v87, v87, v6
    v_sub_f32 v88, v88, v6
    v_sub_f32 v89, v89, v6
    v_sub_f32 v90, v90, v6
    v_sub_f32 v91, v91, v6
    v_sub_f32 v92, v92, v6
    v_sub_f32 v93, v93, v6
    v_sub_f32 v94, v94, v6
    v_sub_f32 v95, v95, v6
    v_sub_f32 v96, v96, v6
    v_sub_f32 v97, v97, v6
    v_sub_f32 v98, v98, v6
    v_sub_f32 v99, v99, v6
    v_sub_f32 v100, v100, v6
    v_sub_f32 v101, v101, v6
    v_sub_f32 v102, v102, v6
    v_sub_f32 v103, v103, v6
    v_sub_f32 v104, v104, v6
    v_sub_f32 v105, v105, v6
    v_sub_f32 v106, v106, v6
    v_sub_f32 v107, v107, v6
    v_sub_f32 v108, v108, v6
    v_sub_f32 v109, v109, v6
    v_sub_f32 v110, v110, v6
    v_sub_f32 v111, v111, v6
    v_sub_f32 v112, v112, v6
    v_sub_f32 v113, v113, v6
    v_sub_f32 v114, v114, v6
    v_sub_f32 v115, v115, v6
    v_sub_f32 v116, v116, v6
    v_sub_f32 v117, v117, v6
    v_sub_f32 v118, v118, v6
    v_sub_f32 v119, v119, v6
    v_sub_f32 v120, v120, v6
    v_sub_f32 v121, v121, v6
    v_sub_f32 v122, v122, v6
    v_sub_f32 v123, v123, v6
    v_sub_f32 v124, v124, v6
    v_sub_f32 v125, v125, v6
    v_sub_f32 v126, v126, v6
    v_sub_f32 v127, v127, v6
    v_cvt_pk_bf16_f32 v32, v64, v65
    v_cvt_pk_bf16_f32 v33, v66, v67
    v_cvt_pk_bf16_f32 v34, v68, v69
    v_cvt_pk_bf16_f32 v35, v70, v71
    v_cvt_pk_bf16_f32 v36, v72, v73
    v_cvt_pk_bf16_f32 v37, v74, v75
    v_cvt_pk_bf16_f32 v38, v76, v77
    v_cvt_pk_bf16_f32 v39, v78, v79
    v_cvt_pk_bf16_f32 v40, v80, v81
    v_cvt_pk_bf16_f32 v41, v82, v83
    v_cvt_pk_bf16_f32 v42, v84, v85
    v_cvt_pk_bf16_f32 v43, v86, v87
    v_cvt_pk_bf16_f32 v44, v88, v89
    v_cvt_pk_bf16_f32 v45, v90, v91
    v_cvt_pk_bf16_f32 v46, v92, v93
    v_cvt_pk_bf16_f32 v47, v94, v95
    v_cvt_pk_bf16_f32 v48, v96, v97
    v_cvt_pk_bf16_f32 v49, v98, v99
    v_cvt_pk_bf16_f32 v50, v100, v101
    v_cvt_pk_bf16_f32 v51, v102, v103
    v_cvt_pk_bf16_f32 v52, v104, v105
    v_cvt_pk_bf16_f32 v53, v106, v107
    v_cvt_pk_bf16_f32 v54, v108, v109
    v_cvt_pk_bf16_f32 v55, v110, v111
    v_cvt_pk_bf16_f32 v56, v112, v113
    v_cvt_pk_bf16_f32 v57, v114, v115
    v_cvt_pk_bf16_f32 v58, v116, v117
    v_cvt_pk_bf16_f32 v59, v118, v119
    v_cvt_pk_bf16_f32 v60, v120, v121
    v_cvt_pk_bf16_f32 v61, v122, v123
    v_cvt_pk_bf16_f32 v62, v124, v125
    v_cvt_pk_bf16_f32 v63, v126, v127
    v_lshlrev_b32 v64, 16, v32
    v_and_b32 v65, 0xffff0000, v32
    v_lshlrev_b32 v66, 16, v33
    v_and_b32 v67, 0xffff0000, v33
    v_lshlrev_b32 v68, 16, v34
    v_and_b32 v69, 0xffff0000, v34
    v_lshlrev_b32 v70, 16, v35
    v_and_b32 v71, 0xffff0000, v35
    v_lshlrev_b32 v72, 16, v36
    v_and_b32 v73, 0xffff0000, v36
    v_lshlrev_b32 v74, 16, v37
    v_and_b32 v75, 0xffff0000, v37
    v_lshlrev_b32 v76, 16, v38
    v_and_b32 v77, 0xffff0000, v38
    v_lshlrev_b32 v78, 16, v39
    v_and_b32 v79, 0xffff0000, v39
    v_lshlrev_b32 v80, 16, v40
    v_and_b32 v81, 0xffff0000, v40
    v_lshlrev_b32 v82, 16, v41
    v_and_b32 v83, 0xffff0000, v41
    v_lshlrev_b32 v84, 16, v42
    v_and_b32 v85, 0xffff0000, v42
    v_lshlrev_b32 v86, 16, v43
    v_and_b32 v87, 0xffff0000, v43
    v_lshlrev_b32 v88, 16, v44
    v_and_b32 v89, 0xffff0000, v44
    v_lshlrev_b32 v90, 16, v45
    v_and_b32 v91, 0xffff0000, v45
    v_lshlrev_b32 v92, 16, v46
    v_and_b32 v93, 0xffff0000, v46
    v_lshlrev_b32 v94, 16, v47
    v_and_b32 v95, 0xffff0000, v47
    v_lshlrev_b32 v96, 16, v48
    v_and_b32 v97, 0xffff0000, v48
    v_lshlrev_b32 v98, 16, v49
    v_and_b32 v99, 0xffff0000, v49
    v_lshlrev_b32 v100, 16, v50
    v_and_b32 v101, 0xffff0000, v50
    v_lshlrev_b32 v102, 16, v51
    v_and_b32 v103, 0xffff0000, v51
    v_lshlrev_b32 v104, 16, v52
    v_and_b32 v105, 0xffff0000, v52
    v_lshlrev_b32 v106, 16, v53
    v_and_b32 v107, 0xffff0000, v53
    v_lshlrev_b32 v108, 16, v54
    v_and_b32 v109, 0xffff0000, v54
    v_lshlrev_b32 v110, 16, v55
    v_and_b32 v111, 0xffff0000, v55
    v_lshlrev_b32 v112, 16, v56
    v_and_b32 v113, 0xffff0000, v56
    v_lshlrev_b32 v114, 16, v57
    v_and_b32 v115, 0xffff0000, v57
    v_lshlrev_b32 v116, 16, v58
    v_and_b32 v117, 0xffff0000, v58
    v_lshlrev_b32 v118, 16, v59
    v_and_b32 v119, 0xffff0000, v59
    v_lshlrev_b32 v120, 16, v60
    v_and_b32 v121, 0xffff0000, v60
    v_lshlrev_b32 v122, 16, v61
    v_and_b32 v123, 0xffff0000, v61
    v_lshlrev_b32 v124, 16, v62
    v_and_b32 v125, 0xffff0000, v62
    v_lshlrev_b32 v126, 16, v63
    v_and_b32 v127, 0xffff0000, v63
    v_mul_f32 v64, v64, v8
    v_mul_f32 v65, v65, v8
    v_mul_f32 v66, v66, v8
    v_mul_f32 v67, v67, v8
    v_mul_f32 v68, v68, v8
    v_mul_f32 v69, v69, v8
    v_mul_f32 v70, v70, v8
    v_mul_f32 v71, v71, v8
    v_mul_f32 v72, v72, v8
    v_mul_f32 v73, v73, v8
    v_mul_f32 v74, v74, v8
    v_mul_f32 v75, v75, v8
    v_mul_f32 v76, v76, v8
    v_mul_f32 v77, v77, v8
    v_mul_f32 v78, v78, v8
    v_mul_f32 v79, v79, v8
    v_mul_f32 v80, v80, v8
    v_mul_f32 v81, v81, v8
    v_mul_f32 v82, v82, v8
    v_mul_f32 v83, v83, v8
    v_mul_f32 v84, v84, v8
    v_mul_f32 v85, v85, v8
    v_mul_f32 v86, v86, v8
    v_mul_f32 v87, v87, v8
    v_mul_f32 v88, v88, v8
    v_mul_f32 v89, v89, v8
    v_mul_f32 v90, v90, v8
    v_mul_f32 v91, v91, v8
    v_mul_f32 v92, v92, v8
    v_mul_f32 v93, v93, v8
    v_mul_f32 v94, v94, v8
    v_mul_f32 v95, v95, v8
    v_mul_f32 v96, v96, v8
    v_mul_f32 v97, v97, v8
    v_mul_f32 v98, v98, v8
    v_mul_f32 v99, v99, v8
    v_mul_f32 v100, v100, v8
    v_mul_f32 v101, v101, v8
    v_mul_f32 v102, v102, v8
    v_mul_f32 v103, v103, v8
    v_mul_f32 v104, v104, v8
    v_mul_f32 v105, v105, v8
    v_mul_f32 v106, v106, v8
    v_mul_f32 v107, v107, v8
    v_mul_f32 v108, v108, v8
    v_mul_f32 v109, v109, v8
    v_mul_f32 v110, v110, v8
    v_mul_f32 v111, v111, v8
    v_mul_f32 v112, v112, v8
    v_mul_f32 v113, v113, v8
    v_mul_f32 v114, v114, v8
    v_mul_f32 v115, v115, v8
    v_mul_f32 v116, v116, v8
    v_mul_f32 v117, v117, v8
    v_mul_f32 v118, v118, v8
    v_mul_f32 v119, v119, v8
    v_mul_f32 v120, v120, v8
    v_mul_f32 v121, v121, v8
    v_mul_f32 v122, v122, v8
    v_mul_f32 v123, v123, v8
    v_mul_f32 v124, v124, v8
    v_mul_f32 v125, v125, v8
    v_mul_f32 v126, v126, v8
    v_mul_f32 v127, v127, v8
    v_cvt_pk_bf16_f32 v32, v64, v65
    v_cvt_pk_bf16_f32 v33, v66, v67
    v_cvt_pk_bf16_f32 v34, v68, v69
    v_cvt_pk_bf16_f32 v35, v70, v71
    v_cvt_pk_bf16_f32 v36, v72, v73
    v_cvt_pk_bf16_f32 v37, v74, v75
    v_cvt_pk_bf16_f32 v38, v76, v77
    v_cvt_pk_bf16_f32 v39, v78, v79
    v_cvt_pk_bf16_f32 v40, v80, v81
    v_cvt_pk_bf16_f32 v41, v82, v83
    v_cvt_pk_bf16_f32 v42, v84, v85
    v_cvt_pk_bf16_f32 v43, v86, v87
    v_cvt_pk_bf16_f32 v44, v88, v89
    v_cvt_pk_bf16_f32 v45, v90, v91
    v_cvt_pk_bf16_f32 v46, v92, v93
    v_cvt_pk_bf16_f32 v47, v94, v95
    v_cvt_pk_bf16_f32 v48, v96, v97
    v_cvt_pk_bf16_f32 v49, v98, v99
    v_cvt_pk_bf16_f32 v50, v100, v101
    v_cvt_pk_bf16_f32 v51, v102, v103
    v_cvt_pk_bf16_f32 v52, v104, v105
    v_cvt_pk_bf16_f32 v53, v106, v107
    v_cvt_pk_bf16_f32 v54, v108, v109
    v_cvt_pk_bf16_f32 v55, v110, v111
    v_cvt_pk_bf16_f32 v56, v112, v113
    v_cvt_pk_bf16_f32 v57, v114, v115
    v_cvt_pk_bf16_f32 v58, v116, v117
    v_cvt_pk_bf16_f32 v59, v118, v119
    v_cvt_pk_bf16_f32 v60, v120, v121
    v_cvt_pk_bf16_f32 v61, v122, v123
    v_cvt_pk_bf16_f32 v62, v124, v125
    v_cvt_pk_bf16_f32 v63, v126, v127
    s_add_u32 s67, s67, 1048576
    buffer_store_dwordx4 v[32:35], v5, s[4:7], s67 offen sc1
    s_add_u32 s67, s67, 0x1000
    buffer_store_dwordx4 v[36:39], v5, s[4:7], s67 offen sc1
    s_add_u32 s67, s67, 0x1000
    buffer_store_dwordx4 v[40:43], v5, s[4:7], s67 offen sc1
    s_add_u32 s67, s67, 0x1000
    buffer_store_dwordx4 v[44:47], v5, s[4:7], s67 offen sc1
    s_add_u32 s67, s67, 0x1000
    buffer_store_dwordx4 v[48:51], v5, s[4:7], s67 offen sc1
    s_add_u32 s67, s67, 0x1000
    buffer_store_dwordx4 v[52:55], v5, s[4:7], s67 offen sc1
    s_add_u32 s67, s67, 0x1000
    buffer_store_dwordx4 v[56:59], v5, s[4:7], s67 offen sc1
    s_add_u32 s67, s67, 0x1000
    buffer_store_dwordx4 v[60:63], v5, s[4:7], s67 offen sc1
    s_add_u32 s67, s67, 0x1000
    s_waitcnt vmcnt(0)
    s_barrier
    s_cmp_lg_u32 s25, 1
    s_cbranch_scc1 F_clr
    s_mov_b32 s77, 1
    s_atomic_add s77, s[60:61], 72 glc
    s_waitcnt lgkmcnt(0)
    s_cmp_lg_u32 s77, 95
    s_cbranch_scc1 F_clr
    s_mov_b32 s77, 1
    s_atomic_add s77, s[60:61], 136
F_clr:
    v_mov_b32 v3, 136
    s_mov_b32 s35, 0
F_kv0:
    global_load_dword v4, v3, s[60:61] sc1
    s_waitcnt vmcnt(0)
    v_cmp_eq_u32 vcc, 0, v4
    s_cbranch_vccz F_kv0_ok
    s_sleep 4
    s_add_u32 s35, s35, 1
    s_cmp_lt_u32 s35, 131072
    s_cbranch_scc1 F_kv0
    s_branch L_END
F_kv0_ok:
    s_and_b32 s67, s24, 31
    s_lshl_b32 s67, s67, 10
    s_mov_b32 s35, 0
F_kv:
    buffer_load_dword v4, off, s[4:7], s67 sc1
    s_waitcnt vmcnt(0)
    v_cmp_eq_u32 vcc, 0, v4
    s_cbranch_vccz F_kv_ok
    s_sleep 8
    s_add_u32 s35, s35, 1
    s_cmp_lt_u32 s35, 131072
    s_cbranch_scc1 F_kv
    s_branch L_END
F_kv_ok:
    s_and_b32 s34, s26, 15
    s_lshl_b32 s34, s34, 6
    v_lshrrev_b32 v2, 2, v0
    v_lshlrev_b32 v2, 10, v2
    v_and_b32 v3, 3, v0
    v_lshl_add_u32 v2, v3, 4, v2
    v_add_u32 v2, s34, v2
    v_lshrrev_b32 v4, 5, v0
    v_lshlrev_b32 v4, 4, v4
    v_bfe_u32 v5, v0, 2, 3
    v_add_u32 v4, v4, v5
    v_lshlrev_b32 v4, 6, v4
    v_lshl_add_u32 v4, v3, 4, v4
    s_mul_i32 s69, s25, 40960
    v_add_u32 v4, s69, v4
    s_lshl_b32 s28, s25, 20
    s_mul_i32 s29, s25, 360448
    s_add_u32 m0, s69, 0
    s_nop 0
    buffer_load_dwordx4 v2, s[12:15], s28 offen lds
    s_add_u32 s28, s28, 0x4000
    s_add_u32 m0, s69, 1024
    s_nop 0
    buffer_load_dwordx4 v2, s[12:15], s28 offen lds
    s_add_u32 s28, s28, 0x4000
    s_add_u32 m0, s69, 2048
    s_nop 0
    buffer_load_dwordx4 v2, s[12:15], s28 offen lds
    s_add_u32 s28, s28, 0x4000
    s_add_u32 m0, s69, 3072
    s_nop 0
    buffer_load_dwordx4 v2, s[12:15], s28 offen lds
    s_add_u32 s28, s28, 0x4000
    s_add_u32 m0, s69, 4096
    s_nop 0
    buffer_load_dwordx4 v2, s[12:15], s28 offen lds
    s_add_u32 s28, s28, 0x4000
    s_add_u32 m0, s69, 5120
    s_nop 0
    buffer_load_dwordx4 v2, s[12:15], s28 offen lds
    s_add_u32 s28, s28, 0x4000
    s_add_u32 m0, s69, 6144
    s_nop 0
    buffer_load_dwordx4 v2, s[12:15], s28 offen lds
    s_add_u32 s28, s28, 0x4000
    s_add_u32 m0, s69, 7168
    s_nop 0
    buffer_load_dwordx4 v2, s[12:15], s28 offen lds
    s_add_u32 s28, s28, 0x4000
    s_add_u32 m0, s69, 8192
    s_nop 0
    buffer_load_dwordx4 v2, s[12:15], s28 offen lds
    s_add_u32 s28, s28, 0x4000
    s_add_u32 m0, s69, 9216
    s_nop 0
    buffer_load_dwordx4 v2, s[12:15], s28 offen lds
    s_add_u32 s28, s28, 0x4000
    s_add_u32 m0, s69, 10240
    s_nop 0
    buffer_load_dwordx4 v2, s[12:15], s28 offen lds
    s_add_u32 s28, s28, 0x4000
    s_add_u32 m0, s69, 11264
    s_nop 0
    buffer_load_dwordx4 v2, s[12:15], s28 offen lds
    s_add_u32 s28, s28, 0x4000
    s_add_u32 m0, s69, 12288
    s_nop 0
    buffer_load_dwordx4 v2, s[12:15], s28 offen lds
    s_add_u32 s28, s28, 0x4000
    s_add_u32 m0, s69, 13312
    s_nop 0
    buffer_load_dwordx4 v2, s[12:15], s28 offen lds
    s_add_u32 s28, s28, 0x4000
    s_add_u32 m0, s69, 14336
    s_nop 0
    buffer_load_dwordx4 v2, s[12:15], s28 offen lds
    s_add_u32 s28, s28, 0x4000
    s_add_u32 m0, s69, 15360
    s_nop 0
    buffer_load_dwordx4 v2, s[12:15], s28 offen lds
    s_add_u32 s28, s28, 0x4000
    s_add_u32 m0, s69, 16384
    s_nop 0
    buffer_load_dwordx4 v2, s[12:15], s28 offen lds
    s_add_u32 s28, s28, 0x4000
    s_add_u32 m0, s69, 17408
    s_nop 0
    buffer_load_dwordx4 v2, s[12:15], s28 offen lds
    s_add_u32 s28, s28, 0x4000
    s_add_u32 m0, s69, 18432
    s_nop 0
    buffer_load_dwordx4 v2, s[12:15], s28 offen lds
    s_add_u32 s28, s28, 0x4000
    s_add_u32 m0, s69, 19456
    s_nop 0
    buffer_load_dwordx4 v2, s[12:15], s28 offen lds
    s_add_u32 s28, s28, 0x4000
    s_add_u32 m0, s69, 20480
    s_nop 0
    buffer_load_dwordx4 v2, s[12:15], s28 offen lds
    s_add_u32 s28, s28, 0x4000
    s_add_u32 m0, s69, 21504
    s_nop 0
    buffer_load_dwordx4 v2, s[12:15], s28 offen lds
    s_add_u32 s28, s28, 0x4000
    s_add_u32 m0, s69, 22528
    s_nop 0
    buffer_load_dwordx4 v2, s[12:15], s28 offen lds
    s_add_u32 s28, s28, 0x4000
    s_add_u32 m0, s69, 23552
    s_nop 0
    buffer_load_dwordx4 v2, s[12:15], s28 offen lds
    s_add_u32 s28, s28, 0x4000
    s_add_u32 m0, s69, 24576
    s_nop 0
    buffer_load_dwordx4 v2, s[12:15], s28 offen lds
    s_add_u32 s28, s28, 0x4000
    s_add_u32 m0, s69, 25600
    s_nop 0
    buffer_load_dwordx4 v2, s[12:15], s28 offen lds
    s_add_u32 s28, s28, 0x4000
    s_add_u32 m0, s69, 26624
    s_nop 0
    buffer_load_dwordx4 v2, s[12:15], s28 offen lds
    s_add_u32 s28, s28, 0x4000
    s_add_u32 m0, s69, 27648
    s_nop 0
    buffer_load_dwordx4 v2, s[12:15], s28 offen lds
    s_add_u32 s28, s28, 0x4000
    s_add_u32 m0, s69, 28672
    s_nop 0
    buffer_load_dwordx4 v2, s[12:15], s28 offen lds
    s_add_u32 s28, s28, 0x4000
    s_add_u32 m0, s69, 29696
    s_nop 0
    buffer_load_dwordx4 v2, s[12:15], s28 offen lds
    s_add_u32 s28, s28, 0x4000
    s_add_u32 m0, s69, 30720
    s_nop 0
    buffer_load_dwordx4 v2, s[12:15], s28 offen lds
    s_add_u32 s28, s28, 0x4000
    s_add_u32 m0, s69, 31744
    s_nop 0
    buffer_load_dwordx4 v2, s[12:15], s28 offen lds
    s_add_u32 s28, s28, 0x4000
    s_add_u32 m0, s69, 32768
    s_nop 0
    buffer_load_dwordx4 v2, s[12:15], s28 offen lds
    s_add_u32 s28, s28, 0x4000
    s_add_u32 m0, s69, 33792
    s_nop 0
    buffer_load_dwordx4 v2, s[12:15], s28 offen lds
    s_add_u32 s28, s28, 0x4000
    s_add_u32 m0, s69, 34816
    s_nop 0
    buffer_load_dwordx4 v2, s[12:15], s28 offen lds
    s_add_u32 s28, s28, 0x4000
    s_add_u32 m0, s69, 35840
    s_nop 0
    buffer_load_dwordx4 v2, s[12:15], s28 offen lds
    s_add_u32 s28, s28, 0x4000
    s_add_u32 m0, s69, 36864
    s_nop 0
    buffer_load_dwordx4 v2, s[12:15], s28 offen lds
    s_add_u32 s28, s28, 0x4000
    s_add_u32 m0, s69, 37888
    s_nop 0
    buffer_load_dwordx4 v2, s[12:15], s28 offen lds
    s_add_u32 s28, s28, 0x4000
    s_add_u32 m0, s69, 38912
    s_nop 0
    buffer_load_dwordx4 v2, s[12:15], s28 offen lds
    s_add_u32 s28, s28, 0x4000
    s_add_u32 m0, s69, 39936
    s_nop 0
    buffer_load_dwordx4 v2, s[12:15], s28 offen lds
    s_add_u32 s28, s28, 0x4000
    s_waitcnt vmcnt(38)
    ds_read_b64_tr_b16 a[0:1], v4 offset:0
    ds_read_b64_tr_b16 a[2:3], v4 offset:512
    ds_read_b64_tr_b16 a[4:5], v4 offset:8
    ds_read_b64_tr_b16 a[6:7], v4 offset:520
    s_waitcnt vmcnt(36)
    ds_read_b64_tr_b16 a[8:9], v4 offset:2048
    ds_read_b64_tr_b16 a[10:11], v4 offset:2560
    ds_read_b64_tr_b16 a[12:13], v4 offset:2056
    ds_read_b64_tr_b16 a[14:15], v4 offset:2568
    s_waitcnt lgkmcnt(4)
    s_add_u32 m0, s69, 0
    s_nop 0
    buffer_load_dwordx4 v2, s[12:15], s28 offen lds
    s_add_u32 s28, s28, 0x4000
    s_add_u32 m0, s69, 1024
    s_nop 0
    buffer_load_dwordx4 v2, s[12:15], s28 offen lds
    s_add_u32 s28, s28, 0x4000
    s_waitcnt vmcnt(36)
    ds_read_b64_tr_b16 a[16:17], v4 offset:4096
    ds_read_b64_tr_b16 a[18:19], v4 offset:4608
    ds_read_b64_tr_b16 a[20:21], v4 offset:4104
    ds_read_b64_tr_b16 a[22:23], v4 offset:4616
    s_waitcnt lgkmcnt(4)
    s_add_u32 m0, s69, 2048
    s_nop 0
    buffer_load_dwordx4 v2, s[12:15], s28 offen lds
    s_add_u32 s28, s28, 0x4000
    s_add_u32 m0, s69, 3072
    s_nop 0
    buffer_load_dwordx4 v2, s[12:15], s28 offen lds
    s_add_u32 s28, s28, 0x4000
    s_waitcnt vmcnt(36)
    ds_read_b64_tr_b16 a[24:25], v4 offset:6144
    ds_read_b64_tr_b16 a[26:27], v4 offset:6656
    ds_read_b64_tr_b16 a[28:29], v4 offset:6152
    ds_read_b64_tr_b16 a[30:31], v4 offset:6664
    s_waitcnt lgkmcnt(4)
    s_add_u32 m0, s69, 4096
    s_nop 0
    buffer_load_dwordx4 v2, s[12:15], s28 offen lds
    s_add_u32 s28, s28, 0x4000
    s_add_u32 m0, s69, 5120
    s_nop 0
    buffer_load_dwordx4 v2, s[12:15], s28 offen lds
    s_add_u32 s28, s28, 0x4000
    s_waitcnt vmcnt(36)
    ds_read_b64_tr_b16 a[32:33], v4 offset:8192
    ds_read_b64_tr_b16 a[34:35], v4 offset:8704
    ds_read_b64_tr_b16 a[36:37], v4 offset:8200
    ds_read_b64_tr_b16 a[38:39], v4 offset:8712
    s_waitcnt lgkmcnt(4)
    s_add_u32 m0, s69, 6144
    s_nop 0
    buffer_load_dwordx4 v2, s[12:15], s28 offen lds
    s_add_u32 s28, s28, 0x4000
    s_add_u32 m0, s69, 7168
    s_nop 0
    buffer_load_dwordx4 v2, s[12:15], s28 offen lds
    s_add_u32 s28, s28, 0x4000
    s_waitcnt vmcnt(36)
    ds_read_b64_tr_b16 a[40:41], v4 offset:10240
    ds_read_b64_tr_b16 a[42:43], v4 offset:10752
    ds_read_b64_tr_b16 a[44:45], v4 offset:10248
    ds_read_b64_tr_b16 a[46:47], v4 offset:10760
    s_waitcnt lgkmcnt(4)
    s_add_u32 m0, s69, 8192
    s_nop 0
    buffer_load_dwordx4 v2, s[12:15], s28 offen lds
    s_add_u32 s28, s28, 0x4000
    s_add_u32 m0, s69, 9216
    s_nop 0
    buffer_load_dwordx4 v2, s[12:15], s28 offen lds
    s_add_u32 s28, s28, 0x4000
    s_waitcnt vmcnt(36)
    ds_read_b64_tr_b16 a[48:49], v4 offset:12288
    ds_read_b64_tr_b16 a[50:51], v4 offset:12800
    ds_read_b64_tr_b16 a[52:53], v4 offset:12296
    ds_read_b64_tr_b16 a[54:55], v4 offset:12808
    s_waitcnt lgkmcnt(4)
    s_add_u32 m0, s69, 10240
    s_nop 0
    buffer_load_dwordx4 v2, s[12:15], s28 offen lds
    s_add_u32 s28, s28, 0x4000
    s_add_u32 m0, s69, 11264
    s_nop 0
    buffer_load_dwordx4 v2, s[12:15], s28 offen lds
    s_add_u32 s28, s28, 0x4000
    s_waitcnt vmcnt(36)
    ds_read_b64_tr_b16 a[56:57], v4 offset:14336
    ds_read_b64_tr_b16 a[58:59], v4 offset:14848
    ds_read_b64_tr_b16 a[60:61], v4 offset:14344
    ds_read_b64_tr_b16 a[62:63], v4 offset:14856
    s_waitcnt lgkmcnt(4)
    s_add_u32 m0, s69, 12288
    s_nop 0
    buffer_load_dwordx4 v2, s[12:15], s28 offen lds
    s_add_u32 s28, s28, 0x4000
    s_add_u32 m0, s69, 13312
    s_nop 0
    buffer_load_dwordx4 v2, s[12:15], s28 offen lds
    s_add_u32 s28, s28, 0x4000
    s_waitcnt vmcnt(36)
    ds_read_b64_tr_b16 a[64:65], v4 offset:16384
    ds_read_b64_tr_b16 a[66:67], v4 offset:16896
    ds_read_b64_tr_b16 a[68:69], v4 offset:16392
    ds_read_b64_tr_b16 a[70:71], v4 offset:16904
    s_waitcnt lgkmcnt(4)
    s_add_u32 m0, s69, 14336
    s_nop 0
    buffer_load_dwordx4 v2, s[12:15], s28 offen lds
    s_add_u32 s28, s28, 0x4000
    s_add_u32 m0, s69, 15360
    s_nop 0
    buffer_load_dwordx4 v2, s[12:15], s28 offen lds
    s_add_u32 s28, s28, 0x4000
    s_waitcnt vmcnt(36)
    ds_read_b64_tr_b16 a[72:73], v4 offset:18432
    ds_read_b64_tr_b16 a[74:75], v4 offset:18944
    ds_read_b64_tr_b16 a[76:77], v4 offset:18440
    ds_read_b64_tr_b16 a[78:79], v4 offset:18952
    s_waitcnt lgkmcnt(4)
    s_add_u32 m0, s69, 16384
    s_nop 0
    buffer_load_dwordx4 v2, s[12:15], s28 offen lds
    s_add_u32 s28, s28, 0x4000
    s_add_u32 m0, s69, 17408
    s_nop 0
    buffer_load_dwordx4 v2, s[12:15], s28 offen lds
    s_add_u32 s28, s28, 0x4000
    s_waitcnt vmcnt(36)
    ds_read_b64_tr_b16 a[80:81], v4 offset:20480
    ds_read_b64_tr_b16 a[82:83], v4 offset:20992
    ds_read_b64_tr_b16 a[84:85], v4 offset:20488
    ds_read_b64_tr_b16 a[86:87], v4 offset:21000
    s_waitcnt lgkmcnt(4)
    s_add_u32 m0, s69, 18432
    s_nop 0
    buffer_load_dwordx4 v2, s[12:15], s28 offen lds
    s_add_u32 s28, s28, 0x4000
    s_add_u32 m0, s69, 19456
    s_nop 0
    buffer_load_dwordx4 v2, s[12:15], s28 offen lds
    s_add_u32 s28, s28, 0x4000
    s_waitcnt vmcnt(36)
    ds_read_b64_tr_b16 a[88:89], v4 offset:22528
    ds_read_b64_tr_b16 a[90:91], v4 offset:23040
    ds_read_b64_tr_b16 a[92:93], v4 offset:22536
    ds_read_b64_tr_b16 a[94:95], v4 offset:23048
    s_waitcnt lgkmcnt(4)
    s_add_u32 m0, s69, 20480
    s_nop 0
    buffer_load_dwordx4 v2, s[12:15], s28 offen lds
    s_add_u32 s28, s28, 0x4000
    s_add_u32 m0, s69, 21504
    s_nop 0
    buffer_load_dwordx4 v2, s[12:15], s28 offen lds
    s_add_u32 s28, s28, 0x4000
    s_waitcnt vmcnt(36)
    ds_read_b64_tr_b16 a[96:97], v4 offset:24576
    ds_read_b64_tr_b16 a[98:99], v4 offset:25088
    ds_read_b64_tr_b16 a[100:101], v4 offset:24584
    ds_read_b64_tr_b16 a[102:103], v4 offset:25096
    s_waitcnt lgkmcnt(4)
    s_add_u32 m0, s69, 22528
    s_nop 0
    buffer_load_dwordx4 v2, s[12:15], s28 offen lds
    s_add_u32 s28, s28, 0x4000
    s_add_u32 m0, s69, 23552
    s_nop 0
    buffer_load_dwordx4 v2, s[12:15], s28 offen lds
    s_add_u32 s28, s28, 0x4000
    s_waitcnt vmcnt(36)
    ds_read_b64_tr_b16 a[104:105], v4 offset:26624
    ds_read_b64_tr_b16 a[106:107], v4 offset:27136
    ds_read_b64_tr_b16 a[108:109], v4 offset:26632
    ds_read_b64_tr_b16 a[110:111], v4 offset:27144
    s_waitcnt lgkmcnt(4)
    s_add_u32 m0, s69, 24576
    s_nop 0
    buffer_load_dwordx4 v2, s[16:19], s29 offen lds
    s_add_u32 s29, s29, 0x4000
    s_add_u32 m0, s69, 25600
    s_nop 0
    buffer_load_dwordx4 v2, s[16:19], s29 offen lds
    s_add_u32 s29, s29, 0x4000
    s_waitcnt vmcnt(36)
    ds_read_b64_tr_b16 a[112:113], v4 offset:28672
    ds_read_b64_tr_b16 a[114:115], v4 offset:29184
    ds_read_b64_tr_b16 a[116:117], v4 offset:28680
    ds_read_b64_tr_b16 a[118:119], v4 offset:29192
    s_waitcnt lgkmcnt(4)
    s_add_u32 m0, s69, 26624
    s_nop 0
    buffer_load_dwordx4 v2, s[16:19], s29 offen lds
    s_add_u32 s29, s29, 0x4000
    s_add_u32 m0, s69, 27648
    s_nop 0
    buffer_load_dwordx4 v2, s[16:19], s29 offen lds
    s_add_u32 s29, s29, 0x4000
    s_waitcnt vmcnt(36)
    ds_read_b64_tr_b16 a[120:121], v4 offset:30720
    ds_read_b64_tr_b16 a[122:123], v4 offset:31232
    ds_read_b64_tr_b16 a[124:125], v4 offset:30728
    ds_read_b64_tr_b16 a[126:127], v4 offset:31240
    s_waitcnt lgkmcnt(4)
    s_add_u32 m0, s69, 28672
    s_nop 0
    buffer_load_dwordx4 v2, s[16:19], s29 offen lds
    s_add_u32 s29, s29, 0x4000
    s_add_u32 m0, s69, 29696
    s_nop 0
    buffer_load_dwordx4 v2, s[16:19], s29 offen lds
    s_add_u32 s29, s29, 0x4000
    s_waitcnt vmcnt(36)
    ds_read_b64_tr_b16 a[128:129], v4 offset:32768
    ds_read_b64_tr_b16 a[130:131], v4 offset:33280
    ds_read_b64_tr_b16 a[132:133], v4 offset:32776
    ds_read_b64_tr_b16 a[134:135], v4 offset:33288
    s_waitcnt lgkmcnt(4)
    s_add_u32 m0, s69, 30720
    s_nop 0
    buffer_load_dwordx4 v2, s[16:19], s29 offen lds
    s_add_u32 s29, s29, 0x4000
    s_add_u32 m0, s69, 31744
    s_nop 0
    buffer_load_dwordx4 v2, s[16:19], s29 offen lds
    s_add_u32 s29, s29, 0x4000
    s_waitcnt vmcnt(36)
    ds_read_b64_tr_b16 a[136:137], v4 offset:34816
    ds_read_b64_tr_b16 a[138:139], v4 offset:35328
    ds_read_b64_tr_b16 a[140:141], v4 offset:34824
    ds_read_b64_tr_b16 a[142:143], v4 offset:35336
    s_waitcnt lgkmcnt(4)
    s_add_u32 m0, s69, 32768
    s_nop 0
    buffer_load_dwordx4 v2, s[16:19], s29 offen lds
    s_add_u32 s29, s29, 0x4000
    s_add_u32 m0, s69, 33792
    s_nop 0
    buffer_load_dwordx4 v2, s[16:19], s29 offen lds
    s_add_u32 s29, s29, 0x4000
    s_waitcnt vmcnt(36)
    ds_read_b64_tr_b16 a[144:145], v4 offset:36864
    ds_read_b64_tr_b16 a[146:147], v4 offset:37376
    ds_read_b64_tr_b16 a[148:149], v4 offset:36872
    ds_read_b64_tr_b16 a[150:151], v4 offset:37384
    s_waitcnt lgkmcnt(4)
    s_add_u32 m0, s69, 34816
    s_nop 0
    buffer_load_dwordx4 v2, s[16:19], s29 offen lds
    s_add_u32 s29, s29, 0x4000
    s_add_u32 m0, s69, 35840
    s_nop 0
    buffer_load_dwordx4 v2, s[16:19], s29 offen lds
    s_add_u32 s29, s29, 0x4000
    s_waitcnt vmcnt(36)
    ds_read_b64_tr_b16 a[152:153], v4 offset:38912
    ds_read_b64_tr_b16 a[154:155], v4 offset:39424
    ds_read_b64_tr_b16 a[156:157], v4 offset:38920
    ds_read_b64_tr_b16 a[158:159], v4 offset:39432
    s_waitcnt lgkmcnt(4)
    s_add_u32 m0, s69, 36864
    s_nop 0
    buffer_load_dwordx4 v2, s[16:19], s29 offen lds
    s_add_u32 s29, s29, 0x4000
    s_add_u32 m0, s69, 37888
    s_nop 0
    buffer_load_dwordx4 v2, s[16:19], s29 offen lds
    s_add_u32 s29, s29, 0x4000
    s_waitcnt vmcnt(36)
    ds_read_b64_tr_b16 a[160:161], v4 offset:0
    ds_read_b64_tr_b16 a[162:163], v4 offset:512
    ds_read_b64_tr_b16 a[164:165], v4 offset:8
    ds_read_b64_tr_b16 a[166:167], v4 offset:520
    s_waitcnt lgkmcnt(4)
    s_add_u32 m0, s69, 38912
    s_nop 0
    buffer_load_dwordx4 v2, s[16:19], s29 offen lds
    s_add_u32 s29, s29, 0x4000
    s_add_u32 m0, s69, 39936
    s_nop 0
    buffer_load_dwordx4 v2, s[16:19], s29 offen lds
    s_add_u32 s29, s29, 0x4000
    s_waitcnt vmcnt(36)
    ds_read_b64_tr_b16 a[168:169], v4 offset:2048
    ds_read_b64_tr_b16 a[170:171], v4 offset:2560
    ds_read_b64_tr_b16 a[172:173], v4 offset:2056
    ds_read_b64_tr_b16 a[174:175], v4 offset:2568
    s_waitcnt lgkmcnt(4)
    s_add_u32 m0, s69, 0
    s_nop 0
    buffer_load_dwordx4 v2, s[16:19], s29 offen lds
    s_add_u32 s29, s29, 0x4000
    s_add_u32 m0, s69, 1024
    s_nop 0
    buffer_load_dwordx4 v2, s[16:19], s29 offen lds
    s_add_u32 s29, s29, 0x4000
    s_waitcnt vmcnt(36)
    ds_read_b64_tr_b16 a[176:177], v4 offset:4096
    ds_read_b64_tr_b16 a[178:179], v4 offset:4608
    ds_read_b64_tr_b16 a[180:181], v4 offset:4104
    ds_read_b64_tr_b16 a[182:183], v4 offset:4616
    s_waitcnt lgkmcnt(4)
    s_add_u32 m0, s69, 2048
    s_nop 0
    buffer_load_dwordx4 v2, s[16:19], s29 offen lds
    s_add_u32 s29, s29, 0x4000
    s_add_u32 m0, s69, 3072
    s_nop 0
    buffer_load_dwordx4 v2, s[16:19], s29 offen lds
    s_add_u32 s29, s29, 0x4000
    s_waitcnt vmcnt(36)
    ds_read_b64_tr_b16 a[184:185], v4 offset:6144
    ds_read_b64_tr_b16 a[186:187], v4 offset:6656
    ds_read_b64_tr_b16 a[188:189], v4 offset:6152
    ds_read_b64_tr_b16 a[190:191], v4 offset:6664
    s_waitcnt lgkmcnt(4)
    s_add_u32 m0, s69, 4096
    s_nop 0
    buffer_load_dwordx4 v2, s[16:19], s29 offen lds
    s_add_u32 s29, s29, 0x4000
    s_add_u32 m0, s69, 5120
    s_nop 0
    buffer_load_dwordx4 v2, s[16:19], s29 offen lds
    s_add_u32 s29, s29, 0x4000
    s_waitcnt vmcnt(36)
    ds_read_b64_tr_b16 a[192:193], v4 offset:8192
    ds_read_b64_tr_b16 a[194:195], v4 offset:8704
    ds_read_b64_tr_b16 a[196:197], v4 offset:8200
    ds_read_b64_tr_b16 a[198:199], v4 offset:8712
    s_waitcnt vmcnt(34)
    ds_read_b64_tr_b16 a[200:201], v4 offset:10240
    ds_read_b64_tr_b16 a[202:203], v4 offset:10752
    ds_read_b64_tr_b16 a[204:205], v4 offset:10248
    ds_read_b64_tr_b16 a[206:207], v4 offset:10760
    s_waitcnt lgkmcnt(4)
    s_waitcnt vmcnt(32)
    ds_read_b64_tr_b16 a[208:209], v4 offset:12288
    ds_read_b64_tr_b16 a[210:211], v4 offset:12800
    ds_read_b64_tr_b16 a[212:213], v4 offset:12296
    ds_read_b64_tr_b16 a[214:215], v4 offset:12808
    s_waitcnt vmcnt(30)
    ds_read_b64_tr_b16 a[216:217], v4 offset:14336
    ds_read_b64_tr_b16 a[218:219], v4 offset:14848
    ds_read_b64_tr_b16 a[220:221], v4 offset:14344
    ds_read_b64_tr_b16 a[222:223], v4 offset:14856
    s_waitcnt lgkmcnt(4)
    s_waitcnt vmcnt(28)
    ds_read_b64_tr_b16 a[224:225], v4 offset:16384
    ds_read_b64_tr_b16 a[226:227], v4 offset:16896
    ds_read_b64_tr_b16 a[228:229], v4 offset:16392
    ds_read_b64_tr_b16 a[230:231], v4 offset:16904
    s_waitcnt vmcnt(26)
    ds_read_b64_tr_b16 a[232:233], v4 offset:18432
    ds_read_b64_tr_b16 a[234:235], v4 offset:18944
    ds_read_b64_tr_b16 a[236:237], v4 offset:18440
    ds_read_b64_tr_b16 a[238:239], v4 offset:18952
    s_waitcnt lgkmcnt(4)
    s_waitcnt vmcnt(24)
    ds_read_b64_tr_b16 a[240:241], v4 offset:20480
    ds_read_b64_tr_b16 a[242:243], v4 offset:20992
    ds_read_b64_tr_b16 a[244:245], v4 offset:20488
    ds_read_b64_tr_b16 a[246:247], v4 offset:21000
    s_waitcnt vmcnt(22)
    ds_read_b64_tr_b16 a[248:249], v4 offset:22528
    ds_read_b64_tr_b16 a[250:251], v4 offset:23040
    ds_read_b64_tr_b16 a[252:253], v4 offset:22536
    ds_read_b64_tr_b16 a[254:255], v4 offset:23048
    s_waitcnt lgkmcnt(4)
    s_waitcnt vmcnt(20)
    ds_read_b64_tr_b16 v[168:169], v4 offset:24576
    ds_read_b64_tr_b16 v[170:171], v4 offset:25088
    ds_read_b64_tr_b16 v[172:173], v4 offset:24584
    ds_read_b64_tr_b16 v[174:175], v4 offset:25096
    s_waitcnt vmcnt(18)
    ds_read_b64_tr_b16 v[176:177], v4 offset:26624
    ds_read_b64_tr_b16 v[178:179], v4 offset:27136
    ds_read_b64_tr_b16 v[180:181], v4 offset:26632
    ds_read_b64_tr_b16 v[182:183], v4 offset:27144
    s_waitcnt lgkmcnt(4)
    s_waitcnt vmcnt(16)
    ds_read_b64_tr_b16 v[184:185], v4 offset:28672
    ds_read_b64_tr_b16 v[186:187], v4 offset:29184
    ds_read_b64_tr_b16 v[188:189], v4 offset:28680
    ds_read_b64_tr_b16 v[190:191], v4 offset:29192
    s_waitcnt vmcnt(14)
    ds_read_b64_tr_b16 v[192:193], v4 offset:30720
    ds_read_b64_tr_b16 v[194:195], v4 offset:31232
    ds_read_b64_tr_b16 v[196:197], v4 offset:30728
    ds_read_b64_tr_b16 v[198:199], v4 offset:31240
    s_waitcnt lgkmcnt(4)
    s_waitcnt vmcnt(12)
    ds_read_b64_tr_b16 v[200:201], v4 offset:32768
    ds_read_b64_tr_b16 v[202:203], v4 offset:33280
    ds_read_b64_tr_b16 v[204:205], v4 offset:32776
    ds_read_b64_tr_b16 v[206:207], v4 offset:33288
    s_waitcnt vmcnt(10)
    ds_read_b64_tr_b16 v[208:209], v4 offset:34816
    ds_read_b64_tr_b16 v[210:211], v4 offset:35328
    ds_read_b64_tr_b16 v[212:213], v4 offset:34824
    ds_read_b64_tr_b16 v[214:215], v4 offset:35336
    s_waitcnt lgkmcnt(4)
    s_waitcnt vmcnt(8)
    ds_read_b64_tr_b16 v[216:217], v4 offset:36864
    ds_read_b64_tr_b16 v[218:219], v4 offset:37376
    ds_read_b64_tr_b16 v[220:221], v4 offset:36872
    ds_read_b64_tr_b16 v[222:223], v4 offset:37384
    s_waitcnt vmcnt(6)
    ds_read_b64_tr_b16 v[224:225], v4 offset:38912
    ds_read_b64_tr_b16 v[226:227], v4 offset:39424
    ds_read_b64_tr_b16 v[228:229], v4 offset:38920
    ds_read_b64_tr_b16 v[230:231], v4 offset:39432
    s_waitcnt lgkmcnt(4)
    s_waitcnt vmcnt(4)
    ds_read_b64_tr_b16 v[232:233], v4 offset:0
    ds_read_b64_tr_b16 v[234:235], v4 offset:512
    ds_read_b64_tr_b16 v[236:237], v4 offset:8
    ds_read_b64_tr_b16 v[238:239], v4 offset:520
    s_waitcnt vmcnt(2)
    ds_read_b64_tr_b16 v[240:241], v4 offset:2048
    ds_read_b64_tr_b16 v[242:243], v4 offset:2560
    ds_read_b64_tr_b16 v[244:245], v4 offset:2056
    ds_read_b64_tr_b16 v[246:247], v4 offset:2568
    s_waitcnt lgkmcnt(4)
    s_waitcnt vmcnt(0)
    ds_read_b64_tr_b16 v[248:249], v4 offset:4096
    ds_read_b64_tr_b16 v[250:251], v4 offset:4608
    ds_read_b64_tr_b16 v[252:253], v4 offset:4104
    ds_read_b64_tr_b16 v[254:255], v4 offset:4616
    s_waitcnt lgkmcnt(0)
    s_barrier
    s_lshr_b32 s27, s26, 4
    v_bfe_u32 v2, v0, 2, 3
    v_lshlrev_b32 v2, 10, v2
    v_and_b32 v3, 3, v0
    v_lshl_add_u32 v2, v3, 2, v2
    s_lshl_b32 s67, s25, 13
    v_add_u32 v10, s67, v2
    v_min_u32 v2, 42, v0
    v_lshlrev_b32 v11, 2, v2
    v_and_b32 v2, 15, v0
    v_lshrrev_b32 v3, 4, v0
    v_lshlrev_b32 v2, 10, v2
    v_lshl_add_u32 v2, v3, 4, v2
    v_add_u32 v12, s34, v2
    s_cmp_eq_u32 s25, 0
    s_cselect_b32 s67, 0, 0x1000000
    v_add_u32 v9, s67, v12
    v_mov_b32 v14, 0
    s_mov_b32 s64, 0
    s_mov_b32 s65, 0
    s_mov_b32 s31, s27
    v_lshlrev_b32 v2, 9, v0
    s_lshl_b32 s67, s25, 15
    s_add_u32 s67, s67, 508
    v_add_u32 v8, s67, v2
    s_mov_b32 s66, 0
    v_mov_b32 v3, 136
    s_mov_b32 s35, 0
F_go:
    global_load_dword v4, v3, s[60:61] sc1
    s_waitcnt vmcnt(0)
    v_cmp_eq_u32 vcc, 0, v4
    s_cbranch_vccz F_go_ok
    s_sleep 4
    s_add_u32 s35, s35, 1
    s_cmp_lt_u32 s35, 131072
    s_cbranch_scc1 F_go
    s_branch L_END
F_go_ok:
    s_lshr_b32 s67, s31, 1
    s_lshl_b32 s33, s67, 8
    s_add_u32 s33, s33, 65536
    s_lshl_b32 s32, s67, 4
    s_add_u32 s32, s32, 32768
    v_cmp_eq_u32 vcc, 0, v14
    s_mul_i32 s29, s31, 196608
    s_add_u32 s29, s29, 52559872
    s_mul_i32 s67, s25, 11
    s_add_u32 s68, s67, 10
    s_min_u32 s68, s68, 42
    s_lshl_b32 s67, s67, 10
    s_lshl_b32 s68, s68, 10
    s_add_u32 s30, s29, s68
    s_add_u32 s29, s29, s67
    s_cbranch_vccnz F_h0
F_h0_go:
    buffer_load_dwordx4 v[28:31], v1, s[4:7], s29 offen offset:0 sc1
    buffer_load_dwordx4 v[32:35], v1, s[4:7], s29 offen offset:1024 sc1
    buffer_load_dwordx4 v[36:39], v1, s[4:7], s29 offen offset:2048 sc1
    buffer_load_dwordx4 v[40:43], v1, s[4:7], s29 offen offset:3072 sc1
    s_add_u32 s29, s29, 0x1000
    buffer_load_dwordx4 v[44:47], v1, s[4:7], s29 offen offset:0 sc1
    buffer_load_dwordx4 v[48:51], v1, s[4:7], s29 offen offset:1024 sc1
    buffer_load_dwordx4 v[52:55], v1, s[4:7], s29 offen offset:2048 sc1
    buffer_load_dwordx4 v[56:59], v1, s[4:7], s29 offen offset:3072 sc1
    s_add_u32 s29, s29, 0x1000
    buffer_load_dwordx4 v[60:63], v1, s[4:7], s29 offen offset:0 sc1
    buffer_load_dwordx4 v[64:67], v1, s[4:7], s29 offen offset:1024 sc1
    buffer_load_dwordx4 v[68:71], v1, s[4:7], s30 offen sc1
    s_lshl_b32 s67, s31, 14
    buffer_load_dwordx4 v[16:19], v9, s[8:11], s67 offen
    s_add_u32 s33, s33, 512
    s_min_u32 s33, s33, 81664
    buffer_load_dword v14, v11, s[4:7], s33 offen sc1
    buffer_load_dword v15, v10, s[4:7], s32 offen sc1
F_U0:
    s_waitcnt vmcnt(0)
F_U:
    s_mul_i32 s28, s27, 196608
    s_lshl_b32 s67, s25, 15
    s_add_u32 s28, s28, s67
    s_add_u32 s28, s28, 52428800
    s_lshl_b32 s34, s27, 14
    s_add_u32 s27, s27, 4
    s_mov_b32 s31, s27
    v_cmp_eq_u32 vcc, s66, v15
    s_cbranch_vccz F_o_ok
    s_mov_b32 s35, 0
F_o:
    buffer_load_dword v15, v10, s[4:7], s32 offen sc1
    s_waitcnt vmcnt(0)
    v_cmp_eq_u32 vcc, s66, v15
    s_cbranch_vccz F_o_ok
    s_add_u32 s35, s35, 1
    s_cmp_lt_u32 s35, 131072
    s_cbranch_scc1 F_o
    s_branch L_END
F_o_ok:
    buffer_load_dwordx4 v[72:75], v1, s[4:7], s28 offen offset:0 sc1
    buffer_load_dwordx4 v[76:79], v1, s[4:7], s28 offen offset:1024 sc1
    buffer_load_dwordx4 v[80:83], v1, s[4:7], s28 offen offset:2048 sc1
    buffer_load_dwordx4 v[84:87], v1, s[4:7], s28 offen offset:3072 sc1
    s_add_u32 s28, s28, 0x1000
    buffer_load_dwordx4 v[88:91], v1, s[4:7], s28 offen offset:0 sc1
    buffer_load_dwordx4 v[92:95], v1, s[4:7], s28 offen offset:1024 sc1
    buffer_load_dwordx4 v[96:99], v1, s[4:7], s28 offen offset:2048 sc1
    buffer_load_dwordx4 v[100:103], v1, s[4:7], s28 offen offset:3072 sc1
    s_add_u32 s28, s28, 0x1000
    buffer_load_dwordx4 v[104:107], v1, s[4:7], s28 offen offset:0 sc1
    buffer_load_dwordx4 v[108:111], v1, s[4:7], s28 offen offset:1024 sc1
    buffer_load_dwordx4 v[112:115], v1, s[4:7], s28 offen offset:2048 sc1
    buffer_load_dwordx4 v[116:119], v1, s[4:7], s28 offen offset:3072 sc1
    s_add_u32 s28, s28, 0x1000
    buffer_load_dwordx4 v[120:123], v1, s[4:7], s28 offen offset:0 sc1
    buffer_load_dwordx4 v[124:127], v1, s[4:7], s28 offen offset:1024 sc1
    buffer_load_dwordx4 v[128:131], v1, s[4:7], s28 offen offset:2048 sc1
    buffer_load_dwordx4 v[132:135], v1, s[4:7], s28 offen offset:3072 sc1
    s_add_u32 s28, s28, 0x1000
    buffer_load_dwordx4 v[136:139], v1, s[4:7], s28 offen offset:0 sc1
    buffer_load_dwordx4 v[140:143], v1, s[4:7], s28 offen offset:1024 sc1
    buffer_load_dwordx4 v[144:147], v1, s[4:7], s28 offen offset:2048 sc1
    buffer_load_dwordx4 v[148:151], v1, s[4:7], s28 offen offset:3072 sc1
    s_add_u32 s28, s28, 0x1000
    buffer_load_dwordx4 v[152:155], v1, s[4:7], s28 offen offset:0 sc1
    buffer_load_dwordx4 v[156:159], v1, s[4:7], s28 offen offset:1024 sc1
    buffer_load_dwordx4 v[160:163], v1, s[4:7], s28 offen offset:2048 sc1
    buffer_load_dwordx4 v[164:167], v1, s[4:7], s28 offen offset:3072 sc1
    s_add_u32 s28, s28, 0x1000
    v_lshlrev_b32 v20, 16, v16
    v_and_b32 v21, 0xffff0000, v16
    v_lshlrev_b32 v22, 16, v17
    v_and_b32 v23, 0xffff0000, v17
    v_lshlrev_b32 v24, 16, v18
    v_and_b32 v25, 0xffff0000, v18
    v_lshlrev_b32 v26, 16, v19
    v_and_b32 v27, 0xffff0000, v19
    s_nop 1
    v_mfma_f32_16x16x32_bf16 v[20:23], v[168:171], v[28:31], v[20:23]
    v_mfma_f32_16x16x32_bf16 v[24:27], v[172:175], v[28:31], v[24:27]
    v_mfma_f32_16x16x32_bf16 v[20:23], v[176:179], v[32:35], v[20:23]
    v_mfma_f32_16x16x32_bf16 v[24:27], v[180:183], v[32:35], v[24:27]
    v_mfma_f32_16x16x32_bf16 v[20:23], v[184:187], v[36:39], v[20:23]
    v_mfma_f32_16x16x32_bf16 v[24:27], v[188:191], v[36:39], v[24:27]
    v_mfma_f32_16x16x32_bf16 v[20:23], v[192:195], v[40:43], v[20:23]
    v_mfma_f32_16x16x32_bf16 v[24:27], v[196:199], v[40:43], v[24:27]
    v_mfma_f32_16x16x32_bf16 v[20:23], v[200:203], v[44:47], v[20:23]
    v_mfma_f32_16x16x32_bf16 v[24:27], v[204:207], v[44:47], v[24:27]
    v_mfma_f32_16x16x32_bf16 v[20:23], v[208:211], v[48:51], v[20:23]
    v_mfma_f32_16x16x32_bf16 v[24:27], v[212:215], v[48:51], v[24:27]
    v_mfma_f32_16x16x32_bf16 v[20:23], v[216:219], v[52:55], v[20:23]
    v_mfma_f32_16x16x32_bf16 v[24:27], v[220:223], v[52:55], v[24:27]
    v_mfma_f32_16x16x32_bf16 v[20:23], v[224:227], v[56:59], v[20:23]
    v_mfma_f32_16x16x32_bf16 v[24:27], v[228:231], v[56:59], v[24:27]
    v_mfma_f32_16x16x32_bf16 v[20:23], v[232:235], v[60:63], v[20:23]
    v_mfma_f32_16x16x32_bf16 v[24:27], v[236:239], v[60:63], v[24:27]
    v_mfma_f32_16x16x32_bf16 v[20:23], v[240:243], v[64:67], v[20:23]
    v_mfma_f32_16x16x32_bf16 v[24:27], v[244:247], v[64:67], v[24:27]
    v_mfma_f32_16x16x32_bf16 v[20:23], v[248:251], v[68:71], v[20:23]
    v_mfma_f32_16x16x32_bf16 v[24:27], v[252:255], v[68:71], v[24:27]
    s_waitcnt vmcnt(23)
    v_mfma_f32_16x16x32_bf16 v[20:23], a[0:3], v[72:75], v[20:23]
    v_mfma_f32_16x16x32_bf16 v[24:27], a[4:7], v[72:75], v[24:27]
    buffer_load_dwordx4 v[72:75], v1, s[4:7], s28 offen offset:0 sc1
    s_waitcnt vmcnt(23)
    v_mfma_f32_16x16x32_bf16 v[20:23], a[8:11], v[76:79], v[20:23]
    v_mfma_f32_16x16x32_bf16 v[24:27], a[12:15], v[76:79], v[24:27]
    buffer_load_dwordx4 v[76:79], v1, s[4:7], s28 offen offset:1024 sc1
    s_waitcnt vmcnt(23)
    v_mfma_f32_16x16x32_bf16 v[20:23], a[16:19], v[80:83], v[20:23]
    v_mfma_f32_16x16x32_bf16 v[24:27], a[20:23], v[80:83], v[24:27]
    buffer_load_dwordx4 v[80:83], v1, s[4:7], s28 offen offset:2048 sc1
    s_waitcnt vmcnt(23)
    v_mfma_f32_16x16x32_bf16 v[20:23], a[24:27], v[84:87], v[20:23]
    v_mfma_f32_16x16x32_bf16 v[24:27], a[28:31], v[84:87], v[24:27]
    buffer_load_dwordx4 v[84:87], v1, s[4:7], s28 offen offset:3072 sc1
    s_add_u32 s28, s28, 0x1000
    s_waitcnt vmcnt(23)
    v_mfma_f32_16x16x32_bf16 v[20:23], a[32:35], v[88:91], v[20:23]
    v_mfma_f32_16x16x32_bf16 v[24:27], a[36:39], v[88:91], v[24:27]
    buffer_load_dwordx4 v[88:91], v1, s[4:7], s28 offen offset:0 sc1
    s_waitcnt vmcnt(23)
    v_mfma_f32_16x16x32_bf16 v[20:23], a[40:43], v[92:95], v[20:23]
    v_mfma_f32_16x16x32_bf16 v[24:27], a[44:47], v[92:95], v[24:27]
    buffer_load_dwordx4 v[92:95], v1, s[4:7], s28 offen offset:1024 sc1
    s_waitcnt vmcnt(23)
    v_mfma_f32_16x16x32_bf16 v[20:23], a[48:51], v[96:99], v[20:23]
    v_mfma_f32_16x16x32_bf16 v[24:27], a[52:55], v[96:99], v[24:27]
    buffer_load_dwordx4 v[96:99], v1, s[4:7], s28 offen offset:2048 sc1
    s_waitcnt vmcnt(23)
    v_mfma_f32_16x16x32_bf16 v[20:23], a[56:59], v[100:103], v[20:23]
    v_mfma_f32_16x16x32_bf16 v[24:27], a[60:63], v[100:103], v[24:27]
    buffer_load_dwordx4 v[100:103], v1, s[4:7], s28 offen offset:3072 sc1
    s_add_u32 s28, s28, 0x1000
    s_waitcnt vmcnt(23)
    v_mfma_f32_16x16x32_bf16 v[20:23], a[64:67], v[104:107], v[20:23]
    v_mfma_f32_16x16x32_bf16 v[24:27], a[68:71], v[104:107], v[24:27]
    s_waitcnt vmcnt(22)
    v_mfma_f32_16x16x32_bf16 v[20:23], a[72:75], v[108:111], v[20:23]
    v_mfma_f32_16x16x32_bf16 v[24:27], a[76:79], v[108:111], v[24:27]
    s_waitcnt vmcnt(21)
    v_mfma_f32_16x16x32_bf16 v[20:23], a[80:83], v[112:115], v[20:23]
    v_mfma_f32_16x16x32_bf16 v[24:27], a[84:87], v[112:115], v[24:27]
    s_cmp_ge_u32 s27, 128
    s_cbranch_scc1 F_last
    s_lshr_b32 s67, s31, 1
    s_lshl_b32 s33, s67, 8
    s_add_u32 s33, s33, 65536
    s_lshl_b32 s32, s67, 4
    s_add_u32 s32, s32, 32768
    v_cmp_eq_u32 vcc, 0, v14
    s_mul_i32 s29, s31, 196608
    s_add_u32 s29, s29, 52559872
    s_mul_i32 s67, s25, 11
    s_add_u32 s68, s67, 10
    s_min_u32 s68, s68, 42
    s_lshl_b32 s67, s67, 10
    s_lshl_b32 s68, s68, 10
    s_add_u32 s30, s29, s68
    s_add_u32 s29, s29, s67
    s_cbranch_vccnz F_h1
F_h1_go:
    buffer_load_dwordx4 v[28:31], v1, s[4:7], s29 offen offset:0 sc1
    buffer_load_dwordx4 v[32:35], v1, s[4:7], s29 offen offset:1024 sc1
    buffer_load_dwordx4 v[36:39], v1, s[4:7], s29 offen offset:2048 sc1
    buffer_load_dwordx4 v[40:43], v1, s[4:7], s29 offen offset:3072 sc1
    s_add_u32 s29, s29, 0x1000
    buffer_load_dwordx4 v[44:47], v1, s[4:7], s29 offen offset:0 sc1
    buffer_load_dwordx4 v[48:51], v1, s[4:7], s29 offen offset:1024 sc1
    buffer_load_dwordx4 v[52:55], v1, s[4:7], s29 offen offset:2048 sc1
    buffer_load_dwordx4 v[56:59], v1, s[4:7], s29 offen offset:3072 sc1
    s_add_u32 s29, s29, 0x1000
    buffer_load_dwordx4 v[60:63], v1, s[4:7], s29 offen offset:0 sc1
    buffer_load_dwordx4 v[64:67], v1, s[4:7], s29 offen offset:1024 sc1
    buffer_load_dwordx4 v[68:71], v1, s[4:7], s30 offen sc1
    s_lshl_b32 s67, s31, 14
    buffer_load_dwordx4 v[16:19], v9, s[8:11], s67 offen
    s_add_u32 s33, s33, 512
    s_min_u32 s33, s33, 81664
    buffer_load_dword v14, v11, s[4:7], s33 offen sc1
    buffer_load_dword v15, v10, s[4:7], s32 offen sc1
    s_waitcnt vmcnt(34)
    v_mfma_f32_16x16x32_bf16 v[20:23], a[88:91], v[116:119], v[20:23]
    v_mfma_f32_16x16x32_bf16 v[24:27], a[92:95], v[116:119], v[24:27]
    s_waitcnt vmcnt(33)
    v_mfma_f32_16x16x32_bf16 v[20:23], a[96:99], v[120:123], v[20:23]
    v_mfma_f32_16x16x32_bf16 v[24:27], a[100:103], v[120:123], v[24:27]
    s_waitcnt vmcnt(32)
    v_mfma_f32_16x16x32_bf16 v[20:23], a[104:107], v[124:127], v[20:23]
    v_mfma_f32_16x16x32_bf16 v[24:27], a[108:111], v[124:127], v[24:27]
    s_waitcnt vmcnt(31)
    v_mfma_f32_16x16x32_bf16 v[20:23], a[112:115], v[128:131], v[20:23]
    v_mfma_f32_16x16x32_bf16 v[24:27], a[116:119], v[128:131], v[24:27]
    s_waitcnt vmcnt(30)
    v_mfma_f32_16x16x32_bf16 v[20:23], a[120:123], v[132:135], v[20:23]
    v_mfma_f32_16x16x32_bf16 v[24:27], a[124:127], v[132:135], v[24:27]
    s_waitcnt vmcnt(29)
    v_mfma_f32_16x16x32_bf16 v[20:23], a[128:131], v[136:139], v[20:23]
    v_mfma_f32_16x16x32_bf16 v[24:27], a[132:135], v[136:139], v[24:27]
    s_waitcnt vmcnt(28)
    v_mfma_f32_16x16x32_bf16 v[20:23], a[136:139], v[140:143], v[20:23]
    v_mfma_f32_16x16x32_bf16 v[24:27], a[140:143], v[140:143], v[24:27]
    s_waitcnt vmcnt(27)
    v_mfma_f32_16x16x32_bf16 v[20:23], a[144:147], v[144:147], v[20:23]
    v_mfma_f32_16x16x32_bf16 v[24:27], a[148:151], v[144:147], v[24:27]
    s_waitcnt vmcnt(26)
    v_mfma_f32_16x16x32_bf16 v[20:23], a[152:155], v[148:151], v[20:23]
    v_mfma_f32_16x16x32_bf16 v[24:27], a[156:159], v[148:151], v[24:27]
    s_waitcnt vmcnt(25)
    v_mfma_f32_16x16x32_bf16 v[20:23], a[160:163], v[152:155], v[20:23]
    v_mfma_f32_16x16x32_bf16 v[24:27], a[164:167], v[152:155], v[24:27]
    s_waitcnt vmcnt(24)
    v_mfma_f32_16x16x32_bf16 v[20:23], a[168:171], v[156:159], v[20:23]
    v_mfma_f32_16x16x32_bf16 v[24:27], a[172:175], v[156:159], v[24:27]
    s_waitcnt vmcnt(23)
    v_mfma_f32_16x16x32_bf16 v[20:23], a[176:179], v[160:163], v[20:23]
    v_mfma_f32_16x16x32_bf16 v[24:27], a[180:183], v[160:163], v[24:27]
    s_waitcnt vmcnt(22)
    v_mfma_f32_16x16x32_bf16 v[20:23], a[184:187], v[164:167], v[20:23]
    v_mfma_f32_16x16x32_bf16 v[24:27], a[188:191], v[164:167], v[24:27]
    s_waitcnt vmcnt(21)
    v_mfma_f32_16x16x32_bf16 v[20:23], a[192:195], v[72:75], v[20:23]
    v_mfma_f32_16x16x32_bf16 v[24:27], a[196:199], v[72:75], v[24:27]
    s_waitcnt vmcnt(20)
    v_mfma_f32_16x16x32_bf16 v[20:23], a[200:203], v[76:79], v[20:23]
    v_mfma_f32_16x16x32_bf16 v[24:27], a[204:207], v[76:79], v[24:27]
    s_waitcnt vmcnt(19)
    v_mfma_f32_16x16x32_bf16 v[20:23], a[208:211], v[80:83], v[20:23]
    v_mfma_f32_16x16x32_bf16 v[24:27], a[212:215], v[80:83], v[24:27]
    s_waitcnt vmcnt(18)
    v_mfma_f32_16x16x32_bf16 v[20:23], a[216:219], v[84:87], v[20:23]
    v_mfma_f32_16x16x32_bf16 v[24:27], a[220:223], v[84:87], v[24:27]
    s_waitcnt vmcnt(17)
    v_mfma_f32_16x16x32_bf16 v[20:23], a[224:227], v[88:91], v[20:23]
    v_mfma_f32_16x16x32_bf16 v[24:27], a[228:231], v[88:91], v[24:27]
    s_waitcnt vmcnt(16)
    v_mfma_f32_16x16x32_bf16 v[20:23], a[232:235], v[92:95], v[20:23]
    v_mfma_f32_16x16x32_bf16 v[24:27], a[236:239], v[92:95], v[24:27]
    s_waitcnt vmcnt(15)
    v_mfma_f32_16x16x32_bf16 v[20:23], a[240:243], v[96:99], v[20:23]
    v_mfma_f32_16x16x32_bf16 v[24:27], a[244:247], v[96:99], v[24:27]
    s_waitcnt vmcnt(14)
    v_mfma_f32_16x16x32_bf16 v[20:23], a[248:251], v[100:103], v[20:23]
    v_mfma_f32_16x16x32_bf16 v[24:27], a[252:255], v[100:103], v[24:27]
F_red:
    s_lshl_b32 s67, s25, 11
    s_add_u32 s67, s67, s64
    v_add_u32 v13, s67, v1
    v_add_u32 v2, s64, v1
    s_xor_b32 s64, s64, 0x2000
    s_nop 2
    ds_write_b128 v13, v[20:23]
    ds_write_b128 v13, v[24:27] offset:1024
    s_waitcnt lgkmcnt(0)
    s_barrier
    s_cmp_lg_u32 s25, 0
    s_cbranch_scc1 F_next
    ds_read_b128 v[72:75], v2 offset:2048
    ds_read_b128 v[76:79], v2 offset:3072
    ds_read_b128 v[80:83], v2 offset:4096
    ds_read_b128 v[84:87], v2 offset:5120
    ds_read_b128 v[88:91], v2 offset:6144
    ds_read_b128 v[92:95], v2 offset:7168
    s_waitcnt lgkmcnt(0)
    v_add_f32 v72, v72, v80
    v_add_f32 v20, v20, v88
    v_add_f32 v73, v73, v81
    v_add_f32 v21, v21, v89
    v_add_f32 v74, v74, v82
    v_add_f32 v22, v22, v90
    v_add_f32 v75, v75, v83
    v_add_f32 v23, v23, v91
    v_add_f32 v76, v76, v84
    v_add_f32 v24, v24, v92
    v_add_f32 v77, v77, v85
    v_add_f32 v25, v25, v93
    v_add_f32 v78, v78, v86
    v_add_f32 v26, v26, v94
    v_add_f32 v79, v79, v87
    v_add_f32 v27, v27, v95
    v_add_f32 v20, v20, v72
    v_add_f32 v21, v21, v73
    v_add_f32 v22, v22, v74
    v_add_f32 v23, v23, v75
    v_add_f32 v24, v24, v76
    v_add_f32 v25, v25, v77
    v_add_f32 v26, v26, v78
    v_add_f32 v27, v27, v79
    v_cvt_pk_bf16_f32 v4, v20, v21
    v_cvt_pk_bf16_f32 v5, v22, v23
    v_cvt_pk_bf16_f32 v6, v24, v25
    v_cvt_pk_bf16_f32 v7, v26, v27
    buffer_store_dwordx4 v[4:7], v12, s[20:23], s34 offen nt
    s_waitcnt vmcnt(1)
    s_cmp_lt_u32 s27, 128
    s_cbranch_scc1 F_U
    s_branch L_END
F_next:
    s_cmp_lt_u32 s27, 128
    s_cbranch_scc1 F_U0
    s_branch L_END
F_h0:
    s_mov_b32 s35, 0
F_h0s:
    buffer_load_dword v14, v11, s[4:7], s33 offen sc1
    s_waitcnt vmcnt(0)
    v_cmp_eq_u32 vcc, 0, v14
    s_cbranch_vccz F_h0s_ok
    s_sleep 1
    s_add_u32 s35, s35, 1
    s_cmp_lt_u32 s35, 131072
    s_cbranch_scc1 F_h0s
    s_branch L_END
F_h0s_ok:
    s_branch F_h0_go
F_last:
    s_waitcnt vmcnt(20)
    v_mfma_f32_16x16x32_bf16 v[20:23], a[88:91], v[116:119], v[20:23]
    v_mfma_f32_16x16x32_bf16 v[24:27], a[92:95], v[116:119], v[24:27]
    s_waitcnt vmcnt(19)
    v_mfma_f32_16x16x32_bf16 v[20:23], a[96:99], v[120:123], v[20:23]
    v_mfma_f32_16x16x32_bf16 v[24:27], a[100:103], v[120:123], v[24:27]
    s_waitcnt vmcnt(18)
    v_mfma_f32_16x16x32_bf16 v[20:23], a[104:107], v[124:127], v[20:23]
    v_mfma_f32_16x16x32_bf16 v[24:27], a[108:111], v[124:127], v[24:27]
    s_waitcnt vmcnt(17)
    v_mfma_f32_16x16x32_bf16 v[20:23], a[112:115], v[128:131], v[20:23]
    v_mfma_f32_16x16x32_bf16 v[24:27], a[116:119], v[128:131], v[24:27]
    s_waitcnt vmcnt(16)
    v_mfma_f32_16x16x32_bf16 v[20:23], a[120:123], v[132:135], v[20:23]
    v_mfma_f32_16x16x32_bf16 v[24:27], a[124:127], v[132:135], v[24:27]
    s_waitcnt vmcnt(15)
    v_mfma_f32_16x16x32_bf16 v[20:23], a[128:131], v[136:139], v[20:23]
    v_mfma_f32_16x16x32_bf16 v[24:27], a[132:135], v[136:139], v[24:27]
    s_waitcnt vmcnt(14)
    v_mfma_f32_16x16x32_bf16 v[20:23], a[136:139], v[140:143], v[20:23]
    v_mfma_f32_16x16x32_bf16 v[24:27], a[140:143], v[140:143], v[24:27]
    s_waitcnt vmcnt(13)
    v_mfma_f32_16x16x32_bf16 v[20:23], a[144:147], v[144:147], v[20:23]
    v_mfma_f32_16x16x32_bf16 v[24:27], a[148:151], v[144:147], v[24:27]
    s_waitcnt vmcnt(12)
    v_mfma_f32_16x16x32_bf16 v[20:23], a[152:155], v[148:151], v[20:23]
    v_mfma_f32_16x16x32_bf16 v[24:27], a[156:159], v[148:151], v[24:27]
    s_waitcnt vmcnt(11)
    v_mfma_f32_16x16x32_bf16 v[20:23], a[160:163], v[152:155], v[20:23]
    v_mfma_f32_16x16x32_bf16 v[24:27], a[164:167], v[152:155], v[24:27]
    s_waitcnt vmcnt(10)
    v_mfma_f32_16x16x32_bf16 v[20:23], a[168:171], v[156:159], v[20:23]
    v_mfma_f32_16x16x32_bf16 v[24:27], a[172:175], v[156:159], v[24:27]
    s_waitcnt vmcnt(9)
    v_mfma_f32_16x16x32_bf16 v[20:23], a[176:179], v[160:163], v[20:23]
    v_mfma_f32_16x16x32_bf16 v[24:27], a[180:183], v[160:163], v[24:27]
    s_waitcnt vmcnt(8)
    v_mfma_f32_16x16x32_bf16 v[20:23], a[184:187], v[164:167], v[20:23]
    v_mfma_f32_16x16x32_bf16 v[24:27], a[188:191], v[164:167], v[24:27]
    s_waitcnt vmcnt(7)
    v_mfma_f32_16x16x32_bf16 v[20:23], a[192:195], v[72:75], v[20:23]
    v_mfma_f32_16x16x32_bf16 v[24:27], a[196:199], v[72:75], v[24:27]
    s_waitcnt vmcnt(6)
    v_mfma_f32_16x16x32_bf16 v[20:23], a[200:203], v[76:79], v[20:23]
    v_mfma_f32_16x16x32_bf16 v[24:27], a[204:207], v[76:79], v[24:27]
    s_waitcnt vmcnt(5)
    v_mfma_f32_16x16x32_bf16 v[20:23], a[208:211], v[80:83], v[20:23]
    v_mfma_f32_16x16x32_bf16 v[24:27], a[212:215], v[80:83], v[24:27]
    s_waitcnt vmcnt(4)
    v_mfma_f32_16x16x32_bf16 v[20:23], a[216:219], v[84:87], v[20:23]
    v_mfma_f32_16x16x32_bf16 v[24:27], a[220:223], v[84:87], v[24:27]
    s_waitcnt vmcnt(3)
    v_mfma_f32_16x16x32_bf16 v[20:23], a[224:227], v[88:91], v[20:23]
    v_mfma_f32_16x16x32_bf16 v[24:27], a[228:231], v[88:91], v[24:27]
    s_waitcnt vmcnt(2)
    v_mfma_f32_16x16x32_bf16 v[20:23], a[232:235], v[92:95], v[20:23]
    v_mfma_f32_16x16x32_bf16 v[24:27], a[236:239], v[92:95], v[24:27]
    s_waitcnt vmcnt(1)
    v_mfma_f32_16x16x32_bf16 v[20:23], a[240:243], v[96:99], v[20:23]
    v_mfma_f32_16x16x32_bf16 v[24:27], a[244:247], v[96:99], v[24:27]
    s_waitcnt vmcnt(0)
    v_mfma_f32_16x16x32_bf16 v[20:23], a[248:251], v[100:103], v[20:23]
    v_mfma_f32_16x16x32_bf16 v[24:27], a[252:255], v[100:103], v[24:27]
    s_branch F_red
F_h1:
    s_mov_b32 s35, 0
F_h1s:
    buffer_load_dword v14, v11, s[4:7], s33 offen sc1
    s_waitcnt vmcnt(0)
    v_cmp_eq_u32 vcc, 0, v14
    s_cbranch_vccz F_h1s_ok
    s_sleep 1
    s_add_u32 s35, s35, 1
    s_cmp_lt_u32 s35, 131072
    s_cbranch_scc1 F_h1s
    s_branch L_END
F_h1s_ok:
    s_branch F_h1_go
ROLE_R:
    s_mov_b32 s8, s44
    s_mov_b32 s9, s45
    s_mov_b32 s10, 0x400000
    s_mov_b32 s11, 0x20000
    s_mov_b32 s12, s40
    s_mov_b32 s13, s41
    s_mov_b32 s14, 0x400000
    s_mov_b32 s15, 0x20000
    s_mov_b32 s16, s42
    s_mov_b32 s17, s43
    s_mov_b32 s18, 0x400000
    s_mov_b32 s19, 0x20000
    s_mov_b32 s20, s46
    s_mov_b32 s21, s47
    s_mov_b32 s22, 0x400000
    s_mov_b32 s23, 0x20000
    v_mov_b32 v12, v0
    v_lshrrev_b32 v13, 4, v12
    v_and_b32 v14, 15, v12
    v_lshlrev_b32 v0, 4, v12
    v_add_u32 v1, 0x10000, v0
    v_add_u32 v2, 0x20000, v0
    v_mov_b32 v9, v0
    v_bfe_u32 v15, v12, 1, 1
    v_mul_u32_u24 v15, 0xaaaa, v15
    v_add_u32 v3, 0x4444, v15
    v_and_b32 v15, 7, v14
    v_lshlrev_b32 v15, 3, v15
    v_lshrrev_b32 v16, 1, v13
    v_lshl_add_u32 v15, v16, 14, v15
    v_lshrrev_b32 v16, 3, v14
    v_lshl_add_u32 v15, v16, 15, v15
    v_and_b32 v16, 1, v13
    v_lshl_add_u32 v15, v16, 7, v15
    v_lshlrev_b32 v16, 3, v16
    s_lshr_b32 s67, s24, 1
    v_xor_b32 v16, s67, v16
    v_lshl_add_u32 v4, v16, 8, v15
    v_and_b32 v17, 3, v12
    v_lshlrev_b32 v15, 2, v17
    v_lshl_add_u32 v5, v13, 4, v15
    v_lshrrev_b32 v15, 2, v14
    v_mul_u32_u24 v15, 136, v15
    v_lshl_add_u32 v15, v13, 3, v15
    v_lshl_add_u32 v6, v17, 5, v15
    v_lshrrev_b32 v15, 1, v13
    v_mul_u32_u24 v15, 544, v15
    v_and_b32 v16, 1, v13
    v_mul_u32_u24 v16, 136, v16
    v_add_u32 v15, v15, v16
    v_lshl_add_u32 v7, v14, 3, v15
    v_lshrrev_b32 v15, 2, v14
    v_and_b32 v16, 1, v14
    v_lshl_add_u32 v15, v15, 1, v16
    v_lshlrev_b32 v15, 4, v15
    v_lshl_add_u32 v8, v13, 7, v15
    v_lshrrev_b32 v15, 3, v12
    v_and_b32 v16, 7, v12
    v_lshlrev_b32 v16, 4, v16
    v_lshl_add_u32 v10, v15, 8, v16
    v_mov_b32 v16, 0x3f80
    v_bfe_u32 v15, v14, 2, 1
    v_lshlrev_b32 v15, 4, v15
    v_lshlrev_b32 v16, v15, v16
    v_and_b32 v15, 11, v14
    v_cmp_eq_u32 vcc, 0, v15
    s_nop 1
    v_cndmask_b32 v20, 0, v16, vcc
    v_cmp_eq_u32 vcc, 8, v15
    s_nop 1
    v_cndmask_b32 v21, 0, v16, vcc
    v_cmp_eq_u32 vcc, 1, v15
    s_nop 1
    v_cndmask_b32 v22, 0, v16, vcc
    v_cmp_eq_u32 vcc, 9, v15
    s_nop 1
    v_cndmask_b32 v23, 0, v16, vcc
    ds_write_b128 v0, v[20:23] offset:30976
    s_and_b32 s67, s25, 1
    s_lshl_b32 s67, s67, 2
    v_and_b32 v15, 1, v13
    v_or_b32 v15, s67, v15
    v_lshlrev_b32 v15, 1, v15
    v_xor_b32 v15, v15, v14
    v_lshlrev_b32 v15, 4, v15
    v_lshl_add_u32 v15, v13, 13, v15
    s_lshr_b32 s67, s25, 1
    s_lshl_b32 s67, s67, 20
    s_and_b32 s68, s25, 1
    s_lshl_b32 s68, s68, 17
    s_add_u32 s67, s67, s68
    s_lshl_b32 s68, s24, 8
    s_add_u32 s67, s67, s68
    v_add_u32 v24, s67, v15
    v_and_b32 v15, 1, v13
    v_lshlrev_b32 v15, 2, v15
    v_xor_b32 v15, v15, v14
    v_lshlrev_b32 v15, 4, v15
    v_lshl_add_u32 v15, v13, 10, v15
    s_lshl_b32 s67, s25, 8
    s_lshl_b32 s68, s24, 17
    s_add_u32 s67, s67, s68
    v_add_u32 v25, s67, v15
    v_bfe_u32 v15, v12, 2, 1
    v_bfe_u32 v16, v12, 3, 1
    v_and_b32 v18, 1, v13
    v_lshrrev_b32 v19, 1, v13
    v_lshl_add_u32 v28, v16, 1, v18
    v_lshl_add_u32 v29, v28, 1, v15
    v_lshl_add_u32 v28, v13, 2, v15
    v_lshl_add_u32 v28, v16, 4, v28
    s_lshl_b32 s67, s25, 1
    v_xor_b32 v29, s67, v29
    v_lshlrev_b32 v29, 5, v29
    v_lshl_add_u32 v29, v28, 8, v29
    v_lshl_add_u32 v26, v17, 3, v29
    v_lshl_add_u32 v28, v19, 2, v15
    v_lshlrev_b32 v28, 8, v28
    v_lshl_add_u32 v28, v18, 14, v28
    v_lshl_add_u32 v29, v18, 1, v15
    v_lshl_add_u32 v28, v29, 6, v28
    v_lshl_add_u32 v28, v16, 5, v28
    v_lshl_add_u32 v28, v17, 3, v28
    s_lshl_b32 s67, s25, 12
    v_add_u32 v27, s67, v28
    s_lshl_b32 s32, s25, 11
    s_lshl_b32 s67, s24, 6
    s_add_u32 s32, s32, s67
    s_add_u32 s32, s32, 3145728
    s_and_b32 s67, s67, 64
    s_lshr_b32 s27, s24, 1
    s_lshl_b32 s27, s27, 8
    s_add_u32 s27, s27, s67
    s_lshr_b32 s68, s25, 1
    s_lshl_b32 s28, s68, 12
    s_add_u32 s27, s27, s28
    s_xor_b32 s28, s68, 1
    s_lshl_b32 s28, s28, 7
    s_and_b32 s68, s25, 1
    s_lshl_b32 s68, s68, 7
    s_add_u32 s27, s27, s68
    s_add_u32 s27, s27, 131072
    s_lshl_b32 s68, s68, 4
    s_add_u32 s28, s28, s68
    s_add_u32 s28, s28, 131072
    s_add_u32 s69, s28, 0x1000
    s_lshl_b32 s29, s25, 16
    s_add_u32 s29, s29, s67
    s_add_u32 s29, s29, 524288
    s_lshr_b32 s30, s24, 1
    s_lshl_b32 s30, s30, 14
    s_lshl_b32 s67, s67, 1
    s_add_u32 s30, s30, s67
    s_lshl_b32 s67, s25, 12
    s_add_u32 s30, s30, s67
    s_add_u32 s30, s30, 786432
    s_lshl_b32 s67, s25, 11
    s_mul_i32 s31, s24, 1064960
    s_add_u32 s31, s31, s67
    s_add_u32 s31, s31, 16777216
    s_lshl_b32 s66, s25, 11
    s_mov_b32 s64, 0x3e0293ee
    s_mov_b32 s26, 0
    s_add_u32 s31, s31, 0
    s_add_u32 s32, s32, 0
    s_cmp_eq_u32 s25, 1
    s_cbranch_scc1 R1_start
    s_cmp_eq_u32 s25, 2
    s_cbranch_scc1 R2_start
    s_cmp_eq_u32 s25, 3
    s_cbranch_scc1 R3_start
R0_start:
    v_xor_b32 v30, 0x80, v25
    v_xor_b32 v15, 0x40, v24
    v_mov_b32 v31, v27
    s_mov_b32 m0, 32768
    s_mov_b32 s67, 0
    buffer_load_dwordx4 v24, s[16:19], s67 offen lds
    s_mov_b32 m0, 33792
    s_mov_b32 s67, 32768
    buffer_load_dwordx4 v15, s[16:19], s67 offen lds
    s_mov_b32 m0, 34816
    s_mov_b32 s67, 65536
    buffer_load_dwordx4 v24, s[16:19], s67 offen lds
    s_mov_b32 m0, 35840
    s_mov_b32 s67, 98304
    buffer_load_dwordx4 v15, s[16:19], s67 offen lds
    s_mov_b32 m0, 49152
    s_mov_b32 s67, 2097152
    buffer_load_dwordx4 v24, s[16:19], s67 offen lds
    s_mov_b32 m0, 50176
    s_mov_b32 s67, 2129920
    buffer_load_dwordx4 v15, s[16:19], s67 offen lds
    s_mov_b32 m0, 51200
    s_mov_b32 s67, 2162688
    buffer_load_dwordx4 v24, s[16:19], s67 offen lds
    s_mov_b32 m0, 52224
    s_mov_b32 s67, 2195456
    buffer_load_dwordx4 v15, s[16:19], s67 offen lds
    s_mov_b32 m0, 65536
    s_mov_b32 s67, 262144
    buffer_load_dwordx4 v24, s[16:19], s67 offen lds
    s_mov_b32 m0, 66560
    s_mov_b32 s67, 294912
    buffer_load_dwordx4 v15, s[16:19], s67 offen lds
    s_mov_b32 m0, 67584
    s_mov_b32 s67, 327680
    buffer_load_dwordx4 v24, s[16:19], s67 offen lds
    s_mov_b32 m0, 68608
    s_mov_b32 s67, 360448
    buffer_load_dwordx4 v15, s[16:19], s67 offen lds
    s_mov_b32 m0, 81920
    s_mov_b32 s67, 2359296
    buffer_load_dwordx4 v24, s[16:19], s67 offen lds
    s_mov_b32 m0, 82944
    s_mov_b32 s67, 2392064
    buffer_load_dwordx4 v15, s[16:19], s67 offen lds
    s_mov_b32 m0, 83968
    s_mov_b32 s67, 2424832
    buffer_load_dwordx4 v24, s[16:19], s67 offen lds
    s_mov_b32 m0, 84992
    s_mov_b32 s67, 2457600
    buffer_load_dwordx4 v15, s[16:19], s67 offen lds
    s_mov_b32 m0, 98304
    s_mov_b32 s67, 524288
    buffer_load_dwordx4 v24, s[16:19], s67 offen lds
    s_mov_b32 m0, 99328
    s_mov_b32 s67, 557056
    buffer_load_dwordx4 v15, s[16:19], s67 offen lds
    s_mov_b32 m0, 100352
    s_mov_b32 s67, 589824
    buffer_load_dwordx4 v24, s[16:19], s67 offen lds
    s_mov_b32 m0, 101376
    s_mov_b32 s67, 622592
    buffer_load_dwordx4 v15, s[16:19], s67 offen lds
    s_mov_b32 m0, 114688
    s_mov_b32 s67, 2621440
    buffer_load_dwordx4 v24, s[16:19], s67 offen lds
    s_mov_b32 m0, 115712
    s_mov_b32 s67, 2654208
    buffer_load_dwordx4 v15, s[16:19], s67 offen lds
    s_mov_b32 m0, 116736
    s_mov_b32 s67, 2686976
    buffer_load_dwordx4 v24, s[16:19], s67 offen lds
    s_mov_b32 m0, 117760
    s_mov_b32 s67, 2719744
    buffer_load_dwordx4 v15, s[16:19], s67 offen lds
    s_mov_b32 m0, 131072
    s_mov_b32 s67, 786432
    buffer_load_dwordx4 v24, s[16:19], s67 offen lds
    s_mov_b32 m0, 132096
    s_mov_b32 s67, 819200
    buffer_load_dwordx4 v15, s[16:19], s67 offen lds
    s_mov_b32 m0, 133120
    s_mov_b32 s67, 851968
    buffer_load_dwordx4 v24, s[16:19], s67 offen lds
    s_mov_b32 m0, 134144
    s_mov_b32 s67, 884736
    buffer_load_dwordx4 v15, s[16:19], s67 offen lds
    s_mov_b32 m0, 147456
    s_mov_b32 s67, 2883584
    buffer_load_dwordx4 v24, s[16:19], s67 offen lds
    s_mov_b32 m0, 148480
    s_mov_b32 s67, 2916352
    buffer_load_dwordx4 v15, s[16:19], s67 offen lds
    s_mov_b32 m0, 149504
    s_mov_b32 s67, 2949120
    buffer_load_dwordx4 v24, s[16:19], s67 offen lds
    s_mov_b32 m0, 150528
    s_mov_b32 s67, 2981888
    buffer_load_dwordx4 v15, s[16:19], s67 offen lds
    s_mov_b32 s72, s38
    s_mov_b32 s73, s39
    s_mov_b32 s74, 8192
    s_mov_b32 s75, 0x20000
    s_and_b32 s67, s24, 3
    s_lshl_b32 s67, s67, 11
    s_lshr_b32 s68, s24, 3
    s_lshl_b32 s68, s68, 8
    s_add_u32 s67, s67, s68
    s_and_b32 s68, s24, 4
    s_lshl_b32 s68, s68, 2
    s_add_u32 s67, s67, s68
    v_and_b32 v28, 1, v13
    v_lshlrev_b32 v28, 10, v28
    v_lshl_add_u32 v28, v17, 2, v28
    v_lshrrev_b32 v29, 1, v13
    v_lshl_add_u32 v28, v29, 5, v28
    buffer_load_dword v18, v28, s[72:75], s67 offen offset:0
    s_lshl_b32 s33, s24, 10
    s_add_u32 s33, s33, 0
    s_add_u32 s34, s33, 992
    s_add_u32 s33, s33, 0
    s_waitcnt vmcnt(29)
    s_barrier
    v_add_u32 v28, 32768, v26
    v_xor_b32 v29, 32, v28
    ds_read_b64_tr_b16 a[32:33], v28 offset:0
    ds_read_b64_tr_b16 a[34:35], v28 offset:512
    ds_read_b64_tr_b16 a[36:37], v28 offset:8192
    ds_read_b64_tr_b16 a[38:39], v28 offset:8704
    ds_read_b64_tr_b16 a[48:49], v29 offset:0
    ds_read_b64_tr_b16 a[50:51], v29 offset:512
    ds_read_b64_tr_b16 a[52:53], v29 offset:8192
    ds_read_b64_tr_b16 a[54:55], v29 offset:8704
    s_waitcnt lgkmcnt(0)
    s_waitcnt vmcnt(25)
    s_barrier
    s_and_b32 s67, s24, 3
    s_cmp_eq_u32 s67, 1
    s_cbranch_scc1 R0_th1
    s_waitcnt vmcnt(4)
R0_th1:
    s_mov_b32 m0, 32768
    s_mov_b32 s67, 0
    buffer_load_dwordx4 v24, s[8:11], s67 offen lds
    s_mov_b32 m0, 33792
    s_mov_b32 s67, 32768
    buffer_load_dwordx4 v15, s[8:11], s67 offen lds
    s_mov_b32 m0, 34816
    s_mov_b32 s67, 65536
    buffer_load_dwordx4 v24, s[8:11], s67 offen lds
    s_mov_b32 m0, 35840
    s_mov_b32 s67, 98304
    buffer_load_dwordx4 v15, s[8:11], s67 offen lds
    v_add_u32 v28, 49152, v26
    v_xor_b32 v29, 32, v28
    ds_read_b64_tr_b16 v[32:33], v28 offset:0
    ds_read_b64_tr_b16 v[34:35], v28 offset:512
    ds_read_b64_tr_b16 v[36:37], v28 offset:8192
    ds_read_b64_tr_b16 v[38:39], v28 offset:8704
    ds_read_b64_tr_b16 v[40:41], v29 offset:0
    ds_read_b64_tr_b16 v[42:43], v29 offset:512
    ds_read_b64_tr_b16 v[44:45], v29 offset:8192
    ds_read_b64_tr_b16 v[46:47], v29 offset:8704
    s_waitcnt lgkmcnt(0)
    s_waitcnt vmcnt(25)
    s_barrier
    s_and_b32 s67, s24, 3
    s_cmp_eq_u32 s67, 1
    s_cbranch_scc1 R0_th2
    s_waitcnt vmcnt(4)
R0_th2:
    s_mov_b32 m0, 49152
    s_mov_b32 s67, 2097152
    buffer_load_dwordx4 v24, s[8:11], s67 offen lds
    s_mov_b32 m0, 50176
    s_mov_b32 s67, 2129920
    buffer_load_dwordx4 v15, s[8:11], s67 offen lds
    s_mov_b32 m0, 51200
    s_mov_b32 s67, 2162688
    buffer_load_dwordx4 v24, s[8:11], s67 offen lds
    s_mov_b32 m0, 52224
    s_mov_b32 s67, 2195456
    buffer_load_dwordx4 v15, s[8:11], s67 offen lds
    v_add_u32 v28, 65536, v26
    v_xor_b32 v29, 32, v28
    ds_read_b64_tr_b16 v[48:49], v28 offset:0
    ds_read_b64_tr_b16 v[50:51], v28 offset:512
    ds_read_b64_tr_b16 v[52:53], v28 offset:8192
    ds_read_b64_tr_b16 v[54:55], v28 offset:8704
    ds_read_b64_tr_b16 v[56:57], v29 offset:0
    ds_read_b64_tr_b16 v[58:59], v29 offset:512
    ds_read_b64_tr_b16 v[60:61], v29 offset:8192
    ds_read_b64_tr_b16 v[62:63], v29 offset:8704
    s_waitcnt lgkmcnt(0)
    s_waitcnt vmcnt(25)
    s_barrier
    s_and_b32 s67, s24, 3
    s_cmp_eq_u32 s67, 1
    s_cbranch_scc1 R0_th3
    s_waitcnt vmcnt(4)
R0_th3:
    s_mov_b32 m0, 65536
    s_mov_b32 s67, 262144
    buffer_load_dwordx4 v24, s[8:11], s67 offen lds
    s_mov_b32 m0, 66560
    s_mov_b32 s67, 294912
    buffer_load_dwordx4 v15, s[8:11], s67 offen lds
    s_mov_b32 m0, 67584
    s_mov_b32 s67, 327680
    buffer_load_dwordx4 v24, s[8:11], s67 offen lds
    s_mov_b32 m0, 68608
    s_mov_b32 s67, 360448
    buffer_load_dwordx4 v15, s[8:11], s67 offen lds
    v_add_u32 v28, 81920, v26
    v_xor_b32 v29, 32, v28
    ds_read_b64_tr_b16 a[0:1], v28 offset:0
    ds_read_b64_tr_b16 a[2:3], v28 offset:512
    ds_read_b64_tr_b16 a[4:5], v28 offset:8192
    ds_read_b64_tr_b16 a[6:7], v28 offset:8704
    ds_read_b64_tr_b16 a[16:17], v29 offset:0
    ds_read_b64_tr_b16 a[18:19], v29 offset:512
    ds_read_b64_tr_b16 a[20:21], v29 offset:8192
    ds_read_b64_tr_b16 a[22:23], v29 offset:8704
    s_waitcnt lgkmcnt(0)
    s_waitcnt vmcnt(25)
    s_barrier
    s_and_b32 s67, s24, 3
    s_cmp_eq_u32 s67, 1
    s_cbranch_scc1 R0_th4
    s_waitcnt vmcnt(4)
R0_th4:
    s_mov_b32 m0, 81920
    s_mov_b32 s67, 2359296
    buffer_load_dwordx4 v24, s[8:11], s67 offen lds
    s_mov_b32 m0, 82944
    s_mov_b32 s67, 2392064
    buffer_load_dwordx4 v15, s[8:11], s67 offen lds
    s_mov_b32 m0, 83968
    s_mov_b32 s67, 2424832
    buffer_load_dwordx4 v24, s[8:11], s67 offen lds
    s_mov_b32 m0, 84992
    s_mov_b32 s67, 2457600
    buffer_load_dwordx4 v15, s[8:11], s67 offen lds
    v_add_u32 v28, 98304, v26
    v_xor_b32 v29, 32, v28
    ds_read_b64_tr_b16 a[104:105], v28 offset:0
    ds_read_b64_tr_b16 a[106:107], v28 offset:512
    ds_read_b64_tr_b16 a[108:109], v28 offset:8192
    ds_read_b64_tr_b16 a[110:111], v28 offset:8704
    ds_read_b64_tr_b16 a[152:153], v29 offset:0
    ds_read_b64_tr_b16 a[154:155], v29 offset:512
    ds_read_b64_tr_b16 a[156:157], v29 offset:8192
    ds_read_b64_tr_b16 a[158:159], v29 offset:8704
    s_waitcnt lgkmcnt(0)
    s_waitcnt vmcnt(25)
    s_barrier
    s_and_b32 s67, s24, 3
    s_cmp_eq_u32 s67, 1
    s_cbranch_scc1 R0_th5
    s_waitcnt vmcnt(4)
R0_th5:
    s_mov_b32 m0, 98304
    s_mov_b32 s67, 524288
    buffer_load_dwordx4 v24, s[8:11], s67 offen lds
    s_mov_b32 m0, 99328
    s_mov_b32 s67, 557056
    buffer_load_dwordx4 v15, s[8:11], s67 offen lds
    s_mov_b32 m0, 100352
    s_mov_b32 s67, 589824
    buffer_load_dwordx4 v24, s[8:11], s67 offen lds
    s_mov_b32 m0, 101376
    s_mov_b32 s67, 622592
    buffer_load_dwordx4 v15, s[8:11], s67 offen lds
    v_add_u32 v28, 114688, v26
    v_xor_b32 v29, 32, v28
    ds_read_b64_tr_b16 a[112:113], v28 offset:0
    ds_read_b64_tr_b16 a[114:115], v28 offset:512
    ds_read_b64_tr_b16 a[116:117], v28 offset:8192
    ds_read_b64_tr_b16 a[118:119], v28 offset:8704
    ds_read_b64_tr_b16 a[160:161], v29 offset:0
    ds_read_b64_tr_b16 a[162:163], v29 offset:512
    ds_read_b64_tr_b16 a[164:165], v29 offset:8192
    ds_read_b64_tr_b16 a[166:167], v29 offset:8704
    s_waitcnt lgkmcnt(0)
    s_waitcnt vmcnt(25)
    s_barrier
    s_and_b32 s67, s24, 3
    s_cmp_eq_u32 s67, 1
    s_cbranch_scc1 R0_th6
    s_waitcnt vmcnt(4)
R0_th6:
    s_mov_b32 m0, 114688
    s_mov_b32 s67, 2621440
    buffer_load_dwordx4 v24, s[8:11], s67 offen lds
    s_mov_b32 m0, 115712
    s_mov_b32 s67, 2654208
    buffer_load_dwordx4 v15, s[8:11], s67 offen lds
    s_mov_b32 m0, 116736
    s_mov_b32 s67, 2686976
    buffer_load_dwordx4 v24, s[8:11], s67 offen lds
    s_mov_b32 m0, 117760
    s_mov_b32 s67, 2719744
    buffer_load_dwordx4 v15, s[8:11], s67 offen lds
    v_add_u32 v28, 131072, v26
    v_xor_b32 v29, 32, v28
    ds_read_b64_tr_b16 v[64:65], v28 offset:0
    ds_read_b64_tr_b16 v[66:67], v28 offset:512
    ds_read_b64_tr_b16 v[68:69], v28 offset:8192
    ds_read_b64_tr_b16 v[70:71], v28 offset:8704
    ds_read_b64_tr_b16 v[72:73], v29 offset:0
    ds_read_b64_tr_b16 v[74:75], v29 offset:512
    ds_read_b64_tr_b16 v[76:77], v29 offset:8192
    ds_read_b64_tr_b16 v[78:79], v29 offset:8704
    s_waitcnt lgkmcnt(0)
    s_waitcnt vmcnt(25)
    s_barrier
    s_and_b32 s67, s24, 3
    s_cmp_eq_u32 s67, 1
    s_cbranch_scc1 R0_th7
    s_waitcnt vmcnt(4)
R0_th7:
    s_mov_b32 m0, 131072
    s_mov_b32 s67, 786432
    buffer_load_dwordx4 v24, s[8:11], s67 offen lds
    s_mov_b32 m0, 132096
    s_mov_b32 s67, 819200
    buffer_load_dwordx4 v15, s[8:11], s67 offen lds
    s_mov_b32 m0, 133120
    s_mov_b32 s67, 851968
    buffer_load_dwordx4 v24, s[8:11], s67 offen lds
    s_mov_b32 m0, 134144
    s_mov_b32 s67, 884736
    buffer_load_dwordx4 v15, s[8:11], s67 offen lds
    v_add_u32 v28, 147456, v26
    v_xor_b32 v29, 32, v28
    ds_read_b64_tr_b16 a[96:97], v28 offset:0
    ds_read_b64_tr_b16 a[98:99], v28 offset:512
    ds_read_b64_tr_b16 a[100:101], v28 offset:8192
    ds_read_b64_tr_b16 a[102:103], v28 offset:8704
    ds_read_b64_tr_b16 a[144:145], v29 offset:0
    ds_read_b64_tr_b16 a[146:147], v29 offset:512
    ds_read_b64_tr_b16 a[148:149], v29 offset:8192
    ds_read_b64_tr_b16 a[150:151], v29 offset:8704
    s_waitcnt lgkmcnt(0)
    s_waitcnt vmcnt(24)
    s_barrier
    s_and_b32 s67, s24, 3
    s_cmp_eq_u32 s67, 1
    s_cbranch_scc1 R0_th8
    s_waitcnt vmcnt(4)
R0_th8:
    s_mov_b32 m0, 147456
    s_mov_b32 s67, 2883584
    buffer_load_dwordx4 v24, s[8:11], s67 offen lds
    s_mov_b32 m0, 148480
    s_mov_b32 s67, 2916352
    buffer_load_dwordx4 v15, s[8:11], s67 offen lds
    s_mov_b32 m0, 149504
    s_mov_b32 s67, 2949120
    buffer_load_dwordx4 v24, s[8:11], s67 offen lds
    s_mov_b32 m0, 150528
    s_mov_b32 s67, 2981888
    buffer_load_dwordx4 v15, s[8:11], s67 offen lds
    v_add_u32 v28, 32768, v26
    v_xor_b32 v29, 32, v28
    ds_read_b64_tr_b16 a[224:225], v28 offset:0
    ds_read_b64_tr_b16 a[226:227], v28 offset:512
    ds_read_b64_tr_b16 a[228:229], v28 offset:8192
    ds_read_b64_tr_b16 a[230:231], v28 offset:8704
    ds_read_b64_tr_b16 a[232:233], v29 offset:0
    ds_read_b64_tr_b16 a[234:235], v29 offset:512
    ds_read_b64_tr_b16 a[236:237], v29 offset:8192
    ds_read_b64_tr_b16 a[238:239], v29 offset:8704
    s_waitcnt lgkmcnt(0)
    s_waitcnt vmcnt(24)
    s_barrier
    s_and_b32 s67, s24, 3
    s_cmp_eq_u32 s67, 1
    s_cbranch_scc1 R0_th9
    s_waitcnt vmcnt(4)
R0_th9:
    s_mov_b32 m0, 32768
    s_mov_b32 s67, 0
    buffer_load_dwordx4 v24, s[12:15], s67 offen lds
    s_mov_b32 m0, 33792
    s_mov_b32 s67, 32768
    buffer_load_dwordx4 v15, s[12:15], s67 offen lds
    s_mov_b32 m0, 34816
    s_mov_b32 s67, 65536
    buffer_load_dwordx4 v24, s[12:15], s67 offen lds
    s_mov_b32 m0, 35840
    s_mov_b32 s67, 98304
    buffer_load_dwordx4 v15, s[12:15], s67 offen lds
    v_add_u32 v28, 49152, v26
    v_xor_b32 v29, 32, v28
    ds_read_b64_tr_b16 a[240:241], v28 offset:0
    ds_read_b64_tr_b16 a[242:243], v28 offset:512
    ds_read_b64_tr_b16 a[244:245], v28 offset:8192
    ds_read_b64_tr_b16 a[246:247], v28 offset:8704
    ds_read_b64_tr_b16 a[248:249], v29 offset:0
    ds_read_b64_tr_b16 a[250:251], v29 offset:512
    ds_read_b64_tr_b16 a[252:253], v29 offset:8192
    ds_read_b64_tr_b16 a[254:255], v29 offset:8704
    s_waitcnt lgkmcnt(0)
    s_waitcnt vmcnt(24)
    s_barrier
    s_and_b32 s67, s24, 3
    s_cmp_eq_u32 s67, 1
    s_cbranch_scc1 R0_th10
    s_waitcnt vmcnt(4)
R0_th10:
    s_mov_b32 m0, 49152
    s_mov_b32 s67, 2097152
    buffer_load_dwordx4 v24, s[12:15], s67 offen lds
    s_mov_b32 m0, 50176
    s_mov_b32 s67, 2129920
    buffer_load_dwordx4 v15, s[12:15], s67 offen lds
    s_mov_b32 m0, 51200
    s_mov_b32 s67, 2162688
    buffer_load_dwordx4 v24, s[12:15], s67 offen lds
    s_mov_b32 m0, 52224
    s_mov_b32 s67, 2195456
    buffer_load_dwordx4 v15, s[12:15], s67 offen lds
    v_add_u32 v28, 65536, v26
    v_xor_b32 v29, 32, v28
    ds_read_b64_tr_b16 a[192:193], v28 offset:0
    ds_read_b64_tr_b16 a[194:195], v28 offset:512
    ds_read_b64_tr_b16 a[196:197], v28 offset:8192
    ds_read_b64_tr_b16 a[198:199], v28 offset:8704
    ds_read_b64_tr_b16 a[200:201], v29 offset:0
    ds_read_b64_tr_b16 a[202:203], v29 offset:512
    ds_read_b64_tr_b16 a[204:205], v29 offset:8192
    ds_read_b64_tr_b16 a[206:207], v29 offset:8704
    s_waitcnt lgkmcnt(0)
    s_waitcnt vmcnt(24)
    s_barrier
    s_and_b32 s67, s24, 3
    s_cmp_eq_u32 s67, 1
    s_cbranch_scc1 R0_th11
    s_waitcnt vmcnt(4)
R0_th11:
    s_mov_b32 m0, 65536
    s_mov_b32 s67, 262144
    buffer_load_dwordx4 v24, s[12:15], s67 offen lds
    s_mov_b32 m0, 66560
    s_mov_b32 s67, 294912
    buffer_load_dwordx4 v15, s[12:15], s67 offen lds
    s_mov_b32 m0, 67584
    s_mov_b32 s67, 327680
    buffer_load_dwordx4 v24, s[12:15], s67 offen lds
    s_mov_b32 m0, 68608
    s_mov_b32 s67, 360448
    buffer_load_dwordx4 v15, s[12:15], s67 offen lds
    v_add_u32 v28, 81920, v26
    v_xor_b32 v29, 32, v28
    ds_read_b64_tr_b16 a[208:209], v28 offset:0
    ds_read_b64_tr_b16 a[210:211], v28 offset:512
    ds_read_b64_tr_b16 a[212:213], v28 offset:8192
    ds_read_b64_tr_b16 a[214:215], v28 offset:8704
    ds_read_b64_tr_b16 a[216:217], v29 offset:0
    ds_read_b64_tr_b16 a[218:219], v29 offset:512
    ds_read_b64_tr_b16 a[220:221], v29 offset:8192
    ds_read_b64_tr_b16 a[222:223], v29 offset:8704
    s_waitcnt lgkmcnt(0)
    s_waitcnt vmcnt(24)
    s_barrier
    s_and_b32 s67, s24, 3
    s_cmp_eq_u32 s67, 1
    s_cbranch_scc1 R0_th12
    s_waitcnt vmcnt(4)
R0_th12:
    s_mov_b32 m0, 81920
    s_mov_b32 s67, 2359296
    buffer_load_dwordx4 v24, s[12:15], s67 offen lds
    s_mov_b32 m0, 82944
    s_mov_b32 s67, 2392064
    buffer_load_dwordx4 v15, s[12:15], s67 offen lds
    s_mov_b32 m0, 83968
    s_mov_b32 s67, 2424832
    buffer_load_dwordx4 v24, s[12:15], s67 offen lds
    s_mov_b32 m0, 84992
    s_mov_b32 s67, 2457600
    buffer_load_dwordx4 v15, s[12:15], s67 offen lds
    v_mov_b32 v16, 136
    global_load_dword v11, v16, s[60:61] sc1
    global_load_dword v14, v16, s[60:61] offset:-136 sc1
    v_add_u32 v28, 98304, v26
    v_xor_b32 v29, 32, v28
    ds_read_b64_tr_b16 v[160:161], v28 offset:0
    ds_read_b64_tr_b16 v[162:163], v28 offset:512
    ds_read_b64_tr_b16 v[164:165], v28 offset:8192
    ds_read_b64_tr_b16 v[166:167], v28 offset:8704
    ds_read_b64_tr_b16 v[168:169], v29 offset:0
    ds_read_b64_tr_b16 v[170:171], v29 offset:512
    ds_read_b64_tr_b16 v[172:173], v29 offset:8192
    ds_read_b64_tr_b16 v[174:175], v29 offset:8704
    s_waitcnt lgkmcnt(0)
    s_waitcnt vmcnt(26)
    s_barrier
    s_and_b32 s67, s24, 3
    s_cmp_eq_u32 s67, 1
    s_cbranch_scc1 R0_th13
    s_waitcnt vmcnt(4)
R0_th13:
    s_mov_b32 m0, 98304
    s_mov_b32 s67, 524288
    buffer_load_dwordx4 v24, s[12:15], s67 offen lds
    s_mov_b32 m0, 99328
    s_mov_b32 s67, 557056
    buffer_load_dwordx4 v15, s[12:15], s67 offen lds
    s_mov_b32 m0, 100352
    s_mov_b32 s67, 589824
    buffer_load_dwordx4 v24, s[12:15], s67 offen lds
    s_mov_b32 m0, 101376
    s_mov_b32 s67, 622592
    buffer_load_dwordx4 v15, s[12:15], s67 offen lds
    v_add_u32 v28, 114688, v26
    v_xor_b32 v29, 32, v28
    ds_read_b64_tr_b16 v[176:177], v28 offset:0
    ds_read_b64_tr_b16 v[178:179], v28 offset:512
    ds_read_b64_tr_b16 v[180:181], v28 offset:8192
    ds_read_b64_tr_b16 v[182:183], v28 offset:8704
    ds_read_b64_tr_b16 v[184:185], v29 offset:0
    ds_read_b64_tr_b16 v[186:187], v29 offset:512
    ds_read_b64_tr_b16 v[188:189], v29 offset:8192
    ds_read_b64_tr_b16 v[190:191], v29 offset:8704
    s_waitcnt lgkmcnt(0)
    s_waitcnt vmcnt(26)
    s_barrier
    s_and_b32 s67, s24, 3
    s_cmp_eq_u32 s67, 1
    s_cbranch_scc1 R0_th14
    s_waitcnt vmcnt(4)
R0_th14:
    s_mov_b32 m0, 114688
    s_mov_b32 s67, 2621440
    buffer_load_dwordx4 v24, s[12:15], s67 offen lds
    s_mov_b32 m0, 115712
    s_mov_b32 s67, 2654208
    buffer_load_dwordx4 v15, s[12:15], s67 offen lds
    s_mov_b32 m0, 116736
    s_mov_b32 s67, 2686976
    buffer_load_dwordx4 v24, s[12:15], s67 offen lds
    s_mov_b32 m0, 117760
    s_mov_b32 s67, 2719744
    buffer_load_dwordx4 v15, s[12:15], s67 offen lds
    v_add_u32 v28, 131072, v26
    v_xor_b32 v29, 32, v28
    ds_read_b64_tr_b16 v[128:129], v28 offset:0
    ds_read_b64_tr_b16 v[130:131], v28 offset:512
    ds_read_b64_tr_b16 v[132:133], v28 offset:8192
    ds_read_b64_tr_b16 v[134:135], v28 offset:8704
    ds_read_b64_tr_b16 v[136:137], v29 offset:0
    ds_read_b64_tr_b16 v[138:139], v29 offset:512
    ds_read_b64_tr_b16 v[140:141], v29 offset:8192
    ds_read_b64_tr_b16 v[142:143], v29 offset:8704
    s_waitcnt lgkmcnt(0)
    s_waitcnt vmcnt(26)
    s_barrier
    s_and_b32 s67, s24, 3
    s_cmp_eq_u32 s67, 1
    s_cbranch_scc1 R0_th15
    s_waitcnt vmcnt(4)
R0_th15:
    s_mov_b32 m0, 131072
    s_mov_b32 s67, 786432
    buffer_load_dwordx4 v24, s[12:15], s67 offen lds
    s_mov_b32 m0, 132096
    s_mov_b32 s67, 819200
    buffer_load_dwordx4 v15, s[12:15], s67 offen lds
    s_mov_b32 m0, 133120
    s_mov_b32 s67, 851968
    buffer_load_dwordx4 v24, s[12:15], s67 offen lds
    s_mov_b32 m0, 134144
    s_mov_b32 s67, 884736
    buffer_load_dwordx4 v15, s[12:15], s67 offen lds
    v_add_u32 v28, 147456, v26
    v_xor_b32 v29, 32, v28
    ds_read_b64_tr_b16 v[144:145], v28 offset:0
    ds_read_b64_tr_b16 v[146:147], v28 offset:512
    ds_read_b64_tr_b16 v[148:149], v28 offset:8192
    ds_read_b64_tr_b16 v[150:151], v28 offset:8704
    ds_read_b64_tr_b16 v[152:153], v29 offset:0
    ds_read_b64_tr_b16 v[154:155], v29 offset:512
    ds_read_b64_tr_b16 v[156:157], v29 offset:8192
    ds_read_b64_tr_b16 v[158:159], v29 offset:8704
    s_waitcnt lgkmcnt(0)
    s_waitcnt vmcnt(26)
    s_barrier
    s_and_b32 s67, s24, 3
    s_cmp_eq_u32 s67, 1
    s_cbranch_scc1 R0_th16
    s_waitcnt vmcnt(4)
R0_th16:
    s_mov_b32 m0, 147456
    s_mov_b32 s67, 2883584
    buffer_load_dwordx4 v24, s[12:15], s67 offen lds
    s_mov_b32 m0, 148480
    s_mov_b32 s67, 2916352
    buffer_load_dwordx4 v15, s[12:15], s67 offen lds
    s_mov_b32 m0, 149504
    s_mov_b32 s67, 2949120
    buffer_load_dwordx4 v24, s[12:15], s67 offen lds
    s_mov_b32 m0, 150528
    s_mov_b32 s67, 2981888
    buffer_load_dwordx4 v15, s[12:15], s67 offen lds
    v_add_u32 v28, 32768, v26
    v_xor_b32 v29, 32, v28
    ds_read_b64_tr_b16 a[40:41], v28 offset:0
    ds_read_b64_tr_b16 a[42:43], v28 offset:512
    ds_read_b64_tr_b16 a[44:45], v28 offset:8192
    ds_read_b64_tr_b16 a[46:47], v28 offset:8704
    ds_read_b64_tr_b16 a[56:57], v29 offset:0
    ds_read_b64_tr_b16 a[58:59], v29 offset:512
    ds_read_b64_tr_b16 a[60:61], v29 offset:8192
    ds_read_b64_tr_b16 a[62:63], v29 offset:8704
    s_waitcnt lgkmcnt(0)
    s_waitcnt vmcnt(26)
    s_barrier
    s_and_b32 s67, s24, 3
    s_cmp_eq_u32 s67, 1
    s_cbranch_scc1 R0_th17
    s_waitcnt vmcnt(4)
R0_th17:
    s_mov_b32 m0, 32768
    s_mov_b32 s67, 0
    buffer_load_dwordx4 v25, s[20:23], s67 offen lds
    s_mov_b32 m0, 33792
    s_mov_b32 s67, 4096
    buffer_load_dwordx4 v25, s[20:23], s67 offen lds
    s_mov_b32 m0, 34816
    s_mov_b32 s67, 8192
    buffer_load_dwordx4 v25, s[20:23], s67 offen lds
    s_mov_b32 m0, 35840
    s_mov_b32 s67, 12288
    buffer_load_dwordx4 v25, s[20:23], s67 offen lds
    v_add_u32 v28, 49152, v26
    v_xor_b32 v29, 32, v28
    ds_read_b64_tr_b16 a[64:65], v28 offset:0
    ds_read_b64_tr_b16 a[66:67], v28 offset:512
    ds_read_b64_tr_b16 a[68:69], v28 offset:8192
    ds_read_b64_tr_b16 a[70:71], v28 offset:8704
    ds_read_b64_tr_b16 a[72:73], v29 offset:0
    ds_read_b64_tr_b16 a[74:75], v29 offset:512
    ds_read_b64_tr_b16 a[76:77], v29 offset:8192
    ds_read_b64_tr_b16 a[78:79], v29 offset:8704
    s_waitcnt lgkmcnt(0)
    s_waitcnt vmcnt(26)
    s_barrier
    s_and_b32 s67, s24, 3
    s_cmp_eq_u32 s67, 1
    s_cbranch_scc1 R0_th18
    s_waitcnt vmcnt(4)
R0_th18:
    s_mov_b32 m0, 49152
    s_mov_b32 s67, 16384
    buffer_load_dwordx4 v30, s[20:23], s67 offen lds
    s_mov_b32 m0, 50176
    s_mov_b32 s67, 20480
    buffer_load_dwordx4 v30, s[20:23], s67 offen lds
    s_mov_b32 m0, 51200
    s_mov_b32 s67, 24576
    buffer_load_dwordx4 v30, s[20:23], s67 offen lds
    s_mov_b32 m0, 52224
    s_mov_b32 s67, 28672
    buffer_load_dwordx4 v30, s[20:23], s67 offen lds
    v_add_u32 v28, 65536, v26
    v_xor_b32 v29, 32, v28
    ds_read_b64_tr_b16 v[80:81], v28 offset:0
    ds_read_b64_tr_b16 v[82:83], v28 offset:512
    ds_read_b64_tr_b16 v[84:85], v28 offset:8192
    ds_read_b64_tr_b16 v[86:87], v28 offset:8704
    ds_read_b64_tr_b16 v[88:89], v29 offset:0
    ds_read_b64_tr_b16 v[90:91], v29 offset:512
    ds_read_b64_tr_b16 v[92:93], v29 offset:8192
    ds_read_b64_tr_b16 v[94:95], v29 offset:8704
    s_waitcnt lgkmcnt(0)
    s_waitcnt vmcnt(26)
    s_barrier
    s_and_b32 s67, s24, 3
    s_cmp_eq_u32 s67, 1
    s_cbranch_scc1 R0_th19
    s_waitcnt vmcnt(4)
R0_th19:
    s_mov_b32 m0, 65536
    s_mov_b32 s67, 32768
    buffer_load_dwordx4 v25, s[20:23], s67 offen lds
    s_mov_b32 m0, 66560
    s_mov_b32 s67, 36864
    buffer_load_dwordx4 v25, s[20:23], s67 offen lds
    s_mov_b32 m0, 67584
    s_mov_b32 s67, 40960
    buffer_load_dwordx4 v25, s[20:23], s67 offen lds
    s_mov_b32 m0, 68608
    s_mov_b32 s67, 45056
    buffer_load_dwordx4 v25, s[20:23], s67 offen lds
    v_add_u32 v28, 81920, v26
    v_xor_b32 v29, 32, v28
    ds_read_b64_tr_b16 a[8:9], v28 offset:0
    ds_read_b64_tr_b16 a[10:11], v28 offset:512
    ds_read_b64_tr_b16 a[12:13], v28 offset:8192
    ds_read_b64_tr_b16 a[14:15], v28 offset:8704
    ds_read_b64_tr_b16 a[24:25], v29 offset:0
    ds_read_b64_tr_b16 a[26:27], v29 offset:512
    ds_read_b64_tr_b16 a[28:29], v29 offset:8192
    ds_read_b64_tr_b16 a[30:31], v29 offset:8704
    s_waitcnt lgkmcnt(0)
    s_waitcnt vmcnt(24)
    s_barrier
    s_and_b32 s67, s24, 3
    s_cmp_eq_u32 s67, 1
    s_cbranch_scc1 R0_th20
    s_waitcnt vmcnt(4)
R0_th20:
    s_mov_b32 m0, 81920
    s_mov_b32 s67, 49152
    buffer_load_dwordx4 v30, s[20:23], s67 offen lds
    s_mov_b32 m0, 82944
    s_mov_b32 s67, 53248
    buffer_load_dwordx4 v30, s[20:23], s67 offen lds
    s_mov_b32 m0, 83968
    s_mov_b32 s67, 57344
    buffer_load_dwordx4 v30, s[20:23], s67 offen lds
    s_mov_b32 m0, 84992
    s_mov_b32 s67, 61440
    buffer_load_dwordx4 v30, s[20:23], s67 offen lds
    v_cmp_eq_u32 vcc, 0, v11
    s_cbranch_vccnz R0_reg
R0_regok:
    s_mov_b32 s79, 0
    v_cmp_gt_u32 vcc, 32, v14
    s_cbranch_vccnz R0_md
R0_mdok:
    s_getpc_b64 s[80:81]
R0_pc20:
    v_lshlrev_b32 v20, 3, v0
    v_add_u32 v20, 2048, v20
    v_min_u32 v20, L_LAST-R0_pc20, v20
    global_load_dword v21, v20, s[80:81]
    v_add_u32 v28, 98304, v26
    v_xor_b32 v29, 32, v28
    ds_read_b64_tr_b16 a[128:129], v28 offset:0
    ds_read_b64_tr_b16 a[130:131], v28 offset:512
    ds_read_b64_tr_b16 a[132:133], v28 offset:8192
    ds_read_b64_tr_b16 a[134:135], v28 offset:8704
    ds_read_b64_tr_b16 a[176:177], v29 offset:0
    ds_read_b64_tr_b16 a[178:179], v29 offset:512
    ds_read_b64_tr_b16 a[180:181], v29 offset:8192
    ds_read_b64_tr_b16 a[182:183], v29 offset:8704
    s_waitcnt lgkmcnt(0)
    s_waitcnt vmcnt(25)
    s_barrier
    s_and_b32 s67, s24, 3
    s_cmp_eq_u32 s67, 1
    s_cbranch_scc1 R0_th21
    s_waitcnt vmcnt(4)
R0_th21:
    s_mov_b32 m0, 98304
    s_mov_b32 s67, 65536
    buffer_load_dwordx4 v25, s[20:23], s67 offen lds
    s_mov_b32 m0, 99328
    s_mov_b32 s67, 69632
    buffer_load_dwordx4 v25, s[20:23], s67 offen lds
    s_mov_b32 m0, 100352
    s_mov_b32 s67, 73728
    buffer_load_dwordx4 v25, s[20:23], s67 offen lds
    s_mov_b32 m0, 101376
    s_mov_b32 s67, 77824
    buffer_load_dwordx4 v25, s[20:23], s67 offen lds
    buffer_load_dword v17, off, s[4:7], s33 offset:16 sc1
    buffer_load_dword v16, off, s[4:7], s33 sc1
    v_add_u32 v28, 114688, v26
    v_xor_b32 v29, 32, v28
    ds_read_b64_tr_b16 a[136:137], v28 offset:0
    ds_read_b64_tr_b16 a[138:139], v28 offset:512
    ds_read_b64_tr_b16 a[140:141], v28 offset:8192
    ds_read_b64_tr_b16 a[142:143], v28 offset:8704
    ds_read_b64_tr_b16 a[184:185], v29 offset:0
    ds_read_b64_tr_b16 a[186:187], v29 offset:512
    ds_read_b64_tr_b16 a[188:189], v29 offset:8192
    ds_read_b64_tr_b16 a[190:191], v29 offset:8704
    s_waitcnt lgkmcnt(0)
    s_waitcnt vmcnt(27)
    s_barrier
    s_and_b32 s67, s24, 3
    s_cmp_eq_u32 s67, 1
    s_cbranch_scc1 R0_th22
    s_waitcnt vmcnt(4)
R0_th22:
    s_mov_b32 m0, 114688
    s_mov_b32 s67, 81920
    buffer_load_dwordx4 v30, s[20:23], s67 offen lds
    s_mov_b32 m0, 115712
    s_mov_b32 s67, 86016
    buffer_load_dwordx4 v30, s[20:23], s67 offen lds
    s_mov_b32 m0, 116736
    s_mov_b32 s67, 90112
    buffer_load_dwordx4 v30, s[20:23], s67 offen lds
    s_mov_b32 m0, 117760
    s_mov_b32 s67, 94208
    buffer_load_dwordx4 v30, s[20:23], s67 offen lds
    v_add_u32 v28, 131072, v26
    v_xor_b32 v29, 32, v28
    ds_read_b64_tr_b16 a[80:81], v28 offset:0
    ds_read_b64_tr_b16 a[82:83], v28 offset:512
    ds_read_b64_tr_b16 a[84:85], v28 offset:8192
    ds_read_b64_tr_b16 a[86:87], v28 offset:8704
    ds_read_b64_tr_b16 a[88:89], v29 offset:0
    ds_read_b64_tr_b16 a[90:91], v29 offset:512
    ds_read_b64_tr_b16 a[92:93], v29 offset:8192
    ds_read_b64_tr_b16 a[94:95], v29 offset:8704
    s_waitcnt lgkmcnt(0)
    s_waitcnt vmcnt(27)
    s_barrier
    s_and_b32 s67, s24, 3
    s_cmp_eq_u32 s67, 1
    s_cbranch_scc1 R0_th23
    s_waitcnt vmcnt(4)
R0_th23:
    s_mov_b32 m0, 131072
    s_mov_b32 s67, 98304
    buffer_load_dwordx4 v25, s[20:23], s67 offen lds
    s_mov_b32 m0, 132096
    s_mov_b32 s67, 102400
    buffer_load_dwordx4 v25, s[20:23], s67 offen lds
    s_mov_b32 m0, 133120
    s_mov_b32 s67, 106496
    buffer_load_dwordx4 v25, s[20:23], s67 offen lds
    s_mov_b32 m0, 134144
    s_mov_b32 s67, 110592
    buffer_load_dwordx4 v25, s[20:23], s67 offen lds
    v_add_u32 v28, 147456, v26
    v_xor_b32 v29, 32, v28
    ds_read_b64_tr_b16 a[120:121], v28 offset:0
    ds_read_b64_tr_b16 a[122:123], v28 offset:512
    ds_read_b64_tr_b16 a[124:125], v28 offset:8192
    ds_read_b64_tr_b16 a[126:127], v28 offset:8704
    ds_read_b64_tr_b16 a[168:169], v29 offset:0
    ds_read_b64_tr_b16 a[170:171], v29 offset:512
    ds_read_b64_tr_b16 a[172:173], v29 offset:8192
    ds_read_b64_tr_b16 a[174:175], v29 offset:8704
    s_waitcnt lgkmcnt(0)
    s_barrier
    s_mov_b32 m0, 147456
    s_mov_b32 s67, 114688
    buffer_load_dwordx4 v30, s[20:23], s67 offen lds
    s_mov_b32 m0, 148480
    s_mov_b32 s67, 118784
    buffer_load_dwordx4 v30, s[20:23], s67 offen lds
    s_mov_b32 m0, 149504
    s_mov_b32 s67, 122880
    buffer_load_dwordx4 v30, s[20:23], s67 offen lds
    s_mov_b32 m0, 150528
    s_mov_b32 s67, 126976
    buffer_load_dwordx4 v30, s[20:23], s67 offen lds
    v_min_u32 v18, -2, v18
    s_cmp_lg_u32 s79, 0
    s_cbranch_scc1 R0_p0
    buffer_store_dword v18, v5, s[4:7], s27 offen
R0_p0ok:
    s_add_u32 s67, s27, 0x2000
    buffer_load_dword v15, v5, s[4:7], s27 offen sc1
    buffer_load_dword v15, v5, s[4:7], s67 offen sc1
    s_add_u32 s67, s27, 0x4000
    buffer_load_dword v15, v5, s[4:7], s67 offen sc1
    s_add_u32 s67, s27, 0x6000
    buffer_load_dword v15, v5, s[4:7], s67 offen sc1
    buffer_load_dword v15, v5, s[4:7], s32 offen sc1
    s_waitcnt vmcnt(33)
    v_xor_b32 v28, 0, v31
    v_add_u32 v28, 32768, v28
    ds_read_b64_tr_b16 v[96:97], v28 offset:0
    ds_read_b64_tr_b16 v[98:99], v28 offset:512
    ds_read_b64_tr_b16 v[100:101], v28 offset:2048
    ds_read_b64_tr_b16 v[102:103], v28 offset:2560
    v_xor_b32 v28, 64, v31
    v_add_u32 v28, 32768, v28
    ds_read_b64_tr_b16 v[104:105], v28 offset:0
    ds_read_b64_tr_b16 v[106:107], v28 offset:512
    ds_read_b64_tr_b16 v[108:109], v28 offset:2048
    ds_read_b64_tr_b16 v[110:111], v28 offset:2560
    v_xor_b32 v28, 128, v31
    v_add_u32 v28, 32768, v28
    ds_read_b64_tr_b16 v[112:113], v28 offset:0
    ds_read_b64_tr_b16 v[114:115], v28 offset:512
    ds_read_b64_tr_b16 v[116:117], v28 offset:2048
    ds_read_b64_tr_b16 v[118:119], v28 offset:2560
    v_xor_b32 v28, 192, v31
    v_add_u32 v28, 32768, v28
    ds_read_b64_tr_b16 v[120:121], v28 offset:0
    ds_read_b64_tr_b16 v[122:123], v28 offset:512
    ds_read_b64_tr_b16 v[124:125], v28 offset:2048
    ds_read_b64_tr_b16 v[126:127], v28 offset:2560
    s_waitcnt lgkmcnt(0)
    ds_write_b128 v0, v[32:35] offset:32768
    ds_write_b128 v0, v[36:39] offset:33792
    ds_write_b128 v0, v[40:43] offset:34816
    ds_write_b128 v0, v[44:47] offset:35840
    ds_write_b128 v0, v[48:51] offset:49152
    ds_write_b128 v0, v[52:55] offset:50176
    ds_write_b128 v0, v[56:59] offset:51200
    ds_write_b128 v0, v[60:63] offset:52224
    s_waitcnt lgkmcnt(0)
    s_waitcnt vmcnt(25)
    v_xor_b32 v28, 0, v31
    v_add_u32 v28, 65536, v28
    ds_read_b64_tr_b16 v[192:193], v28 offset:0
    ds_read_b64_tr_b16 v[194:195], v28 offset:512
    ds_read_b64_tr_b16 v[196:197], v28 offset:2048
    ds_read_b64_tr_b16 v[198:199], v28 offset:2560
    v_xor_b32 v28, 64, v31
    v_add_u32 v28, 65536, v28
    ds_read_b64_tr_b16 v[216:217], v28 offset:0
    ds_read_b64_tr_b16 v[218:219], v28 offset:512
    ds_read_b64_tr_b16 v[220:221], v28 offset:2048
    ds_read_b64_tr_b16 v[222:223], v28 offset:2560
    v_xor_b32 v28, 128, v31
    v_add_u32 v28, 65536, v28
    ds_read_b64_tr_b16 v[240:241], v28 offset:0
    ds_read_b64_tr_b16 v[242:243], v28 offset:512
    ds_read_b64_tr_b16 v[244:245], v28 offset:2048
    ds_read_b64_tr_b16 v[246:247], v28 offset:2560
    v_xor_b32 v28, 192, v31
    v_add_u32 v28, 65536, v28
    ds_read_b64_tr_b16 v[32:33], v28 offset:0
    ds_read_b64_tr_b16 v[34:35], v28 offset:512
    ds_read_b64_tr_b16 v[36:37], v28 offset:2048
    ds_read_b64_tr_b16 v[38:39], v28 offset:2560
    s_waitcnt lgkmcnt(0)
    ds_write_b128 v1, v[64:67] offset:0
    ds_write_b128 v1, v[68:71] offset:1024
    ds_write_b128 v1, v[72:75] offset:2048
    ds_write_b128 v1, v[76:79] offset:3072
    ds_write_b128 v1, v[80:83] offset:16384
    ds_write_b128 v1, v[84:87] offset:17408
    ds_write_b128 v1, v[88:91] offset:18432
    ds_write_b128 v1, v[92:95] offset:19456
    s_waitcnt lgkmcnt(0)
    s_waitcnt vmcnt(14)
    v_cmp_eq_u32 vcc, 0, v16
    s_cbranch_vccnz R0_kv0
R0_kv0ok:
    s_add_u32 s33, s33, 16
    s_add_u32 s70, s31, 0x2000
    s_mov_b32 m0, s66
    v_mov_b32 v11, v17
    buffer_load_dwordx4 v0, s[4:7], s31 offen sc1 lds
    buffer_load_dwordx4 v0, s[4:7], s31 offen offset:1024 sc1 lds
    buffer_load_dwordx4 v[20:23], v0, s[4:7], s70 offen sc1
    buffer_load_dwordx4 v[24:27], v0, s[4:7], s70 offen offset:1024 sc1
    s_add_u32 s31, s31, 0x4000
    s_add_u32 s70, s31, 0x2000
    s_xor_b32 s66, s66, 0x2000
    s_xor_b32 s67, s30, 0x40000
    buffer_load_dword v15, v10, s[4:7], s67 offen sc1
    buffer_load_dword v15, v10, s[4:7], s67 offen offset:2048 sc1
    buffer_load_dword v15, v10, s[4:7], s30 offen sc1
    buffer_load_dword v15, v10, s[4:7], s30 offen offset:2048 sc1
    v_xor_b32 v28, 0, v31
    v_add_u32 v28, 98304, v28
    ds_read_b64_tr_b16 v[200:201], v28 offset:0
    ds_read_b64_tr_b16 v[202:203], v28 offset:512
    ds_read_b64_tr_b16 v[204:205], v28 offset:2048
    ds_read_b64_tr_b16 v[206:207], v28 offset:2560
    v_xor_b32 v28, 64, v31
    v_add_u32 v28, 98304, v28
    ds_read_b64_tr_b16 v[224:225], v28 offset:0
    ds_read_b64_tr_b16 v[226:227], v28 offset:512
    ds_read_b64_tr_b16 v[228:229], v28 offset:2048
    ds_read_b64_tr_b16 v[230:231], v28 offset:2560
    v_xor_b32 v28, 128, v31
    v_add_u32 v28, 98304, v28
    ds_read_b64_tr_b16 v[248:249], v28 offset:0
    ds_read_b64_tr_b16 v[250:251], v28 offset:512
    ds_read_b64_tr_b16 v[252:253], v28 offset:2048
    ds_read_b64_tr_b16 v[254:255], v28 offset:2560
    v_xor_b32 v28, 192, v31
    v_add_u32 v28, 98304, v28
    ds_read_b64_tr_b16 v[40:41], v28 offset:0
    ds_read_b64_tr_b16 v[42:43], v28 offset:512
    ds_read_b64_tr_b16 v[44:45], v28 offset:2048
    ds_read_b64_tr_b16 v[46:47], v28 offset:2560
    s_waitcnt lgkmcnt(0)
    ds_write_b128 v1, v[96:99] offset:32768
    ds_write_b128 v1, v[100:103] offset:33792
    ds_write_b128 v1, v[104:107] offset:34816
    ds_write_b128 v1, v[108:111] offset:35840
    ds_write_b128 v1, v[112:115] offset:49152
    ds_write_b128 v1, v[116:119] offset:50176
    ds_write_b128 v1, v[120:123] offset:51200
    ds_write_b128 v1, v[124:127] offset:52224
    s_waitcnt lgkmcnt(0)
    s_waitcnt vmcnt(14)
    v_xor_b32 v28, 0, v31
    v_add_u32 v28, 131072, v28
    ds_read_b64_tr_b16 v[208:209], v28 offset:0
    ds_read_b64_tr_b16 v[210:211], v28 offset:512
    ds_read_b64_tr_b16 v[212:213], v28 offset:2048
    ds_read_b64_tr_b16 v[214:215], v28 offset:2560
    v_xor_b32 v28, 64, v31
    v_add_u32 v28, 131072, v28
    ds_read_b64_tr_b16 v[232:233], v28 offset:0
    ds_read_b64_tr_b16 v[234:235], v28 offset:512
    ds_read_b64_tr_b16 v[236:237], v28 offset:2048
    ds_read_b64_tr_b16 v[238:239], v28 offset:2560
    v_xor_b32 v28, 128, v31
    v_add_u32 v28, 131072, v28
    ds_read_b64_tr_b16 v[48:49], v28 offset:0
    ds_read_b64_tr_b16 v[50:51], v28 offset:512
    ds_read_b64_tr_b16 v[52:53], v28 offset:2048
    ds_read_b64_tr_b16 v[54:55], v28 offset:2560
    v_xor_b32 v28, 192, v31
    v_add_u32 v28, 131072, v28
    ds_read_b64_tr_b16 v[56:57], v28 offset:0
    ds_read_b64_tr_b16 v[58:59], v28 offset:512
    ds_read_b64_tr_b16 v[60:61], v28 offset:2048
    ds_read_b64_tr_b16 v[62:63], v28 offset:2560
    s_waitcnt lgkmcnt(0)
    ds_write_b128 v2, v[32:35] offset:0
    ds_write_b128 v2, v[36:39] offset:1024
    ds_write_b128 v2, v[40:43] offset:2048
    ds_write_b128 v2, v[44:47] offset:3072
    ds_write_b128 v2, v[48:51] offset:16384
    ds_write_b128 v2, v[52:55] offset:17408
    ds_write_b128 v2, v[56:59] offset:18432
    ds_write_b128 v2, v[60:63] offset:19456
    s_waitcnt lgkmcnt(0)
    v_min_u32 v18, -2, v18
    s_waitcnt vmcnt(0)
    v_cmp_ne_u32 vcc, 32, v14
    s_mov_b32 m0, 20480
    v_mov_b64 v[28:29], v[20:21]
    v_mov_b64 v[30:31], v[22:23]
    v_mov_b64 v[32:33], v[24:25]
    v_mov_b64 v[34:35], v[26:27]
    s_add_u32 s8, s29, 0x1000
    s_add_u32 s9, s29, 0x2000
    s_add_u32 s10, s29, 0x3000
    s_mov_b32 s20, 0
    s_mov_b32 s21, 0x3f803f80
    s_mov_b32 s12, s64
    s_mov_b32 s13, s64
    s_mov_b32 s14, 0xcccccccc
    s_mov_b32 s15, 0xcccccccc
    s_mov_b32 s16, 0x3f803f80
    s_mov_b32 s17, 0x3f803f80
    v_mov_b64 v[68:69], 0
    v_mov_b64 v[70:71], 0
    v_mov_b64 v[72:73], 0
    v_mov_b64 v[74:75], 0
    v_mov_b64 v[76:77], 0
    v_mov_b64 v[78:79], 0
    v_mov_b64 v[82:83], 0
    v_mov_b64 v[84:85], 0
    v_mov_b64 v[86:87], 0
    v_mov_b64 v[88:89], 0
    v_mov_b64 v[90:91], 0
    v_mov_b64 v[126:127], 0
    v_mov_b64 v[80:81], 0
    v_mov_b64 v[124:125], 0
    ds_read_b128 v[12:15], v0 offset:30976
    ds_read_b128 v[92:95], v0 offset:49152
    ds_read_b128 v[96:99], v0 offset:50176
    ds_read_b128 v[100:103], v1 offset:16384
    ds_read_b128 v[104:107], v1 offset:17408
    ds_read_b128 v[108:111], v0 offset:51200
    ds_read_b128 v[112:115], v0 offset:52224
    ds_read_b128 v[116:119], v1 offset:18432
    ds_read_b128 v[120:123], v1 offset:19456
    v_mov_b64 v[36:37], -1
    v_mov_b64 v[38:39], -1
    v_mov_b32 v19, -1
    s_waitcnt lgkmcnt(0)
    s_cmp_lg_u32 s79, 0
    s_cbranch_scc1 S0_pub2
    s_branch R0_pub2
.p2align 6
R0_loop:
    ds_read_b128 v[12:15], v0 offset:30976
    buffer_load_dwordx4 v[40:43], v10, s[4:7], s30 offen sc1
    buffer_load_dwordx4 v[44:47], v10, s[4:7], s30 offen offset:2048 sc1
    v_mov_b64_e64 v[68:69], 0
    s_xor_b32 s29, s29, 0x40000
    v_mov_b64_e64 v[70:71], 0
    s_xor_b32 s8, s8, 0x40000
    ds_read_b128 v[92:95], v0 offset:49152
    ds_read_b128 v[96:99], v0 offset:50176
    v_mov_b64_e64 v[72:73], 0
    buffer_store_dwordx2 v[124:125], v4, s[4:7], s10 offen
    s_xor_b32 s9, s9, 0x40000
    s_xor_b32 s10, s10, 0x40000
    v_mov_b64 v[80:81], 0
    v_mov_b64 v[124:125], 0
    s_add_u32 s32, s32, 0x2000
    v_mov_b64_e64 v[74:75], 0
    s_add_u32 s31, s31, 0x4000
    ds_read_b128 v[100:103], v1 offset:16384
    ds_read_b128 v[104:107], v1 offset:17408
    v_mov_b64_e64 v[76:77], 0
    s_add_u32 s70, s31, 0x2000
    v_mov_b64_e64 v[78:79], 0
    s_xor_b32 s66, s66, 0x2000
    ds_read_b128 v[108:111], v0 offset:51200
    ds_read_b128 v[112:115], v0 offset:52224
    v_mov_b64_e64 v[82:83], 0
    s_mov_b32 m0, 20480
    v_mov_b64 v[84:85], 0
    v_mov_b64 v[86:87], 0
    ds_read_b128 v[116:119], v1 offset:18432
    ds_read_b128 v[120:123], v1 offset:19456
    v_mov_b64 v[88:89], 0
    v_mov_b64 v[90:91], 0
    buffer_load_dwordx4 v[48:51], v10, s[4:7], s30 offen sc1
    buffer_load_dwordx4 v[52:55], v10, s[4:7], s30 offen offset:2048 sc1
    s_waitcnt lgkmcnt(8)
    s_waitcnt vmcnt(4)
    v_mfma_f32_16x16x32_bf16 v[64:67], v[12:15], v[40:43], 0
    v_bitop3_b32 v16, v40, v41, s18 bitop3:0x7e
    v_bitop3_b32 v17, v42, v43, s18 bitop3:0x7e
    s_waitcnt vmcnt(3)
    v_mfma_f32_16x16x32_bf16 v[64:67], v[12:15], v[44:47], v[64:67]
    v_bitop3_b32 v18, v44, v45, s18 bitop3:0x7e
    v_or3_b32 v16, v16, v17, v18
    v_bitop3_b32 v17, v46, v47, s18 bitop3:0x7e
    v_bitop3_b32 v16, v16, v17, 1 bitop3:0xa8
    v_cmp_ne_u32_e64 vcc, 0, v16
    s_nop 1
    v_add_f32_dpp v64, v64, v64 row_ror:4 row_mask:0xf bank_mask:0xf
    v_add_f32_dpp v65, v65, v65 row_ror:4 row_mask:0xf bank_mask:0xf
    s_nop 0
    v_add_f32_dpp v64, v64, v64 row_ror:8 row_mask:0xf bank_mask:0xf
    v_add_f32_dpp v65, v65, v65 row_ror:8 row_mask:0xf bank_mask:0xf
    v_cvt_pk_bf16_f32 v18, v64, v65
    s_cbranch_vccnz R0_pa1
R0_pub:
    buffer_store_dword v18, v5, s[4:7], s27 offen
R0_pub2:
    s_cmp_eq_u32 s26, 63
    s_cbranch_scc1 R0_last
    v_cmp_eq_u32 vcc, 0, v11
    v_mov_b64 v[20:21], v[28:29]
    v_mov_b64 v[22:23], v[30:31]
    v_mov_b64 v[24:25], v[32:33]
    v_mov_b64_e64 v[26:27], v[34:35]
    s_xor_b32 s19, s27, 0x4000
    s_add_u32 s27, s27, 0x2000
    s_bitset0_b32 s27, 15
    s_xor_b32 s30, s30, 0x40000
    s_mov_b32 s35, 0
    s_cbranch_vccnz R0_flag
R0_flagok:
    s_add_u32 s67, s26, 2
    s_lshr_b32 s18, s67, 1
    s_add_u32 s33, s33, 16
    s_min_u32 s33, s33, s34
    s_add_u32 s26, s26, 1
    v_mov_b64_e64 v[126:127], 0
    s_waitcnt lgkmcnt(0)
    s_nop 7
    buffer_load_dwordx4 v[36:39], v10, s[4:7], s28 offen sc1
    s_nop 14
    buffer_load_dwordx4 v[36:39], v10, s[4:7], s28 offen sc1
    s_nop 14
    buffer_load_dwordx4 v[36:39], v10, s[4:7], s28 offen sc1
    s_waitcnt vmcnt(2)
    v_max3_u32 v16, v36, v37, v38
    v_max_u32 v16, v16, v39
    v_cmp_eq_u32_e64 vcc, -1, v16
    ds_write_b128 v0, v[36:39] offset:16384
    s_cbranch_vccnz R0_pe1
R0_peok:
    v_smfmac_f32_16x16x64_bf16 v[68:71], v[36:39], v[92:99], v3
    v_smfmac_f32_16x16x64_bf16 v[72:75], v[36:39], v[100:107], v3
    buffer_load_dwordx4 v[52:55], v10, s[4:7], s69 offen sc1
    buffer_load_dwordx4 v10, s[4:7], s69 offen sc1 lds
    v_smfmac_f32_16x16x64_bf16 v[76:79], v[36:39], v[108:115], v3
    s_mov_b32 m0, s66
    s_waitcnt lgkmcnt(0)
    s_barrier
    ds_read_b128 v[40:43], v0 offset:17408
    ds_read_b128 v[44:47], v0 offset:18432
    v_smfmac_f32_16x16x64_bf16 v[80:83], v[36:39], v[116:123], v3
    ds_read_b128 v[48:51], v0 offset:19456
    v_smfmac_f32_16x16x64_bf16 v[84:87], v[36:39], a[192:199], v3
    ds_read_b128 v[92:95], v0 offset:32768
    v_smfmac_f32_16x16x64_bf16 v[88:91], v[36:39], a[200:207], v3
    ds_read_b128 v[96:99], v0 offset:33792
    s_waitcnt lgkmcnt(4)
    v_smfmac_f32_16x16x64_bf16 v[68:71], v[40:43], a[0:7], v3
    ds_read_b128 v[100:103], v0 offset:34816
    v_smfmac_f32_16x16x64_bf16 v[72:75], v[40:43], a[8:15], v3
    ds_read_b128 v[104:107], v0 offset:35840
    v_smfmac_f32_16x16x64_bf16 v[76:79], v[40:43], a[16:23], v3
    ds_read_b128 v[108:111], v1 offset:0
    v_smfmac_f32_16x16x64_bf16 v[80:83], v[40:43], a[24:31], v3
    ds_read_b128 v[112:115], v1 offset:1024
    s_waitcnt lgkmcnt(7)
    v_smfmac_f32_16x16x64_bf16 v[68:71], v[44:47], a[32:39], v3
    ds_read_b128 v[116:119], v1 offset:2048
    v_smfmac_f32_16x16x64_bf16 v[72:75], v[44:47], a[40:47], v3
    ds_read_b128 v[120:123], v1 offset:3072
    v_smfmac_f32_16x16x64_bf16 v[76:79], v[44:47], a[48:55], v3
    v_smfmac_f32_16x16x64_bf16 v[80:83], v[44:47], a[56:63], v3
    s_waitcnt lgkmcnt(8)
    s_waitcnt lgkmcnt(6)
    v_smfmac_f32_16x16x64_bf16 v[68:71], v[48:51], v[92:99], v3
    s_waitcnt vmcnt(1)
    v_max3_u32 v16, v52, v53, v54
    v_smfmac_f32_16x16x64_bf16 v[72:75], v[48:51], a[64:71], v3
    s_waitcnt lgkmcnt(4)
    v_max_u32_e64 v16, v16, v55
    v_smfmac_f32_16x16x64_bf16 v[76:79], v[48:51], v[100:107], v3
    v_cmp_eq_u32_e64 vcc, -1, v16
    v_smfmac_f32_16x16x64_bf16 v[80:83], v[48:51], a[72:79], v3
    s_waitcnt vmcnt(0)
    s_waitcnt lgkmcnt(0)
    v_smfmac_f32_16x16x64_bf16 v[84:87], v[40:43], a[208:215], v3
    s_cbranch_vccnz R0_plr
R0_plok:
    s_barrier
    ds_read_b128 v[56:59], v0 offset:21504
    v_smfmac_f32_16x16x64_bf16 v[68:71], v[52:55], v[108:115], v3
    ds_read_b128 v[60:63], v0 offset:22528
    ds_read_b128 v[64:67], v0 offset:23552
    v_smfmac_f32_16x16x64_bf16 v[72:75], v[52:55], a[80:87], v3
    v_smfmac_f32_16x16x64_bf16 v[76:79], v[52:55], v[116:123], v3
    buffer_load_dwordx4 v0, s[4:7], s31 offen sc1 lds
    v_smfmac_f32_16x16x64_bf16 v[80:83], v[52:55], a[88:95], v3
    s_waitcnt lgkmcnt(2)
    v_smfmac_f32_16x16x64_bf16 v[68:71], v[56:59], a[96:103], v3
    buffer_load_dword v11, off, s[4:7], s33 sc1
    s_waitcnt lgkmcnt(1)
    v_smfmac_f32_16x16x64_bf16 v[68:71], v[60:63], a[104:111], v3
    s_waitcnt lgkmcnt(0)
    v_smfmac_f32_16x16x64_bf16 v[68:71], v[64:67], a[112:119], v3
    buffer_load_dwordx4 v0, s[4:7], s31 offen offset:1024 sc1 lds
    ds_read_b128 v[104:107], v9 offset:0
    v_smfmac_f32_16x16x64_bf16 v[72:75], v[56:59], a[120:127], v3
    v_smfmac_f32_16x16x64_bf16 v[72:75], v[60:63], a[128:135], v3
    buffer_load_dwordx4 v[28:31], v0, s[4:7], s70 offen sc1
    ds_read_b128 v[108:111], v9 offset:1024
    v_add_f32 v68, v68, v70
    v_smfmac_f32_16x16x64_bf16 v[72:75], v[64:67], a[136:143], v3
    ds_read_b128 v[112:115], v9 offset:2048
    v_add_f32_e64 v69, v69, v71
    v_smfmac_f32_16x16x64_bf16 v[76:79], v[56:59], a[144:151], v3
    v_cvt_pk_bf16_f32 v92, v68, v69
    v_smfmac_f32_16x16x64_bf16 v[76:79], v[60:63], a[152:159], v3
    buffer_load_dwordx4 v[32:35], v0, s[4:7], s70 offen offset:1024 sc1
    ds_read_b128 v[116:119], v9 offset:3072
    v_add_f32_e64 v72, v72, v74
    v_smfmac_f32_16x16x64_bf16 v[76:79], v[64:67], a[160:167], v3
    ds_read_b128 v[120:123], v9 offset:4096
    v_add_f32_e64 v73, v73, v75
    v_smfmac_f32_16x16x64_bf16 v[80:83], v[56:59], a[168:175], v3
    v_cvt_pk_bf16_f32 v93, v72, v73
    v_smfmac_f32_16x16x64_bf16 v[80:83], v[60:63], a[176:183], v3
    buffer_store_dword v19, v5, s[4:7], s19 offen
    ds_write_b64 v6, v[92:93] offset:24576
    v_add_f32_e64 v76, v76, v78
    v_smfmac_f32_16x16x64_bf16 v[80:83], v[64:67], a[184:191], v3
    v_add_f32_e64 v77, v77, v79
    v_smfmac_f32_16x16x64_bf16 v[88:91], v[40:43], a[216:223], v3
    s_add_u32 s28, s28, 0x2000
    s_bitset0_b32 s28, 15
    v_cvt_pk_bf16_f32 v94, v76, v77
    s_add_u32 s69, s28, 0x1000
    v_add_f32 v80, v80, v82
    v_add_f32_e64 v81, v81, v83
    v_cvt_pk_bf16_f32 v95, v80, v81
    ds_write_b64 v6, v[94:95] offset:25120
    ds_read_b64_tr_b16 v[12:13], v7 offset:24576
    ds_read_b64_tr_b16 v[14:15], v7 offset:24848
    v_smfmac_f32_16x16x64_bf16 v[84:87], v[44:47], a[224:231], v3
    ds_read_b128 v[80:83], v9 offset:6144
    v_smfmac_f32_16x16x64_bf16 v[88:91], v[44:47], a[232:239], v3
    buffer_store_dword v18, v5, s[4:7], s32 offen sc1
    v_smfmac_f32_16x16x64_bf16 v[84:87], v[48:51], a[240:247], v3
    s_waitcnt lgkmcnt(3)
    s_barrier
    ds_read_b64_tr_b16 v[92:93], v7 offset:25664
    ds_read_b64_tr_b16 v[94:95], v7 offset:25936
    v_smfmac_f32_16x16x64_bf16 v[88:91], v[48:51], a[248:255], v3
    v_smfmac_f32_16x16x64_bf16 v[84:87], v[52:55], v[128:135], v3
    ds_read_b64_tr_b16 v[96:97], v7 offset:26752
    s_waitcnt lgkmcnt(4)
    v_mfma_f32_16x16x32_bf16 v[76:79], v[12:15], v[12:15], 0
    ds_read_b64_tr_b16 v[98:99], v7 offset:27024
    ds_read_b64_tr_b16 v[100:101], v7 offset:27840
    v_mfma_f32_16x16x32_bf16 v[68:71], v[104:107], v[12:15], 0
    ds_read_b64_tr_b16 v[102:103], v7 offset:28112
    ds_read_b128 v[104:107], v9 offset:5120
    v_mfma_f32_16x16x32_bf16 v[72:75], v[108:111], v[12:15], 0
    ds_read_b128 v[108:111], v9 offset:7168
    s_waitcnt lgkmcnt(6)
    v_mfma_f32_16x16x32_bf16 v[76:79], v[92:95], v[92:95], v[76:79]
    ds_read_b128 v[36:39], v1 offset:32768
    v_mfma_f32_16x16x32_bf16 v[68:71], v[112:115], v[92:95], v[68:71]
    v_mov_b64 v[112:113], s[20:21]
    v_mov_b64 v[114:115], s[16:17]
    v_mfma_f32_16x16x32_bf16 v[72:75], v[116:119], v[92:95], v[72:75]
    s_waitcnt lgkmcnt(3)
    v_mov_b64 v[116:117], 0
    v_mov_b64_e64 v[118:119], 0
    v_mfma_f32_16x16x32_bf16 v[68:71], v[120:123], v[96:99], v[68:71]
    s_mov_b64 vcc, s[14:15]
    v_mov_b64 v[120:121], 0
    v_mov_b64_e64 v[122:123], 0
    v_mfma_f32_16x16x32_bf16 v[68:71], v[80:83], v[100:103], v[68:71]
    s_waitcnt lgkmcnt(1)
    v_mov_b64 v[80:81], 0
    v_mov_b64_e64 v[82:83], 0
    v_mfma_f32_16x16x32_bf16 v[72:75], v[104:107], v[96:99], v[72:75]
    v_xor_b32 v9, 0x2000, v9
    v_mov_b32_e64 v16, s64
    v_mfma_f32_16x16x32_bf16 v[72:75], v[108:111], v[100:103], v[72:75]
    v_max3_f32 v12, v68, v69, v70
    v_mov_b32_e64 v109, 0
    v_mfma_f32_16x16x32_bf16 v[76:79], v[96:99], v[96:99], v[76:79]
    v_max_f32 v12, v12, v71
    v_mov_b32 v110, 0
    v_mfma_f32_16x16x32_bf16 v[76:79], v[100:103], v[100:103], v[76:79]
    v_max3_f32 v12, v12, v72, v73
    v_max3_f32 v12, v12, v74, v75
    v_smfmac_f32_16x16x64_bf16 v[88:91], v[52:55], v[136:143], v3
    ds_read_b128 v[40:43], v1 offset:33792
    v_cndmask_b32_dpp v68, v72, v68, vcc quad_perm:[2,3,2,3] row_mask:0xf bank_mask:0xf
    v_cndmask_b32_dpp v69, v73, v69, vcc quad_perm:[2,3,2,3] row_mask:0xf bank_mask:0xf
    v_max3_f32 v79, v12, v76, v77
    v_max3_f32 v96, v12, v76, v77
    v_smfmac_f32_16x16x64_bf16 v[84:87], v[56:59], v[144:151], v3
    ds_read_b128 v[44:47], v1 offset:34816
    v_permlane16_swap_b32 v79, v96
    v_max_f32 v78, v79, v96
    v_max_f32_e64 v79, v79, v96
    v_smfmac_f32_16x16x64_bf16 v[88:91], v[56:59], v[152:159], v3
    ds_read_b128 v[48:51], v1 offset:35840
    v_permlane32_swap_b32 v78, v79
    v_max_f32 v78, v78, v79
    v_smfmac_f32_16x16x64_bf16 v[84:87], v[60:63], v[160:167], v3
    ds_read_b128 v[52:55], v1 offset:49152
    v_mul_f32_dpp v78, v78, v16 quad_perm:[2,3,2,3] row_mask:0xf bank_mask:0xf
    v_smfmac_f32_16x16x64_bf16 v[88:91], v[60:63], v[168:175], v3
    ds_read_b128 v[56:59], v1 offset:50176
    v_cndmask_b32_dpp v76, v77, v76, vcc quad_perm:[2,3,2,3] row_mask:0xf bank_mask:0xf
    v_smfmac_f32_16x16x64_bf16 v[84:87], v[64:67], v[176:183], v3
    ds_read_b128 v[60:63], v1 offset:51200
    v_cndmask_b32_dpp v70, v74, v70, vcc quad_perm:[2,3,2,3] row_mask:0xf bank_mask:0xf
    v_smfmac_f32_16x16x64_bf16 v[88:91], v[64:67], v[184:191], v3
    ds_read_b128 v[64:67], v1 offset:52224
    v_cndmask_b32_dpp v71, v75, v71, vcc quad_perm:[2,3,2,3] row_mask:0xf bank_mask:0xf
    v_fma_f32 v76, v76, s64, -v78
    v_exp_f32_e64 v76, v76
    v_pk_fma_f32 v[68:69], v[68:69], s[12:13], v[78:79] op_sel_hi:[1,1,0] neg_lo:[0,0,1] neg_hi:[0,0,1]
    v_pk_fma_f32 v[70:71], v[70:71], s[12:13], v[78:79] op_sel_hi:[1,1,0] neg_lo:[0,0,1] neg_hi:[0,0,1]
    v_mov_b32_dpp v77, v76 quad_perm:[0,1,0,1] row_mask:0xf bank_mask:0xf
    v_pk_add_f32 v[84:85], v[84:85], v[86:87]
    v_pk_add_f32 v[88:89], v[88:89], v[90:91]
    v_cvt_pk_bf16_f32 v108, v76, v77
    v_cvt_pk_bf16_f32 v111, v76, v77
    v_cvt_pk_bf16_f32 v16, v84, v85
    v_cvt_pk_bf16_f32 v17, v88, v89
    v_exp_f32 v68, v68
    v_exp_f32 v69, v69
    v_mfma_f32_16x16x16_bf16 v[92:95], v[16:17], v[108:109], 0
    v_cvt_pk_bf16_f32 v104, v68, v69
    v_exp_f32_e64 v70, v70
    v_mfma_f32_16x16x16_bf16 v[96:99], v[16:17], v[110:111], 0
    v_exp_f32_e64 v71, v71
    v_cvt_pk_bf16_f32 v103, v76, 0
    v_cvt_pk_bf16_f32 v105, v70, v71
    v_mov_b32_dpp v106, v104 quad_perm:[0,1,0,1] row_mask:0xf bank_mask:0xf
    s_nop 0
    v_mfma_f32_16x16x32_bf16 v[72:75], v[112:115], v[102:105], 0
    v_mov_b32_dpp v107, v105 quad_perm:[0,1,0,1] row_mask:0xf bank_mask:0xf
    s_nop 1
    v_mfma_f32_16x16x32_bf16 v[92:95], v[20:23], v[104:107], v[92:95]
    v_mfma_f32_16x16x32_bf16 v[96:99], v[24:27], v[104:107], v[96:99]
    v_add_f32_dpp v72, v72, v72 quad_perm:[2,3,0,1] row_mask:0xf bank_mask:0xf
    v_rcp_f32 v72, v72
    s_mov_b64 exec, s[14:15]
    v_mul_f32 v92, v72, v92
    v_mul_f32 v93, v72, v93
    v_mul_f32 v94, v72, v94
    v_mul_f32 v95, v72, v95
    v_cvt_pk_bf16_f32 v84, v92, v93
    v_cvt_pk_bf16_f32 v85, v94, v95
    ds_write_b64 v8, v[84:85] offset:28928
    v_pk_mul_f32 v[96:97], v[96:97], v[72:73] op_sel_hi:[1,0]
    v_pk_mul_f32 v[98:99], v[98:99], v[72:73] op_sel_hi:[1,0]
    v_cvt_pk_bf16_f32 v86, v96, v97
    v_cvt_pk_bf16_f32 v87, v98, v99
    ds_write_b64 v8, v[86:87] offset:28936
    s_mov_b64 exec, -1
    v_mov_b32_dpp v88, v84 quad_perm:[2,3,2,3] row_mask:0xf bank_mask:0xf
    v_mov_b32_dpp v89, v85 quad_perm:[2,3,2,3] row_mask:0xf bank_mask:0xf
    v_mov_b32_dpp v90, v86 quad_perm:[2,3,2,3] row_mask:0xf bank_mask:0xf
    v_mov_b32_dpp v91, v87 quad_perm:[2,3,2,3] row_mask:0xf bank_mask:0xf
    s_waitcnt lgkmcnt(2)
    s_nop 0
    v_smfmac_f32_16x16x64_bf16 v[116:119], v[88:91], v[36:43], v3
    s_waitcnt lgkmcnt(0)
    s_barrier
    ds_read_b128 v[68:71], v8 offset:29440
    ds_read_b128 v[72:75], v8 offset:29952
    ds_read_b128 v[76:79], v8 offset:30464
    v_smfmac_f32_16x16x64_bf16 v[120:123], v[88:91], v[44:51], v3
    ds_read_b128 v[36:39], v2 offset:16384
    v_smfmac_f32_16x16x64_bf16 v[80:83], v[88:91], v[52:59], v3
    ds_read_b128 v[40:43], v2 offset:17408
    v_smfmac_f32_16x16x64_bf16 v[124:127], v[88:91], v[60:67], v3
    ds_read_b128 v[44:47], v2 offset:0
    s_waitcnt lgkmcnt(5)
    v_smfmac_f32_16x16x64_bf16 v[116:119], v[68:71], v[192:199], v3
    ds_read_b128 v[48:51], v2 offset:1024
    s_waitcnt lgkmcnt(5)
    v_smfmac_f32_16x16x64_bf16 v[116:119], v[72:75], v[200:207], v3
    ds_read_b128 v[52:55], v2 offset:2048
    s_waitcnt lgkmcnt(5)
    v_smfmac_f32_16x16x64_bf16 v[116:119], v[76:79], v[208:215], v3
    ds_read_b128 v[56:59], v2 offset:3072
    ds_read_b128 v[60:63], v2 offset:18432
    v_smfmac_f32_16x16x64_bf16 v[120:123], v[68:71], v[216:223], v3
    ds_read_b128 v[64:67], v2 offset:19456
    v_smfmac_f32_16x16x64_bf16 v[120:123], v[72:75], v[224:231], v3
    v_cvt_pk_bf16_f32 v116, v116, v117
    v_cvt_pk_bf16_f32 v117, v118, v119
    v_bfi_b32 v116, 1, s18, v116
    v_bfi_b32 v117, 1, s18, v117
    v_smfmac_f32_16x16x64_bf16 v[120:123], v[76:79], v[232:239], v3
    buffer_store_dwordx2 v[116:117], v4, s[4:7], s29 offen
    v_smfmac_f32_16x16x64_bf16 v[80:83], v[68:71], v[240:247], v3
    s_waitcnt lgkmcnt(0)
    v_smfmac_f32_16x16x64_bf16 v[80:83], v[72:75], v[248:255], v3
    v_cvt_pk_bf16_f32 v120, v120, v121
    v_cvt_pk_bf16_f32 v121, v122, v123
    v_bfi_b32 v120, 1, s18, v120
    v_bfi_b32 v121, 1, s18, v121
    v_smfmac_f32_16x16x64_bf16 v[80:83], v[76:79], v[36:43], v3
    buffer_store_dwordx2 v[120:121], v4, s[4:7], s8 offen
    v_smfmac_f32_16x16x64_bf16 v[124:127], v[68:71], v[44:51], v3
    v_smfmac_f32_16x16x64_bf16 v[124:127], v[72:75], v[52:59], v3
    v_cvt_pk_bf16_f32 v80, v80, v81
    v_cvt_pk_bf16_f32 v81, v82, v83
    v_bfi_b32 v80, 1, s18, v80
    v_bfi_b32 v81, 1, s18, v81
    v_smfmac_f32_16x16x64_bf16 v[124:127], v[76:79], v[60:67], v3
    buffer_store_dwordx2 v[80:81], v4, s[4:7], s9 offen
    s_nop 6
    v_cvt_pk_bf16_f32 v124, v124, v125
    v_cvt_pk_bf16_f32 v125, v126, v127
    v_bfi_b32 v124, 1, s18, v124
    v_bfi_b32 v125, 1, s18, v125
    s_nop 0
    s_branch R0_loop
.p2align 5
R0_pa1:
    buffer_load_dwordx4 v[40:43], v10, s[4:7], s30 offen sc1
    buffer_load_dwordx4 v[44:47], v10, s[4:7], s30 offen offset:2048 sc1
    s_waitcnt vmcnt(3)
    v_mfma_f32_16x16x32_bf16 v[64:67], v[12:15], v[48:51], 0
    v_bitop3_b32 v16, v48, v49, s18 bitop3:0x7e
    v_bitop3_b32 v17, v50, v51, s18 bitop3:0x7e
    s_waitcnt vmcnt(2)
    v_mfma_f32_16x16x32_bf16 v[64:67], v[12:15], v[52:55], v[64:67]
    v_bitop3_b32 v18, v52, v53, s18 bitop3:0x7e
    v_or3_b32 v16, v16, v17, v18
    v_bitop3_b32 v17, v54, v55, s18 bitop3:0x7e
    v_bitop3_b32 v16, v16, v17, 1 bitop3:0xa8
    v_cmp_ne_u32 vcc, 0, v16
    s_nop 1
    v_add_f32_dpp v64, v64, v64 row_ror:4 row_mask:0xf bank_mask:0xf
    v_add_f32_dpp v65, v65, v65 row_ror:4 row_mask:0xf bank_mask:0xf
    s_nop 0
    v_add_f32_dpp v64, v64, v64 row_ror:8 row_mask:0xf bank_mask:0xf
    v_add_f32_dpp v65, v65, v65 row_ror:8 row_mask:0xf bank_mask:0xf
    v_cvt_pk_bf16_f32 v18, v64, v65
    s_cbranch_vccz R0_pub
R0_par:
    buffer_load_dwordx4 v[48:51], v10, s[4:7], s30 offen sc1
    buffer_load_dwordx4 v[52:55], v10, s[4:7], s30 offen offset:2048 sc1
    s_waitcnt vmcnt(3)
    v_mfma_f32_16x16x32_bf16 v[64:67], v[12:15], v[40:43], 0
    v_bitop3_b32 v16, v40, v41, s18 bitop3:0x7e
    v_bitop3_b32 v17, v42, v43, s18 bitop3:0x7e
    s_waitcnt vmcnt(2)
    v_mfma_f32_16x16x32_bf16 v[64:67], v[12:15], v[44:47], v[64:67]
    v_bitop3_b32 v18, v44, v45, s18 bitop3:0x7e
    v_or3_b32 v16, v16, v17, v18
    v_bitop3_b32 v17, v46, v47, s18 bitop3:0x7e
    v_bitop3_b32 v16, v16, v17, 1 bitop3:0xa8
    v_cmp_ne_u32 vcc, 0, v16
    s_nop 1
    v_add_f32_dpp v64, v64, v64 row_ror:4 row_mask:0xf bank_mask:0xf
    v_add_f32_dpp v65, v65, v65 row_ror:4 row_mask:0xf bank_mask:0xf
    s_nop 0
    v_add_f32_dpp v64, v64, v64 row_ror:8 row_mask:0xf bank_mask:0xf
    v_add_f32_dpp v65, v65, v65 row_ror:8 row_mask:0xf bank_mask:0xf
    v_cvt_pk_bf16_f32 v18, v64, v65
    s_cbranch_vccz R0_pub
    buffer_load_dwordx4 v[40:43], v10, s[4:7], s30 offen sc1
    buffer_load_dwordx4 v[44:47], v10, s[4:7], s30 offen offset:2048 sc1
    s_waitcnt vmcnt(3)
    v_mfma_f32_16x16x32_bf16 v[64:67], v[12:15], v[48:51], 0
    v_bitop3_b32 v16, v48, v49, s18 bitop3:0x7e
    v_bitop3_b32 v17, v50, v51, s18 bitop3:0x7e
    s_waitcnt vmcnt(2)
    v_mfma_f32_16x16x32_bf16 v[64:67], v[12:15], v[52:55], v[64:67]
    v_bitop3_b32 v18, v52, v53, s18 bitop3:0x7e
    v_or3_b32 v16, v16, v17, v18
    v_bitop3_b32 v17, v54, v55, s18 bitop3:0x7e
    v_bitop3_b32 v16, v16, v17, 1 bitop3:0xa8
    v_cmp_ne_u32 vcc, 0, v16
    s_nop 1
    v_add_f32_dpp v64, v64, v64 row_ror:4 row_mask:0xf bank_mask:0xf
    v_add_f32_dpp v65, v65, v65 row_ror:4 row_mask:0xf bank_mask:0xf
    s_nop 0
    v_add_f32_dpp v64, v64, v64 row_ror:8 row_mask:0xf bank_mask:0xf
    v_add_f32_dpp v65, v65, v65 row_ror:8 row_mask:0xf bank_mask:0xf
    v_cvt_pk_bf16_f32 v18, v64, v65
    s_cbranch_vccz R0_pub
    s_add_u32 s35, s35, 1
    s_cmp_lt_u32 s35, 131072
    s_cbranch_scc1 R0_par
    s_branch L_END
R0_last:
    buffer_store_dword v18, v5, s[4:7], s32 offen sc1
    s_branch R_DONE
R0_flag:
    buffer_load_dword v11, off, s[4:7], s33 sc1
    s_waitcnt vmcnt(0)
    v_cmp_eq_u32 vcc, 0, v11
    s_cbranch_vccz R0_flagok
    s_add_u32 s35, s35, 1
    s_cmp_lt_u32 s35, 131072
    s_cbranch_scc1 R0_flag
    s_branch L_END
.p2align 5
R0_pe1:
    buffer_load_dwordx4 v[36:39], v10, s[4:7], s28 offen sc1
    s_waitcnt vmcnt(2)
    v_max3_u32 v16, v36, v37, v38
    v_max_u32 v16, v16, v39
    v_cmp_eq_u32 vcc, -1, v16
    ds_write_b128 v0, v[36:39] offset:16384
    s_cbranch_vccz R0_peok
    buffer_load_dwordx4 v[36:39], v10, s[4:7], s28 offen sc1
    s_waitcnt vmcnt(2)
    v_max3_u32 v16, v36, v37, v38
    v_max_u32 v16, v16, v39
    v_cmp_eq_u32 vcc, -1, v16
    ds_write_b128 v0, v[36:39] offset:16384
    s_cbranch_vccz R0_peok
R0_pe2:
    buffer_load_dwordx4 v[36:39], v10, s[4:7], s28 offen sc1
    s_add_u32 s35, s35, 1
    s_cmp_ge_u32 s35, 131072
    s_cbranch_scc1 L_END
    s_waitcnt vmcnt(2)
    v_max3_u32 v16, v36, v37, v38
    v_max_u32 v16, v16, v39
    v_cmp_eq_u32 vcc, -1, v16
    ds_write_b128 v0, v[36:39] offset:16384
    s_cbranch_vccz R0_peok
    s_branch R0_pe2
R0_plr:
    s_mov_b32 m0, 20480
    s_nop 0
    buffer_load_dwordx4 v[52:55], v10, s[4:7], s69 offen sc1
    buffer_load_dwordx4 v10, s[4:7], s69 offen sc1 lds
    s_mov_b32 m0, s66
    s_waitcnt vmcnt(0)
    v_max3_u32 v16, v52, v53, v54
    v_max_u32 v16, v16, v55
    v_cmp_eq_u32 vcc, -1, v16
    s_waitcnt lgkmcnt(0)
    s_cbranch_vccz R0_plok
    s_add_u32 s35, s35, 1
    s_cmp_lt_u32 s35, 131072
    s_cbranch_scc1 R0_plr
    s_branch L_END
R0_reg:
    s_mov_b32 s35, 0
R0_reg2:
    global_load_dword v11, v16, s[60:61] sc1
    s_waitcnt vmcnt(0)
    v_cmp_eq_u32 vcc, 0, v11
    s_cbranch_vccz R0_reg2_ok
    s_add_u32 s35, s35, 1
    s_cmp_lt_u32 s35, 131072
    s_cbranch_scc1 R0_reg2
    s_branch L_END
R0_reg2_ok:
    s_branch R0_regok
R0_md:
    v_lshlrev_b32 v12, 1, v0
    v_and_b32 v12, 0xe0, v12
    s_mov_b32 s89, 0
R0_md2:
    global_load_dword v14, v12, s[60:61] sc1
    s_waitcnt vmcnt(0)
    v_readlane_b32 s80, v14, 0
    v_readlane_b32 s81, v14, 1
    v_readlane_b32 s82, v14, 2
    v_readlane_b32 s83, v14, 3
    v_readlane_b32 s84, v14, 4
    v_readlane_b32 s85, v14, 5
    v_readlane_b32 s86, v14, 6
    v_readlane_b32 s87, v14, 7
    s_nop 3
    s_add_u32 s88, s80, s81
    s_add_u32 s88, s88, s82
    s_add_u32 s88, s88, s83
    s_add_u32 s88, s88, s84
    s_add_u32 s88, s88, s85
    s_add_u32 s88, s88, s86
    s_add_u32 s88, s88, s87
    s_cmp_ge_u32 s80, 32
    s_cbranch_scc1 R0_mdok
    s_cmp_ge_u32 s88, 256
    s_cbranch_scc1 R0_md3
    s_sleep 16
    s_add_u32 s89, s89, 1
    s_cmp_lt_u32 s89, 131072
    s_cbranch_scc1 R0_md2
    s_branch L_END
R0_md3:
    s_mov_b32 s79, 1
    s_branch R0_mdok
R0_p0:
    buffer_store_dword v18, v5, s[4:7], s27 offen sc1
    s_branch R0_p0ok
R0_kv0:
    s_mov_b32 s35, 0
R0_kv02:
    buffer_load_dword v17, off, s[4:7], s33 offset:16 sc1
    buffer_load_dword v16, off, s[4:7], s33 sc1
    s_waitcnt vmcnt(0)
    v_cmp_eq_u32 vcc, 0, v16
    s_cbranch_vccz R0_kv02_ok
    s_add_u32 s35, s35, 1
    s_cmp_lt_u32 s35, 131072
    s_cbranch_scc1 R0_kv02
    s_branch L_END
R0_kv02_ok:
    s_branch R0_kv0ok
R1_start:
    v_xor_b32 v30, 0x80, v25
    v_xor_b32 v15, 0x40, v24
    v_mov_b32 v31, v27
    s_mov_b32 m0, 36864
    s_mov_b32 s67, 0
    buffer_load_dwordx4 v24, s[16:19], s67 offen lds
    s_mov_b32 m0, 37888
    s_mov_b32 s67, 32768
    buffer_load_dwordx4 v15, s[16:19], s67 offen lds
    s_mov_b32 m0, 38912
    s_mov_b32 s67, 65536
    buffer_load_dwordx4 v24, s[16:19], s67 offen lds
    s_mov_b32 m0, 39936
    s_mov_b32 s67, 98304
    buffer_load_dwordx4 v15, s[16:19], s67 offen lds
    s_mov_b32 m0, 53248
    s_mov_b32 s67, 2097152
    buffer_load_dwordx4 v24, s[16:19], s67 offen lds
    s_mov_b32 m0, 54272
    s_mov_b32 s67, 2129920
    buffer_load_dwordx4 v15, s[16:19], s67 offen lds
    s_mov_b32 m0, 55296
    s_mov_b32 s67, 2162688
    buffer_load_dwordx4 v24, s[16:19], s67 offen lds
    s_mov_b32 m0, 56320
    s_mov_b32 s67, 2195456
    buffer_load_dwordx4 v15, s[16:19], s67 offen lds
    s_mov_b32 m0, 69632
    s_mov_b32 s67, 262144
    buffer_load_dwordx4 v24, s[16:19], s67 offen lds
    s_mov_b32 m0, 70656
    s_mov_b32 s67, 294912
    buffer_load_dwordx4 v15, s[16:19], s67 offen lds
    s_mov_b32 m0, 71680
    s_mov_b32 s67, 327680
    buffer_load_dwordx4 v24, s[16:19], s67 offen lds
    s_mov_b32 m0, 72704
    s_mov_b32 s67, 360448
    buffer_load_dwordx4 v15, s[16:19], s67 offen lds
    s_mov_b32 m0, 86016
    s_mov_b32 s67, 2359296
    buffer_load_dwordx4 v24, s[16:19], s67 offen lds
    s_mov_b32 m0, 87040
    s_mov_b32 s67, 2392064
    buffer_load_dwordx4 v15, s[16:19], s67 offen lds
    s_mov_b32 m0, 88064
    s_mov_b32 s67, 2424832
    buffer_load_dwordx4 v24, s[16:19], s67 offen lds
    s_mov_b32 m0, 89088
    s_mov_b32 s67, 2457600
    buffer_load_dwordx4 v15, s[16:19], s67 offen lds
    s_mov_b32 m0, 102400
    s_mov_b32 s67, 524288
    buffer_load_dwordx4 v24, s[16:19], s67 offen lds
    s_mov_b32 m0, 103424
    s_mov_b32 s67, 557056
    buffer_load_dwordx4 v15, s[16:19], s67 offen lds
    s_mov_b32 m0, 104448
    s_mov_b32 s67, 589824
    buffer_load_dwordx4 v24, s[16:19], s67 offen lds
    s_mov_b32 m0, 105472
    s_mov_b32 s67, 622592
    buffer_load_dwordx4 v15, s[16:19], s67 offen lds
    s_mov_b32 m0, 118784
    s_mov_b32 s67, 2621440
    buffer_load_dwordx4 v24, s[16:19], s67 offen lds
    s_mov_b32 m0, 119808
    s_mov_b32 s67, 2654208
    buffer_load_dwordx4 v15, s[16:19], s67 offen lds
    s_mov_b32 m0, 120832
    s_mov_b32 s67, 2686976
    buffer_load_dwordx4 v24, s[16:19], s67 offen lds
    s_mov_b32 m0, 121856
    s_mov_b32 s67, 2719744
    buffer_load_dwordx4 v15, s[16:19], s67 offen lds
    s_mov_b32 m0, 135168
    s_mov_b32 s67, 786432
    buffer_load_dwordx4 v24, s[16:19], s67 offen lds
    s_mov_b32 m0, 136192
    s_mov_b32 s67, 819200
    buffer_load_dwordx4 v15, s[16:19], s67 offen lds
    s_mov_b32 m0, 137216
    s_mov_b32 s67, 851968
    buffer_load_dwordx4 v24, s[16:19], s67 offen lds
    s_mov_b32 m0, 138240
    s_mov_b32 s67, 884736
    buffer_load_dwordx4 v15, s[16:19], s67 offen lds
    s_mov_b32 m0, 151552
    s_mov_b32 s67, 2883584
    buffer_load_dwordx4 v24, s[16:19], s67 offen lds
    s_mov_b32 m0, 152576
    s_mov_b32 s67, 2916352
    buffer_load_dwordx4 v15, s[16:19], s67 offen lds
    s_mov_b32 m0, 153600
    s_mov_b32 s67, 2949120
    buffer_load_dwordx4 v24, s[16:19], s67 offen lds
    s_mov_b32 m0, 154624
    s_mov_b32 s67, 2981888
    buffer_load_dwordx4 v15, s[16:19], s67 offen lds
    s_mov_b32 s72, s38
    s_mov_b32 s73, s39
    s_mov_b32 s74, 8192
    s_mov_b32 s75, 0x20000
    s_and_b32 s67, s24, 3
    s_lshl_b32 s67, s67, 11
    s_lshr_b32 s68, s24, 3
    s_lshl_b32 s68, s68, 8
    s_add_u32 s67, s67, s68
    s_and_b32 s68, s24, 4
    s_lshl_b32 s68, s68, 2
    s_add_u32 s67, s67, s68
    v_and_b32 v28, 1, v13
    v_lshlrev_b32 v28, 10, v28
    v_lshl_add_u32 v28, v17, 2, v28
    v_lshrrev_b32 v29, 1, v13
    v_lshl_add_u32 v28, v29, 5, v28
    buffer_load_dword v18, v28, s[72:75], s67 offen offset:64
    s_lshl_b32 s33, s24, 10
    s_add_u32 s33, s33, 4
    s_add_u32 s34, s33, 992
    s_add_u32 s33, s33, 0
    s_waitcnt vmcnt(29)
    s_barrier
    v_add_u32 v28, 32768, v26
    v_xor_b32 v29, 32, v28
    ds_read_b64_tr_b16 a[0:1], v28 offset:0
    ds_read_b64_tr_b16 a[2:3], v28 offset:512
    ds_read_b64_tr_b16 a[4:5], v28 offset:8192
    ds_read_b64_tr_b16 a[6:7], v28 offset:8704
    ds_read_b64_tr_b16 a[16:17], v29 offset:0
    ds_read_b64_tr_b16 a[18:19], v29 offset:512
    ds_read_b64_tr_b16 a[20:21], v29 offset:8192
    ds_read_b64_tr_b16 a[22:23], v29 offset:8704
    s_waitcnt lgkmcnt(0)
    s_waitcnt vmcnt(25)
    s_barrier
    s_and_b32 s67, s24, 3
    s_cmp_eq_u32 s67, 1
    s_cbranch_scc1 R1_th1
    s_waitcnt vmcnt(4)
R1_th1:
    s_mov_b32 m0, 36864
    s_mov_b32 s67, 0
    buffer_load_dwordx4 v24, s[8:11], s67 offen lds
    s_mov_b32 m0, 37888
    s_mov_b32 s67, 32768
    buffer_load_dwordx4 v15, s[8:11], s67 offen lds
    s_mov_b32 m0, 38912
    s_mov_b32 s67, 65536
    buffer_load_dwordx4 v24, s[8:11], s67 offen lds
    s_mov_b32 m0, 39936
    s_mov_b32 s67, 98304
    buffer_load_dwordx4 v15, s[8:11], s67 offen lds
    v_add_u32 v28, 49152, v26
    v_xor_b32 v29, 32, v28
    ds_read_b64_tr_b16 a[32:33], v28 offset:0
    ds_read_b64_tr_b16 a[34:35], v28 offset:512
    ds_read_b64_tr_b16 a[36:37], v28 offset:8192
    ds_read_b64_tr_b16 a[38:39], v28 offset:8704
    ds_read_b64_tr_b16 a[48:49], v29 offset:0
    ds_read_b64_tr_b16 a[50:51], v29 offset:512
    ds_read_b64_tr_b16 a[52:53], v29 offset:8192
    ds_read_b64_tr_b16 a[54:55], v29 offset:8704
    s_waitcnt lgkmcnt(0)
    s_waitcnt vmcnt(25)
    s_barrier
    s_and_b32 s67, s24, 3
    s_cmp_eq_u32 s67, 1
    s_cbranch_scc1 R1_th2
    s_waitcnt vmcnt(4)
R1_th2:
    s_mov_b32 m0, 53248
    s_mov_b32 s67, 2097152
    buffer_load_dwordx4 v24, s[8:11], s67 offen lds
    s_mov_b32 m0, 54272
    s_mov_b32 s67, 2129920
    buffer_load_dwordx4 v15, s[8:11], s67 offen lds
    s_mov_b32 m0, 55296
    s_mov_b32 s67, 2162688
    buffer_load_dwordx4 v24, s[8:11], s67 offen lds
    s_mov_b32 m0, 56320
    s_mov_b32 s67, 2195456
    buffer_load_dwordx4 v15, s[8:11], s67 offen lds
    v_add_u32 v28, 65536, v26
    v_xor_b32 v29, 32, v28
    ds_read_b64_tr_b16 v[32:33], v28 offset:0
    ds_read_b64_tr_b16 v[34:35], v28 offset:512
    ds_read_b64_tr_b16 v[36:37], v28 offset:8192
    ds_read_b64_tr_b16 v[38:39], v28 offset:8704
    ds_read_b64_tr_b16 v[40:41], v29 offset:0
    ds_read_b64_tr_b16 v[42:43], v29 offset:512
    ds_read_b64_tr_b16 v[44:45], v29 offset:8192
    ds_read_b64_tr_b16 v[46:47], v29 offset:8704
    s_waitcnt lgkmcnt(0)
    s_waitcnt vmcnt(25)
    s_barrier
    s_and_b32 s67, s24, 3
    s_cmp_eq_u32 s67, 1
    s_cbranch_scc1 R1_th3
    s_waitcnt vmcnt(4)
R1_th3:
    s_mov_b32 m0, 69632
    s_mov_b32 s67, 262144
    buffer_load_dwordx4 v24, s[8:11], s67 offen lds
    s_mov_b32 m0, 70656
    s_mov_b32 s67, 294912
    buffer_load_dwordx4 v15, s[8:11], s67 offen lds
    s_mov_b32 m0, 71680
    s_mov_b32 s67, 327680
    buffer_load_dwordx4 v24, s[8:11], s67 offen lds
    s_mov_b32 m0, 72704
    s_mov_b32 s67, 360448
    buffer_load_dwordx4 v15, s[8:11], s67 offen lds
    v_add_u32 v28, 81920, v26
    v_xor_b32 v29, 32, v28
    ds_read_b64_tr_b16 v[48:49], v28 offset:0
    ds_read_b64_tr_b16 v[50:51], v28 offset:512
    ds_read_b64_tr_b16 v[52:53], v28 offset:8192
    ds_read_b64_tr_b16 v[54:55], v28 offset:8704
    ds_read_b64_tr_b16 v[56:57], v29 offset:0
    ds_read_b64_tr_b16 v[58:59], v29 offset:512
    ds_read_b64_tr_b16 v[60:61], v29 offset:8192
    ds_read_b64_tr_b16 v[62:63], v29 offset:8704
    s_waitcnt lgkmcnt(0)
    s_waitcnt vmcnt(25)
    s_barrier
    s_and_b32 s67, s24, 3
    s_cmp_eq_u32 s67, 1
    s_cbranch_scc1 R1_th4
    s_waitcnt vmcnt(4)
R1_th4:
    s_mov_b32 m0, 86016
    s_mov_b32 s67, 2359296
    buffer_load_dwordx4 v24, s[8:11], s67 offen lds
    s_mov_b32 m0, 87040
    s_mov_b32 s67, 2392064
    buffer_load_dwordx4 v15, s[8:11], s67 offen lds
    s_mov_b32 m0, 88064
    s_mov_b32 s67, 2424832
    buffer_load_dwordx4 v24, s[8:11], s67 offen lds
    s_mov_b32 m0, 89088
    s_mov_b32 s67, 2457600
    buffer_load_dwordx4 v15, s[8:11], s67 offen lds
    v_add_u32 v28, 98304, v26
    v_xor_b32 v29, 32, v28
    ds_read_b64_tr_b16 a[96:97], v28 offset:0
    ds_read_b64_tr_b16 a[98:99], v28 offset:512
    ds_read_b64_tr_b16 a[100:101], v28 offset:8192
    ds_read_b64_tr_b16 a[102:103], v28 offset:8704
    ds_read_b64_tr_b16 a[144:145], v29 offset:0
    ds_read_b64_tr_b16 a[146:147], v29 offset:512
    ds_read_b64_tr_b16 a[148:149], v29 offset:8192
    ds_read_b64_tr_b16 a[150:151], v29 offset:8704
    s_waitcnt lgkmcnt(0)
    s_waitcnt vmcnt(25)
    s_barrier
    s_and_b32 s67, s24, 3
    s_cmp_eq_u32 s67, 1
    s_cbranch_scc1 R1_th5
    s_waitcnt vmcnt(4)
R1_th5:
    s_mov_b32 m0, 102400
    s_mov_b32 s67, 524288
    buffer_load_dwordx4 v24, s[8:11], s67 offen lds
    s_mov_b32 m0, 103424
    s_mov_b32 s67, 557056
    buffer_load_dwordx4 v15, s[8:11], s67 offen lds
    s_mov_b32 m0, 104448
    s_mov_b32 s67, 589824
    buffer_load_dwordx4 v24, s[8:11], s67 offen lds
    s_mov_b32 m0, 105472
    s_mov_b32 s67, 622592
    buffer_load_dwordx4 v15, s[8:11], s67 offen lds
    v_add_u32 v28, 114688, v26
    v_xor_b32 v29, 32, v28
    ds_read_b64_tr_b16 a[104:105], v28 offset:0
    ds_read_b64_tr_b16 a[106:107], v28 offset:512
    ds_read_b64_tr_b16 a[108:109], v28 offset:8192
    ds_read_b64_tr_b16 a[110:111], v28 offset:8704
    ds_read_b64_tr_b16 a[152:153], v29 offset:0
    ds_read_b64_tr_b16 a[154:155], v29 offset:512
    ds_read_b64_tr_b16 a[156:157], v29 offset:8192
    ds_read_b64_tr_b16 a[158:159], v29 offset:8704
    s_waitcnt lgkmcnt(0)
    s_waitcnt vmcnt(25)
    s_barrier
    s_and_b32 s67, s24, 3
    s_cmp_eq_u32 s67, 1
    s_cbranch_scc1 R1_th6
    s_waitcnt vmcnt(4)
R1_th6:
    s_mov_b32 m0, 118784
    s_mov_b32 s67, 2621440
    buffer_load_dwordx4 v24, s[8:11], s67 offen lds
    s_mov_b32 m0, 119808
    s_mov_b32 s67, 2654208
    buffer_load_dwordx4 v15, s[8:11], s67 offen lds
    s_mov_b32 m0, 120832
    s_mov_b32 s67, 2686976
    buffer_load_dwordx4 v24, s[8:11], s67 offen lds
    s_mov_b32 m0, 121856
    s_mov_b32 s67, 2719744
    buffer_load_dwordx4 v15, s[8:11], s67 offen lds
    v_add_u32 v28, 131072, v26
    v_xor_b32 v29, 32, v28
    ds_read_b64_tr_b16 a[112:113], v28 offset:0
    ds_read_b64_tr_b16 a[114:115], v28 offset:512
    ds_read_b64_tr_b16 a[116:117], v28 offset:8192
    ds_read_b64_tr_b16 a[118:119], v28 offset:8704
    ds_read_b64_tr_b16 a[160:161], v29 offset:0
    ds_read_b64_tr_b16 a[162:163], v29 offset:512
    ds_read_b64_tr_b16 a[164:165], v29 offset:8192
    ds_read_b64_tr_b16 a[166:167], v29 offset:8704
    s_waitcnt lgkmcnt(0)
    s_waitcnt vmcnt(25)
    s_barrier
    s_and_b32 s67, s24, 3
    s_cmp_eq_u32 s67, 1
    s_cbranch_scc1 R1_th7
    s_waitcnt vmcnt(4)
R1_th7:
    s_mov_b32 m0, 135168
    s_mov_b32 s67, 786432
    buffer_load_dwordx4 v24, s[8:11], s67 offen lds
    s_mov_b32 m0, 136192
    s_mov_b32 s67, 819200
    buffer_load_dwordx4 v15, s[8:11], s67 offen lds
    s_mov_b32 m0, 137216
    s_mov_b32 s67, 851968
    buffer_load_dwordx4 v24, s[8:11], s67 offen lds
    s_mov_b32 m0, 138240
    s_mov_b32 s67, 884736
    buffer_load_dwordx4 v15, s[8:11], s67 offen lds
    v_add_u32 v28, 147456, v26
    v_xor_b32 v29, 32, v28
    ds_read_b64_tr_b16 v[64:65], v28 offset:0
    ds_read_b64_tr_b16 v[66:67], v28 offset:512
    ds_read_b64_tr_b16 v[68:69], v28 offset:8192
    ds_read_b64_tr_b16 v[70:71], v28 offset:8704
    ds_read_b64_tr_b16 v[72:73], v29 offset:0
    ds_read_b64_tr_b16 v[74:75], v29 offset:512
    ds_read_b64_tr_b16 v[76:77], v29 offset:8192
    ds_read_b64_tr_b16 v[78:79], v29 offset:8704
    s_waitcnt lgkmcnt(0)
    s_waitcnt vmcnt(24)
    s_barrier
    s_and_b32 s67, s24, 3
    s_cmp_eq_u32 s67, 1
    s_cbranch_scc1 R1_th8
    s_waitcnt vmcnt(4)
R1_th8:
    s_mov_b32 m0, 151552
    s_mov_b32 s67, 2883584
    buffer_load_dwordx4 v24, s[8:11], s67 offen lds
    s_mov_b32 m0, 152576
    s_mov_b32 s67, 2916352
    buffer_load_dwordx4 v15, s[8:11], s67 offen lds
    s_mov_b32 m0, 153600
    s_mov_b32 s67, 2949120
    buffer_load_dwordx4 v24, s[8:11], s67 offen lds
    s_mov_b32 m0, 154624
    s_mov_b32 s67, 2981888
    buffer_load_dwordx4 v15, s[8:11], s67 offen lds
    v_add_u32 v28, 32768, v26
    v_xor_b32 v29, 32, v28
    ds_read_b64_tr_b16 a[208:209], v28 offset:0
    ds_read_b64_tr_b16 a[210:211], v28 offset:512
    ds_read_b64_tr_b16 a[212:213], v28 offset:8192
    ds_read_b64_tr_b16 a[214:215], v28 offset:8704
    ds_read_b64_tr_b16 a[216:217], v29 offset:0
    ds_read_b64_tr_b16 a[218:219], v29 offset:512
    ds_read_b64_tr_b16 a[220:221], v29 offset:8192
    ds_read_b64_tr_b16 a[222:223], v29 offset:8704
    s_waitcnt lgkmcnt(0)
    s_waitcnt vmcnt(24)
    s_barrier
    s_and_b32 s67, s24, 3
    s_cmp_eq_u32 s67, 1
    s_cbranch_scc1 R1_th9
    s_waitcnt vmcnt(4)
R1_th9:
    s_mov_b32 m0, 36864
    s_mov_b32 s67, 0
    buffer_load_dwordx4 v24, s[12:15], s67 offen lds
    s_mov_b32 m0, 37888
    s_mov_b32 s67, 32768
    buffer_load_dwordx4 v15, s[12:15], s67 offen lds
    s_mov_b32 m0, 38912
    s_mov_b32 s67, 65536
    buffer_load_dwordx4 v24, s[12:15], s67 offen lds
    s_mov_b32 m0, 39936
    s_mov_b32 s67, 98304
    buffer_load_dwordx4 v15, s[12:15], s67 offen lds
    v_add_u32 v28, 49152, v26
    v_xor_b32 v29, 32, v28
    ds_read_b64_tr_b16 a[224:225], v28 offset:0
    ds_read_b64_tr_b16 a[226:227], v28 offset:512
    ds_read_b64_tr_b16 a[228:229], v28 offset:8192
    ds_read_b64_tr_b16 a[230:231], v28 offset:8704
    ds_read_b64_tr_b16 a[232:233], v29 offset:0
    ds_read_b64_tr_b16 a[234:235], v29 offset:512
    ds_read_b64_tr_b16 a[236:237], v29 offset:8192
    ds_read_b64_tr_b16 a[238:239], v29 offset:8704
    s_waitcnt lgkmcnt(0)
    s_waitcnt vmcnt(24)
    s_barrier
    s_and_b32 s67, s24, 3
    s_cmp_eq_u32 s67, 1
    s_cbranch_scc1 R1_th10
    s_waitcnt vmcnt(4)
R1_th10:
    s_mov_b32 m0, 53248
    s_mov_b32 s67, 2097152
    buffer_load_dwordx4 v24, s[12:15], s67 offen lds
    s_mov_b32 m0, 54272
    s_mov_b32 s67, 2129920
    buffer_load_dwordx4 v15, s[12:15], s67 offen lds
    s_mov_b32 m0, 55296
    s_mov_b32 s67, 2162688
    buffer_load_dwordx4 v24, s[12:15], s67 offen lds
    s_mov_b32 m0, 56320
    s_mov_b32 s67, 2195456
    buffer_load_dwordx4 v15, s[12:15], s67 offen lds
    v_add_u32 v28, 65536, v26
    v_xor_b32 v29, 32, v28
    ds_read_b64_tr_b16 a[240:241], v28 offset:0
    ds_read_b64_tr_b16 a[242:243], v28 offset:512
    ds_read_b64_tr_b16 a[244:245], v28 offset:8192
    ds_read_b64_tr_b16 a[246:247], v28 offset:8704
    ds_read_b64_tr_b16 a[248:249], v29 offset:0
    ds_read_b64_tr_b16 a[250:251], v29 offset:512
    ds_read_b64_tr_b16 a[252:253], v29 offset:8192
    ds_read_b64_tr_b16 a[254:255], v29 offset:8704
    s_waitcnt lgkmcnt(0)
    s_waitcnt vmcnt(24)
    s_barrier
    s_and_b32 s67, s24, 3
    s_cmp_eq_u32 s67, 1
    s_cbranch_scc1 R1_th11
    s_waitcnt vmcnt(4)
R1_th11:
    s_mov_b32 m0, 69632
    s_mov_b32 s67, 262144
    buffer_load_dwordx4 v24, s[12:15], s67 offen lds
    s_mov_b32 m0, 70656
    s_mov_b32 s67, 294912
    buffer_load_dwordx4 v15, s[12:15], s67 offen lds
    s_mov_b32 m0, 71680
    s_mov_b32 s67, 327680
    buffer_load_dwordx4 v24, s[12:15], s67 offen lds
    s_mov_b32 m0, 72704
    s_mov_b32 s67, 360448
    buffer_load_dwordx4 v15, s[12:15], s67 offen lds
    v_add_u32 v28, 81920, v26
    v_xor_b32 v29, 32, v28
    ds_read_b64_tr_b16 a[192:193], v28 offset:0
    ds_read_b64_tr_b16 a[194:195], v28 offset:512
    ds_read_b64_tr_b16 a[196:197], v28 offset:8192
    ds_read_b64_tr_b16 a[198:199], v28 offset:8704
    ds_read_b64_tr_b16 a[200:201], v29 offset:0
    ds_read_b64_tr_b16 a[202:203], v29 offset:512
    ds_read_b64_tr_b16 a[204:205], v29 offset:8192
    ds_read_b64_tr_b16 a[206:207], v29 offset:8704
    s_waitcnt lgkmcnt(0)
    s_waitcnt vmcnt(24)
    s_barrier
    s_and_b32 s67, s24, 3
    s_cmp_eq_u32 s67, 1
    s_cbranch_scc1 R1_th12
    s_waitcnt vmcnt(4)
R1_th12:
    s_mov_b32 m0, 86016
    s_mov_b32 s67, 2359296
    buffer_load_dwordx4 v24, s[12:15], s67 offen lds
    s_mov_b32 m0, 87040
    s_mov_b32 s67, 2392064
    buffer_load_dwordx4 v15, s[12:15], s67 offen lds
    s_mov_b32 m0, 88064
    s_mov_b32 s67, 2424832
    buffer_load_dwordx4 v24, s[12:15], s67 offen lds
    s_mov_b32 m0, 89088
    s_mov_b32 s67, 2457600
    buffer_load_dwordx4 v15, s[12:15], s67 offen lds
    v_mov_b32 v16, 136
    global_load_dword v11, v16, s[60:61] sc1
    global_load_dword v14, v16, s[60:61] offset:-136 sc1
    v_add_u32 v28, 98304, v26
    v_xor_b32 v29, 32, v28
    ds_read_b64_tr_b16 v[144:145], v28 offset:0
    ds_read_b64_tr_b16 v[146:147], v28 offset:512
    ds_read_b64_tr_b16 v[148:149], v28 offset:8192
    ds_read_b64_tr_b16 v[150:151], v28 offset:8704
    ds_read_b64_tr_b16 v[152:153], v29 offset:0
    ds_read_b64_tr_b16 v[154:155], v29 offset:512
    ds_read_b64_tr_b16 v[156:157], v29 offset:8192
    ds_read_b64_tr_b16 v[158:159], v29 offset:8704
    s_waitcnt lgkmcnt(0)
    s_waitcnt vmcnt(26)
    s_barrier
    s_and_b32 s67, s24, 3
    s_cmp_eq_u32 s67, 1
    s_cbranch_scc1 R1_th13
    s_waitcnt vmcnt(4)
R1_th13:
    s_mov_b32 m0, 102400
    s_mov_b32 s67, 524288
    buffer_load_dwordx4 v24, s[12:15], s67 offen lds
    s_mov_b32 m0, 103424
    s_mov_b32 s67, 557056
    buffer_load_dwordx4 v15, s[12:15], s67 offen lds
    s_mov_b32 m0, 104448
    s_mov_b32 s67, 589824
    buffer_load_dwordx4 v24, s[12:15], s67 offen lds
    s_mov_b32 m0, 105472
    s_mov_b32 s67, 622592
    buffer_load_dwordx4 v15, s[12:15], s67 offen lds
    v_add_u32 v28, 114688, v26
    v_xor_b32 v29, 32, v28
    ds_read_b64_tr_b16 v[160:161], v28 offset:0
    ds_read_b64_tr_b16 v[162:163], v28 offset:512
    ds_read_b64_tr_b16 v[164:165], v28 offset:8192
    ds_read_b64_tr_b16 v[166:167], v28 offset:8704
    ds_read_b64_tr_b16 v[168:169], v29 offset:0
    ds_read_b64_tr_b16 v[170:171], v29 offset:512
    ds_read_b64_tr_b16 v[172:173], v29 offset:8192
    ds_read_b64_tr_b16 v[174:175], v29 offset:8704
    s_waitcnt lgkmcnt(0)
    s_waitcnt vmcnt(26)
    s_barrier
    s_and_b32 s67, s24, 3
    s_cmp_eq_u32 s67, 1
    s_cbranch_scc1 R1_th14
    s_waitcnt vmcnt(4)
R1_th14:
    s_mov_b32 m0, 118784
    s_mov_b32 s67, 2621440
    buffer_load_dwordx4 v24, s[12:15], s67 offen lds
    s_mov_b32 m0, 119808
    s_mov_b32 s67, 2654208
    buffer_load_dwordx4 v15, s[12:15], s67 offen lds
    s_mov_b32 m0, 120832
    s_mov_b32 s67, 2686976
    buffer_load_dwordx4 v24, s[12:15], s67 offen lds
    s_mov_b32 m0, 121856
    s_mov_b32 s67, 2719744
    buffer_load_dwordx4 v15, s[12:15], s67 offen lds
    v_add_u32 v28, 131072, v26
    v_xor_b32 v29, 32, v28
    ds_read_b64_tr_b16 v[176:177], v28 offset:0
    ds_read_b64_tr_b16 v[178:179], v28 offset:512
    ds_read_b64_tr_b16 v[180:181], v28 offset:8192
    ds_read_b64_tr_b16 v[182:183], v28 offset:8704
    ds_read_b64_tr_b16 v[184:185], v29 offset:0
    ds_read_b64_tr_b16 v[186:187], v29 offset:512
    ds_read_b64_tr_b16 v[188:189], v29 offset:8192
    ds_read_b64_tr_b16 v[190:191], v29 offset:8704
    s_waitcnt lgkmcnt(0)
    s_waitcnt vmcnt(26)
    s_barrier
    s_and_b32 s67, s24, 3
    s_cmp_eq_u32 s67, 1
    s_cbranch_scc1 R1_th15
    s_waitcnt vmcnt(4)
R1_th15:
    s_mov_b32 m0, 135168
    s_mov_b32 s67, 786432
    buffer_load_dwordx4 v24, s[12:15], s67 offen lds
    s_mov_b32 m0, 136192
    s_mov_b32 s67, 819200
    buffer_load_dwordx4 v15, s[12:15], s67 offen lds
    s_mov_b32 m0, 137216
    s_mov_b32 s67, 851968
    buffer_load_dwordx4 v24, s[12:15], s67 offen lds
    s_mov_b32 m0, 138240
    s_mov_b32 s67, 884736
    buffer_load_dwordx4 v15, s[12:15], s67 offen lds
    v_add_u32 v28, 147456, v26
    v_xor_b32 v29, 32, v28
    ds_read_b64_tr_b16 v[128:129], v28 offset:0
    ds_read_b64_tr_b16 v[130:131], v28 offset:512
    ds_read_b64_tr_b16 v[132:133], v28 offset:8192
    ds_read_b64_tr_b16 v[134:135], v28 offset:8704
    ds_read_b64_tr_b16 v[136:137], v29 offset:0
    ds_read_b64_tr_b16 v[138:139], v29 offset:512
    ds_read_b64_tr_b16 v[140:141], v29 offset:8192
    ds_read_b64_tr_b16 v[142:143], v29 offset:8704
    s_waitcnt lgkmcnt(0)
    s_waitcnt vmcnt(26)
    s_barrier
    s_and_b32 s67, s24, 3
    s_cmp_eq_u32 s67, 1
    s_cbranch_scc1 R1_th16
    s_waitcnt vmcnt(4)
R1_th16:
    s_mov_b32 m0, 151552
    s_mov_b32 s67, 2883584
    buffer_load_dwordx4 v24, s[12:15], s67 offen lds
    s_mov_b32 m0, 152576
    s_mov_b32 s67, 2916352
    buffer_load_dwordx4 v15, s[12:15], s67 offen lds
    s_mov_b32 m0, 153600
    s_mov_b32 s67, 2949120
    buffer_load_dwordx4 v24, s[12:15], s67 offen lds
    s_mov_b32 m0, 154624
    s_mov_b32 s67, 2981888
    buffer_load_dwordx4 v15, s[12:15], s67 offen lds
    v_add_u32 v28, 32768, v26
    v_xor_b32 v29, 32, v28
    ds_read_b64_tr_b16 a[8:9], v28 offset:0
    ds_read_b64_tr_b16 a[10:11], v28 offset:512
    ds_read_b64_tr_b16 a[12:13], v28 offset:8192
    ds_read_b64_tr_b16 a[14:15], v28 offset:8704
    ds_read_b64_tr_b16 a[24:25], v29 offset:0
    ds_read_b64_tr_b16 a[26:27], v29 offset:512
    ds_read_b64_tr_b16 a[28:29], v29 offset:8192
    ds_read_b64_tr_b16 a[30:31], v29 offset:8704
    s_waitcnt lgkmcnt(0)
    s_waitcnt vmcnt(26)
    s_barrier
    s_and_b32 s67, s24, 3
    s_cmp_eq_u32 s67, 1
    s_cbranch_scc1 R1_th17
    s_waitcnt vmcnt(4)
R1_th17:
    s_mov_b32 m0, 36864
    s_mov_b32 s67, 0
    buffer_load_dwordx4 v25, s[20:23], s67 offen lds
    s_mov_b32 m0, 37888
    s_mov_b32 s67, 4096
    buffer_load_dwordx4 v25, s[20:23], s67 offen lds
    s_mov_b32 m0, 38912
    s_mov_b32 s67, 8192
    buffer_load_dwordx4 v25, s[20:23], s67 offen lds
    s_mov_b32 m0, 39936
    s_mov_b32 s67, 12288
    buffer_load_dwordx4 v25, s[20:23], s67 offen lds
    v_add_u32 v28, 49152, v26
    v_xor_b32 v29, 32, v28
    ds_read_b64_tr_b16 a[40:41], v28 offset:0
    ds_read_b64_tr_b16 a[42:43], v28 offset:512
    ds_read_b64_tr_b16 a[44:45], v28 offset:8192
    ds_read_b64_tr_b16 a[46:47], v28 offset:8704
    ds_read_b64_tr_b16 a[56:57], v29 offset:0
    ds_read_b64_tr_b16 a[58:59], v29 offset:512
    ds_read_b64_tr_b16 a[60:61], v29 offset:8192
    ds_read_b64_tr_b16 a[62:63], v29 offset:8704
    s_waitcnt lgkmcnt(0)
    s_waitcnt vmcnt(26)
    s_barrier
    s_and_b32 s67, s24, 3
    s_cmp_eq_u32 s67, 1
    s_cbranch_scc1 R1_th18
    s_waitcnt vmcnt(4)
R1_th18:
    s_mov_b32 m0, 53248
    s_mov_b32 s67, 16384
    buffer_load_dwordx4 v30, s[20:23], s67 offen lds
    s_mov_b32 m0, 54272
    s_mov_b32 s67, 20480
    buffer_load_dwordx4 v30, s[20:23], s67 offen lds
    s_mov_b32 m0, 55296
    s_mov_b32 s67, 24576
    buffer_load_dwordx4 v30, s[20:23], s67 offen lds
    s_mov_b32 m0, 56320
    s_mov_b32 s67, 28672
    buffer_load_dwordx4 v30, s[20:23], s67 offen lds
    v_add_u32 v28, 65536, v26
    v_xor_b32 v29, 32, v28
    ds_read_b64_tr_b16 a[64:65], v28 offset:0
    ds_read_b64_tr_b16 a[66:67], v28 offset:512
    ds_read_b64_tr_b16 a[68:69], v28 offset:8192
    ds_read_b64_tr_b16 a[70:71], v28 offset:8704
    ds_read_b64_tr_b16 a[72:73], v29 offset:0
    ds_read_b64_tr_b16 a[74:75], v29 offset:512
    ds_read_b64_tr_b16 a[76:77], v29 offset:8192
    ds_read_b64_tr_b16 a[78:79], v29 offset:8704
    s_waitcnt lgkmcnt(0)
    s_waitcnt vmcnt(26)
    s_barrier
    s_and_b32 s67, s24, 3
    s_cmp_eq_u32 s67, 1
    s_cbranch_scc1 R1_th19
    s_waitcnt vmcnt(4)
R1_th19:
    s_mov_b32 m0, 69632
    s_mov_b32 s67, 32768
    buffer_load_dwordx4 v25, s[20:23], s67 offen lds
    s_mov_b32 m0, 70656
    s_mov_b32 s67, 36864
    buffer_load_dwordx4 v25, s[20:23], s67 offen lds
    s_mov_b32 m0, 71680
    s_mov_b32 s67, 40960
    buffer_load_dwordx4 v25, s[20:23], s67 offen lds
    s_mov_b32 m0, 72704
    s_mov_b32 s67, 45056
    buffer_load_dwordx4 v25, s[20:23], s67 offen lds
    v_add_u32 v28, 81920, v26
    v_xor_b32 v29, 32, v28
    ds_read_b64_tr_b16 v[80:81], v28 offset:0
    ds_read_b64_tr_b16 v[82:83], v28 offset:512
    ds_read_b64_tr_b16 v[84:85], v28 offset:8192
    ds_read_b64_tr_b16 v[86:87], v28 offset:8704
    ds_read_b64_tr_b16 v[88:89], v29 offset:0
    ds_read_b64_tr_b16 v[90:91], v29 offset:512
    ds_read_b64_tr_b16 v[92:93], v29 offset:8192
    ds_read_b64_tr_b16 v[94:95], v29 offset:8704
    s_waitcnt lgkmcnt(0)
    s_waitcnt vmcnt(24)
    s_barrier
    s_and_b32 s67, s24, 3
    s_cmp_eq_u32 s67, 1
    s_cbranch_scc1 R1_th20
    s_waitcnt vmcnt(4)
R1_th20:
    s_mov_b32 m0, 86016
    s_mov_b32 s67, 49152
    buffer_load_dwordx4 v30, s[20:23], s67 offen lds
    s_mov_b32 m0, 87040
    s_mov_b32 s67, 53248
    buffer_load_dwordx4 v30, s[20:23], s67 offen lds
    s_mov_b32 m0, 88064
    s_mov_b32 s67, 57344
    buffer_load_dwordx4 v30, s[20:23], s67 offen lds
    s_mov_b32 m0, 89088
    s_mov_b32 s67, 61440
    buffer_load_dwordx4 v30, s[20:23], s67 offen lds
    v_cmp_eq_u32 vcc, 0, v11
    s_cbranch_vccnz R1_reg
R1_regok:
    s_mov_b32 s79, 0
    v_cmp_gt_u32 vcc, 32, v14
    s_cbranch_vccnz R1_md
R1_mdok:
    s_getpc_b64 s[80:81]
R1_pc20:
    v_lshlrev_b32 v20, 3, v0
    v_add_u32 v20, 2048, v20
    v_min_u32 v20, L_LAST-R1_pc20, v20
    global_load_dword v21, v20, s[80:81]
    v_add_u32 v28, 98304, v26
    v_xor_b32 v29, 32, v28
    ds_read_b64_tr_b16 a[120:121], v28 offset:0
    ds_read_b64_tr_b16 a[122:123], v28 offset:512
    ds_read_b64_tr_b16 a[124:125], v28 offset:8192
    ds_read_b64_tr_b16 a[126:127], v28 offset:8704
    ds_read_b64_tr_b16 a[168:169], v29 offset:0
    ds_read_b64_tr_b16 a[170:171], v29 offset:512
    ds_read_b64_tr_b16 a[172:173], v29 offset:8192
    ds_read_b64_tr_b16 a[174:175], v29 offset:8704
    s_waitcnt lgkmcnt(0)
    s_waitcnt vmcnt(25)
    s_barrier
    s_and_b32 s67, s24, 3
    s_cmp_eq_u32 s67, 1
    s_cbranch_scc1 R1_th21
    s_waitcnt vmcnt(4)
R1_th21:
    s_mov_b32 m0, 102400
    s_mov_b32 s67, 65536
    buffer_load_dwordx4 v25, s[20:23], s67 offen lds
    s_mov_b32 m0, 103424
    s_mov_b32 s67, 69632
    buffer_load_dwordx4 v25, s[20:23], s67 offen lds
    s_mov_b32 m0, 104448
    s_mov_b32 s67, 73728
    buffer_load_dwordx4 v25, s[20:23], s67 offen lds
    s_mov_b32 m0, 105472
    s_mov_b32 s67, 77824
    buffer_load_dwordx4 v25, s[20:23], s67 offen lds
    buffer_load_dword v17, off, s[4:7], s33 offset:16 sc1
    buffer_load_dword v16, off, s[4:7], s33 sc1
    v_add_u32 v28, 114688, v26
    v_xor_b32 v29, 32, v28
    ds_read_b64_tr_b16 a[128:129], v28 offset:0
    ds_read_b64_tr_b16 a[130:131], v28 offset:512
    ds_read_b64_tr_b16 a[132:133], v28 offset:8192
    ds_read_b64_tr_b16 a[134:135], v28 offset:8704
    ds_read_b64_tr_b16 a[176:177], v29 offset:0
    ds_read_b64_tr_b16 a[178:179], v29 offset:512
    ds_read_b64_tr_b16 a[180:181], v29 offset:8192
    ds_read_b64_tr_b16 a[182:183], v29 offset:8704
    s_waitcnt lgkmcnt(0)
    s_waitcnt vmcnt(27)
    s_barrier
    s_and_b32 s67, s24, 3
    s_cmp_eq_u32 s67, 1
    s_cbranch_scc1 R1_th22
    s_waitcnt vmcnt(4)
R1_th22:
    s_mov_b32 m0, 118784
    s_mov_b32 s67, 81920
    buffer_load_dwordx4 v30, s[20:23], s67 offen lds
    s_mov_b32 m0, 119808
    s_mov_b32 s67, 86016
    buffer_load_dwordx4 v30, s[20:23], s67 offen lds
    s_mov_b32 m0, 120832
    s_mov_b32 s67, 90112
    buffer_load_dwordx4 v30, s[20:23], s67 offen lds
    s_mov_b32 m0, 121856
    s_mov_b32 s67, 94208
    buffer_load_dwordx4 v30, s[20:23], s67 offen lds
    v_add_u32 v28, 131072, v26
    v_xor_b32 v29, 32, v28
    ds_read_b64_tr_b16 a[136:137], v28 offset:0
    ds_read_b64_tr_b16 a[138:139], v28 offset:512
    ds_read_b64_tr_b16 a[140:141], v28 offset:8192
    ds_read_b64_tr_b16 a[142:143], v28 offset:8704
    ds_read_b64_tr_b16 a[184:185], v29 offset:0
    ds_read_b64_tr_b16 a[186:187], v29 offset:512
    ds_read_b64_tr_b16 a[188:189], v29 offset:8192
    ds_read_b64_tr_b16 a[190:191], v29 offset:8704
    s_waitcnt lgkmcnt(0)
    s_waitcnt vmcnt(27)
    s_barrier
    s_and_b32 s67, s24, 3
    s_cmp_eq_u32 s67, 1
    s_cbranch_scc1 R1_th23
    s_waitcnt vmcnt(4)
R1_th23:
    s_mov_b32 m0, 135168
    s_mov_b32 s67, 98304
    buffer_load_dwordx4 v25, s[20:23], s67 offen lds
    s_mov_b32 m0, 136192
    s_mov_b32 s67, 102400
    buffer_load_dwordx4 v25, s[20:23], s67 offen lds
    s_mov_b32 m0, 137216
    s_mov_b32 s67, 106496
    buffer_load_dwordx4 v25, s[20:23], s67 offen lds
    s_mov_b32 m0, 138240
    s_mov_b32 s67, 110592
    buffer_load_dwordx4 v25, s[20:23], s67 offen lds
    v_add_u32 v28, 147456, v26
    v_xor_b32 v29, 32, v28
    ds_read_b64_tr_b16 a[80:81], v28 offset:0
    ds_read_b64_tr_b16 a[82:83], v28 offset:512
    ds_read_b64_tr_b16 a[84:85], v28 offset:8192
    ds_read_b64_tr_b16 a[86:87], v28 offset:8704
    ds_read_b64_tr_b16 a[88:89], v29 offset:0
    ds_read_b64_tr_b16 a[90:91], v29 offset:512
    ds_read_b64_tr_b16 a[92:93], v29 offset:8192
    ds_read_b64_tr_b16 a[94:95], v29 offset:8704
    s_waitcnt lgkmcnt(0)
    s_barrier
    s_mov_b32 m0, 151552
    s_mov_b32 s67, 114688
    buffer_load_dwordx4 v30, s[20:23], s67 offen lds
    s_mov_b32 m0, 152576
    s_mov_b32 s67, 118784
    buffer_load_dwordx4 v30, s[20:23], s67 offen lds
    s_mov_b32 m0, 153600
    s_mov_b32 s67, 122880
    buffer_load_dwordx4 v30, s[20:23], s67 offen lds
    s_mov_b32 m0, 154624
    s_mov_b32 s67, 126976
    buffer_load_dwordx4 v30, s[20:23], s67 offen lds
    v_min_u32 v18, -2, v18
    s_cmp_lg_u32 s79, 0
    s_cbranch_scc1 R1_p0
    buffer_store_dword v18, v5, s[4:7], s27 offen
R1_p0ok:
    s_add_u32 s67, s27, 0x2000
    buffer_load_dword v15, v5, s[4:7], s27 offen sc1
    buffer_load_dword v15, v5, s[4:7], s67 offen sc1
    s_add_u32 s67, s27, 0x4000
    buffer_load_dword v15, v5, s[4:7], s67 offen sc1
    s_add_u32 s67, s27, 0x6000
    buffer_load_dword v15, v5, s[4:7], s67 offen sc1
    buffer_load_dword v15, v5, s[4:7], s32 offen sc1
    s_waitcnt vmcnt(33)
    v_xor_b32 v28, 0, v31
    v_add_u32 v28, 32768, v28
    ds_read_b64_tr_b16 v[208:209], v28 offset:0
    ds_read_b64_tr_b16 v[210:211], v28 offset:512
    ds_read_b64_tr_b16 v[212:213], v28 offset:2048
    ds_read_b64_tr_b16 v[214:215], v28 offset:2560
    v_xor_b32 v28, 64, v31
    v_add_u32 v28, 32768, v28
    ds_read_b64_tr_b16 v[232:233], v28 offset:0
    ds_read_b64_tr_b16 v[234:235], v28 offset:512
    ds_read_b64_tr_b16 v[236:237], v28 offset:2048
    ds_read_b64_tr_b16 v[238:239], v28 offset:2560
    v_xor_b32 v28, 128, v31
    v_add_u32 v28, 32768, v28
    ds_read_b64_tr_b16 v[96:97], v28 offset:0
    ds_read_b64_tr_b16 v[98:99], v28 offset:512
    ds_read_b64_tr_b16 v[100:101], v28 offset:2048
    ds_read_b64_tr_b16 v[102:103], v28 offset:2560
    v_xor_b32 v28, 192, v31
    v_add_u32 v28, 32768, v28
    ds_read_b64_tr_b16 v[104:105], v28 offset:0
    ds_read_b64_tr_b16 v[106:107], v28 offset:512
    ds_read_b64_tr_b16 v[108:109], v28 offset:2048
    ds_read_b64_tr_b16 v[110:111], v28 offset:2560
    s_waitcnt lgkmcnt(0)
    ds_write_b128 v0, v[32:35] offset:36864
    ds_write_b128 v0, v[36:39] offset:37888
    ds_write_b128 v0, v[40:43] offset:38912
    ds_write_b128 v0, v[44:47] offset:39936
    ds_write_b128 v0, v[48:51] offset:53248
    ds_write_b128 v0, v[52:55] offset:54272
    ds_write_b128 v0, v[56:59] offset:55296
    ds_write_b128 v0, v[60:63] offset:56320
    s_waitcnt lgkmcnt(0)
    s_waitcnt vmcnt(25)
    v_xor_b32 v28, 0, v31
    v_add_u32 v28, 65536, v28
    ds_read_b64_tr_b16 v[112:113], v28 offset:0
    ds_read_b64_tr_b16 v[114:115], v28 offset:512
    ds_read_b64_tr_b16 v[116:117], v28 offset:2048
    ds_read_b64_tr_b16 v[118:119], v28 offset:2560
    v_xor_b32 v28, 64, v31
    v_add_u32 v28, 65536, v28
    ds_read_b64_tr_b16 v[120:121], v28 offset:0
    ds_read_b64_tr_b16 v[122:123], v28 offset:512
    ds_read_b64_tr_b16 v[124:125], v28 offset:2048
    ds_read_b64_tr_b16 v[126:127], v28 offset:2560
    v_xor_b32 v28, 128, v31
    v_add_u32 v28, 65536, v28
    ds_read_b64_tr_b16 v[32:33], v28 offset:0
    ds_read_b64_tr_b16 v[34:35], v28 offset:512
    ds_read_b64_tr_b16 v[36:37], v28 offset:2048
    ds_read_b64_tr_b16 v[38:39], v28 offset:2560
    v_xor_b32 v28, 192, v31
    v_add_u32 v28, 65536, v28
    ds_read_b64_tr_b16 v[40:41], v28 offset:0
    ds_read_b64_tr_b16 v[42:43], v28 offset:512
    ds_read_b64_tr_b16 v[44:45], v28 offset:2048
    ds_read_b64_tr_b16 v[46:47], v28 offset:2560
    s_waitcnt lgkmcnt(0)
    ds_write_b128 v1, v[64:67] offset:4096
    ds_write_b128 v1, v[68:71] offset:5120
    ds_write_b128 v1, v[72:75] offset:6144
    ds_write_b128 v1, v[76:79] offset:7168
    ds_write_b128 v1, v[80:83] offset:20480
    ds_write_b128 v1, v[84:87] offset:21504
    ds_write_b128 v1, v[88:91] offset:22528
    ds_write_b128 v1, v[92:95] offset:23552
    s_waitcnt lgkmcnt(0)
    s_waitcnt vmcnt(14)
    v_cmp_eq_u32 vcc, 0, v16
    s_cbranch_vccnz R1_kv0
R1_kv0ok:
    s_add_u32 s33, s33, 16
    s_add_u32 s70, s31, 0x2000
    s_mov_b32 m0, s66
    v_mov_b32 v11, v17
    buffer_load_dwordx4 v0, s[4:7], s31 offen sc1 lds
    buffer_load_dwordx4 v0, s[4:7], s31 offen offset:1024 sc1 lds
    buffer_load_dwordx4 v[20:23], v0, s[4:7], s70 offen sc1
    buffer_load_dwordx4 v[24:27], v0, s[4:7], s70 offen offset:1024 sc1
    s_add_u32 s31, s31, 0x4000
    s_add_u32 s70, s31, 0x2000
    s_xor_b32 s66, s66, 0x2000
    s_xor_b32 s67, s30, 0x40000
    buffer_load_dword v15, v10, s[4:7], s67 offen sc1
    buffer_load_dword v15, v10, s[4:7], s67 offen offset:2048 sc1
    buffer_load_dword v15, v10, s[4:7], s30 offen sc1
    buffer_load_dword v15, v10, s[4:7], s30 offen offset:2048 sc1
    v_xor_b32 v28, 0, v31
    v_add_u32 v28, 98304, v28
    ds_read_b64_tr_b16 v[192:193], v28 offset:0
    ds_read_b64_tr_b16 v[194:195], v28 offset:512
    ds_read_b64_tr_b16 v[196:197], v28 offset:2048
    ds_read_b64_tr_b16 v[198:199], v28 offset:2560
    v_xor_b32 v28, 64, v31
    v_add_u32 v28, 98304, v28
    ds_read_b64_tr_b16 v[216:217], v28 offset:0
    ds_read_b64_tr_b16 v[218:219], v28 offset:512
    ds_read_b64_tr_b16 v[220:221], v28 offset:2048
    ds_read_b64_tr_b16 v[222:223], v28 offset:2560
    v_xor_b32 v28, 128, v31
    v_add_u32 v28, 98304, v28
    ds_read_b64_tr_b16 v[240:241], v28 offset:0
    ds_read_b64_tr_b16 v[242:243], v28 offset:512
    ds_read_b64_tr_b16 v[244:245], v28 offset:2048
    ds_read_b64_tr_b16 v[246:247], v28 offset:2560
    v_xor_b32 v28, 192, v31
    v_add_u32 v28, 98304, v28
    ds_read_b64_tr_b16 v[48:49], v28 offset:0
    ds_read_b64_tr_b16 v[50:51], v28 offset:512
    ds_read_b64_tr_b16 v[52:53], v28 offset:2048
    ds_read_b64_tr_b16 v[54:55], v28 offset:2560
    s_waitcnt lgkmcnt(0)
    ds_write_b128 v1, v[96:99] offset:36864
    ds_write_b128 v1, v[100:103] offset:37888
    ds_write_b128 v1, v[104:107] offset:38912
    ds_write_b128 v1, v[108:111] offset:39936
    ds_write_b128 v1, v[112:115] offset:53248
    ds_write_b128 v1, v[116:119] offset:54272
    ds_write_b128 v1, v[120:123] offset:55296
    ds_write_b128 v1, v[124:127] offset:56320
    s_waitcnt lgkmcnt(0)
    s_waitcnt vmcnt(14)
    v_xor_b32 v28, 0, v31
    v_add_u32 v28, 131072, v28
    ds_read_b64_tr_b16 v[200:201], v28 offset:0
    ds_read_b64_tr_b16 v[202:203], v28 offset:512
    ds_read_b64_tr_b16 v[204:205], v28 offset:2048
    ds_read_b64_tr_b16 v[206:207], v28 offset:2560
    v_xor_b32 v28, 64, v31
    v_add_u32 v28, 131072, v28
    ds_read_b64_tr_b16 v[224:225], v28 offset:0
    ds_read_b64_tr_b16 v[226:227], v28 offset:512
    ds_read_b64_tr_b16 v[228:229], v28 offset:2048
    ds_read_b64_tr_b16 v[230:231], v28 offset:2560
    v_xor_b32 v28, 128, v31
    v_add_u32 v28, 131072, v28
    ds_read_b64_tr_b16 v[248:249], v28 offset:0
    ds_read_b64_tr_b16 v[250:251], v28 offset:512
    ds_read_b64_tr_b16 v[252:253], v28 offset:2048
    ds_read_b64_tr_b16 v[254:255], v28 offset:2560
    v_xor_b32 v28, 192, v31
    v_add_u32 v28, 131072, v28
    ds_read_b64_tr_b16 v[56:57], v28 offset:0
    ds_read_b64_tr_b16 v[58:59], v28 offset:512
    ds_read_b64_tr_b16 v[60:61], v28 offset:2048
    ds_read_b64_tr_b16 v[62:63], v28 offset:2560
    s_waitcnt lgkmcnt(0)
    ds_write_b128 v2, v[32:35] offset:4096
    ds_write_b128 v2, v[36:39] offset:5120
    ds_write_b128 v2, v[40:43] offset:6144
    ds_write_b128 v2, v[44:47] offset:7168
    ds_write_b128 v2, v[48:51] offset:20480
    ds_write_b128 v2, v[52:55] offset:21504
    ds_write_b128 v2, v[56:59] offset:22528
    ds_write_b128 v2, v[60:63] offset:23552
    s_waitcnt lgkmcnt(0)
    v_min_u32 v18, -2, v18
    s_waitcnt vmcnt(0)
    v_cmp_ne_u32 vcc, 32, v14
    s_mov_b32 m0, 21504
    v_mov_b64 v[28:29], v[20:21]
    v_mov_b64 v[30:31], v[22:23]
    v_mov_b64 v[32:33], v[24:25]
    v_mov_b64 v[34:35], v[26:27]
    s_add_u32 s8, s29, 0x1000
    s_add_u32 s9, s29, 0x2000
    s_add_u32 s10, s29, 0x3000
    s_mov_b32 s20, 0
    s_mov_b32 s21, 0x3f803f80
    s_mov_b32 s12, s64
    s_mov_b32 s13, s64
    s_mov_b32 s14, 0xcccccccc
    s_mov_b32 s15, 0xcccccccc
    s_mov_b32 s16, 0x3f803f80
    s_mov_b32 s17, 0x3f803f80
    v_mov_b64 v[68:69], 0
    v_mov_b64 v[70:71], 0
    v_mov_b64 v[72:73], 0
    v_mov_b64 v[74:75], 0
    v_mov_b64 v[76:77], 0
    v_mov_b64 v[78:79], 0
    v_mov_b64 v[82:83], 0
    v_mov_b64 v[84:85], 0
    v_mov_b64 v[86:87], 0
    v_mov_b64 v[88:89], 0
    v_mov_b64 v[90:91], 0
    v_mov_b64 v[126:127], 0
    v_mov_b64 v[80:81], 0
    v_mov_b64 v[124:125], 0
    ds_read_b128 v[12:15], v0 offset:30976
    ds_read_b128 v[92:95], v0 offset:53248
    ds_read_b128 v[96:99], v0 offset:54272
    ds_read_b128 v[100:103], v1 offset:20480
    ds_read_b128 v[104:107], v1 offset:21504
    ds_read_b128 v[108:111], v0 offset:55296
    ds_read_b128 v[112:115], v0 offset:56320
    ds_read_b128 v[116:119], v1 offset:22528
    ds_read_b128 v[120:123], v1 offset:23552
    v_mov_b64 v[36:37], -1
    v_mov_b64 v[38:39], -1
    v_mov_b32 v19, -1
    s_waitcnt lgkmcnt(0)
    s_cmp_lg_u32 s79, 0
    s_cbranch_scc1 S1_pub2
    s_branch R1_pub2
.p2align 6
R1_loop:
    ds_read_b128 v[12:15], v0 offset:30976
    v_mov_b64_e64 v[68:69], 0
    s_xor_b32 s29, s29, 0x40000
    v_mov_b64_e64 v[70:71], 0
    s_xor_b32 s8, s8, 0x40000
    ds_read_b128 v[92:95], v0 offset:53248
    ds_read_b128 v[96:99], v0 offset:54272
    v_mov_b64_e64 v[72:73], 0
    s_add_u32 s32, s32, 0x2000
    v_mov_b64_e64 v[74:75], 0
    s_add_u32 s31, s31, 0x4000
    ds_read_b128 v[100:103], v1 offset:20480
    ds_read_b128 v[104:107], v1 offset:21504
    v_mov_b64_e64 v[76:77], 0
    s_add_u32 s70, s31, 0x2000
    v_mov_b64_e64 v[78:79], 0
    s_xor_b32 s66, s66, 0x2000
    ds_read_b128 v[108:111], v0 offset:55296
    buffer_load_dwordx4 v[40:43], v10, s[4:7], s30 offen sc1
    buffer_load_dwordx4 v[44:47], v10, s[4:7], s30 offen offset:2048 sc1
    buffer_store_dwordx2 v[124:125], v4, s[4:7], s10 offen
    s_xor_b32 s9, s9, 0x40000
    s_xor_b32 s10, s10, 0x40000
    v_mov_b64 v[80:81], 0
    v_mov_b64 v[124:125], 0
    ds_read_b128 v[112:115], v0 offset:56320
    v_mov_b64_e64 v[82:83], 0
    s_mov_b32 m0, 21504
    v_mov_b64 v[84:85], 0
    v_mov_b64 v[86:87], 0
    ds_read_b128 v[116:119], v1 offset:22528
    ds_read_b128 v[120:123], v1 offset:23552
    v_mov_b64 v[88:89], 0
    v_mov_b64 v[90:91], 0
    v_mov_b64_e64 v[126:127], 0
    s_waitcnt lgkmcnt(0)
    s_nop 2
    buffer_load_dwordx4 v[48:51], v10, s[4:7], s30 offen sc1
    buffer_load_dwordx4 v[52:55], v10, s[4:7], s30 offen offset:2048 sc1
    s_waitcnt vmcnt(4)
    v_mfma_f32_16x16x32_bf16 v[64:67], v[12:15], v[40:43], 0
    v_bitop3_b32 v16, v40, v41, s18 bitop3:0x7e
    v_bitop3_b32 v17, v42, v43, s18 bitop3:0x7e
    s_waitcnt vmcnt(3)
    v_mfma_f32_16x16x32_bf16 v[64:67], v[12:15], v[44:47], v[64:67]
    v_bitop3_b32 v18, v44, v45, s18 bitop3:0x7e
    v_or3_b32 v16, v16, v17, v18
    v_bitop3_b32 v17, v46, v47, s18 bitop3:0x7e
    v_bitop3_b32 v16, v16, v17, 1 bitop3:0xa8
    v_cmp_ne_u32 vcc, 0, v16
    s_nop 1
    v_add_f32_dpp v64, v64, v64 row_ror:4 row_mask:0xf bank_mask:0xf
    v_add_f32_dpp v65, v65, v65 row_ror:4 row_mask:0xf bank_mask:0xf
    s_nop 0
    v_add_f32_dpp v64, v64, v64 row_ror:8 row_mask:0xf bank_mask:0xf
    v_add_f32_dpp v65, v65, v65 row_ror:8 row_mask:0xf bank_mask:0xf
    v_cvt_pk_bf16_f32 v18, v64, v65
    s_cbranch_vccnz R1_pa1
R1_pub:
    buffer_store_dword v18, v5, s[4:7], s27 offen
R1_pub2:
    s_cmp_eq_u32 s26, 63
    s_cbranch_scc1 R1_last
    v_cmp_eq_u32 vcc, 0, v11
    v_mov_b64 v[20:21], v[28:29]
    v_mov_b64 v[22:23], v[30:31]
    v_mov_b64 v[24:25], v[32:33]
    v_mov_b64_e64 v[26:27], v[34:35]
    s_xor_b32 s19, s27, 0x4000
    s_add_u32 s27, s27, 0x2000
    s_bitset0_b32 s27, 15
    buffer_load_dwordx4 v[36:39], v10, s[4:7], s28 offen sc1
    s_xor_b32 s30, s30, 0x40000
    s_mov_b32 s35, 0
    s_cbranch_vccnz R1_flag
R1_flagok:
    s_add_u32 s67, s26, 2
    s_lshr_b32 s18, s67, 1
    s_add_u32 s33, s33, 16
    s_min_u32 s33, s33, s34
    s_add_u32 s26, s26, 1
    s_nop 8
    buffer_load_dwordx4 v[36:39], v10, s[4:7], s28 offen sc1
    s_nop 15
    s_nop 0
    buffer_load_dwordx4 v[36:39], v10, s[4:7], s28 offen sc1
    s_waitcnt vmcnt(2)
    v_max3_u32 v16, v36, v37, v38
    v_max_u32 v16, v16, v39
    v_cmp_eq_u32 vcc, -1, v16
    ds_write_b128 v0, v[36:39] offset:17408
    s_cbranch_vccnz R1_pe1
R1_peok:
    v_smfmac_f32_16x16x64_bf16 v[68:71], v[36:39], v[92:99], v3
    buffer_load_dwordx4 v[52:55], v10, s[4:7], s69 offen sc1
    buffer_load_dwordx4 v10, s[4:7], s69 offen sc1 lds
    v_smfmac_f32_16x16x64_bf16 v[72:75], v[36:39], v[100:107], v3
    s_mov_b32 m0, s66
    v_smfmac_f32_16x16x64_bf16 v[76:79], v[36:39], v[108:115], v3
    s_waitcnt lgkmcnt(0)
    s_barrier
    ds_read_b128 v[40:43], v0 offset:18432
    ds_read_b128 v[44:47], v0 offset:19456
    v_smfmac_f32_16x16x64_bf16 v[80:83], v[36:39], v[116:123], v3
    ds_read_b128 v[48:51], v0 offset:16384
    v_smfmac_f32_16x16x64_bf16 v[84:87], v[36:39], a[192:199], v3
    ds_read_b128 v[92:95], v0 offset:36864
    v_smfmac_f32_16x16x64_bf16 v[88:91], v[36:39], a[200:207], v3
    ds_read_b128 v[96:99], v0 offset:37888
    s_waitcnt lgkmcnt(4)
    v_smfmac_f32_16x16x64_bf16 v[68:71], v[40:43], a[0:7], v3
    ds_read_b128 v[100:103], v0 offset:38912
    v_smfmac_f32_16x16x64_bf16 v[72:75], v[40:43], a[8:15], v3
    ds_read_b128 v[104:107], v0 offset:39936
    v_smfmac_f32_16x16x64_bf16 v[76:79], v[40:43], a[16:23], v3
    ds_read_b128 v[108:111], v1 offset:4096
    v_smfmac_f32_16x16x64_bf16 v[80:83], v[40:43], a[24:31], v3
    ds_read_b128 v[112:115], v1 offset:5120
    s_waitcnt lgkmcnt(7)
    v_smfmac_f32_16x16x64_bf16 v[68:71], v[44:47], a[32:39], v3
    ds_read_b128 v[116:119], v1 offset:6144
    v_smfmac_f32_16x16x64_bf16 v[72:75], v[44:47], a[40:47], v3
    ds_read_b128 v[120:123], v1 offset:7168
    v_smfmac_f32_16x16x64_bf16 v[76:79], v[44:47], a[48:55], v3
    v_smfmac_f32_16x16x64_bf16 v[80:83], v[44:47], a[56:63], v3
    s_waitcnt lgkmcnt(8)
    s_waitcnt lgkmcnt(6)
    v_smfmac_f32_16x16x64_bf16 v[68:71], v[48:51], v[92:99], v3
    s_waitcnt vmcnt(1)
    v_max3_u32 v16, v52, v53, v54
    v_smfmac_f32_16x16x64_bf16 v[72:75], v[48:51], a[64:71], v3
    s_waitcnt lgkmcnt(4)
    v_max_u32_e64 v16, v16, v55
    v_smfmac_f32_16x16x64_bf16 v[76:79], v[48:51], v[100:107], v3
    v_cmp_eq_u32_e64 vcc, -1, v16
    v_smfmac_f32_16x16x64_bf16 v[80:83], v[48:51], a[72:79], v3
    s_waitcnt vmcnt(0)
    s_waitcnt lgkmcnt(0)
    v_smfmac_f32_16x16x64_bf16 v[84:87], v[40:43], a[208:215], v3
    s_cbranch_vccnz R1_plr
R1_plok:
    s_barrier
    ds_read_b128 v[56:59], v0 offset:22528
    v_smfmac_f32_16x16x64_bf16 v[68:71], v[52:55], v[108:115], v3
    ds_read_b128 v[60:63], v0 offset:23552
    ds_read_b128 v[64:67], v0 offset:20480
    v_smfmac_f32_16x16x64_bf16 v[72:75], v[52:55], a[80:87], v3
    buffer_load_dwordx4 v0, s[4:7], s31 offen sc1 lds
    v_smfmac_f32_16x16x64_bf16 v[76:79], v[52:55], v[116:123], v3
    v_smfmac_f32_16x16x64_bf16 v[80:83], v[52:55], a[88:95], v3
    buffer_load_dword v11, off, s[4:7], s33 sc1
    s_waitcnt lgkmcnt(2)
    v_smfmac_f32_16x16x64_bf16 v[68:71], v[56:59], a[96:103], v3
    s_waitcnt lgkmcnt(1)
    v_smfmac_f32_16x16x64_bf16 v[68:71], v[60:63], a[104:111], v3
    buffer_load_dwordx4 v0, s[4:7], s31 offen offset:1024 sc1 lds
    s_waitcnt lgkmcnt(0)
    v_smfmac_f32_16x16x64_bf16 v[68:71], v[64:67], a[112:119], v3
    ds_read_b128 v[104:107], v9 offset:2048
    v_smfmac_f32_16x16x64_bf16 v[72:75], v[56:59], a[120:127], v3
    buffer_load_dwordx4 v[28:31], v0, s[4:7], s70 offen sc1
    v_smfmac_f32_16x16x64_bf16 v[72:75], v[60:63], a[128:135], v3
    ds_read_b128 v[108:111], v9 offset:3072
    v_add_f32 v68, v68, v70
    v_smfmac_f32_16x16x64_bf16 v[72:75], v[64:67], a[136:143], v3
    ds_read_b128 v[112:115], v9 offset:4096
    v_add_f32_e64 v69, v69, v71
    v_smfmac_f32_16x16x64_bf16 v[76:79], v[56:59], a[144:151], v3
    buffer_load_dwordx4 v[32:35], v0, s[4:7], s70 offen offset:1024 sc1
    v_cvt_pk_bf16_f32 v92, v68, v69
    v_smfmac_f32_16x16x64_bf16 v[76:79], v[60:63], a[152:159], v3
    ds_read_b128 v[116:119], v9 offset:5120
    v_add_f32_e64 v72, v72, v74
    v_smfmac_f32_16x16x64_bf16 v[76:79], v[64:67], a[160:167], v3
    ds_read_b128 v[120:123], v9 offset:6144
    v_add_f32_e64 v73, v73, v75
    v_smfmac_f32_16x16x64_bf16 v[80:83], v[56:59], a[168:175], v3
    buffer_store_dword v19, v5, s[4:7], s19 offen
    v_cvt_pk_bf16_f32 v93, v72, v73
    v_smfmac_f32_16x16x64_bf16 v[80:83], v[60:63], a[176:183], v3
    ds_write_b64 v6, v[92:93] offset:25664
    v_add_f32_e64 v76, v76, v78
    v_smfmac_f32_16x16x64_bf16 v[80:83], v[64:67], a[184:191], v3
    v_add_f32_e64 v77, v77, v79
    v_smfmac_f32_16x16x64_bf16 v[88:91], v[40:43], a[216:223], v3
    s_add_u32 s28, s28, 0x2000
    s_bitset0_b32 s28, 15
    v_cvt_pk_bf16_f32 v94, v76, v77
    s_add_u32 s69, s28, 0x1000
    v_add_f32 v80, v80, v82
    v_add_f32_e64 v81, v81, v83
    v_cvt_pk_bf16_f32 v95, v80, v81
    ds_write_b64 v6, v[94:95] offset:26208
    ds_read_b64_tr_b16 v[12:13], v7 offset:25664
    ds_read_b64_tr_b16 v[14:15], v7 offset:25936
    v_smfmac_f32_16x16x64_bf16 v[84:87], v[44:47], a[224:231], v3
    buffer_store_dword v18, v5, s[4:7], s32 offen sc1
    ds_read_b128 v[80:83], v9 offset:0
    v_smfmac_f32_16x16x64_bf16 v[88:91], v[44:47], a[232:239], v3
    v_smfmac_f32_16x16x64_bf16 v[84:87], v[48:51], a[240:247], v3
    s_waitcnt lgkmcnt(3)
    s_barrier
    ds_read_b64_tr_b16 v[92:93], v7 offset:26752
    ds_read_b64_tr_b16 v[94:95], v7 offset:27024
    v_smfmac_f32_16x16x64_bf16 v[88:91], v[48:51], a[248:255], v3
    v_smfmac_f32_16x16x64_bf16 v[84:87], v[52:55], v[128:135], v3
    ds_read_b64_tr_b16 v[96:97], v7 offset:27840
    s_waitcnt lgkmcnt(4)
    v_mfma_f32_16x16x32_bf16 v[76:79], v[12:15], v[12:15], 0
    ds_read_b64_tr_b16 v[98:99], v7 offset:28112
    ds_read_b64_tr_b16 v[100:101], v7 offset:24576
    v_mfma_f32_16x16x32_bf16 v[68:71], v[104:107], v[12:15], 0
    ds_read_b64_tr_b16 v[102:103], v7 offset:24848
    ds_read_b128 v[104:107], v9 offset:7168
    v_mfma_f32_16x16x32_bf16 v[72:75], v[108:111], v[12:15], 0
    ds_read_b128 v[108:111], v9 offset:1024
    s_waitcnt lgkmcnt(6)
    v_mfma_f32_16x16x32_bf16 v[76:79], v[92:95], v[92:95], v[76:79]
    ds_read_b128 v[36:39], v1 offset:53248
    v_mfma_f32_16x16x32_bf16 v[68:71], v[112:115], v[92:95], v[68:71]
    v_mov_b64 v[112:113], s[20:21]
    v_mov_b64 v[114:115], s[16:17]
    v_mfma_f32_16x16x32_bf16 v[72:75], v[116:119], v[92:95], v[72:75]
    s_waitcnt lgkmcnt(3)
    v_mov_b64 v[116:117], 0
    v_mov_b64_e64 v[118:119], 0
    v_mfma_f32_16x16x32_bf16 v[68:71], v[120:123], v[96:99], v[68:71]
    s_mov_b64 vcc, s[14:15]
    v_mov_b64 v[120:121], 0
    v_mov_b64_e64 v[122:123], 0
    v_mfma_f32_16x16x32_bf16 v[68:71], v[80:83], v[100:103], v[68:71]
    s_waitcnt lgkmcnt(1)
    v_mov_b64 v[80:81], 0
    v_mov_b64_e64 v[82:83], 0
    v_mfma_f32_16x16x32_bf16 v[72:75], v[104:107], v[96:99], v[72:75]
    v_xor_b32 v9, 0x2000, v9
    v_mov_b32_e64 v16, s64
    v_mfma_f32_16x16x32_bf16 v[72:75], v[108:111], v[100:103], v[72:75]
    v_max3_f32 v12, v68, v69, v70
    v_mov_b32_e64 v109, 0
    v_mfma_f32_16x16x32_bf16 v[76:79], v[96:99], v[96:99], v[76:79]
    v_max_f32 v12, v12, v71
    v_mov_b32 v110, 0
    v_mfma_f32_16x16x32_bf16 v[76:79], v[100:103], v[100:103], v[76:79]
    v_max3_f32 v12, v12, v72, v73
    v_max3_f32 v12, v12, v74, v75
    v_smfmac_f32_16x16x64_bf16 v[88:91], v[52:55], v[136:143], v3
    ds_read_b128 v[40:43], v1 offset:54272
    v_cndmask_b32_dpp v68, v72, v68, vcc quad_perm:[2,3,2,3] row_mask:0xf bank_mask:0xf
    v_cndmask_b32_dpp v69, v73, v69, vcc quad_perm:[2,3,2,3] row_mask:0xf bank_mask:0xf
    v_max3_f32 v79, v12, v76, v77
    v_max3_f32 v96, v12, v76, v77
    v_smfmac_f32_16x16x64_bf16 v[84:87], v[56:59], v[144:151], v3
    ds_read_b128 v[44:47], v1 offset:55296
    v_permlane16_swap_b32 v79, v96
    v_max_f32 v78, v79, v96
    v_max_f32_e64 v79, v79, v96
    v_smfmac_f32_16x16x64_bf16 v[88:91], v[56:59], v[152:159], v3
    ds_read_b128 v[48:51], v1 offset:56320
    v_permlane32_swap_b32 v78, v79
    v_max_f32 v78, v78, v79
    v_smfmac_f32_16x16x64_bf16 v[84:87], v[60:63], v[160:167], v3
    ds_read_b128 v[52:55], v2 offset:4096
    v_mul_f32_dpp v78, v78, v16 quad_perm:[2,3,2,3] row_mask:0xf bank_mask:0xf
    v_smfmac_f32_16x16x64_bf16 v[88:91], v[60:63], v[168:175], v3
    ds_read_b128 v[56:59], v2 offset:5120
    v_cndmask_b32_dpp v76, v77, v76, vcc quad_perm:[2,3,2,3] row_mask:0xf bank_mask:0xf
    v_smfmac_f32_16x16x64_bf16 v[84:87], v[64:67], v[176:183], v3
    ds_read_b128 v[60:63], v2 offset:6144
    v_cndmask_b32_dpp v70, v74, v70, vcc quad_perm:[2,3,2,3] row_mask:0xf bank_mask:0xf
    v_smfmac_f32_16x16x64_bf16 v[88:91], v[64:67], v[184:191], v3
    ds_read_b128 v[64:67], v2 offset:7168
    v_cndmask_b32_dpp v71, v75, v71, vcc quad_perm:[2,3,2,3] row_mask:0xf bank_mask:0xf
    v_fma_f32 v76, v76, s64, -v78
    v_exp_f32_e64 v76, v76
    v_pk_fma_f32 v[68:69], v[68:69], s[12:13], v[78:79] op_sel_hi:[1,1,0] neg_lo:[0,0,1] neg_hi:[0,0,1]
    v_pk_fma_f32 v[70:71], v[70:71], s[12:13], v[78:79] op_sel_hi:[1,1,0] neg_lo:[0,0,1] neg_hi:[0,0,1]
    v_mov_b32_dpp v77, v76 quad_perm:[0,1,0,1] row_mask:0xf bank_mask:0xf
    v_pk_add_f32 v[84:85], v[84:85], v[86:87]
    v_pk_add_f32 v[88:89], v[88:89], v[90:91]
    v_cvt_pk_bf16_f32 v108, v76, v77
    v_cvt_pk_bf16_f32 v111, v76, v77
    v_cvt_pk_bf16_f32 v16, v84, v85
    v_cvt_pk_bf16_f32 v17, v88, v89
    v_exp_f32 v68, v68
    v_exp_f32 v69, v69
    v_mfma_f32_16x16x16_bf16 v[92:95], v[16:17], v[108:109], 0
    v_cvt_pk_bf16_f32 v104, v68, v69
    v_exp_f32_e64 v70, v70
    v_mfma_f32_16x16x16_bf16 v[96:99], v[16:17], v[110:111], 0
    v_exp_f32_e64 v71, v71
    v_cvt_pk_bf16_f32 v103, v76, 0
    v_cvt_pk_bf16_f32 v105, v70, v71
    v_mov_b32_dpp v106, v104 quad_perm:[0,1,0,1] row_mask:0xf bank_mask:0xf
    s_nop 0
    v_mfma_f32_16x16x32_bf16 v[72:75], v[112:115], v[102:105], 0
    v_mov_b32_dpp v107, v105 quad_perm:[0,1,0,1] row_mask:0xf bank_mask:0xf
    s_nop 1
    v_mfma_f32_16x16x32_bf16 v[92:95], v[20:23], v[104:107], v[92:95]
    v_mfma_f32_16x16x32_bf16 v[96:99], v[24:27], v[104:107], v[96:99]
    v_add_f32_dpp v72, v72, v72 quad_perm:[2,3,0,1] row_mask:0xf bank_mask:0xf
    v_rcp_f32 v72, v72
    s_mov_b64 exec, s[14:15]
    v_mul_f32 v92, v72, v92
    v_mul_f32 v93, v72, v93
    v_mul_f32 v94, v72, v94
    v_mul_f32 v95, v72, v95
    v_cvt_pk_bf16_f32 v84, v92, v93
    v_cvt_pk_bf16_f32 v85, v94, v95
    ds_write_b64 v8, v[84:85] offset:29440
    v_pk_mul_f32 v[96:97], v[96:97], v[72:73] op_sel_hi:[1,0]
    v_pk_mul_f32 v[98:99], v[98:99], v[72:73] op_sel_hi:[1,0]
    v_cvt_pk_bf16_f32 v86, v96, v97
    v_cvt_pk_bf16_f32 v87, v98, v99
    ds_write_b64 v8, v[86:87] offset:29448
    s_mov_b64 exec, -1
    v_mov_b32_dpp v88, v84 quad_perm:[2,3,2,3] row_mask:0xf bank_mask:0xf
    v_mov_b32_dpp v89, v85 quad_perm:[2,3,2,3] row_mask:0xf bank_mask:0xf
    v_mov_b32_dpp v90, v86 quad_perm:[2,3,2,3] row_mask:0xf bank_mask:0xf
    v_mov_b32_dpp v91, v87 quad_perm:[2,3,2,3] row_mask:0xf bank_mask:0xf
    s_waitcnt lgkmcnt(2)
    s_nop 0
    v_smfmac_f32_16x16x64_bf16 v[116:119], v[88:91], v[36:43], v3
    s_waitcnt lgkmcnt(0)
    s_barrier
    ds_read_b128 v[68:71], v8 offset:29952
    ds_read_b128 v[72:75], v8 offset:30464
    ds_read_b128 v[76:79], v8 offset:28928
    v_smfmac_f32_16x16x64_bf16 v[120:123], v[88:91], v[44:51], v3
    ds_read_b128 v[36:39], v1 offset:36864
    v_smfmac_f32_16x16x64_bf16 v[80:83], v[88:91], v[52:59], v3
    ds_read_b128 v[40:43], v1 offset:37888
    v_smfmac_f32_16x16x64_bf16 v[124:127], v[88:91], v[60:67], v3
    ds_read_b128 v[44:47], v2 offset:20480
    s_waitcnt lgkmcnt(5)
    v_smfmac_f32_16x16x64_bf16 v[116:119], v[68:71], v[192:199], v3
    ds_read_b128 v[48:51], v2 offset:21504
    s_waitcnt lgkmcnt(5)
    v_smfmac_f32_16x16x64_bf16 v[116:119], v[72:75], v[200:207], v3
    ds_read_b128 v[52:55], v2 offset:22528
    s_waitcnt lgkmcnt(5)
    v_smfmac_f32_16x16x64_bf16 v[116:119], v[76:79], v[208:215], v3
    ds_read_b128 v[56:59], v2 offset:23552
    ds_read_b128 v[60:63], v1 offset:38912
    v_smfmac_f32_16x16x64_bf16 v[120:123], v[68:71], v[216:223], v3
    ds_read_b128 v[64:67], v1 offset:39936
    v_smfmac_f32_16x16x64_bf16 v[120:123], v[72:75], v[224:231], v3
    v_cvt_pk_bf16_f32 v116, v116, v117
    v_cvt_pk_bf16_f32 v117, v118, v119
    v_bfi_b32 v116, 1, s18, v116
    v_bfi_b32 v117, 1, s18, v117
    v_smfmac_f32_16x16x64_bf16 v[120:123], v[76:79], v[232:239], v3
    buffer_store_dwordx2 v[116:117], v4, s[4:7], s29 offen
    v_smfmac_f32_16x16x64_bf16 v[80:83], v[68:71], v[240:247], v3
    s_waitcnt lgkmcnt(0)
    v_smfmac_f32_16x16x64_bf16 v[80:83], v[72:75], v[248:255], v3
    v_cvt_pk_bf16_f32 v120, v120, v121
    v_cvt_pk_bf16_f32 v121, v122, v123
    v_bfi_b32 v120, 1, s18, v120
    v_bfi_b32 v121, 1, s18, v121
    v_smfmac_f32_16x16x64_bf16 v[80:83], v[76:79], v[36:43], v3
    buffer_store_dwordx2 v[120:121], v4, s[4:7], s8 offen
    v_smfmac_f32_16x16x64_bf16 v[124:127], v[68:71], v[44:51], v3
    v_smfmac_f32_16x16x64_bf16 v[124:127], v[72:75], v[52:59], v3
    v_cvt_pk_bf16_f32 v80, v80, v81
    v_cvt_pk_bf16_f32 v81, v82, v83
    v_bfi_b32 v80, 1, s18, v80
    v_bfi_b32 v81, 1, s18, v81
    v_smfmac_f32_16x16x64_bf16 v[124:127], v[76:79], v[60:67], v3
    buffer_store_dwordx2 v[80:81], v4, s[4:7], s9 offen
    s_nop 6
    v_cvt_pk_bf16_f32 v124, v124, v125
    v_cvt_pk_bf16_f32 v125, v126, v127
    v_bfi_b32 v124, 1, s18, v124
    v_bfi_b32 v125, 1, s18, v125
    s_nop 0
    s_branch R1_loop
.p2align 5
R1_pa1:
    buffer_load_dwordx4 v[40:43], v10, s[4:7], s30 offen sc1
    buffer_load_dwordx4 v[44:47], v10, s[4:7], s30 offen offset:2048 sc1
    s_waitcnt vmcnt(3)
    v_mfma_f32_16x16x32_bf16 v[64:67], v[12:15], v[48:51], 0
    v_bitop3_b32 v16, v48, v49, s18 bitop3:0x7e
    v_bitop3_b32 v17, v50, v51, s18 bitop3:0x7e
    s_waitcnt vmcnt(2)
    v_mfma_f32_16x16x32_bf16 v[64:67], v[12:15], v[52:55], v[64:67]
    v_bitop3_b32 v18, v52, v53, s18 bitop3:0x7e
    v_or3_b32 v16, v16, v17, v18
    v_bitop3_b32 v17, v54, v55, s18 bitop3:0x7e
    v_bitop3_b32 v16, v16, v17, 1 bitop3:0xa8
    v_cmp_ne_u32 vcc, 0, v16
    s_nop 1
    v_add_f32_dpp v64, v64, v64 row_ror:4 row_mask:0xf bank_mask:0xf
    v_add_f32_dpp v65, v65, v65 row_ror:4 row_mask:0xf bank_mask:0xf
    s_nop 0
    v_add_f32_dpp v64, v64, v64 row_ror:8 row_mask:0xf bank_mask:0xf
    v_add_f32_dpp v65, v65, v65 row_ror:8 row_mask:0xf bank_mask:0xf
    v_cvt_pk_bf16_f32 v18, v64, v65
    s_cbranch_vccz R1_pub
R1_par:
    buffer_load_dwordx4 v[48:51], v10, s[4:7], s30 offen sc1
    buffer_load_dwordx4 v[52:55], v10, s[4:7], s30 offen offset:2048 sc1
    s_waitcnt vmcnt(3)
    v_mfma_f32_16x16x32_bf16 v[64:67], v[12:15], v[40:43], 0
    v_bitop3_b32 v16, v40, v41, s18 bitop3:0x7e
    v_bitop3_b32 v17, v42, v43, s18 bitop3:0x7e
    s_waitcnt vmcnt(2)
    v_mfma_f32_16x16x32_bf16 v[64:67], v[12:15], v[44:47], v[64:67]
    v_bitop3_b32 v18, v44, v45, s18 bitop3:0x7e
    v_or3_b32 v16, v16, v17, v18
    v_bitop3_b32 v17, v46, v47, s18 bitop3:0x7e
    v_bitop3_b32 v16, v16, v17, 1 bitop3:0xa8
    v_cmp_ne_u32 vcc, 0, v16
    s_nop 1
    v_add_f32_dpp v64, v64, v64 row_ror:4 row_mask:0xf bank_mask:0xf
    v_add_f32_dpp v65, v65, v65 row_ror:4 row_mask:0xf bank_mask:0xf
    s_nop 0
    v_add_f32_dpp v64, v64, v64 row_ror:8 row_mask:0xf bank_mask:0xf
    v_add_f32_dpp v65, v65, v65 row_ror:8 row_mask:0xf bank_mask:0xf
    v_cvt_pk_bf16_f32 v18, v64, v65
    s_cbranch_vccz R1_pub
    buffer_load_dwordx4 v[40:43], v10, s[4:7], s30 offen sc1
    buffer_load_dwordx4 v[44:47], v10, s[4:7], s30 offen offset:2048 sc1
    s_waitcnt vmcnt(3)
    v_mfma_f32_16x16x32_bf16 v[64:67], v[12:15], v[48:51], 0
    v_bitop3_b32 v16, v48, v49, s18 bitop3:0x7e
    v_bitop3_b32 v17, v50, v51, s18 bitop3:0x7e
    s_waitcnt vmcnt(2)
    v_mfma_f32_16x16x32_bf16 v[64:67], v[12:15], v[52:55], v[64:67]
    v_bitop3_b32 v18, v52, v53, s18 bitop3:0x7e
    v_or3_b32 v16, v16, v17, v18
    v_bitop3_b32 v17, v54, v55, s18 bitop3:0x7e
    v_bitop3_b32 v16, v16, v17, 1 bitop3:0xa8
    v_cmp_ne_u32 vcc, 0, v16
    s_nop 1
    v_add_f32_dpp v64, v64, v64 row_ror:4 row_mask:0xf bank_mask:0xf
    v_add_f32_dpp v65, v65, v65 row_ror:4 row_mask:0xf bank_mask:0xf
    s_nop 0
    v_add_f32_dpp v64, v64, v64 row_ror:8 row_mask:0xf bank_mask:0xf
    v_add_f32_dpp v65, v65, v65 row_ror:8 row_mask:0xf bank_mask:0xf
    v_cvt_pk_bf16_f32 v18, v64, v65
    s_cbranch_vccz R1_pub
    s_add_u32 s35, s35, 1
    s_cmp_lt_u32 s35, 131072
    s_cbranch_scc1 R1_par
    s_branch L_END
R1_last:
    buffer_store_dword v18, v5, s[4:7], s32 offen sc1
    s_branch R_DONE
R1_flag:
    buffer_load_dword v11, off, s[4:7], s33 sc1
    s_waitcnt vmcnt(0)
    v_cmp_eq_u32 vcc, 0, v11
    s_cbranch_vccz R1_flagok
    s_add_u32 s35, s35, 1
    s_cmp_lt_u32 s35, 131072
    s_cbranch_scc1 R1_flag
    s_branch L_END
.p2align 5
R1_pe1:
    buffer_load_dwordx4 v[36:39], v10, s[4:7], s28 offen sc1
    s_waitcnt vmcnt(2)
    v_max3_u32 v16, v36, v37, v38
    v_max_u32 v16, v16, v39
    v_cmp_eq_u32 vcc, -1, v16
    ds_write_b128 v0, v[36:39] offset:17408
    s_cbranch_vccz R1_peok
    buffer_load_dwordx4 v[36:39], v10, s[4:7], s28 offen sc1
    s_waitcnt vmcnt(2)
    v_max3_u32 v16, v36, v37, v38
    v_max_u32 v16, v16, v39
    v_cmp_eq_u32 vcc, -1, v16
    ds_write_b128 v0, v[36:39] offset:17408
    s_cbranch_vccz R1_peok
R1_pe2:
    buffer_load_dwordx4 v[36:39], v10, s[4:7], s28 offen sc1
    s_add_u32 s35, s35, 1
    s_cmp_ge_u32 s35, 131072
    s_cbranch_scc1 L_END
    s_waitcnt vmcnt(2)
    v_max3_u32 v16, v36, v37, v38
    v_max_u32 v16, v16, v39
    v_cmp_eq_u32 vcc, -1, v16
    ds_write_b128 v0, v[36:39] offset:17408
    s_cbranch_vccz R1_peok
    s_branch R1_pe2
R1_plr:
    s_mov_b32 m0, 21504
    s_nop 0
    buffer_load_dwordx4 v[52:55], v10, s[4:7], s69 offen sc1
    buffer_load_dwordx4 v10, s[4:7], s69 offen sc1 lds
    s_mov_b32 m0, s66
    s_waitcnt vmcnt(0)
    v_max3_u32 v16, v52, v53, v54
    v_max_u32 v16, v16, v55
    v_cmp_eq_u32 vcc, -1, v16
    s_waitcnt lgkmcnt(0)
    s_cbranch_vccz R1_plok
    s_add_u32 s35, s35, 1
    s_cmp_lt_u32 s35, 131072
    s_cbranch_scc1 R1_plr
    s_branch L_END
R1_reg:
    s_mov_b32 s35, 0
R1_reg2:
    global_load_dword v11, v16, s[60:61] sc1
    s_waitcnt vmcnt(0)
    v_cmp_eq_u32 vcc, 0, v11
    s_cbranch_vccz R1_reg2_ok
    s_add_u32 s35, s35, 1
    s_cmp_lt_u32 s35, 131072
    s_cbranch_scc1 R1_reg2
    s_branch L_END
R1_reg2_ok:
    s_branch R1_regok
R1_md:
    v_lshlrev_b32 v12, 1, v0
    v_and_b32 v12, 0xe0, v12
    s_mov_b32 s89, 0
R1_md2:
    global_load_dword v14, v12, s[60:61] sc1
    s_waitcnt vmcnt(0)
    v_readlane_b32 s80, v14, 0
    v_readlane_b32 s81, v14, 1
    v_readlane_b32 s82, v14, 2
    v_readlane_b32 s83, v14, 3
    v_readlane_b32 s84, v14, 4
    v_readlane_b32 s85, v14, 5
    v_readlane_b32 s86, v14, 6
    v_readlane_b32 s87, v14, 7
    s_nop 3
    s_add_u32 s88, s80, s81
    s_add_u32 s88, s88, s82
    s_add_u32 s88, s88, s83
    s_add_u32 s88, s88, s84
    s_add_u32 s88, s88, s85
    s_add_u32 s88, s88, s86
    s_add_u32 s88, s88, s87
    s_cmp_ge_u32 s80, 32
    s_cbranch_scc1 R1_mdok
    s_cmp_ge_u32 s88, 256
    s_cbranch_scc1 R1_md3
    s_sleep 16
    s_add_u32 s89, s89, 1
    s_cmp_lt_u32 s89, 131072
    s_cbranch_scc1 R1_md2
    s_branch L_END
R1_md3:
    s_mov_b32 s79, 1
    s_branch R1_mdok
R1_p0:
    buffer_store_dword v18, v5, s[4:7], s27 offen sc1
    s_branch R1_p0ok
R1_kv0:
    s_mov_b32 s35, 0
R1_kv02:
    buffer_load_dword v17, off, s[4:7], s33 offset:16 sc1
    buffer_load_dword v16, off, s[4:7], s33 sc1
    s_waitcnt vmcnt(0)
    v_cmp_eq_u32 vcc, 0, v16
    s_cbranch_vccz R1_kv02_ok
    s_add_u32 s35, s35, 1
    s_cmp_lt_u32 s35, 131072
    s_cbranch_scc1 R1_kv02
    s_branch L_END
R1_kv02_ok:
    s_branch R1_kv0ok
R2_start:
    v_xor_b32 v30, 0x80, v25
    v_xor_b32 v15, 0x40, v24
    v_mov_b32 v31, v27
    s_mov_b32 m0, 40960
    s_mov_b32 s67, 0
    buffer_load_dwordx4 v24, s[16:19], s67 offen lds
    s_mov_b32 m0, 41984
    s_mov_b32 s67, 32768
    buffer_load_dwordx4 v15, s[16:19], s67 offen lds
    s_mov_b32 m0, 43008
    s_mov_b32 s67, 65536
    buffer_load_dwordx4 v24, s[16:19], s67 offen lds
    s_mov_b32 m0, 44032
    s_mov_b32 s67, 98304
    buffer_load_dwordx4 v15, s[16:19], s67 offen lds
    s_mov_b32 m0, 57344
    s_mov_b32 s67, 2097152
    buffer_load_dwordx4 v24, s[16:19], s67 offen lds
    s_mov_b32 m0, 58368
    s_mov_b32 s67, 2129920
    buffer_load_dwordx4 v15, s[16:19], s67 offen lds
    s_mov_b32 m0, 59392
    s_mov_b32 s67, 2162688
    buffer_load_dwordx4 v24, s[16:19], s67 offen lds
    s_mov_b32 m0, 60416
    s_mov_b32 s67, 2195456
    buffer_load_dwordx4 v15, s[16:19], s67 offen lds
    s_mov_b32 m0, 73728
    s_mov_b32 s67, 262144
    buffer_load_dwordx4 v24, s[16:19], s67 offen lds
    s_mov_b32 m0, 74752
    s_mov_b32 s67, 294912
    buffer_load_dwordx4 v15, s[16:19], s67 offen lds
    s_mov_b32 m0, 75776
    s_mov_b32 s67, 327680
    buffer_load_dwordx4 v24, s[16:19], s67 offen lds
    s_mov_b32 m0, 76800
    s_mov_b32 s67, 360448
    buffer_load_dwordx4 v15, s[16:19], s67 offen lds
    s_mov_b32 m0, 90112
    s_mov_b32 s67, 2359296
    buffer_load_dwordx4 v24, s[16:19], s67 offen lds
    s_mov_b32 m0, 91136
    s_mov_b32 s67, 2392064
    buffer_load_dwordx4 v15, s[16:19], s67 offen lds
    s_mov_b32 m0, 92160
    s_mov_b32 s67, 2424832
    buffer_load_dwordx4 v24, s[16:19], s67 offen lds
    s_mov_b32 m0, 93184
    s_mov_b32 s67, 2457600
    buffer_load_dwordx4 v15, s[16:19], s67 offen lds
    s_mov_b32 m0, 106496
    s_mov_b32 s67, 524288
    buffer_load_dwordx4 v24, s[16:19], s67 offen lds
    s_mov_b32 m0, 107520
    s_mov_b32 s67, 557056
    buffer_load_dwordx4 v15, s[16:19], s67 offen lds
    s_mov_b32 m0, 108544
    s_mov_b32 s67, 589824
    buffer_load_dwordx4 v24, s[16:19], s67 offen lds
    s_mov_b32 m0, 109568
    s_mov_b32 s67, 622592
    buffer_load_dwordx4 v15, s[16:19], s67 offen lds
    s_mov_b32 m0, 122880
    s_mov_b32 s67, 2621440
    buffer_load_dwordx4 v24, s[16:19], s67 offen lds
    s_mov_b32 m0, 123904
    s_mov_b32 s67, 2654208
    buffer_load_dwordx4 v15, s[16:19], s67 offen lds
    s_mov_b32 m0, 124928
    s_mov_b32 s67, 2686976
    buffer_load_dwordx4 v24, s[16:19], s67 offen lds
    s_mov_b32 m0, 125952
    s_mov_b32 s67, 2719744
    buffer_load_dwordx4 v15, s[16:19], s67 offen lds
    s_mov_b32 m0, 139264
    s_mov_b32 s67, 786432
    buffer_load_dwordx4 v24, s[16:19], s67 offen lds
    s_mov_b32 m0, 140288
    s_mov_b32 s67, 819200
    buffer_load_dwordx4 v15, s[16:19], s67 offen lds
    s_mov_b32 m0, 141312
    s_mov_b32 s67, 851968
    buffer_load_dwordx4 v24, s[16:19], s67 offen lds
    s_mov_b32 m0, 142336
    s_mov_b32 s67, 884736
    buffer_load_dwordx4 v15, s[16:19], s67 offen lds
    s_mov_b32 m0, 155648
    s_mov_b32 s67, 2883584
    buffer_load_dwordx4 v24, s[16:19], s67 offen lds
    s_mov_b32 m0, 156672
    s_mov_b32 s67, 2916352
    buffer_load_dwordx4 v15, s[16:19], s67 offen lds
    s_mov_b32 m0, 157696
    s_mov_b32 s67, 2949120
    buffer_load_dwordx4 v24, s[16:19], s67 offen lds
    s_mov_b32 m0, 158720
    s_mov_b32 s67, 2981888
    buffer_load_dwordx4 v15, s[16:19], s67 offen lds
    s_mov_b32 s72, s38
    s_mov_b32 s73, s39
    s_mov_b32 s74, 8192
    s_mov_b32 s75, 0x20000
    s_and_b32 s67, s24, 3
    s_lshl_b32 s67, s67, 11
    s_lshr_b32 s68, s24, 3
    s_lshl_b32 s68, s68, 8
    s_add_u32 s67, s67, s68
    s_and_b32 s68, s24, 4
    s_lshl_b32 s68, s68, 2
    s_add_u32 s67, s67, s68
    v_and_b32 v28, 1, v13
    v_lshlrev_b32 v28, 10, v28
    v_lshl_add_u32 v28, v17, 2, v28
    v_lshrrev_b32 v29, 1, v13
    v_lshl_add_u32 v28, v29, 5, v28
    buffer_load_dword v18, v28, s[72:75], s67 offen offset:128
    s_lshl_b32 s33, s24, 10
    s_add_u32 s33, s33, 8
    s_add_u32 s34, s33, 992
    s_add_u32 s33, s33, 0
    s_waitcnt vmcnt(29)
    s_barrier
    v_add_u32 v28, 32768, v26
    v_xor_b32 v29, 32, v28
    ds_read_b64_tr_b16 v[32:33], v28 offset:0
    ds_read_b64_tr_b16 v[34:35], v28 offset:512
    ds_read_b64_tr_b16 v[36:37], v28 offset:8192
    ds_read_b64_tr_b16 v[38:39], v28 offset:8704
    ds_read_b64_tr_b16 v[40:41], v29 offset:0
    ds_read_b64_tr_b16 v[42:43], v29 offset:512
    ds_read_b64_tr_b16 v[44:45], v29 offset:8192
    ds_read_b64_tr_b16 v[46:47], v29 offset:8704
    s_waitcnt lgkmcnt(0)
    s_waitcnt vmcnt(25)
    s_barrier
    s_and_b32 s67, s24, 3
    s_cmp_eq_u32 s67, 1
    s_cbranch_scc1 R2_th1
    s_waitcnt vmcnt(4)
R2_th1:
    s_mov_b32 m0, 40960
    s_mov_b32 s67, 0
    buffer_load_dwordx4 v24, s[8:11], s67 offen lds
    s_mov_b32 m0, 41984
    s_mov_b32 s67, 32768
    buffer_load_dwordx4 v15, s[8:11], s67 offen lds
    s_mov_b32 m0, 43008
    s_mov_b32 s67, 65536
    buffer_load_dwordx4 v24, s[8:11], s67 offen lds
    s_mov_b32 m0, 44032
    s_mov_b32 s67, 98304
    buffer_load_dwordx4 v15, s[8:11], s67 offen lds
    v_add_u32 v28, 49152, v26
    v_xor_b32 v29, 32, v28
    ds_read_b64_tr_b16 a[0:1], v28 offset:0
    ds_read_b64_tr_b16 a[2:3], v28 offset:512
    ds_read_b64_tr_b16 a[4:5], v28 offset:8192
    ds_read_b64_tr_b16 a[6:7], v28 offset:8704
    ds_read_b64_tr_b16 a[16:17], v29 offset:0
    ds_read_b64_tr_b16 a[18:19], v29 offset:512
    ds_read_b64_tr_b16 a[20:21], v29 offset:8192
    ds_read_b64_tr_b16 a[22:23], v29 offset:8704
    s_waitcnt lgkmcnt(0)
    s_waitcnt vmcnt(25)
    s_barrier
    s_and_b32 s67, s24, 3
    s_cmp_eq_u32 s67, 1
    s_cbranch_scc1 R2_th2
    s_waitcnt vmcnt(4)
R2_th2:
    s_mov_b32 m0, 57344
    s_mov_b32 s67, 2097152
    buffer_load_dwordx4 v24, s[8:11], s67 offen lds
    s_mov_b32 m0, 58368
    s_mov_b32 s67, 2129920
    buffer_load_dwordx4 v15, s[8:11], s67 offen lds
    s_mov_b32 m0, 59392
    s_mov_b32 s67, 2162688
    buffer_load_dwordx4 v24, s[8:11], s67 offen lds
    s_mov_b32 m0, 60416
    s_mov_b32 s67, 2195456
    buffer_load_dwordx4 v15, s[8:11], s67 offen lds
    v_add_u32 v28, 65536, v26
    v_xor_b32 v29, 32, v28
    ds_read_b64_tr_b16 a[32:33], v28 offset:0
    ds_read_b64_tr_b16 a[34:35], v28 offset:512
    ds_read_b64_tr_b16 a[36:37], v28 offset:8192
    ds_read_b64_tr_b16 a[38:39], v28 offset:8704
    ds_read_b64_tr_b16 a[48:49], v29 offset:0
    ds_read_b64_tr_b16 a[50:51], v29 offset:512
    ds_read_b64_tr_b16 a[52:53], v29 offset:8192
    ds_read_b64_tr_b16 a[54:55], v29 offset:8704
    s_waitcnt lgkmcnt(0)
    s_waitcnt vmcnt(25)
    s_barrier
    s_and_b32 s67, s24, 3
    s_cmp_eq_u32 s67, 1
    s_cbranch_scc1 R2_th3
    s_waitcnt vmcnt(4)
R2_th3:
    s_mov_b32 m0, 73728
    s_mov_b32 s67, 262144
    buffer_load_dwordx4 v24, s[8:11], s67 offen lds
    s_mov_b32 m0, 74752
    s_mov_b32 s67, 294912
    buffer_load_dwordx4 v15, s[8:11], s67 offen lds
    s_mov_b32 m0, 75776
    s_mov_b32 s67, 327680
    buffer_load_dwordx4 v24, s[8:11], s67 offen lds
    s_mov_b32 m0, 76800
    s_mov_b32 s67, 360448
    buffer_load_dwordx4 v15, s[8:11], s67 offen lds
    v_add_u32 v28, 81920, v26
    v_xor_b32 v29, 32, v28
    ds_read_b64_tr_b16 v[48:49], v28 offset:0
    ds_read_b64_tr_b16 v[50:51], v28 offset:512
    ds_read_b64_tr_b16 v[52:53], v28 offset:8192
    ds_read_b64_tr_b16 v[54:55], v28 offset:8704
    ds_read_b64_tr_b16 v[56:57], v29 offset:0
    ds_read_b64_tr_b16 v[58:59], v29 offset:512
    ds_read_b64_tr_b16 v[60:61], v29 offset:8192
    ds_read_b64_tr_b16 v[62:63], v29 offset:8704
    s_waitcnt lgkmcnt(0)
    s_waitcnt vmcnt(25)
    s_barrier
    s_and_b32 s67, s24, 3
    s_cmp_eq_u32 s67, 1
    s_cbranch_scc1 R2_th4
    s_waitcnt vmcnt(4)
R2_th4:
    s_mov_b32 m0, 90112
    s_mov_b32 s67, 2359296
    buffer_load_dwordx4 v24, s[8:11], s67 offen lds
    s_mov_b32 m0, 91136
    s_mov_b32 s67, 2392064
    buffer_load_dwordx4 v15, s[8:11], s67 offen lds
    s_mov_b32 m0, 92160
    s_mov_b32 s67, 2424832
    buffer_load_dwordx4 v24, s[8:11], s67 offen lds
    s_mov_b32 m0, 93184
    s_mov_b32 s67, 2457600
    buffer_load_dwordx4 v15, s[8:11], s67 offen lds
    v_add_u32 v28, 98304, v26
    v_xor_b32 v29, 32, v28
    ds_read_b64_tr_b16 v[64:65], v28 offset:0
    ds_read_b64_tr_b16 v[66:67], v28 offset:512
    ds_read_b64_tr_b16 v[68:69], v28 offset:8192
    ds_read_b64_tr_b16 v[70:71], v28 offset:8704
    ds_read_b64_tr_b16 v[72:73], v29 offset:0
    ds_read_b64_tr_b16 v[74:75], v29 offset:512
    ds_read_b64_tr_b16 v[76:77], v29 offset:8192
    ds_read_b64_tr_b16 v[78:79], v29 offset:8704
    s_waitcnt lgkmcnt(0)
    s_waitcnt vmcnt(25)
    s_barrier
    s_and_b32 s67, s24, 3
    s_cmp_eq_u32 s67, 1
    s_cbranch_scc1 R2_th5
    s_waitcnt vmcnt(4)
R2_th5:
    s_mov_b32 m0, 106496
    s_mov_b32 s67, 524288
    buffer_load_dwordx4 v24, s[8:11], s67 offen lds
    s_mov_b32 m0, 107520
    s_mov_b32 s67, 557056
    buffer_load_dwordx4 v15, s[8:11], s67 offen lds
    s_mov_b32 m0, 108544
    s_mov_b32 s67, 589824
    buffer_load_dwordx4 v24, s[8:11], s67 offen lds
    s_mov_b32 m0, 109568
    s_mov_b32 s67, 622592
    buffer_load_dwordx4 v15, s[8:11], s67 offen lds
    v_add_u32 v28, 114688, v26
    v_xor_b32 v29, 32, v28
    ds_read_b64_tr_b16 a[96:97], v28 offset:0
    ds_read_b64_tr_b16 a[98:99], v28 offset:512
    ds_read_b64_tr_b16 a[100:101], v28 offset:8192
    ds_read_b64_tr_b16 a[102:103], v28 offset:8704
    ds_read_b64_tr_b16 a[144:145], v29 offset:0
    ds_read_b64_tr_b16 a[146:147], v29 offset:512
    ds_read_b64_tr_b16 a[148:149], v29 offset:8192
    ds_read_b64_tr_b16 a[150:151], v29 offset:8704
    s_waitcnt lgkmcnt(0)
    s_waitcnt vmcnt(25)
    s_barrier
    s_and_b32 s67, s24, 3
    s_cmp_eq_u32 s67, 1
    s_cbranch_scc1 R2_th6
    s_waitcnt vmcnt(4)
R2_th6:
    s_mov_b32 m0, 122880
    s_mov_b32 s67, 2621440
    buffer_load_dwordx4 v24, s[8:11], s67 offen lds
    s_mov_b32 m0, 123904
    s_mov_b32 s67, 2654208
    buffer_load_dwordx4 v15, s[8:11], s67 offen lds
    s_mov_b32 m0, 124928
    s_mov_b32 s67, 2686976
    buffer_load_dwordx4 v24, s[8:11], s67 offen lds
    s_mov_b32 m0, 125952
    s_mov_b32 s67, 2719744
    buffer_load_dwordx4 v15, s[8:11], s67 offen lds
    v_add_u32 v28, 131072, v26
    v_xor_b32 v29, 32, v28
    ds_read_b64_tr_b16 a[104:105], v28 offset:0
    ds_read_b64_tr_b16 a[106:107], v28 offset:512
    ds_read_b64_tr_b16 a[108:109], v28 offset:8192
    ds_read_b64_tr_b16 a[110:111], v28 offset:8704
    ds_read_b64_tr_b16 a[152:153], v29 offset:0
    ds_read_b64_tr_b16 a[154:155], v29 offset:512
    ds_read_b64_tr_b16 a[156:157], v29 offset:8192
    ds_read_b64_tr_b16 a[158:159], v29 offset:8704
    s_waitcnt lgkmcnt(0)
    s_waitcnt vmcnt(25)
    s_barrier
    s_and_b32 s67, s24, 3
    s_cmp_eq_u32 s67, 1
    s_cbranch_scc1 R2_th7
    s_waitcnt vmcnt(4)
R2_th7:
    s_mov_b32 m0, 139264
    s_mov_b32 s67, 786432
    buffer_load_dwordx4 v24, s[8:11], s67 offen lds
    s_mov_b32 m0, 140288
    s_mov_b32 s67, 819200
    buffer_load_dwordx4 v15, s[8:11], s67 offen lds
    s_mov_b32 m0, 141312
    s_mov_b32 s67, 851968
    buffer_load_dwordx4 v24, s[8:11], s67 offen lds
    s_mov_b32 m0, 142336
    s_mov_b32 s67, 884736
    buffer_load_dwordx4 v15, s[8:11], s67 offen lds
    v_add_u32 v28, 147456, v26
    v_xor_b32 v29, 32, v28
    ds_read_b64_tr_b16 a[112:113], v28 offset:0
    ds_read_b64_tr_b16 a[114:115], v28 offset:512
    ds_read_b64_tr_b16 a[116:117], v28 offset:8192
    ds_read_b64_tr_b16 a[118:119], v28 offset:8704
    ds_read_b64_tr_b16 a[160:161], v29 offset:0
    ds_read_b64_tr_b16 a[162:163], v29 offset:512
    ds_read_b64_tr_b16 a[164:165], v29 offset:8192
    ds_read_b64_tr_b16 a[166:167], v29 offset:8704
    s_waitcnt lgkmcnt(0)
    s_waitcnt vmcnt(24)
    s_barrier
    s_and_b32 s67, s24, 3
    s_cmp_eq_u32 s67, 1
    s_cbranch_scc1 R2_th8
    s_waitcnt vmcnt(4)
R2_th8:
    s_mov_b32 m0, 155648
    s_mov_b32 s67, 2883584
    buffer_load_dwordx4 v24, s[8:11], s67 offen lds
    s_mov_b32 m0, 156672
    s_mov_b32 s67, 2916352
    buffer_load_dwordx4 v15, s[8:11], s67 offen lds
    s_mov_b32 m0, 157696
    s_mov_b32 s67, 2949120
    buffer_load_dwordx4 v24, s[8:11], s67 offen lds
    s_mov_b32 m0, 158720
    s_mov_b32 s67, 2981888
    buffer_load_dwordx4 v15, s[8:11], s67 offen lds
    v_add_u32 v28, 32768, v26
    v_xor_b32 v29, 32, v28
    ds_read_b64_tr_b16 a[192:193], v28 offset:0
    ds_read_b64_tr_b16 a[194:195], v28 offset:512
    ds_read_b64_tr_b16 a[196:197], v28 offset:8192
    ds_read_b64_tr_b16 a[198:199], v28 offset:8704
    ds_read_b64_tr_b16 a[200:201], v29 offset:0
    ds_read_b64_tr_b16 a[202:203], v29 offset:512
    ds_read_b64_tr_b16 a[204:205], v29 offset:8192
    ds_read_b64_tr_b16 a[206:207], v29 offset:8704
    s_waitcnt lgkmcnt(0)
    s_waitcnt vmcnt(24)
    s_barrier
    s_and_b32 s67, s24, 3
    s_cmp_eq_u32 s67, 1
    s_cbranch_scc1 R2_th9
    s_waitcnt vmcnt(4)
R2_th9:
    s_mov_b32 m0, 40960
    s_mov_b32 s67, 0
    buffer_load_dwordx4 v24, s[12:15], s67 offen lds
    s_mov_b32 m0, 41984
    s_mov_b32 s67, 32768
    buffer_load_dwordx4 v15, s[12:15], s67 offen lds
    s_mov_b32 m0, 43008
    s_mov_b32 s67, 65536
    buffer_load_dwordx4 v24, s[12:15], s67 offen lds
    s_mov_b32 m0, 44032
    s_mov_b32 s67, 98304
    buffer_load_dwordx4 v15, s[12:15], s67 offen lds
    v_add_u32 v28, 49152, v26
    v_xor_b32 v29, 32, v28
    ds_read_b64_tr_b16 a[208:209], v28 offset:0
    ds_read_b64_tr_b16 a[210:211], v28 offset:512
    ds_read_b64_tr_b16 a[212:213], v28 offset:8192
    ds_read_b64_tr_b16 a[214:215], v28 offset:8704
    ds_read_b64_tr_b16 a[216:217], v29 offset:0
    ds_read_b64_tr_b16 a[218:219], v29 offset:512
    ds_read_b64_tr_b16 a[220:221], v29 offset:8192
    ds_read_b64_tr_b16 a[222:223], v29 offset:8704
    s_waitcnt lgkmcnt(0)
    s_waitcnt vmcnt(24)
    s_barrier
    s_and_b32 s67, s24, 3
    s_cmp_eq_u32 s67, 1
    s_cbranch_scc1 R2_th10
    s_waitcnt vmcnt(4)
R2_th10:
    s_mov_b32 m0, 57344
    s_mov_b32 s67, 2097152
    buffer_load_dwordx4 v24, s[12:15], s67 offen lds
    s_mov_b32 m0, 58368
    s_mov_b32 s67, 2129920
    buffer_load_dwordx4 v15, s[12:15], s67 offen lds
    s_mov_b32 m0, 59392
    s_mov_b32 s67, 2162688
    buffer_load_dwordx4 v24, s[12:15], s67 offen lds
    s_mov_b32 m0, 60416
    s_mov_b32 s67, 2195456
    buffer_load_dwordx4 v15, s[12:15], s67 offen lds
    v_add_u32 v28, 65536, v26
    v_xor_b32 v29, 32, v28
    ds_read_b64_tr_b16 a[224:225], v28 offset:0
    ds_read_b64_tr_b16 a[226:227], v28 offset:512
    ds_read_b64_tr_b16 a[228:229], v28 offset:8192
    ds_read_b64_tr_b16 a[230:231], v28 offset:8704
    ds_read_b64_tr_b16 a[232:233], v29 offset:0
    ds_read_b64_tr_b16 a[234:235], v29 offset:512
    ds_read_b64_tr_b16 a[236:237], v29 offset:8192
    ds_read_b64_tr_b16 a[238:239], v29 offset:8704
    s_waitcnt lgkmcnt(0)
    s_waitcnt vmcnt(24)
    s_barrier
    s_and_b32 s67, s24, 3
    s_cmp_eq_u32 s67, 1
    s_cbranch_scc1 R2_th11
    s_waitcnt vmcnt(4)
R2_th11:
    s_mov_b32 m0, 73728
    s_mov_b32 s67, 262144
    buffer_load_dwordx4 v24, s[12:15], s67 offen lds
    s_mov_b32 m0, 74752
    s_mov_b32 s67, 294912
    buffer_load_dwordx4 v15, s[12:15], s67 offen lds
    s_mov_b32 m0, 75776
    s_mov_b32 s67, 327680
    buffer_load_dwordx4 v24, s[12:15], s67 offen lds
    s_mov_b32 m0, 76800
    s_mov_b32 s67, 360448
    buffer_load_dwordx4 v15, s[12:15], s67 offen lds
    v_add_u32 v28, 81920, v26
    v_xor_b32 v29, 32, v28
    ds_read_b64_tr_b16 a[240:241], v28 offset:0
    ds_read_b64_tr_b16 a[242:243], v28 offset:512
    ds_read_b64_tr_b16 a[244:245], v28 offset:8192
    ds_read_b64_tr_b16 a[246:247], v28 offset:8704
    ds_read_b64_tr_b16 a[248:249], v29 offset:0
    ds_read_b64_tr_b16 a[250:251], v29 offset:512
    ds_read_b64_tr_b16 a[252:253], v29 offset:8192
    ds_read_b64_tr_b16 a[254:255], v29 offset:8704
    s_waitcnt lgkmcnt(0)
    s_waitcnt vmcnt(24)
    s_barrier
    s_and_b32 s67, s24, 3
    s_cmp_eq_u32 s67, 1
    s_cbranch_scc1 R2_th12
    s_waitcnt vmcnt(4)
R2_th12:
    s_mov_b32 m0, 90112
    s_mov_b32 s67, 2359296
    buffer_load_dwordx4 v24, s[12:15], s67 offen lds
    s_mov_b32 m0, 91136
    s_mov_b32 s67, 2392064
    buffer_load_dwordx4 v15, s[12:15], s67 offen lds
    s_mov_b32 m0, 92160
    s_mov_b32 s67, 2424832
    buffer_load_dwordx4 v24, s[12:15], s67 offen lds
    s_mov_b32 m0, 93184
    s_mov_b32 s67, 2457600
    buffer_load_dwordx4 v15, s[12:15], s67 offen lds
    v_mov_b32 v16, 136
    global_load_dword v11, v16, s[60:61] sc1
    global_load_dword v14, v16, s[60:61] offset:-136 sc1
    v_add_u32 v28, 98304, v26
    v_xor_b32 v29, 32, v28
    ds_read_b64_tr_b16 v[128:129], v28 offset:0
    ds_read_b64_tr_b16 v[130:131], v28 offset:512
    ds_read_b64_tr_b16 v[132:133], v28 offset:8192
    ds_read_b64_tr_b16 v[134:135], v28 offset:8704
    ds_read_b64_tr_b16 v[136:137], v29 offset:0
    ds_read_b64_tr_b16 v[138:139], v29 offset:512
    ds_read_b64_tr_b16 v[140:141], v29 offset:8192
    ds_read_b64_tr_b16 v[142:143], v29 offset:8704
    s_waitcnt lgkmcnt(0)
    s_waitcnt vmcnt(26)
    s_barrier
    s_and_b32 s67, s24, 3
    s_cmp_eq_u32 s67, 1
    s_cbranch_scc1 R2_th13
    s_waitcnt vmcnt(4)
R2_th13:
    s_mov_b32 m0, 106496
    s_mov_b32 s67, 524288
    buffer_load_dwordx4 v24, s[12:15], s67 offen lds
    s_mov_b32 m0, 107520
    s_mov_b32 s67, 557056
    buffer_load_dwordx4 v15, s[12:15], s67 offen lds
    s_mov_b32 m0, 108544
    s_mov_b32 s67, 589824
    buffer_load_dwordx4 v24, s[12:15], s67 offen lds
    s_mov_b32 m0, 109568
    s_mov_b32 s67, 622592
    buffer_load_dwordx4 v15, s[12:15], s67 offen lds
    v_add_u32 v28, 114688, v26
    v_xor_b32 v29, 32, v28
    ds_read_b64_tr_b16 v[144:145], v28 offset:0
    ds_read_b64_tr_b16 v[146:147], v28 offset:512
    ds_read_b64_tr_b16 v[148:149], v28 offset:8192
    ds_read_b64_tr_b16 v[150:151], v28 offset:8704
    ds_read_b64_tr_b16 v[152:153], v29 offset:0
    ds_read_b64_tr_b16 v[154:155], v29 offset:512
    ds_read_b64_tr_b16 v[156:157], v29 offset:8192
    ds_read_b64_tr_b16 v[158:159], v29 offset:8704
    s_waitcnt lgkmcnt(0)
    s_waitcnt vmcnt(26)
    s_barrier
    s_and_b32 s67, s24, 3
    s_cmp_eq_u32 s67, 1
    s_cbranch_scc1 R2_th14
    s_waitcnt vmcnt(4)
R2_th14:
    s_mov_b32 m0, 122880
    s_mov_b32 s67, 2621440
    buffer_load_dwordx4 v24, s[12:15], s67 offen lds
    s_mov_b32 m0, 123904
    s_mov_b32 s67, 2654208
    buffer_load_dwordx4 v15, s[12:15], s67 offen lds
    s_mov_b32 m0, 124928
    s_mov_b32 s67, 2686976
    buffer_load_dwordx4 v24, s[12:15], s67 offen lds
    s_mov_b32 m0, 125952
    s_mov_b32 s67, 2719744
    buffer_load_dwordx4 v15, s[12:15], s67 offen lds
    v_add_u32 v28, 131072, v26
    v_xor_b32 v29, 32, v28
    ds_read_b64_tr_b16 v[160:161], v28 offset:0
    ds_read_b64_tr_b16 v[162:163], v28 offset:512
    ds_read_b64_tr_b16 v[164:165], v28 offset:8192
    ds_read_b64_tr_b16 v[166:167], v28 offset:8704
    ds_read_b64_tr_b16 v[168:169], v29 offset:0
    ds_read_b64_tr_b16 v[170:171], v29 offset:512
    ds_read_b64_tr_b16 v[172:173], v29 offset:8192
    ds_read_b64_tr_b16 v[174:175], v29 offset:8704
    s_waitcnt lgkmcnt(0)
    s_waitcnt vmcnt(26)
    s_barrier
    s_and_b32 s67, s24, 3
    s_cmp_eq_u32 s67, 1
    s_cbranch_scc1 R2_th15
    s_waitcnt vmcnt(4)
R2_th15:
    s_mov_b32 m0, 139264
    s_mov_b32 s67, 786432
    buffer_load_dwordx4 v24, s[12:15], s67 offen lds
    s_mov_b32 m0, 140288
    s_mov_b32 s67, 819200
    buffer_load_dwordx4 v15, s[12:15], s67 offen lds
    s_mov_b32 m0, 141312
    s_mov_b32 s67, 851968
    buffer_load_dwordx4 v24, s[12:15], s67 offen lds
    s_mov_b32 m0, 142336
    s_mov_b32 s67, 884736
    buffer_load_dwordx4 v15, s[12:15], s67 offen lds
    v_add_u32 v28, 147456, v26
    v_xor_b32 v29, 32, v28
    ds_read_b64_tr_b16 v[176:177], v28 offset:0
    ds_read_b64_tr_b16 v[178:179], v28 offset:512
    ds_read_b64_tr_b16 v[180:181], v28 offset:8192
    ds_read_b64_tr_b16 v[182:183], v28 offset:8704
    ds_read_b64_tr_b16 v[184:185], v29 offset:0
    ds_read_b64_tr_b16 v[186:187], v29 offset:512
    ds_read_b64_tr_b16 v[188:189], v29 offset:8192
    ds_read_b64_tr_b16 v[190:191], v29 offset:8704
    s_waitcnt lgkmcnt(0)
    s_waitcnt vmcnt(26)
    s_barrier
    s_and_b32 s67, s24, 3
    s_cmp_eq_u32 s67, 1
    s_cbranch_scc1 R2_th16
    s_waitcnt vmcnt(4)
R2_th16:
    s_mov_b32 m0, 155648
    s_mov_b32 s67, 2883584
    buffer_load_dwordx4 v24, s[12:15], s67 offen lds
    s_mov_b32 m0, 156672
    s_mov_b32 s67, 2916352
    buffer_load_dwordx4 v15, s[12:15], s67 offen lds
    s_mov_b32 m0, 157696
    s_mov_b32 s67, 2949120
    buffer_load_dwordx4 v24, s[12:15], s67 offen lds
    s_mov_b32 m0, 158720
    s_mov_b32 s67, 2981888
    buffer_load_dwordx4 v15, s[12:15], s67 offen lds
    v_add_u32 v28, 32768, v26
    v_xor_b32 v29, 32, v28
    ds_read_b64_tr_b16 v[80:81], v28 offset:0
    ds_read_b64_tr_b16 v[82:83], v28 offset:512
    ds_read_b64_tr_b16 v[84:85], v28 offset:8192
    ds_read_b64_tr_b16 v[86:87], v28 offset:8704
    ds_read_b64_tr_b16 v[88:89], v29 offset:0
    ds_read_b64_tr_b16 v[90:91], v29 offset:512
    ds_read_b64_tr_b16 v[92:93], v29 offset:8192
    ds_read_b64_tr_b16 v[94:95], v29 offset:8704
    s_waitcnt lgkmcnt(0)
    s_waitcnt vmcnt(26)
    s_barrier
    s_and_b32 s67, s24, 3
    s_cmp_eq_u32 s67, 1
    s_cbranch_scc1 R2_th17
    s_waitcnt vmcnt(4)
R2_th17:
    s_mov_b32 m0, 40960
    s_mov_b32 s67, 0
    buffer_load_dwordx4 v25, s[20:23], s67 offen lds
    s_mov_b32 m0, 41984
    s_mov_b32 s67, 4096
    buffer_load_dwordx4 v25, s[20:23], s67 offen lds
    s_mov_b32 m0, 43008
    s_mov_b32 s67, 8192
    buffer_load_dwordx4 v25, s[20:23], s67 offen lds
    s_mov_b32 m0, 44032
    s_mov_b32 s67, 12288
    buffer_load_dwordx4 v25, s[20:23], s67 offen lds
    v_add_u32 v28, 49152, v26
    v_xor_b32 v29, 32, v28
    ds_read_b64_tr_b16 a[8:9], v28 offset:0
    ds_read_b64_tr_b16 a[10:11], v28 offset:512
    ds_read_b64_tr_b16 a[12:13], v28 offset:8192
    ds_read_b64_tr_b16 a[14:15], v28 offset:8704
    ds_read_b64_tr_b16 a[24:25], v29 offset:0
    ds_read_b64_tr_b16 a[26:27], v29 offset:512
    ds_read_b64_tr_b16 a[28:29], v29 offset:8192
    ds_read_b64_tr_b16 a[30:31], v29 offset:8704
    s_waitcnt lgkmcnt(0)
    s_waitcnt vmcnt(26)
    s_barrier
    s_and_b32 s67, s24, 3
    s_cmp_eq_u32 s67, 1
    s_cbranch_scc1 R2_th18
    s_waitcnt vmcnt(4)
R2_th18:
    s_mov_b32 m0, 57344
    s_mov_b32 s67, 16384
    buffer_load_dwordx4 v30, s[20:23], s67 offen lds
    s_mov_b32 m0, 58368
    s_mov_b32 s67, 20480
    buffer_load_dwordx4 v30, s[20:23], s67 offen lds
    s_mov_b32 m0, 59392
    s_mov_b32 s67, 24576
    buffer_load_dwordx4 v30, s[20:23], s67 offen lds
    s_mov_b32 m0, 60416
    s_mov_b32 s67, 28672
    buffer_load_dwordx4 v30, s[20:23], s67 offen lds
    v_add_u32 v28, 65536, v26
    v_xor_b32 v29, 32, v28
    ds_read_b64_tr_b16 a[40:41], v28 offset:0
    ds_read_b64_tr_b16 a[42:43], v28 offset:512
    ds_read_b64_tr_b16 a[44:45], v28 offset:8192
    ds_read_b64_tr_b16 a[46:47], v28 offset:8704
    ds_read_b64_tr_b16 a[56:57], v29 offset:0
    ds_read_b64_tr_b16 a[58:59], v29 offset:512
    ds_read_b64_tr_b16 a[60:61], v29 offset:8192
    ds_read_b64_tr_b16 a[62:63], v29 offset:8704
    s_waitcnt lgkmcnt(0)
    s_waitcnt vmcnt(26)
    s_barrier
    s_and_b32 s67, s24, 3
    s_cmp_eq_u32 s67, 1
    s_cbranch_scc1 R2_th19
    s_waitcnt vmcnt(4)
R2_th19:
    s_mov_b32 m0, 73728
    s_mov_b32 s67, 32768
    buffer_load_dwordx4 v25, s[20:23], s67 offen lds
    s_mov_b32 m0, 74752
    s_mov_b32 s67, 36864
    buffer_load_dwordx4 v25, s[20:23], s67 offen lds
    s_mov_b32 m0, 75776
    s_mov_b32 s67, 40960
    buffer_load_dwordx4 v25, s[20:23], s67 offen lds
    s_mov_b32 m0, 76800
    s_mov_b32 s67, 45056
    buffer_load_dwordx4 v25, s[20:23], s67 offen lds
    v_add_u32 v28, 81920, v26
    v_xor_b32 v29, 32, v28
    ds_read_b64_tr_b16 a[64:65], v28 offset:0
    ds_read_b64_tr_b16 a[66:67], v28 offset:512
    ds_read_b64_tr_b16 a[68:69], v28 offset:8192
    ds_read_b64_tr_b16 a[70:71], v28 offset:8704
    ds_read_b64_tr_b16 a[72:73], v29 offset:0
    ds_read_b64_tr_b16 a[74:75], v29 offset:512
    ds_read_b64_tr_b16 a[76:77], v29 offset:8192
    ds_read_b64_tr_b16 a[78:79], v29 offset:8704
    s_waitcnt lgkmcnt(0)
    s_waitcnt vmcnt(24)
    s_barrier
    s_and_b32 s67, s24, 3
    s_cmp_eq_u32 s67, 1
    s_cbranch_scc1 R2_th20
    s_waitcnt vmcnt(4)
R2_th20:
    s_mov_b32 m0, 90112
    s_mov_b32 s67, 49152
    buffer_load_dwordx4 v30, s[20:23], s67 offen lds
    s_mov_b32 m0, 91136
    s_mov_b32 s67, 53248
    buffer_load_dwordx4 v30, s[20:23], s67 offen lds
    s_mov_b32 m0, 92160
    s_mov_b32 s67, 57344
    buffer_load_dwordx4 v30, s[20:23], s67 offen lds
    s_mov_b32 m0, 93184
    s_mov_b32 s67, 61440
    buffer_load_dwordx4 v30, s[20:23], s67 offen lds
    v_cmp_eq_u32 vcc, 0, v11
    s_cbranch_vccnz R2_reg
R2_regok:
    s_mov_b32 s79, 0
    v_cmp_gt_u32 vcc, 32, v14
    s_cbranch_vccnz R2_md
R2_mdok:
    s_getpc_b64 s[80:81]
R2_pc20:
    v_lshlrev_b32 v20, 3, v0
    v_add_u32 v20, 2048, v20
    v_min_u32 v20, L_LAST-R2_pc20, v20
    global_load_dword v21, v20, s[80:81]
    v_add_u32 v28, 98304, v26
    v_xor_b32 v29, 32, v28
    ds_read_b64_tr_b16 a[80:81], v28 offset:0
    ds_read_b64_tr_b16 a[82:83], v28 offset:512
    ds_read_b64_tr_b16 a[84:85], v28 offset:8192
    ds_read_b64_tr_b16 a[86:87], v28 offset:8704
    ds_read_b64_tr_b16 a[88:89], v29 offset:0
    ds_read_b64_tr_b16 a[90:91], v29 offset:512
    ds_read_b64_tr_b16 a[92:93], v29 offset:8192
    ds_read_b64_tr_b16 a[94:95], v29 offset:8704
    s_waitcnt lgkmcnt(0)
    s_waitcnt vmcnt(25)
    s_barrier
    s_and_b32 s67, s24, 3
    s_cmp_eq_u32 s67, 1
    s_cbranch_scc1 R2_th21
    s_waitcnt vmcnt(4)
R2_th21:
    s_mov_b32 m0, 106496
    s_mov_b32 s67, 65536
    buffer_load_dwordx4 v25, s[20:23], s67 offen lds
    s_mov_b32 m0, 107520
    s_mov_b32 s67, 69632
    buffer_load_dwordx4 v25, s[20:23], s67 offen lds
    s_mov_b32 m0, 108544
    s_mov_b32 s67, 73728
    buffer_load_dwordx4 v25, s[20:23], s67 offen lds
    s_mov_b32 m0, 109568
    s_mov_b32 s67, 77824
    buffer_load_dwordx4 v25, s[20:23], s67 offen lds
    buffer_load_dword v17, off, s[4:7], s33 offset:16 sc1
    buffer_load_dword v16, off, s[4:7], s33 sc1
    v_add_u32 v28, 114688, v26
    v_xor_b32 v29, 32, v28
    ds_read_b64_tr_b16 a[120:121], v28 offset:0
    ds_read_b64_tr_b16 a[122:123], v28 offset:512
    ds_read_b64_tr_b16 a[124:125], v28 offset:8192
    ds_read_b64_tr_b16 a[126:127], v28 offset:8704
    ds_read_b64_tr_b16 a[168:169], v29 offset:0
    ds_read_b64_tr_b16 a[170:171], v29 offset:512
    ds_read_b64_tr_b16 a[172:173], v29 offset:8192
    ds_read_b64_tr_b16 a[174:175], v29 offset:8704
    s_waitcnt lgkmcnt(0)
    s_waitcnt vmcnt(27)
    s_barrier
    s_and_b32 s67, s24, 3
    s_cmp_eq_u32 s67, 1
    s_cbranch_scc1 R2_th22
    s_waitcnt vmcnt(4)
R2_th22:
    s_mov_b32 m0, 122880
    s_mov_b32 s67, 81920
    buffer_load_dwordx4 v30, s[20:23], s67 offen lds
    s_mov_b32 m0, 123904
    s_mov_b32 s67, 86016
    buffer_load_dwordx4 v30, s[20:23], s67 offen lds
    s_mov_b32 m0, 124928
    s_mov_b32 s67, 90112
    buffer_load_dwordx4 v30, s[20:23], s67 offen lds
    s_mov_b32 m0, 125952
    s_mov_b32 s67, 94208
    buffer_load_dwordx4 v30, s[20:23], s67 offen lds
    v_add_u32 v28, 131072, v26
    v_xor_b32 v29, 32, v28
    ds_read_b64_tr_b16 a[128:129], v28 offset:0
    ds_read_b64_tr_b16 a[130:131], v28 offset:512
    ds_read_b64_tr_b16 a[132:133], v28 offset:8192
    ds_read_b64_tr_b16 a[134:135], v28 offset:8704
    ds_read_b64_tr_b16 a[176:177], v29 offset:0
    ds_read_b64_tr_b16 a[178:179], v29 offset:512
    ds_read_b64_tr_b16 a[180:181], v29 offset:8192
    ds_read_b64_tr_b16 a[182:183], v29 offset:8704
    s_waitcnt lgkmcnt(0)
    s_waitcnt vmcnt(27)
    s_barrier
    s_and_b32 s67, s24, 3
    s_cmp_eq_u32 s67, 1
    s_cbranch_scc1 R2_th23
    s_waitcnt vmcnt(4)
R2_th23:
    s_mov_b32 m0, 139264
    s_mov_b32 s67, 98304
    buffer_load_dwordx4 v25, s[20:23], s67 offen lds
    s_mov_b32 m0, 140288
    s_mov_b32 s67, 102400
    buffer_load_dwordx4 v25, s[20:23], s67 offen lds
    s_mov_b32 m0, 141312
    s_mov_b32 s67, 106496
    buffer_load_dwordx4 v25, s[20:23], s67 offen lds
    s_mov_b32 m0, 142336
    s_mov_b32 s67, 110592
    buffer_load_dwordx4 v25, s[20:23], s67 offen lds
    v_add_u32 v28, 147456, v26
    v_xor_b32 v29, 32, v28
    ds_read_b64_tr_b16 a[136:137], v28 offset:0
    ds_read_b64_tr_b16 a[138:139], v28 offset:512
    ds_read_b64_tr_b16 a[140:141], v28 offset:8192
    ds_read_b64_tr_b16 a[142:143], v28 offset:8704
    ds_read_b64_tr_b16 a[184:185], v29 offset:0
    ds_read_b64_tr_b16 a[186:187], v29 offset:512
    ds_read_b64_tr_b16 a[188:189], v29 offset:8192
    ds_read_b64_tr_b16 a[190:191], v29 offset:8704
    s_waitcnt lgkmcnt(0)
    s_barrier
    s_mov_b32 m0, 155648
    s_mov_b32 s67, 114688
    buffer_load_dwordx4 v30, s[20:23], s67 offen lds
    s_mov_b32 m0, 156672
    s_mov_b32 s67, 118784
    buffer_load_dwordx4 v30, s[20:23], s67 offen lds
    s_mov_b32 m0, 157696
    s_mov_b32 s67, 122880
    buffer_load_dwordx4 v30, s[20:23], s67 offen lds
    s_mov_b32 m0, 158720
    s_mov_b32 s67, 126976
    buffer_load_dwordx4 v30, s[20:23], s67 offen lds
    v_min_u32 v18, -2, v18
    s_cmp_lg_u32 s79, 0
    s_cbranch_scc1 R2_p0
    buffer_store_dword v18, v5, s[4:7], s27 offen
R2_p0ok:
    s_add_u32 s67, s27, 0x2000
    buffer_load_dword v15, v5, s[4:7], s27 offen sc1
    buffer_load_dword v15, v5, s[4:7], s67 offen sc1
    s_add_u32 s67, s27, 0x4000
    buffer_load_dword v15, v5, s[4:7], s67 offen sc1
    s_add_u32 s67, s27, 0x6000
    buffer_load_dword v15, v5, s[4:7], s67 offen sc1
    buffer_load_dword v15, v5, s[4:7], s32 offen sc1
    s_waitcnt vmcnt(33)
    v_xor_b32 v28, 0, v31
    v_add_u32 v28, 32768, v28
    ds_read_b64_tr_b16 v[200:201], v28 offset:0
    ds_read_b64_tr_b16 v[202:203], v28 offset:512
    ds_read_b64_tr_b16 v[204:205], v28 offset:2048
    ds_read_b64_tr_b16 v[206:207], v28 offset:2560
    v_xor_b32 v28, 64, v31
    v_add_u32 v28, 32768, v28
    ds_read_b64_tr_b16 v[224:225], v28 offset:0
    ds_read_b64_tr_b16 v[226:227], v28 offset:512
    ds_read_b64_tr_b16 v[228:229], v28 offset:2048
    ds_read_b64_tr_b16 v[230:231], v28 offset:2560
    v_xor_b32 v28, 128, v31
    v_add_u32 v28, 32768, v28
    ds_read_b64_tr_b16 v[248:249], v28 offset:0
    ds_read_b64_tr_b16 v[250:251], v28 offset:512
    ds_read_b64_tr_b16 v[252:253], v28 offset:2048
    ds_read_b64_tr_b16 v[254:255], v28 offset:2560
    v_xor_b32 v28, 192, v31
    v_add_u32 v28, 32768, v28
    ds_read_b64_tr_b16 v[96:97], v28 offset:0
    ds_read_b64_tr_b16 v[98:99], v28 offset:512
    ds_read_b64_tr_b16 v[100:101], v28 offset:2048
    ds_read_b64_tr_b16 v[102:103], v28 offset:2560
    s_waitcnt lgkmcnt(0)
    ds_write_b128 v0, v[32:35] offset:40960
    ds_write_b128 v0, v[36:39] offset:41984
    ds_write_b128 v0, v[40:43] offset:43008
    ds_write_b128 v0, v[44:47] offset:44032
    ds_write_b128 v0, v[48:51] offset:57344
    ds_write_b128 v0, v[52:55] offset:58368
    ds_write_b128 v0, v[56:59] offset:59392
    ds_write_b128 v0, v[60:63] offset:60416
    s_waitcnt lgkmcnt(0)
    s_waitcnt vmcnt(25)
    v_xor_b32 v28, 0, v31
    v_add_u32 v28, 65536, v28
    ds_read_b64_tr_b16 v[208:209], v28 offset:0
    ds_read_b64_tr_b16 v[210:211], v28 offset:512
    ds_read_b64_tr_b16 v[212:213], v28 offset:2048
    ds_read_b64_tr_b16 v[214:215], v28 offset:2560
    v_xor_b32 v28, 64, v31
    v_add_u32 v28, 65536, v28
    ds_read_b64_tr_b16 v[232:233], v28 offset:0
    ds_read_b64_tr_b16 v[234:235], v28 offset:512
    ds_read_b64_tr_b16 v[236:237], v28 offset:2048
    ds_read_b64_tr_b16 v[238:239], v28 offset:2560
    v_xor_b32 v28, 128, v31
    v_add_u32 v28, 65536, v28
    ds_read_b64_tr_b16 v[104:105], v28 offset:0
    ds_read_b64_tr_b16 v[106:107], v28 offset:512
    ds_read_b64_tr_b16 v[108:109], v28 offset:2048
    ds_read_b64_tr_b16 v[110:111], v28 offset:2560
    v_xor_b32 v28, 192, v31
    v_add_u32 v28, 65536, v28
    ds_read_b64_tr_b16 v[112:113], v28 offset:0
    ds_read_b64_tr_b16 v[114:115], v28 offset:512
    ds_read_b64_tr_b16 v[116:117], v28 offset:2048
    ds_read_b64_tr_b16 v[118:119], v28 offset:2560
    s_waitcnt lgkmcnt(0)
    ds_write_b128 v1, v[64:67] offset:8192
    ds_write_b128 v1, v[68:71] offset:9216
    ds_write_b128 v1, v[72:75] offset:10240
    ds_write_b128 v1, v[76:79] offset:11264
    ds_write_b128 v1, v[80:83] offset:24576
    ds_write_b128 v1, v[84:87] offset:25600
    ds_write_b128 v1, v[88:91] offset:26624
    ds_write_b128 v1, v[92:95] offset:27648
    s_waitcnt lgkmcnt(0)
    s_waitcnt vmcnt(14)
    v_cmp_eq_u32 vcc, 0, v16
    s_cbranch_vccnz R2_kv0
R2_kv0ok:
    s_add_u32 s33, s33, 16
    s_add_u32 s70, s31, 0x2000
    s_mov_b32 m0, s66
    v_mov_b32 v11, v17
    buffer_load_dwordx4 v0, s[4:7], s31 offen sc1 lds
    buffer_load_dwordx4 v0, s[4:7], s31 offen offset:1024 sc1 lds
    buffer_load_dwordx4 v[20:23], v0, s[4:7], s70 offen sc1
    buffer_load_dwordx4 v[24:27], v0, s[4:7], s70 offen offset:1024 sc1
    s_add_u32 s31, s31, 0x4000
    s_add_u32 s70, s31, 0x2000
    s_xor_b32 s66, s66, 0x2000
    s_xor_b32 s67, s30, 0x40000
    buffer_load_dword v15, v10, s[4:7], s67 offen sc1
    buffer_load_dword v15, v10, s[4:7], s67 offen offset:2048 sc1
    buffer_load_dword v15, v10, s[4:7], s30 offen sc1
    buffer_load_dword v15, v10, s[4:7], s30 offen offset:2048 sc1
    v_xor_b32 v28, 0, v31
    v_add_u32 v28, 98304, v28
    ds_read_b64_tr_b16 v[120:121], v28 offset:0
    ds_read_b64_tr_b16 v[122:123], v28 offset:512
    ds_read_b64_tr_b16 v[124:125], v28 offset:2048
    ds_read_b64_tr_b16 v[126:127], v28 offset:2560
    v_xor_b32 v28, 64, v31
    v_add_u32 v28, 98304, v28
    ds_read_b64_tr_b16 v[32:33], v28 offset:0
    ds_read_b64_tr_b16 v[34:35], v28 offset:512
    ds_read_b64_tr_b16 v[36:37], v28 offset:2048
    ds_read_b64_tr_b16 v[38:39], v28 offset:2560
    v_xor_b32 v28, 128, v31
    v_add_u32 v28, 98304, v28
    ds_read_b64_tr_b16 v[40:41], v28 offset:0
    ds_read_b64_tr_b16 v[42:43], v28 offset:512
    ds_read_b64_tr_b16 v[44:45], v28 offset:2048
    ds_read_b64_tr_b16 v[46:47], v28 offset:2560
    v_xor_b32 v28, 192, v31
    v_add_u32 v28, 98304, v28
    ds_read_b64_tr_b16 v[48:49], v28 offset:0
    ds_read_b64_tr_b16 v[50:51], v28 offset:512
    ds_read_b64_tr_b16 v[52:53], v28 offset:2048
    ds_read_b64_tr_b16 v[54:55], v28 offset:2560
    s_waitcnt lgkmcnt(0)
    ds_write_b128 v1, v[96:99] offset:40960
    ds_write_b128 v1, v[100:103] offset:41984
    ds_write_b128 v1, v[104:107] offset:43008
    ds_write_b128 v1, v[108:111] offset:44032
    ds_write_b128 v1, v[112:115] offset:57344
    ds_write_b128 v1, v[116:119] offset:58368
    ds_write_b128 v1, v[120:123] offset:59392
    ds_write_b128 v1, v[124:127] offset:60416
    s_waitcnt lgkmcnt(0)
    s_waitcnt vmcnt(14)
    v_xor_b32 v28, 0, v31
    v_add_u32 v28, 131072, v28
    ds_read_b64_tr_b16 v[192:193], v28 offset:0
    ds_read_b64_tr_b16 v[194:195], v28 offset:512
    ds_read_b64_tr_b16 v[196:197], v28 offset:2048
    ds_read_b64_tr_b16 v[198:199], v28 offset:2560
    v_xor_b32 v28, 64, v31
    v_add_u32 v28, 131072, v28
    ds_read_b64_tr_b16 v[216:217], v28 offset:0
    ds_read_b64_tr_b16 v[218:219], v28 offset:512
    ds_read_b64_tr_b16 v[220:221], v28 offset:2048
    ds_read_b64_tr_b16 v[222:223], v28 offset:2560
    v_xor_b32 v28, 128, v31
    v_add_u32 v28, 131072, v28
    ds_read_b64_tr_b16 v[240:241], v28 offset:0
    ds_read_b64_tr_b16 v[242:243], v28 offset:512
    ds_read_b64_tr_b16 v[244:245], v28 offset:2048
    ds_read_b64_tr_b16 v[246:247], v28 offset:2560
    v_xor_b32 v28, 192, v31
    v_add_u32 v28, 131072, v28
    ds_read_b64_tr_b16 v[56:57], v28 offset:0
    ds_read_b64_tr_b16 v[58:59], v28 offset:512
    ds_read_b64_tr_b16 v[60:61], v28 offset:2048
    ds_read_b64_tr_b16 v[62:63], v28 offset:2560
    s_waitcnt lgkmcnt(0)
    ds_write_b128 v2, v[32:35] offset:8192
    ds_write_b128 v2, v[36:39] offset:9216
    ds_write_b128 v2, v[40:43] offset:10240
    ds_write_b128 v2, v[44:47] offset:11264
    ds_write_b128 v2, v[48:51] offset:24576
    ds_write_b128 v2, v[52:55] offset:25600
    ds_write_b128 v2, v[56:59] offset:26624
    ds_write_b128 v2, v[60:63] offset:27648
    s_waitcnt lgkmcnt(0)
    v_min_u32 v18, -2, v18
    s_waitcnt vmcnt(0)
    v_cmp_ne_u32 vcc, 32, v14
    s_mov_b32 m0, 22528
    v_mov_b64 v[28:29], v[20:21]
    v_mov_b64 v[30:31], v[22:23]
    v_mov_b64 v[32:33], v[24:25]
    v_mov_b64 v[34:35], v[26:27]
    s_add_u32 s8, s29, 0x1000
    s_add_u32 s9, s29, 0x2000
    s_add_u32 s10, s29, 0x3000
    s_mov_b32 s20, 0
    s_mov_b32 s21, 0x3f803f80
    s_mov_b32 s12, s64
    s_mov_b32 s13, s64
    s_mov_b32 s14, 0xcccccccc
    s_mov_b32 s15, 0xcccccccc
    s_mov_b32 s16, 0x3f803f80
    s_mov_b32 s17, 0x3f803f80
    v_mov_b64 v[68:69], 0
    v_mov_b64 v[70:71], 0
    v_mov_b64 v[72:73], 0
    v_mov_b64 v[74:75], 0
    v_mov_b64 v[76:77], 0
    v_mov_b64 v[78:79], 0
    v_mov_b64 v[82:83], 0
    v_mov_b64 v[84:85], 0
    v_mov_b64 v[86:87], 0
    v_mov_b64 v[88:89], 0
    v_mov_b64 v[90:91], 0
    v_mov_b64 v[126:127], 0
    v_mov_b64 v[80:81], 0
    v_mov_b64 v[124:125], 0
    ds_read_b128 v[12:15], v0 offset:30976
    ds_read_b128 v[92:95], v0 offset:40960
    ds_read_b128 v[96:99], v0 offset:41984
    ds_read_b128 v[100:103], v1 offset:24576
    ds_read_b128 v[104:107], v1 offset:25600
    ds_read_b128 v[108:111], v0 offset:43008
    ds_read_b128 v[112:115], v0 offset:44032
    ds_read_b128 v[116:119], v1 offset:26624
    ds_read_b128 v[120:123], v1 offset:27648
    v_mov_b64 v[36:37], -1
    v_mov_b64 v[38:39], -1
    v_mov_b32 v19, -1
    s_waitcnt lgkmcnt(0)
    s_cmp_lg_u32 s79, 0
    s_cbranch_scc1 S2_pub2
    s_branch R2_pub2
.p2align 6
R2_loop:
    ds_read_b128 v[12:15], v0 offset:30976
    v_mov_b64_e64 v[68:69], 0
    buffer_store_dwordx2 v[124:125], v4, s[4:7], s10 offen
    s_xor_b32 s9, s9, 0x40000
    s_xor_b32 s10, s10, 0x40000
    v_mov_b64 v[80:81], 0
    v_mov_b64 v[124:125], 0
    s_xor_b32 s29, s29, 0x40000
    v_mov_b64_e64 v[70:71], 0
    s_xor_b32 s8, s8, 0x40000
    ds_read_b128 v[92:95], v0 offset:40960
    ds_read_b128 v[96:99], v0 offset:41984
    v_mov_b64_e64 v[72:73], 0
    s_add_u32 s32, s32, 0x2000
    v_mov_b64_e64 v[74:75], 0
    s_add_u32 s31, s31, 0x4000
    ds_read_b128 v[100:103], v1 offset:24576
    ds_read_b128 v[104:107], v1 offset:25600
    v_mov_b64_e64 v[76:77], 0
    s_add_u32 s70, s31, 0x2000
    v_mov_b64_e64 v[78:79], 0
    s_xor_b32 s66, s66, 0x2000
    ds_read_b128 v[108:111], v0 offset:43008
    ds_read_b128 v[112:115], v0 offset:44032
    v_mov_b64_e64 v[82:83], 0
    s_mov_b32 m0, 22528
    v_mov_b64 v[84:85], 0
    v_mov_b64 v[86:87], 0
    ds_read_b128 v[116:119], v1 offset:26624
    ds_read_b128 v[120:123], v1 offset:27648
    v_mov_b64 v[88:89], 0
    v_mov_b64 v[90:91], 0
    v_mov_b64_e64 v[126:127], 0
    s_waitcnt lgkmcnt(0)
    s_nop 2
    buffer_load_dwordx4 v[40:43], v10, s[4:7], s30 offen sc1
    buffer_load_dwordx4 v[44:47], v10, s[4:7], s30 offen offset:2048 sc1
    s_nop 15
    s_nop 11
    buffer_load_dwordx4 v[48:51], v10, s[4:7], s30 offen sc1
    buffer_load_dwordx4 v[52:55], v10, s[4:7], s30 offen offset:2048 sc1
    s_waitcnt vmcnt(3)
    v_mfma_f32_16x16x32_bf16 v[64:67], v[12:15], v[40:43], 0
    v_bitop3_b32 v16, v40, v41, s18 bitop3:0x7e
    v_bitop3_b32 v17, v42, v43, s18 bitop3:0x7e
    s_waitcnt vmcnt(2)
    v_mfma_f32_16x16x32_bf16 v[64:67], v[12:15], v[44:47], v[64:67]
    v_bitop3_b32 v18, v44, v45, s18 bitop3:0x7e
    v_or3_b32 v16, v16, v17, v18
    v_bitop3_b32 v17, v46, v47, s18 bitop3:0x7e
    v_bitop3_b32 v16, v16, v17, 1 bitop3:0xa8
    v_cmp_ne_u32 vcc, 0, v16
    s_nop 1
    v_add_f32_dpp v64, v64, v64 row_ror:4 row_mask:0xf bank_mask:0xf
    v_add_f32_dpp v65, v65, v65 row_ror:4 row_mask:0xf bank_mask:0xf
    s_nop 0
    v_add_f32_dpp v64, v64, v64 row_ror:8 row_mask:0xf bank_mask:0xf
    v_add_f32_dpp v65, v65, v65 row_ror:8 row_mask:0xf bank_mask:0xf
    v_cvt_pk_bf16_f32 v18, v64, v65
    s_cbranch_vccnz R2_pa1
R2_pub:
    buffer_store_dword v18, v5, s[4:7], s27 offen
R2_pub2:
    buffer_load_dwordx4 v[36:39], v10, s[4:7], s28 offen sc1
    s_cmp_eq_u32 s26, 63
    s_cbranch_scc1 R2_last
    v_cmp_eq_u32 vcc, 0, v11
    v_mov_b64 v[20:21], v[28:29]
    v_mov_b64 v[22:23], v[30:31]
    v_mov_b64 v[24:25], v[32:33]
    v_mov_b64_e64 v[26:27], v[34:35]
    s_xor_b32 s19, s27, 0x4000
    s_add_u32 s27, s27, 0x2000
    s_bitset0_b32 s27, 15
    s_xor_b32 s30, s30, 0x40000
    s_mov_b32 s35, 0
    s_cbranch_vccnz R2_flag
R2_flagok:
    s_add_u32 s67, s26, 2
    s_lshr_b32 s18, s67, 1
    s_add_u32 s33, s33, 16
    s_min_u32 s33, s33, s34
    s_add_u32 s26, s26, 1
    s_nop 2
    buffer_load_dwordx4 v[36:39], v10, s[4:7], s28 offen sc1
    s_nop 15
    s_nop 4
    buffer_load_dwordx4 v[36:39], v10, s[4:7], s28 offen sc1
    s_waitcnt vmcnt(2)
    v_max3_u32 v16, v36, v37, v38
    v_max_u32 v16, v16, v39
    v_cmp_eq_u32 vcc, -1, v16
    ds_write_b128 v0, v[36:39] offset:18432
    s_cbranch_vccnz R2_pe1
R2_peok:
    v_smfmac_f32_16x16x64_bf16 v[68:71], v[36:39], v[92:99], v3
    buffer_load_dwordx4 v[52:55], v10, s[4:7], s69 offen sc1
    buffer_load_dwordx4 v10, s[4:7], s69 offen sc1 lds
    v_smfmac_f32_16x16x64_bf16 v[72:75], v[36:39], v[100:107], v3
    s_mov_b32 m0, s66
    v_smfmac_f32_16x16x64_bf16 v[76:79], v[36:39], v[108:115], v3
    s_waitcnt lgkmcnt(0)
    s_barrier
    ds_read_b128 v[40:43], v0 offset:19456
    ds_read_b128 v[44:47], v0 offset:16384
    v_smfmac_f32_16x16x64_bf16 v[80:83], v[36:39], v[116:123], v3
    ds_read_b128 v[48:51], v0 offset:17408
    v_smfmac_f32_16x16x64_bf16 v[84:87], v[36:39], a[192:199], v3
    ds_read_b128 v[92:95], v0 offset:57344
    v_smfmac_f32_16x16x64_bf16 v[88:91], v[36:39], a[200:207], v3
    ds_read_b128 v[96:99], v0 offset:58368
    s_waitcnt lgkmcnt(4)
    v_smfmac_f32_16x16x64_bf16 v[68:71], v[40:43], a[0:7], v3
    ds_read_b128 v[100:103], v0 offset:59392
    v_smfmac_f32_16x16x64_bf16 v[72:75], v[40:43], a[8:15], v3
    ds_read_b128 v[104:107], v0 offset:60416
    v_smfmac_f32_16x16x64_bf16 v[76:79], v[40:43], a[16:23], v3
    ds_read_b128 v[108:111], v1 offset:8192
    v_smfmac_f32_16x16x64_bf16 v[80:83], v[40:43], a[24:31], v3
    ds_read_b128 v[112:115], v1 offset:9216
    s_waitcnt lgkmcnt(7)
    v_smfmac_f32_16x16x64_bf16 v[68:71], v[44:47], a[32:39], v3
    ds_read_b128 v[116:119], v1 offset:10240
    v_smfmac_f32_16x16x64_bf16 v[72:75], v[44:47], a[40:47], v3
    ds_read_b128 v[120:123], v1 offset:11264
    v_smfmac_f32_16x16x64_bf16 v[76:79], v[44:47], a[48:55], v3
    v_smfmac_f32_16x16x64_bf16 v[80:83], v[44:47], a[56:63], v3
    s_waitcnt lgkmcnt(8)
    s_waitcnt lgkmcnt(6)
    v_smfmac_f32_16x16x64_bf16 v[68:71], v[48:51], v[92:99], v3
    s_waitcnt vmcnt(1)
    v_max3_u32 v16, v52, v53, v54
    v_smfmac_f32_16x16x64_bf16 v[72:75], v[48:51], a[64:71], v3
    s_waitcnt lgkmcnt(4)
    v_max_u32_e64 v16, v16, v55
    v_smfmac_f32_16x16x64_bf16 v[76:79], v[48:51], v[100:107], v3
    v_cmp_eq_u32_e64 vcc, -1, v16
    v_smfmac_f32_16x16x64_bf16 v[80:83], v[48:51], a[72:79], v3
    s_waitcnt vmcnt(0)
    s_waitcnt lgkmcnt(0)
    v_smfmac_f32_16x16x64_bf16 v[84:87], v[40:43], a[208:215], v3
    s_cbranch_vccnz R2_plr
R2_plok:
    s_barrier
    ds_read_b128 v[56:59], v0 offset:23552
    v_smfmac_f32_16x16x64_bf16 v[68:71], v[52:55], v[108:115], v3
    ds_read_b128 v[60:63], v0 offset:20480
    ds_read_b128 v[64:67], v0 offset:21504
    v_smfmac_f32_16x16x64_bf16 v[72:75], v[52:55], a[80:87], v3
    buffer_load_dwordx4 v0, s[4:7], s31 offen sc1 lds
    v_smfmac_f32_16x16x64_bf16 v[76:79], v[52:55], v[116:123], v3
    v_smfmac_f32_16x16x64_bf16 v[80:83], v[52:55], a[88:95], v3
    buffer_load_dword v11, off, s[4:7], s33 sc1
    s_waitcnt lgkmcnt(2)
    v_smfmac_f32_16x16x64_bf16 v[68:71], v[56:59], a[96:103], v3
    s_waitcnt lgkmcnt(1)
    v_smfmac_f32_16x16x64_bf16 v[68:71], v[60:63], a[104:111], v3
    buffer_load_dwordx4 v0, s[4:7], s31 offen offset:1024 sc1 lds
    s_waitcnt lgkmcnt(0)
    v_smfmac_f32_16x16x64_bf16 v[68:71], v[64:67], a[112:119], v3
    ds_read_b128 v[104:107], v9 offset:4096
    v_smfmac_f32_16x16x64_bf16 v[72:75], v[56:59], a[120:127], v3
    buffer_load_dwordx4 v[28:31], v0, s[4:7], s70 offen sc1
    v_smfmac_f32_16x16x64_bf16 v[72:75], v[60:63], a[128:135], v3
    ds_read_b128 v[108:111], v9 offset:5120
    v_add_f32 v68, v68, v70
    v_smfmac_f32_16x16x64_bf16 v[72:75], v[64:67], a[136:143], v3
    ds_read_b128 v[112:115], v9 offset:6144
    v_add_f32_e64 v69, v69, v71
    v_smfmac_f32_16x16x64_bf16 v[76:79], v[56:59], a[144:151], v3
    buffer_load_dwordx4 v[32:35], v0, s[4:7], s70 offen offset:1024 sc1
    v_cvt_pk_bf16_f32 v92, v68, v69
    v_smfmac_f32_16x16x64_bf16 v[76:79], v[60:63], a[152:159], v3
    ds_read_b128 v[116:119], v9 offset:7168
    v_add_f32_e64 v72, v72, v74
    v_smfmac_f32_16x16x64_bf16 v[76:79], v[64:67], a[160:167], v3
    ds_read_b128 v[120:123], v9 offset:0
    v_add_f32_e64 v73, v73, v75
    v_smfmac_f32_16x16x64_bf16 v[80:83], v[56:59], a[168:175], v3
    buffer_store_dword v19, v5, s[4:7], s19 offen
    v_cvt_pk_bf16_f32 v93, v72, v73
    v_smfmac_f32_16x16x64_bf16 v[80:83], v[60:63], a[176:183], v3
    ds_write_b64 v6, v[92:93] offset:26752
    v_add_f32_e64 v76, v76, v78
    v_smfmac_f32_16x16x64_bf16 v[80:83], v[64:67], a[184:191], v3
    v_add_f32_e64 v77, v77, v79
    v_smfmac_f32_16x16x64_bf16 v[88:91], v[40:43], a[216:223], v3
    s_add_u32 s28, s28, 0x2000
    s_bitset0_b32 s28, 15
    v_cvt_pk_bf16_f32 v94, v76, v77
    s_add_u32 s69, s28, 0x1000
    v_add_f32 v80, v80, v82
    v_add_f32_e64 v81, v81, v83
    v_cvt_pk_bf16_f32 v95, v80, v81
    ds_write_b64 v6, v[94:95] offset:27296
    ds_read_b64_tr_b16 v[12:13], v7 offset:26752
    ds_read_b64_tr_b16 v[14:15], v7 offset:27024
    v_smfmac_f32_16x16x64_bf16 v[84:87], v[44:47], a[224:231], v3
    buffer_store_dword v18, v5, s[4:7], s32 offen sc1
    ds_read_b128 v[80:83], v9 offset:2048
    v_smfmac_f32_16x16x64_bf16 v[88:91], v[44:47], a[232:239], v3
    v_smfmac_f32_16x16x64_bf16 v[84:87], v[48:51], a[240:247], v3
    s_waitcnt lgkmcnt(3)
    s_barrier
    ds_read_b64_tr_b16 v[92:93], v7 offset:27840
    ds_read_b64_tr_b16 v[94:95], v7 offset:28112
    v_smfmac_f32_16x16x64_bf16 v[88:91], v[48:51], a[248:255], v3
    v_smfmac_f32_16x16x64_bf16 v[84:87], v[52:55], v[128:135], v3
    ds_read_b64_tr_b16 v[96:97], v7 offset:24576
    s_waitcnt lgkmcnt(4)
    v_mfma_f32_16x16x32_bf16 v[76:79], v[12:15], v[12:15], 0
    ds_read_b64_tr_b16 v[98:99], v7 offset:24848
    ds_read_b64_tr_b16 v[100:101], v7 offset:25664
    v_mfma_f32_16x16x32_bf16 v[68:71], v[104:107], v[12:15], 0
    ds_read_b64_tr_b16 v[102:103], v7 offset:25936
    ds_read_b128 v[104:107], v9 offset:1024
    v_mfma_f32_16x16x32_bf16 v[72:75], v[108:111], v[12:15], 0
    ds_read_b128 v[108:111], v9 offset:3072
    s_waitcnt lgkmcnt(6)
    v_mfma_f32_16x16x32_bf16 v[76:79], v[92:95], v[92:95], v[76:79]
    ds_read_b128 v[36:39], v1 offset:59392
    v_mfma_f32_16x16x32_bf16 v[68:71], v[112:115], v[92:95], v[68:71]
    v_mov_b64 v[112:113], s[20:21]
    v_mov_b64 v[114:115], s[16:17]
    v_mfma_f32_16x16x32_bf16 v[72:75], v[116:119], v[92:95], v[72:75]
    s_waitcnt lgkmcnt(3)
    v_mov_b64 v[116:117], 0
    v_mov_b64_e64 v[118:119], 0
    v_mfma_f32_16x16x32_bf16 v[68:71], v[120:123], v[96:99], v[68:71]
    s_mov_b64 vcc, s[14:15]
    v_mov_b64 v[120:121], 0
    v_mov_b64_e64 v[122:123], 0
    v_mfma_f32_16x16x32_bf16 v[68:71], v[80:83], v[100:103], v[68:71]
    s_waitcnt lgkmcnt(1)
    v_mov_b64 v[80:81], 0
    v_mov_b64_e64 v[82:83], 0
    v_mfma_f32_16x16x32_bf16 v[72:75], v[104:107], v[96:99], v[72:75]
    v_xor_b32 v9, 0x2000, v9
    v_mov_b32_e64 v16, s64
    v_mfma_f32_16x16x32_bf16 v[72:75], v[108:111], v[100:103], v[72:75]
    v_max3_f32 v12, v68, v69, v70
    v_mov_b32_e64 v109, 0
    v_mfma_f32_16x16x32_bf16 v[76:79], v[96:99], v[96:99], v[76:79]
    v_max_f32 v12, v12, v71
    v_mov_b32 v110, 0
    v_mfma_f32_16x16x32_bf16 v[76:79], v[100:103], v[100:103], v[76:79]
    v_max3_f32 v12, v12, v72, v73
    v_max3_f32 v12, v12, v74, v75
    v_smfmac_f32_16x16x64_bf16 v[88:91], v[52:55], v[136:143], v3
    ds_read_b128 v[40:43], v1 offset:60416
    v_cndmask_b32_dpp v68, v72, v68, vcc quad_perm:[2,3,2,3] row_mask:0xf bank_mask:0xf
    v_cndmask_b32_dpp v69, v73, v69, vcc quad_perm:[2,3,2,3] row_mask:0xf bank_mask:0xf
    v_max3_f32 v79, v12, v76, v77
    v_max3_f32 v96, v12, v76, v77
    v_smfmac_f32_16x16x64_bf16 v[84:87], v[56:59], v[144:151], v3
    ds_read_b128 v[44:47], v2 offset:8192
    v_permlane16_swap_b32 v79, v96
    v_max_f32 v78, v79, v96
    v_max_f32_e64 v79, v79, v96
    v_smfmac_f32_16x16x64_bf16 v[88:91], v[56:59], v[152:159], v3
    ds_read_b128 v[48:51], v2 offset:9216
    v_permlane32_swap_b32 v78, v79
    v_max_f32 v78, v78, v79
    v_smfmac_f32_16x16x64_bf16 v[84:87], v[60:63], v[160:167], v3
    ds_read_b128 v[52:55], v2 offset:10240
    v_mul_f32_dpp v78, v78, v16 quad_perm:[2,3,2,3] row_mask:0xf bank_mask:0xf
    v_smfmac_f32_16x16x64_bf16 v[88:91], v[60:63], v[168:175], v3
    ds_read_b128 v[56:59], v2 offset:11264
    v_cndmask_b32_dpp v76, v77, v76, vcc quad_perm:[2,3,2,3] row_mask:0xf bank_mask:0xf
    v_smfmac_f32_16x16x64_bf16 v[84:87], v[64:67], v[176:183], v3
    ds_read_b128 v[60:63], v2 offset:24576
    v_cndmask_b32_dpp v70, v74, v70, vcc quad_perm:[2,3,2,3] row_mask:0xf bank_mask:0xf
    v_smfmac_f32_16x16x64_bf16 v[88:91], v[64:67], v[184:191], v3
    ds_read_b128 v[64:67], v2 offset:25600
    v_cndmask_b32_dpp v71, v75, v71, vcc quad_perm:[2,3,2,3] row_mask:0xf bank_mask:0xf
    v_fma_f32 v76, v76, s64, -v78
    v_exp_f32_e64 v76, v76
    v_pk_fma_f32 v[68:69], v[68:69], s[12:13], v[78:79] op_sel_hi:[1,1,0] neg_lo:[0,0,1] neg_hi:[0,0,1]
    v_pk_fma_f32 v[70:71], v[70:71], s[12:13], v[78:79] op_sel_hi:[1,1,0] neg_lo:[0,0,1] neg_hi:[0,0,1]
    v_mov_b32_dpp v77, v76 quad_perm:[0,1,0,1] row_mask:0xf bank_mask:0xf
    v_pk_add_f32 v[84:85], v[84:85], v[86:87]
    v_pk_add_f32 v[88:89], v[88:89], v[90:91]
    v_cvt_pk_bf16_f32 v108, v76, v77
    v_cvt_pk_bf16_f32 v111, v76, v77
    v_cvt_pk_bf16_f32 v16, v84, v85
    v_cvt_pk_bf16_f32 v17, v88, v89
    v_exp_f32 v68, v68
    v_exp_f32 v69, v69
    v_mfma_f32_16x16x16_bf16 v[92:95], v[16:17], v[108:109], 0
    v_cvt_pk_bf16_f32 v104, v68, v69
    v_exp_f32_e64 v70, v70
    v_mfma_f32_16x16x16_bf16 v[96:99], v[16:17], v[110:111], 0
    v_exp_f32_e64 v71, v71
    v_cvt_pk_bf16_f32 v103, v76, 0
    v_cvt_pk_bf16_f32 v105, v70, v71
    v_mov_b32_dpp v106, v104 quad_perm:[0,1,0,1] row_mask:0xf bank_mask:0xf
    s_nop 0
    v_mfma_f32_16x16x32_bf16 v[72:75], v[112:115], v[102:105], 0
    v_mov_b32_dpp v107, v105 quad_perm:[0,1,0,1] row_mask:0xf bank_mask:0xf
    s_nop 1
    v_mfma_f32_16x16x32_bf16 v[92:95], v[20:23], v[104:107], v[92:95]
    v_mfma_f32_16x16x32_bf16 v[96:99], v[24:27], v[104:107], v[96:99]
    v_add_f32_dpp v72, v72, v72 quad_perm:[2,3,0,1] row_mask:0xf bank_mask:0xf
    v_rcp_f32 v72, v72
    s_mov_b64 exec, s[14:15]
    v_mul_f32 v92, v72, v92
    v_mul_f32 v93, v72, v93
    v_mul_f32 v94, v72, v94
    v_mul_f32 v95, v72, v95
    v_cvt_pk_bf16_f32 v84, v92, v93
    v_cvt_pk_bf16_f32 v85, v94, v95
    ds_write_b64 v8, v[84:85] offset:29952
    v_pk_mul_f32 v[96:97], v[96:97], v[72:73] op_sel_hi:[1,0]
    v_pk_mul_f32 v[98:99], v[98:99], v[72:73] op_sel_hi:[1,0]
    v_cvt_pk_bf16_f32 v86, v96, v97
    v_cvt_pk_bf16_f32 v87, v98, v99
    ds_write_b64 v8, v[86:87] offset:29960
    s_mov_b64 exec, -1
    v_mov_b32_dpp v88, v84 quad_perm:[2,3,2,3] row_mask:0xf bank_mask:0xf
    v_mov_b32_dpp v89, v85 quad_perm:[2,3,2,3] row_mask:0xf bank_mask:0xf
    v_mov_b32_dpp v90, v86 quad_perm:[2,3,2,3] row_mask:0xf bank_mask:0xf
    v_mov_b32_dpp v91, v87 quad_perm:[2,3,2,3] row_mask:0xf bank_mask:0xf
    s_waitcnt lgkmcnt(2)
    s_nop 0
    v_smfmac_f32_16x16x64_bf16 v[116:119], v[88:91], v[36:43], v3
    s_waitcnt lgkmcnt(0)
    s_barrier
    ds_read_b128 v[68:71], v8 offset:30464
    ds_read_b128 v[72:75], v8 offset:28928
    ds_read_b128 v[76:79], v8 offset:29440
    v_smfmac_f32_16x16x64_bf16 v[120:123], v[88:91], v[44:51], v3
    ds_read_b128 v[36:39], v1 offset:43008
    v_smfmac_f32_16x16x64_bf16 v[80:83], v[88:91], v[52:59], v3
    ds_read_b128 v[40:43], v1 offset:44032
    v_smfmac_f32_16x16x64_bf16 v[124:127], v[88:91], v[60:67], v3
    ds_read_b128 v[44:47], v2 offset:26624
    s_waitcnt lgkmcnt(5)
    v_smfmac_f32_16x16x64_bf16 v[116:119], v[68:71], v[192:199], v3
    ds_read_b128 v[48:51], v2 offset:27648
    s_waitcnt lgkmcnt(5)
    v_smfmac_f32_16x16x64_bf16 v[116:119], v[72:75], v[200:207], v3
    ds_read_b128 v[52:55], v1 offset:40960
    s_waitcnt lgkmcnt(5)
    v_smfmac_f32_16x16x64_bf16 v[116:119], v[76:79], v[208:215], v3
    ds_read_b128 v[56:59], v1 offset:41984
    ds_read_b128 v[60:63], v1 offset:57344
    v_smfmac_f32_16x16x64_bf16 v[120:123], v[68:71], v[216:223], v3
    ds_read_b128 v[64:67], v1 offset:58368
    v_smfmac_f32_16x16x64_bf16 v[120:123], v[72:75], v[224:231], v3
    v_cvt_pk_bf16_f32 v116, v116, v117
    v_cvt_pk_bf16_f32 v117, v118, v119
    v_bfi_b32 v116, 1, s18, v116
    v_bfi_b32 v117, 1, s18, v117
    v_smfmac_f32_16x16x64_bf16 v[120:123], v[76:79], v[232:239], v3
    buffer_store_dwordx2 v[116:117], v4, s[4:7], s29 offen
    v_smfmac_f32_16x16x64_bf16 v[80:83], v[68:71], v[240:247], v3
    s_waitcnt lgkmcnt(0)
    v_smfmac_f32_16x16x64_bf16 v[80:83], v[72:75], v[248:255], v3
    v_cvt_pk_bf16_f32 v120, v120, v121
    v_cvt_pk_bf16_f32 v121, v122, v123
    v_bfi_b32 v120, 1, s18, v120
    v_bfi_b32 v121, 1, s18, v121
    v_smfmac_f32_16x16x64_bf16 v[80:83], v[76:79], v[36:43], v3
    buffer_store_dwordx2 v[120:121], v4, s[4:7], s8 offen
    v_smfmac_f32_16x16x64_bf16 v[124:127], v[68:71], v[44:51], v3
    v_smfmac_f32_16x16x64_bf16 v[124:127], v[72:75], v[52:59], v3
    v_cvt_pk_bf16_f32 v80, v80, v81
    v_cvt_pk_bf16_f32 v81, v82, v83
    v_bfi_b32 v80, 1, s18, v80
    v_bfi_b32 v81, 1, s18, v81
    v_smfmac_f32_16x16x64_bf16 v[124:127], v[76:79], v[60:67], v3
    buffer_store_dwordx2 v[80:81], v4, s[4:7], s9 offen
    s_nop 6
    v_cvt_pk_bf16_f32 v124, v124, v125
    v_cvt_pk_bf16_f32 v125, v126, v127
    v_bfi_b32 v124, 1, s18, v124
    v_bfi_b32 v125, 1, s18, v125
    s_nop 0
    s_branch R2_loop
.p2align 5
R2_pa1:
    buffer_load_dwordx4 v[40:43], v10, s[4:7], s30 offen sc1
    buffer_load_dwordx4 v[44:47], v10, s[4:7], s30 offen offset:2048 sc1
    s_waitcnt vmcnt(3)
    v_mfma_f32_16x16x32_bf16 v[64:67], v[12:15], v[48:51], 0
    v_bitop3_b32 v16, v48, v49, s18 bitop3:0x7e
    v_bitop3_b32 v17, v50, v51, s18 bitop3:0x7e
    s_waitcnt vmcnt(2)
    v_mfma_f32_16x16x32_bf16 v[64:67], v[12:15], v[52:55], v[64:67]
    v_bitop3_b32 v18, v52, v53, s18 bitop3:0x7e
    v_or3_b32 v16, v16, v17, v18
    v_bitop3_b32 v17, v54, v55, s18 bitop3:0x7e
    v_bitop3_b32 v16, v16, v17, 1 bitop3:0xa8
    v_cmp_ne_u32 vcc, 0, v16
    s_nop 1
    v_add_f32_dpp v64, v64, v64 row_ror:4 row_mask:0xf bank_mask:0xf
    v_add_f32_dpp v65, v65, v65 row_ror:4 row_mask:0xf bank_mask:0xf
    s_nop 0
    v_add_f32_dpp v64, v64, v64 row_ror:8 row_mask:0xf bank_mask:0xf
    v_add_f32_dpp v65, v65, v65 row_ror:8 row_mask:0xf bank_mask:0xf
    v_cvt_pk_bf16_f32 v18, v64, v65
    s_cbranch_vccz R2_pub
R2_par:
    buffer_load_dwordx4 v[48:51], v10, s[4:7], s30 offen sc1
    buffer_load_dwordx4 v[52:55], v10, s[4:7], s30 offen offset:2048 sc1
    s_waitcnt vmcnt(3)
    v_mfma_f32_16x16x32_bf16 v[64:67], v[12:15], v[40:43], 0
    v_bitop3_b32 v16, v40, v41, s18 bitop3:0x7e
    v_bitop3_b32 v17, v42, v43, s18 bitop3:0x7e
    s_waitcnt vmcnt(2)
    v_mfma_f32_16x16x32_bf16 v[64:67], v[12:15], v[44:47], v[64:67]
    v_bitop3_b32 v18, v44, v45, s18 bitop3:0x7e
    v_or3_b32 v16, v16, v17, v18
    v_bitop3_b32 v17, v46, v47, s18 bitop3:0x7e
    v_bitop3_b32 v16, v16, v17, 1 bitop3:0xa8
    v_cmp_ne_u32 vcc, 0, v16
    s_nop 1
    v_add_f32_dpp v64, v64, v64 row_ror:4 row_mask:0xf bank_mask:0xf
    v_add_f32_dpp v65, v65, v65 row_ror:4 row_mask:0xf bank_mask:0xf
    s_nop 0
    v_add_f32_dpp v64, v64, v64 row_ror:8 row_mask:0xf bank_mask:0xf
    v_add_f32_dpp v65, v65, v65 row_ror:8 row_mask:0xf bank_mask:0xf
    v_cvt_pk_bf16_f32 v18, v64, v65
    s_cbranch_vccz R2_pub
    buffer_load_dwordx4 v[40:43], v10, s[4:7], s30 offen sc1
    buffer_load_dwordx4 v[44:47], v10, s[4:7], s30 offen offset:2048 sc1
    s_waitcnt vmcnt(3)
    v_mfma_f32_16x16x32_bf16 v[64:67], v[12:15], v[48:51], 0
    v_bitop3_b32 v16, v48, v49, s18 bitop3:0x7e
    v_bitop3_b32 v17, v50, v51, s18 bitop3:0x7e
    s_waitcnt vmcnt(2)
    v_mfma_f32_16x16x32_bf16 v[64:67], v[12:15], v[52:55], v[64:67]
    v_bitop3_b32 v18, v52, v53, s18 bitop3:0x7e
    v_or3_b32 v16, v16, v17, v18
    v_bitop3_b32 v17, v54, v55, s18 bitop3:0x7e
    v_bitop3_b32 v16, v16, v17, 1 bitop3:0xa8
    v_cmp_ne_u32 vcc, 0, v16
    s_nop 1
    v_add_f32_dpp v64, v64, v64 row_ror:4 row_mask:0xf bank_mask:0xf
    v_add_f32_dpp v65, v65, v65 row_ror:4 row_mask:0xf bank_mask:0xf
    s_nop 0
    v_add_f32_dpp v64, v64, v64 row_ror:8 row_mask:0xf bank_mask:0xf
    v_add_f32_dpp v65, v65, v65 row_ror:8 row_mask:0xf bank_mask:0xf
    v_cvt_pk_bf16_f32 v18, v64, v65
    s_cbranch_vccz R2_pub
    s_add_u32 s35, s35, 1
    s_cmp_lt_u32 s35, 131072
    s_cbranch_scc1 R2_par
    s_branch L_END
R2_last:
    buffer_store_dword v18, v5, s[4:7], s32 offen sc1
    s_branch R_DONE
R2_flag:
    buffer_load_dword v11, off, s[4:7], s33 sc1
    s_waitcnt vmcnt(0)
    v_cmp_eq_u32 vcc, 0, v11
    s_cbranch_vccz R2_flagok
    s_add_u32 s35, s35, 1
    s_cmp_lt_u32 s35, 131072
    s_cbranch_scc1 R2_flag
    s_branch L_END
.p2align 5
R2_pe1:
    buffer_load_dwordx4 v[36:39], v10, s[4:7], s28 offen sc1
    s_waitcnt vmcnt(2)
    v_max3_u32 v16, v36, v37, v38
    v_max_u32 v16, v16, v39
    v_cmp_eq_u32 vcc, -1, v16
    ds_write_b128 v0, v[36:39] offset:18432
    s_cbranch_vccz R2_peok
    buffer_load_dwordx4 v[36:39], v10, s[4:7], s28 offen sc1
    s_waitcnt vmcnt(2)
    v_max3_u32 v16, v36, v37, v38
    v_max_u32 v16, v16, v39
    v_cmp_eq_u32 vcc, -1, v16
    ds_write_b128 v0, v[36:39] offset:18432
    s_cbranch_vccz R2_peok
R2_pe2:
    buffer_load_dwordx4 v[36:39], v10, s[4:7], s28 offen sc1
    s_add_u32 s35, s35, 1
    s_cmp_ge_u32 s35, 131072
    s_cbranch_scc1 L_END
    s_waitcnt vmcnt(2)
    v_max3_u32 v16, v36, v37, v38
    v_max_u32 v16, v16, v39
    v_cmp_eq_u32 vcc, -1, v16
    ds_write_b128 v0, v[36:39] offset:18432
    s_cbranch_vccz R2_peok
    s_branch R2_pe2
R2_plr:
    s_mov_b32 m0, 22528
    s_nop 0
    buffer_load_dwordx4 v[52:55], v10, s[4:7], s69 offen sc1
    buffer_load_dwordx4 v10, s[4:7], s69 offen sc1 lds
    s_mov_b32 m0, s66
    s_waitcnt vmcnt(0)
    v_max3_u32 v16, v52, v53, v54
    v_max_u32 v16, v16, v55
    v_cmp_eq_u32 vcc, -1, v16
    s_waitcnt lgkmcnt(0)
    s_cbranch_vccz R2_plok
    s_add_u32 s35, s35, 1
    s_cmp_lt_u32 s35, 131072
    s_cbranch_scc1 R2_plr
    s_branch L_END
R2_reg:
    s_mov_b32 s35, 0
R2_reg2:
    global_load_dword v11, v16, s[60:61] sc1
    s_waitcnt vmcnt(0)
    v_cmp_eq_u32 vcc, 0, v11
    s_cbranch_vccz R2_reg2_ok
    s_add_u32 s35, s35, 1
    s_cmp_lt_u32 s35, 131072
    s_cbranch_scc1 R2_reg2
    s_branch L_END
R2_reg2_ok:
    s_branch R2_regok
R2_md:
    v_lshlrev_b32 v12, 1, v0
    v_and_b32 v12, 0xe0, v12
    s_mov_b32 s89, 0
R2_md2:
    global_load_dword v14, v12, s[60:61] sc1
    s_waitcnt vmcnt(0)
    v_readlane_b32 s80, v14, 0
    v_readlane_b32 s81, v14, 1
    v_readlane_b32 s82, v14, 2
    v_readlane_b32 s83, v14, 3
    v_readlane_b32 s84, v14, 4
    v_readlane_b32 s85, v14, 5
    v_readlane_b32 s86, v14, 6
    v_readlane_b32 s87, v14, 7
    s_nop 3
    s_add_u32 s88, s80, s81
    s_add_u32 s88, s88, s82
    s_add_u32 s88, s88, s83
    s_add_u32 s88, s88, s84
    s_add_u32 s88, s88, s85
    s_add_u32 s88, s88, s86
    s_add_u32 s88, s88, s87
    s_cmp_ge_u32 s80, 32
    s_cbranch_scc1 R2_mdok
    s_cmp_ge_u32 s88, 256
    s_cbranch_scc1 R2_md3
    s_sleep 16
    s_add_u32 s89, s89, 1
    s_cmp_lt_u32 s89, 131072
    s_cbranch_scc1 R2_md2
    s_branch L_END
R2_md3:
    s_mov_b32 s79, 1
    s_branch R2_mdok
R2_p0:
    buffer_store_dword v18, v5, s[4:7], s27 offen sc1
    s_branch R2_p0ok
R2_kv0:
    s_mov_b32 s35, 0
R2_kv02:
    buffer_load_dword v17, off, s[4:7], s33 offset:16 sc1
    buffer_load_dword v16, off, s[4:7], s33 sc1
    s_waitcnt vmcnt(0)
    v_cmp_eq_u32 vcc, 0, v16
    s_cbranch_vccz R2_kv02_ok
    s_add_u32 s35, s35, 1
    s_cmp_lt_u32 s35, 131072
    s_cbranch_scc1 R2_kv02
    s_branch L_END
R2_kv02_ok:
    s_branch R2_kv0ok
R3_start:
    v_xor_b32 v30, 0x80, v25
    v_xor_b32 v15, 0x40, v24
    v_mov_b32 v31, v27
    s_mov_b32 m0, 45056
    s_mov_b32 s67, 0
    buffer_load_dwordx4 v24, s[16:19], s67 offen lds
    s_mov_b32 m0, 46080
    s_mov_b32 s67, 32768
    buffer_load_dwordx4 v15, s[16:19], s67 offen lds
    s_mov_b32 m0, 47104
    s_mov_b32 s67, 65536
    buffer_load_dwordx4 v24, s[16:19], s67 offen lds
    s_mov_b32 m0, 48128
    s_mov_b32 s67, 98304
    buffer_load_dwordx4 v15, s[16:19], s67 offen lds
    s_mov_b32 m0, 61440
    s_mov_b32 s67, 2097152
    buffer_load_dwordx4 v24, s[16:19], s67 offen lds
    s_mov_b32 m0, 62464
    s_mov_b32 s67, 2129920
    buffer_load_dwordx4 v15, s[16:19], s67 offen lds
    s_mov_b32 m0, 63488
    s_mov_b32 s67, 2162688
    buffer_load_dwordx4 v24, s[16:19], s67 offen lds
    s_mov_b32 m0, 64512
    s_mov_b32 s67, 2195456
    buffer_load_dwordx4 v15, s[16:19], s67 offen lds
    s_mov_b32 m0, 77824
    s_mov_b32 s67, 262144
    buffer_load_dwordx4 v24, s[16:19], s67 offen lds
    s_mov_b32 m0, 78848
    s_mov_b32 s67, 294912
    buffer_load_dwordx4 v15, s[16:19], s67 offen lds
    s_mov_b32 m0, 79872
    s_mov_b32 s67, 327680
    buffer_load_dwordx4 v24, s[16:19], s67 offen lds
    s_mov_b32 m0, 80896
    s_mov_b32 s67, 360448
    buffer_load_dwordx4 v15, s[16:19], s67 offen lds
    s_mov_b32 m0, 94208
    s_mov_b32 s67, 2359296
    buffer_load_dwordx4 v24, s[16:19], s67 offen lds
    s_mov_b32 m0, 95232
    s_mov_b32 s67, 2392064
    buffer_load_dwordx4 v15, s[16:19], s67 offen lds
    s_mov_b32 m0, 96256
    s_mov_b32 s67, 2424832
    buffer_load_dwordx4 v24, s[16:19], s67 offen lds
    s_mov_b32 m0, 97280
    s_mov_b32 s67, 2457600
    buffer_load_dwordx4 v15, s[16:19], s67 offen lds
    s_mov_b32 m0, 110592
    s_mov_b32 s67, 524288
    buffer_load_dwordx4 v24, s[16:19], s67 offen lds
    s_mov_b32 m0, 111616
    s_mov_b32 s67, 557056
    buffer_load_dwordx4 v15, s[16:19], s67 offen lds
    s_mov_b32 m0, 112640
    s_mov_b32 s67, 589824
    buffer_load_dwordx4 v24, s[16:19], s67 offen lds
    s_mov_b32 m0, 113664
    s_mov_b32 s67, 622592
    buffer_load_dwordx4 v15, s[16:19], s67 offen lds
    s_mov_b32 m0, 126976
    s_mov_b32 s67, 2621440
    buffer_load_dwordx4 v24, s[16:19], s67 offen lds
    s_mov_b32 m0, 128000
    s_mov_b32 s67, 2654208
    buffer_load_dwordx4 v15, s[16:19], s67 offen lds
    s_mov_b32 m0, 129024
    s_mov_b32 s67, 2686976
    buffer_load_dwordx4 v24, s[16:19], s67 offen lds
    s_mov_b32 m0, 130048
    s_mov_b32 s67, 2719744
    buffer_load_dwordx4 v15, s[16:19], s67 offen lds
    s_mov_b32 m0, 143360
    s_mov_b32 s67, 786432
    buffer_load_dwordx4 v24, s[16:19], s67 offen lds
    s_mov_b32 m0, 144384
    s_mov_b32 s67, 819200
    buffer_load_dwordx4 v15, s[16:19], s67 offen lds
    s_mov_b32 m0, 145408
    s_mov_b32 s67, 851968
    buffer_load_dwordx4 v24, s[16:19], s67 offen lds
    s_mov_b32 m0, 146432
    s_mov_b32 s67, 884736
    buffer_load_dwordx4 v15, s[16:19], s67 offen lds
    s_mov_b32 m0, 159744
    s_mov_b32 s67, 2883584
    buffer_load_dwordx4 v24, s[16:19], s67 offen lds
    s_mov_b32 m0, 160768
    s_mov_b32 s67, 2916352
    buffer_load_dwordx4 v15, s[16:19], s67 offen lds
    s_mov_b32 m0, 161792
    s_mov_b32 s67, 2949120
    buffer_load_dwordx4 v24, s[16:19], s67 offen lds
    s_mov_b32 m0, 162816
    s_mov_b32 s67, 2981888
    buffer_load_dwordx4 v15, s[16:19], s67 offen lds
    s_mov_b32 s72, s38
    s_mov_b32 s73, s39
    s_mov_b32 s74, 8192
    s_mov_b32 s75, 0x20000
    s_and_b32 s67, s24, 3
    s_lshl_b32 s67, s67, 11
    s_lshr_b32 s68, s24, 3
    s_lshl_b32 s68, s68, 8
    s_add_u32 s67, s67, s68
    s_and_b32 s68, s24, 4
    s_lshl_b32 s68, s68, 2
    s_add_u32 s67, s67, s68
    v_and_b32 v28, 1, v13
    v_lshlrev_b32 v28, 10, v28
    v_lshl_add_u32 v28, v17, 2, v28
    v_lshrrev_b32 v29, 1, v13
    v_lshl_add_u32 v28, v29, 5, v28
    buffer_load_dword v18, v28, s[72:75], s67 offen offset:192
    s_lshl_b32 s33, s24, 10
    s_add_u32 s33, s33, 12
    s_add_u32 s34, s33, 992
    s_add_u32 s33, s33, 0
    s_waitcnt vmcnt(29)
    s_barrier
    v_add_u32 v28, 32768, v26
    v_xor_b32 v29, 32, v28
    ds_read_b64_tr_b16 v[32:33], v28 offset:0
    ds_read_b64_tr_b16 v[34:35], v28 offset:512
    ds_read_b64_tr_b16 v[36:37], v28 offset:8192
    ds_read_b64_tr_b16 v[38:39], v28 offset:8704
    ds_read_b64_tr_b16 v[40:41], v29 offset:0
    ds_read_b64_tr_b16 v[42:43], v29 offset:512
    ds_read_b64_tr_b16 v[44:45], v29 offset:8192
    ds_read_b64_tr_b16 v[46:47], v29 offset:8704
    s_waitcnt lgkmcnt(0)
    s_waitcnt vmcnt(25)
    s_barrier
    s_and_b32 s67, s24, 3
    s_cmp_eq_u32 s67, 1
    s_cbranch_scc1 R3_th1
    s_waitcnt vmcnt(4)
R3_th1:
    s_mov_b32 m0, 45056
    s_mov_b32 s67, 0
    buffer_load_dwordx4 v24, s[8:11], s67 offen lds
    s_mov_b32 m0, 46080
    s_mov_b32 s67, 32768
    buffer_load_dwordx4 v15, s[8:11], s67 offen lds
    s_mov_b32 m0, 47104
    s_mov_b32 s67, 65536
    buffer_load_dwordx4 v24, s[8:11], s67 offen lds
    s_mov_b32 m0, 48128
    s_mov_b32 s67, 98304
    buffer_load_dwordx4 v15, s[8:11], s67 offen lds
    v_add_u32 v28, 49152, v26
    v_xor_b32 v29, 32, v28
    ds_read_b64_tr_b16 v[48:49], v28 offset:0
    ds_read_b64_tr_b16 v[50:51], v28 offset:512
    ds_read_b64_tr_b16 v[52:53], v28 offset:8192
    ds_read_b64_tr_b16 v[54:55], v28 offset:8704
    ds_read_b64_tr_b16 v[56:57], v29 offset:0
    ds_read_b64_tr_b16 v[58:59], v29 offset:512
    ds_read_b64_tr_b16 v[60:61], v29 offset:8192
    ds_read_b64_tr_b16 v[62:63], v29 offset:8704
    s_waitcnt lgkmcnt(0)
    s_waitcnt vmcnt(25)
    s_barrier
    s_and_b32 s67, s24, 3
    s_cmp_eq_u32 s67, 1
    s_cbranch_scc1 R3_th2
    s_waitcnt vmcnt(4)
R3_th2:
    s_mov_b32 m0, 61440
    s_mov_b32 s67, 2097152
    buffer_load_dwordx4 v24, s[8:11], s67 offen lds
    s_mov_b32 m0, 62464
    s_mov_b32 s67, 2129920
    buffer_load_dwordx4 v15, s[8:11], s67 offen lds
    s_mov_b32 m0, 63488
    s_mov_b32 s67, 2162688
    buffer_load_dwordx4 v24, s[8:11], s67 offen lds
    s_mov_b32 m0, 64512
    s_mov_b32 s67, 2195456
    buffer_load_dwordx4 v15, s[8:11], s67 offen lds
    v_add_u32 v28, 65536, v26
    v_xor_b32 v29, 32, v28
    ds_read_b64_tr_b16 a[0:1], v28 offset:0
    ds_read_b64_tr_b16 a[2:3], v28 offset:512
    ds_read_b64_tr_b16 a[4:5], v28 offset:8192
    ds_read_b64_tr_b16 a[6:7], v28 offset:8704
    ds_read_b64_tr_b16 a[16:17], v29 offset:0
    ds_read_b64_tr_b16 a[18:19], v29 offset:512
    ds_read_b64_tr_b16 a[20:21], v29 offset:8192
    ds_read_b64_tr_b16 a[22:23], v29 offset:8704
    s_waitcnt lgkmcnt(0)
    s_waitcnt vmcnt(25)
    s_barrier
    s_and_b32 s67, s24, 3
    s_cmp_eq_u32 s67, 1
    s_cbranch_scc1 R3_th3
    s_waitcnt vmcnt(4)
R3_th3:
    s_mov_b32 m0, 77824
    s_mov_b32 s67, 262144
    buffer_load_dwordx4 v24, s[8:11], s67 offen lds
    s_mov_b32 m0, 78848
    s_mov_b32 s67, 294912
    buffer_load_dwordx4 v15, s[8:11], s67 offen lds
    s_mov_b32 m0, 79872
    s_mov_b32 s67, 327680
    buffer_load_dwordx4 v24, s[8:11], s67 offen lds
    s_mov_b32 m0, 80896
    s_mov_b32 s67, 360448
    buffer_load_dwordx4 v15, s[8:11], s67 offen lds
    v_add_u32 v28, 81920, v26
    v_xor_b32 v29, 32, v28
    ds_read_b64_tr_b16 a[32:33], v28 offset:0
    ds_read_b64_tr_b16 a[34:35], v28 offset:512
    ds_read_b64_tr_b16 a[36:37], v28 offset:8192
    ds_read_b64_tr_b16 a[38:39], v28 offset:8704
    ds_read_b64_tr_b16 a[48:49], v29 offset:0
    ds_read_b64_tr_b16 a[50:51], v29 offset:512
    ds_read_b64_tr_b16 a[52:53], v29 offset:8192
    ds_read_b64_tr_b16 a[54:55], v29 offset:8704
    s_waitcnt lgkmcnt(0)
    s_waitcnt vmcnt(25)
    s_barrier
    s_and_b32 s67, s24, 3
    s_cmp_eq_u32 s67, 1
    s_cbranch_scc1 R3_th4
    s_waitcnt vmcnt(4)
R3_th4:
    s_mov_b32 m0, 94208
    s_mov_b32 s67, 2359296
    buffer_load_dwordx4 v24, s[8:11], s67 offen lds
    s_mov_b32 m0, 95232
    s_mov_b32 s67, 2392064
    buffer_load_dwordx4 v15, s[8:11], s67 offen lds
    s_mov_b32 m0, 96256
    s_mov_b32 s67, 2424832
    buffer_load_dwordx4 v24, s[8:11], s67 offen lds
    s_mov_b32 m0, 97280
    s_mov_b32 s67, 2457600
    buffer_load_dwordx4 v15, s[8:11], s67 offen lds
    v_add_u32 v28, 98304, v26
    v_xor_b32 v29, 32, v28
    ds_read_b64_tr_b16 a[112:113], v28 offset:0
    ds_read_b64_tr_b16 a[114:115], v28 offset:512
    ds_read_b64_tr_b16 a[116:117], v28 offset:8192
    ds_read_b64_tr_b16 a[118:119], v28 offset:8704
    ds_read_b64_tr_b16 a[160:161], v29 offset:0
    ds_read_b64_tr_b16 a[162:163], v29 offset:512
    ds_read_b64_tr_b16 a[164:165], v29 offset:8192
    ds_read_b64_tr_b16 a[166:167], v29 offset:8704
    s_waitcnt lgkmcnt(0)
    s_waitcnt vmcnt(25)
    s_barrier
    s_and_b32 s67, s24, 3
    s_cmp_eq_u32 s67, 1
    s_cbranch_scc1 R3_th5
    s_waitcnt vmcnt(4)
R3_th5:
    s_mov_b32 m0, 110592
    s_mov_b32 s67, 524288
    buffer_load_dwordx4 v24, s[8:11], s67 offen lds
    s_mov_b32 m0, 111616
    s_mov_b32 s67, 557056
    buffer_load_dwordx4 v15, s[8:11], s67 offen lds
    s_mov_b32 m0, 112640
    s_mov_b32 s67, 589824
    buffer_load_dwordx4 v24, s[8:11], s67 offen lds
    s_mov_b32 m0, 113664
    s_mov_b32 s67, 622592
    buffer_load_dwordx4 v15, s[8:11], s67 offen lds
    v_add_u32 v28, 114688, v26
    v_xor_b32 v29, 32, v28
    ds_read_b64_tr_b16 v[64:65], v28 offset:0
    ds_read_b64_tr_b16 v[66:67], v28 offset:512
    ds_read_b64_tr_b16 v[68:69], v28 offset:8192
    ds_read_b64_tr_b16 v[70:71], v28 offset:8704
    ds_read_b64_tr_b16 v[72:73], v29 offset:0
    ds_read_b64_tr_b16 v[74:75], v29 offset:512
    ds_read_b64_tr_b16 v[76:77], v29 offset:8192
    ds_read_b64_tr_b16 v[78:79], v29 offset:8704
    s_waitcnt lgkmcnt(0)
    s_waitcnt vmcnt(25)
    s_barrier
    s_and_b32 s67, s24, 3
    s_cmp_eq_u32 s67, 1
    s_cbranch_scc1 R3_th6
    s_waitcnt vmcnt(4)
R3_th6:
    s_mov_b32 m0, 126976
    s_mov_b32 s67, 2621440
    buffer_load_dwordx4 v24, s[8:11], s67 offen lds
    s_mov_b32 m0, 128000
    s_mov_b32 s67, 2654208
    buffer_load_dwordx4 v15, s[8:11], s67 offen lds
    s_mov_b32 m0, 129024
    s_mov_b32 s67, 2686976
    buffer_load_dwordx4 v24, s[8:11], s67 offen lds
    s_mov_b32 m0, 130048
    s_mov_b32 s67, 2719744
    buffer_load_dwordx4 v15, s[8:11], s67 offen lds
    v_add_u32 v28, 131072, v26
    v_xor_b32 v29, 32, v28
    ds_read_b64_tr_b16 a[96:97], v28 offset:0
    ds_read_b64_tr_b16 a[98:99], v28 offset:512
    ds_read_b64_tr_b16 a[100:101], v28 offset:8192
    ds_read_b64_tr_b16 a[102:103], v28 offset:8704
    ds_read_b64_tr_b16 a[144:145], v29 offset:0
    ds_read_b64_tr_b16 a[146:147], v29 offset:512
    ds_read_b64_tr_b16 a[148:149], v29 offset:8192
    ds_read_b64_tr_b16 a[150:151], v29 offset:8704
    s_waitcnt lgkmcnt(0)
    s_waitcnt vmcnt(25)
    s_barrier
    s_and_b32 s67, s24, 3
    s_cmp_eq_u32 s67, 1
    s_cbranch_scc1 R3_th7
    s_waitcnt vmcnt(4)
R3_th7:
    s_mov_b32 m0, 143360
    s_mov_b32 s67, 786432
    buffer_load_dwordx4 v24, s[8:11], s67 offen lds
    s_mov_b32 m0, 144384
    s_mov_b32 s67, 819200
    buffer_load_dwordx4 v15, s[8:11], s67 offen lds
    s_mov_b32 m0, 145408
    s_mov_b32 s67, 851968
    buffer_load_dwordx4 v24, s[8:11], s67 offen lds
    s_mov_b32 m0, 146432
    s_mov_b32 s67, 884736
    buffer_load_dwordx4 v15, s[8:11], s67 offen lds
    v_add_u32 v28, 147456, v26
    v_xor_b32 v29, 32, v28
    ds_read_b64_tr_b16 a[104:105], v28 offset:0
    ds_read_b64_tr_b16 a[106:107], v28 offset:512
    ds_read_b64_tr_b16 a[108:109], v28 offset:8192
    ds_read_b64_tr_b16 a[110:111], v28 offset:8704
    ds_read_b64_tr_b16 a[152:153], v29 offset:0
    ds_read_b64_tr_b16 a[154:155], v29 offset:512
    ds_read_b64_tr_b16 a[156:157], v29 offset:8192
    ds_read_b64_tr_b16 a[158:159], v29 offset:8704
    s_waitcnt lgkmcnt(0)
    s_waitcnt vmcnt(24)
    s_barrier
    s_and_b32 s67, s24, 3
    s_cmp_eq_u32 s67, 1
    s_cbranch_scc1 R3_th8
    s_waitcnt vmcnt(4)
R3_th8:
    s_mov_b32 m0, 159744
    s_mov_b32 s67, 2883584
    buffer_load_dwordx4 v24, s[8:11], s67 offen lds
    s_mov_b32 m0, 160768
    s_mov_b32 s67, 2916352
    buffer_load_dwordx4 v15, s[8:11], s67 offen lds
    s_mov_b32 m0, 161792
    s_mov_b32 s67, 2949120
    buffer_load_dwordx4 v24, s[8:11], s67 offen lds
    s_mov_b32 m0, 162816
    s_mov_b32 s67, 2981888
    buffer_load_dwordx4 v15, s[8:11], s67 offen lds
    v_add_u32 v28, 32768, v26
    v_xor_b32 v29, 32, v28
    ds_read_b64_tr_b16 a[240:241], v28 offset:0
    ds_read_b64_tr_b16 a[242:243], v28 offset:512
    ds_read_b64_tr_b16 a[244:245], v28 offset:8192
    ds_read_b64_tr_b16 a[246:247], v28 offset:8704
    ds_read_b64_tr_b16 a[248:249], v29 offset:0
    ds_read_b64_tr_b16 a[250:251], v29 offset:512
    ds_read_b64_tr_b16 a[252:253], v29 offset:8192
    ds_read_b64_tr_b16 a[254:255], v29 offset:8704
    s_waitcnt lgkmcnt(0)
    s_waitcnt vmcnt(24)
    s_barrier
    s_and_b32 s67, s24, 3
    s_cmp_eq_u32 s67, 1
    s_cbranch_scc1 R3_th9
    s_waitcnt vmcnt(4)
R3_th9:
    s_mov_b32 m0, 45056
    s_mov_b32 s67, 0
    buffer_load_dwordx4 v24, s[12:15], s67 offen lds
    s_mov_b32 m0, 46080
    s_mov_b32 s67, 32768
    buffer_load_dwordx4 v15, s[12:15], s67 offen lds
    s_mov_b32 m0, 47104
    s_mov_b32 s67, 65536
    buffer_load_dwordx4 v24, s[12:15], s67 offen lds
    s_mov_b32 m0, 48128
    s_mov_b32 s67, 98304
    buffer_load_dwordx4 v15, s[12:15], s67 offen lds
    v_add_u32 v28, 49152, v26
    v_xor_b32 v29, 32, v28
    ds_read_b64_tr_b16 a[192:193], v28 offset:0
    ds_read_b64_tr_b16 a[194:195], v28 offset:512
    ds_read_b64_tr_b16 a[196:197], v28 offset:8192
    ds_read_b64_tr_b16 a[198:199], v28 offset:8704
    ds_read_b64_tr_b16 a[200:201], v29 offset:0
    ds_read_b64_tr_b16 a[202:203], v29 offset:512
    ds_read_b64_tr_b16 a[204:205], v29 offset:8192
    ds_read_b64_tr_b16 a[206:207], v29 offset:8704
    s_waitcnt lgkmcnt(0)
    s_waitcnt vmcnt(24)
    s_barrier
    s_and_b32 s67, s24, 3
    s_cmp_eq_u32 s67, 1
    s_cbranch_scc1 R3_th10
    s_waitcnt vmcnt(4)
R3_th10:
    s_mov_b32 m0, 61440
    s_mov_b32 s67, 2097152
    buffer_load_dwordx4 v24, s[12:15], s67 offen lds
    s_mov_b32 m0, 62464
    s_mov_b32 s67, 2129920
    buffer_load_dwordx4 v15, s[12:15], s67 offen lds
    s_mov_b32 m0, 63488
    s_mov_b32 s67, 2162688
    buffer_load_dwordx4 v24, s[12:15], s67 offen lds
    s_mov_b32 m0, 64512
    s_mov_b32 s67, 2195456
    buffer_load_dwordx4 v15, s[12:15], s67 offen lds
    v_add_u32 v28, 65536, v26
    v_xor_b32 v29, 32, v28
    ds_read_b64_tr_b16 a[208:209], v28 offset:0
    ds_read_b64_tr_b16 a[210:211], v28 offset:512
    ds_read_b64_tr_b16 a[212:213], v28 offset:8192
    ds_read_b64_tr_b16 a[214:215], v28 offset:8704
    ds_read_b64_tr_b16 a[216:217], v29 offset:0
    ds_read_b64_tr_b16 a[218:219], v29 offset:512
    ds_read_b64_tr_b16 a[220:221], v29 offset:8192
    ds_read_b64_tr_b16 a[222:223], v29 offset:8704
    s_waitcnt lgkmcnt(0)
    s_waitcnt vmcnt(24)
    s_barrier
    s_and_b32 s67, s24, 3
    s_cmp_eq_u32 s67, 1
    s_cbranch_scc1 R3_th11
    s_waitcnt vmcnt(4)
R3_th11:
    s_mov_b32 m0, 77824
    s_mov_b32 s67, 262144
    buffer_load_dwordx4 v24, s[12:15], s67 offen lds
    s_mov_b32 m0, 78848
    s_mov_b32 s67, 294912
    buffer_load_dwordx4 v15, s[12:15], s67 offen lds
    s_mov_b32 m0, 79872
    s_mov_b32 s67, 327680
    buffer_load_dwordx4 v24, s[12:15], s67 offen lds
    s_mov_b32 m0, 80896
    s_mov_b32 s67, 360448
    buffer_load_dwordx4 v15, s[12:15], s67 offen lds
    v_add_u32 v28, 81920, v26
    v_xor_b32 v29, 32, v28
    ds_read_b64_tr_b16 a[224:225], v28 offset:0
    ds_read_b64_tr_b16 a[226:227], v28 offset:512
    ds_read_b64_tr_b16 a[228:229], v28 offset:8192
    ds_read_b64_tr_b16 a[230:231], v28 offset:8704
    ds_read_b64_tr_b16 a[232:233], v29 offset:0
    ds_read_b64_tr_b16 a[234:235], v29 offset:512
    ds_read_b64_tr_b16 a[236:237], v29 offset:8192
    ds_read_b64_tr_b16 a[238:239], v29 offset:8704
    s_waitcnt lgkmcnt(0)
    s_waitcnt vmcnt(24)
    s_barrier
    s_and_b32 s67, s24, 3
    s_cmp_eq_u32 s67, 1
    s_cbranch_scc1 R3_th12
    s_waitcnt vmcnt(4)
R3_th12:
    s_mov_b32 m0, 94208
    s_mov_b32 s67, 2359296
    buffer_load_dwordx4 v24, s[12:15], s67 offen lds
    s_mov_b32 m0, 95232
    s_mov_b32 s67, 2392064
    buffer_load_dwordx4 v15, s[12:15], s67 offen lds
    s_mov_b32 m0, 96256
    s_mov_b32 s67, 2424832
    buffer_load_dwordx4 v24, s[12:15], s67 offen lds
    s_mov_b32 m0, 97280
    s_mov_b32 s67, 2457600
    buffer_load_dwordx4 v15, s[12:15], s67 offen lds
    v_mov_b32 v16, 136
    global_load_dword v11, v16, s[60:61] sc1
    global_load_dword v14, v16, s[60:61] offset:-136 sc1
    v_add_u32 v28, 98304, v26
    v_xor_b32 v29, 32, v28
    ds_read_b64_tr_b16 v[176:177], v28 offset:0
    ds_read_b64_tr_b16 v[178:179], v28 offset:512
    ds_read_b64_tr_b16 v[180:181], v28 offset:8192
    ds_read_b64_tr_b16 v[182:183], v28 offset:8704
    ds_read_b64_tr_b16 v[184:185], v29 offset:0
    ds_read_b64_tr_b16 v[186:187], v29 offset:512
    ds_read_b64_tr_b16 v[188:189], v29 offset:8192
    ds_read_b64_tr_b16 v[190:191], v29 offset:8704
    s_waitcnt lgkmcnt(0)
    s_waitcnt vmcnt(26)
    s_barrier
    s_and_b32 s67, s24, 3
    s_cmp_eq_u32 s67, 1
    s_cbranch_scc1 R3_th13
    s_waitcnt vmcnt(4)
R3_th13:
    s_mov_b32 m0, 110592
    s_mov_b32 s67, 524288
    buffer_load_dwordx4 v24, s[12:15], s67 offen lds
    s_mov_b32 m0, 111616
    s_mov_b32 s67, 557056
    buffer_load_dwordx4 v15, s[12:15], s67 offen lds
    s_mov_b32 m0, 112640
    s_mov_b32 s67, 589824
    buffer_load_dwordx4 v24, s[12:15], s67 offen lds
    s_mov_b32 m0, 113664
    s_mov_b32 s67, 622592
    buffer_load_dwordx4 v15, s[12:15], s67 offen lds
    v_add_u32 v28, 114688, v26
    v_xor_b32 v29, 32, v28
    ds_read_b64_tr_b16 v[128:129], v28 offset:0
    ds_read_b64_tr_b16 v[130:131], v28 offset:512
    ds_read_b64_tr_b16 v[132:133], v28 offset:8192
    ds_read_b64_tr_b16 v[134:135], v28 offset:8704
    ds_read_b64_tr_b16 v[136:137], v29 offset:0
    ds_read_b64_tr_b16 v[138:139], v29 offset:512
    ds_read_b64_tr_b16 v[140:141], v29 offset:8192
    ds_read_b64_tr_b16 v[142:143], v29 offset:8704
    s_waitcnt lgkmcnt(0)
    s_waitcnt vmcnt(26)
    s_barrier
    s_and_b32 s67, s24, 3
    s_cmp_eq_u32 s67, 1
    s_cbranch_scc1 R3_th14
    s_waitcnt vmcnt(4)
R3_th14:
    s_mov_b32 m0, 126976
    s_mov_b32 s67, 2621440
    buffer_load_dwordx4 v24, s[12:15], s67 offen lds
    s_mov_b32 m0, 128000
    s_mov_b32 s67, 2654208
    buffer_load_dwordx4 v15, s[12:15], s67 offen lds
    s_mov_b32 m0, 129024
    s_mov_b32 s67, 2686976
    buffer_load_dwordx4 v24, s[12:15], s67 offen lds
    s_mov_b32 m0, 130048
    s_mov_b32 s67, 2719744
    buffer_load_dwordx4 v15, s[12:15], s67 offen lds
    v_add_u32 v28, 131072, v26
    v_xor_b32 v29, 32, v28
    ds_read_b64_tr_b16 v[144:145], v28 offset:0
    ds_read_b64_tr_b16 v[146:147], v28 offset:512
    ds_read_b64_tr_b16 v[148:149], v28 offset:8192
    ds_read_b64_tr_b16 v[150:151], v28 offset:8704
    ds_read_b64_tr_b16 v[152:153], v29 offset:0
    ds_read_b64_tr_b16 v[154:155], v29 offset:512
    ds_read_b64_tr_b16 v[156:157], v29 offset:8192
    ds_read_b64_tr_b16 v[158:159], v29 offset:8704
    s_waitcnt lgkmcnt(0)
    s_waitcnt vmcnt(26)
    s_barrier
    s_and_b32 s67, s24, 3
    s_cmp_eq_u32 s67, 1
    s_cbranch_scc1 R3_th15
    s_waitcnt vmcnt(4)
R3_th15:
    s_mov_b32 m0, 143360
    s_mov_b32 s67, 786432
    buffer_load_dwordx4 v24, s[12:15], s67 offen lds
    s_mov_b32 m0, 144384
    s_mov_b32 s67, 819200
    buffer_load_dwordx4 v15, s[12:15], s67 offen lds
    s_mov_b32 m0, 145408
    s_mov_b32 s67, 851968
    buffer_load_dwordx4 v24, s[12:15], s67 offen lds
    s_mov_b32 m0, 146432
    s_mov_b32 s67, 884736
    buffer_load_dwordx4 v15, s[12:15], s67 offen lds
    v_add_u32 v28, 147456, v26
    v_xor_b32 v29, 32, v28
    ds_read_b64_tr_b16 v[160:161], v28 offset:0
    ds_read_b64_tr_b16 v[162:163], v28 offset:512
    ds_read_b64_tr_b16 v[164:165], v28 offset:8192
    ds_read_b64_tr_b16 v[166:167], v28 offset:8704
    ds_read_b64_tr_b16 v[168:169], v29 offset:0
    ds_read_b64_tr_b16 v[170:171], v29 offset:512
    ds_read_b64_tr_b16 v[172:173], v29 offset:8192
    ds_read_b64_tr_b16 v[174:175], v29 offset:8704
    s_waitcnt lgkmcnt(0)
    s_waitcnt vmcnt(26)
    s_barrier
    s_and_b32 s67, s24, 3
    s_cmp_eq_u32 s67, 1
    s_cbranch_scc1 R3_th16
    s_waitcnt vmcnt(4)
R3_th16:
    s_mov_b32 m0, 159744
    s_mov_b32 s67, 2883584
    buffer_load_dwordx4 v24, s[12:15], s67 offen lds
    s_mov_b32 m0, 160768
    s_mov_b32 s67, 2916352
    buffer_load_dwordx4 v15, s[12:15], s67 offen lds
    s_mov_b32 m0, 161792
    s_mov_b32 s67, 2949120
    buffer_load_dwordx4 v24, s[12:15], s67 offen lds
    s_mov_b32 m0, 162816
    s_mov_b32 s67, 2981888
    buffer_load_dwordx4 v15, s[12:15], s67 offen lds
    v_add_u32 v28, 32768, v26
    v_xor_b32 v29, 32, v28
    ds_read_b64_tr_b16 a[64:65], v28 offset:0
    ds_read_b64_tr_b16 a[66:67], v28 offset:512
    ds_read_b64_tr_b16 a[68:69], v28 offset:8192
    ds_read_b64_tr_b16 a[70:71], v28 offset:8704
    ds_read_b64_tr_b16 a[72:73], v29 offset:0
    ds_read_b64_tr_b16 a[74:75], v29 offset:512
    ds_read_b64_tr_b16 a[76:77], v29 offset:8192
    ds_read_b64_tr_b16 a[78:79], v29 offset:8704
    s_waitcnt lgkmcnt(0)
    s_waitcnt vmcnt(26)
    s_barrier
    s_and_b32 s67, s24, 3
    s_cmp_eq_u32 s67, 1
    s_cbranch_scc1 R3_th17
    s_waitcnt vmcnt(4)
R3_th17:
    s_mov_b32 m0, 45056
    s_mov_b32 s67, 0
    buffer_load_dwordx4 v25, s[20:23], s67 offen lds
    s_mov_b32 m0, 46080
    s_mov_b32 s67, 4096
    buffer_load_dwordx4 v25, s[20:23], s67 offen lds
    s_mov_b32 m0, 47104
    s_mov_b32 s67, 8192
    buffer_load_dwordx4 v25, s[20:23], s67 offen lds
    s_mov_b32 m0, 48128
    s_mov_b32 s67, 12288
    buffer_load_dwordx4 v25, s[20:23], s67 offen lds
    v_add_u32 v28, 49152, v26
    v_xor_b32 v29, 32, v28
    ds_read_b64_tr_b16 v[80:81], v28 offset:0
    ds_read_b64_tr_b16 v[82:83], v28 offset:512
    ds_read_b64_tr_b16 v[84:85], v28 offset:8192
    ds_read_b64_tr_b16 v[86:87], v28 offset:8704
    ds_read_b64_tr_b16 v[88:89], v29 offset:0
    ds_read_b64_tr_b16 v[90:91], v29 offset:512
    ds_read_b64_tr_b16 v[92:93], v29 offset:8192
    ds_read_b64_tr_b16 v[94:95], v29 offset:8704
    s_waitcnt lgkmcnt(0)
    s_waitcnt vmcnt(26)
    s_barrier
    s_and_b32 s67, s24, 3
    s_cmp_eq_u32 s67, 1
    s_cbranch_scc1 R3_th18
    s_waitcnt vmcnt(4)
R3_th18:
    s_mov_b32 m0, 61440
    s_mov_b32 s67, 16384
    buffer_load_dwordx4 v30, s[20:23], s67 offen lds
    s_mov_b32 m0, 62464
    s_mov_b32 s67, 20480
    buffer_load_dwordx4 v30, s[20:23], s67 offen lds
    s_mov_b32 m0, 63488
    s_mov_b32 s67, 24576
    buffer_load_dwordx4 v30, s[20:23], s67 offen lds
    s_mov_b32 m0, 64512
    s_mov_b32 s67, 28672
    buffer_load_dwordx4 v30, s[20:23], s67 offen lds
    v_add_u32 v28, 65536, v26
    v_xor_b32 v29, 32, v28
    ds_read_b64_tr_b16 a[8:9], v28 offset:0
    ds_read_b64_tr_b16 a[10:11], v28 offset:512
    ds_read_b64_tr_b16 a[12:13], v28 offset:8192
    ds_read_b64_tr_b16 a[14:15], v28 offset:8704
    ds_read_b64_tr_b16 a[24:25], v29 offset:0
    ds_read_b64_tr_b16 a[26:27], v29 offset:512
    ds_read_b64_tr_b16 a[28:29], v29 offset:8192
    ds_read_b64_tr_b16 a[30:31], v29 offset:8704
    s_waitcnt lgkmcnt(0)
    s_waitcnt vmcnt(26)
    s_barrier
    s_and_b32 s67, s24, 3
    s_cmp_eq_u32 s67, 1
    s_cbranch_scc1 R3_th19
    s_waitcnt vmcnt(4)
R3_th19:
    s_mov_b32 m0, 77824
    s_mov_b32 s67, 32768
    buffer_load_dwordx4 v25, s[20:23], s67 offen lds
    s_mov_b32 m0, 78848
    s_mov_b32 s67, 36864
    buffer_load_dwordx4 v25, s[20:23], s67 offen lds
    s_mov_b32 m0, 79872
    s_mov_b32 s67, 40960
    buffer_load_dwordx4 v25, s[20:23], s67 offen lds
    s_mov_b32 m0, 80896
    s_mov_b32 s67, 45056
    buffer_load_dwordx4 v25, s[20:23], s67 offen lds
    v_add_u32 v28, 81920, v26
    v_xor_b32 v29, 32, v28
    ds_read_b64_tr_b16 a[40:41], v28 offset:0
    ds_read_b64_tr_b16 a[42:43], v28 offset:512
    ds_read_b64_tr_b16 a[44:45], v28 offset:8192
    ds_read_b64_tr_b16 a[46:47], v28 offset:8704
    ds_read_b64_tr_b16 a[56:57], v29 offset:0
    ds_read_b64_tr_b16 a[58:59], v29 offset:512
    ds_read_b64_tr_b16 a[60:61], v29 offset:8192
    ds_read_b64_tr_b16 a[62:63], v29 offset:8704
    s_waitcnt lgkmcnt(0)
    s_waitcnt vmcnt(24)
    s_barrier
    s_and_b32 s67, s24, 3
    s_cmp_eq_u32 s67, 1
    s_cbranch_scc1 R3_th20
    s_waitcnt vmcnt(4)
R3_th20:
    s_mov_b32 m0, 94208
    s_mov_b32 s67, 49152
    buffer_load_dwordx4 v30, s[20:23], s67 offen lds
    s_mov_b32 m0, 95232
    s_mov_b32 s67, 53248
    buffer_load_dwordx4 v30, s[20:23], s67 offen lds
    s_mov_b32 m0, 96256
    s_mov_b32 s67, 57344
    buffer_load_dwordx4 v30, s[20:23], s67 offen lds
    s_mov_b32 m0, 97280
    s_mov_b32 s67, 61440
    buffer_load_dwordx4 v30, s[20:23], s67 offen lds
    v_cmp_eq_u32 vcc, 0, v11
    s_cbranch_vccnz R3_reg
R3_regok:
    s_mov_b32 s79, 0
    v_cmp_gt_u32 vcc, 32, v14
    s_cbranch_vccnz R3_md
R3_mdok:
    s_getpc_b64 s[80:81]
R3_pc20:
    v_lshlrev_b32 v20, 3, v0
    v_add_u32 v20, 2048, v20
    v_min_u32 v20, L_LAST-R3_pc20, v20
    global_load_dword v21, v20, s[80:81]
    v_add_u32 v28, 98304, v26
    v_xor_b32 v29, 32, v28
    ds_read_b64_tr_b16 a[136:137], v28 offset:0
    ds_read_b64_tr_b16 a[138:139], v28 offset:512
    ds_read_b64_tr_b16 a[140:141], v28 offset:8192
    ds_read_b64_tr_b16 a[142:143], v28 offset:8704
    ds_read_b64_tr_b16 a[184:185], v29 offset:0
    ds_read_b64_tr_b16 a[186:187], v29 offset:512
    ds_read_b64_tr_b16 a[188:189], v29 offset:8192
    ds_read_b64_tr_b16 a[190:191], v29 offset:8704
    s_waitcnt lgkmcnt(0)
    s_waitcnt vmcnt(25)
    s_barrier
    s_and_b32 s67, s24, 3
    s_cmp_eq_u32 s67, 1
    s_cbranch_scc1 R3_th21
    s_waitcnt vmcnt(4)
R3_th21:
    s_mov_b32 m0, 110592
    s_mov_b32 s67, 65536
    buffer_load_dwordx4 v25, s[20:23], s67 offen lds
    s_mov_b32 m0, 111616
    s_mov_b32 s67, 69632
    buffer_load_dwordx4 v25, s[20:23], s67 offen lds
    s_mov_b32 m0, 112640
    s_mov_b32 s67, 73728
    buffer_load_dwordx4 v25, s[20:23], s67 offen lds
    s_mov_b32 m0, 113664
    s_mov_b32 s67, 77824
    buffer_load_dwordx4 v25, s[20:23], s67 offen lds
    buffer_load_dword v17, off, s[4:7], s33 offset:16 sc1
    buffer_load_dword v16, off, s[4:7], s33 sc1
    v_add_u32 v28, 114688, v26
    v_xor_b32 v29, 32, v28
    ds_read_b64_tr_b16 a[80:81], v28 offset:0
    ds_read_b64_tr_b16 a[82:83], v28 offset:512
    ds_read_b64_tr_b16 a[84:85], v28 offset:8192
    ds_read_b64_tr_b16 a[86:87], v28 offset:8704
    ds_read_b64_tr_b16 a[88:89], v29 offset:0
    ds_read_b64_tr_b16 a[90:91], v29 offset:512
    ds_read_b64_tr_b16 a[92:93], v29 offset:8192
    ds_read_b64_tr_b16 a[94:95], v29 offset:8704
    s_waitcnt lgkmcnt(0)
    s_waitcnt vmcnt(27)
    s_barrier
    s_and_b32 s67, s24, 3
    s_cmp_eq_u32 s67, 1
    s_cbranch_scc1 R3_th22
    s_waitcnt vmcnt(4)
R3_th22:
    s_mov_b32 m0, 126976
    s_mov_b32 s67, 81920
    buffer_load_dwordx4 v30, s[20:23], s67 offen lds
    s_mov_b32 m0, 128000
    s_mov_b32 s67, 86016
    buffer_load_dwordx4 v30, s[20:23], s67 offen lds
    s_mov_b32 m0, 129024
    s_mov_b32 s67, 90112
    buffer_load_dwordx4 v30, s[20:23], s67 offen lds
    s_mov_b32 m0, 130048
    s_mov_b32 s67, 94208
    buffer_load_dwordx4 v30, s[20:23], s67 offen lds
    v_add_u32 v28, 131072, v26
    v_xor_b32 v29, 32, v28
    ds_read_b64_tr_b16 a[120:121], v28 offset:0
    ds_read_b64_tr_b16 a[122:123], v28 offset:512
    ds_read_b64_tr_b16 a[124:125], v28 offset:8192
    ds_read_b64_tr_b16 a[126:127], v28 offset:8704
    ds_read_b64_tr_b16 a[168:169], v29 offset:0
    ds_read_b64_tr_b16 a[170:171], v29 offset:512
    ds_read_b64_tr_b16 a[172:173], v29 offset:8192
    ds_read_b64_tr_b16 a[174:175], v29 offset:8704
    s_waitcnt lgkmcnt(0)
    s_waitcnt vmcnt(27)
    s_barrier
    s_and_b32 s67, s24, 3
    s_cmp_eq_u32 s67, 1
    s_cbranch_scc1 R3_th23
    s_waitcnt vmcnt(4)
R3_th23:
    s_mov_b32 m0, 143360
    s_mov_b32 s67, 98304
    buffer_load_dwordx4 v25, s[20:23], s67 offen lds
    s_mov_b32 m0, 144384
    s_mov_b32 s67, 102400
    buffer_load_dwordx4 v25, s[20:23], s67 offen lds
    s_mov_b32 m0, 145408
    s_mov_b32 s67, 106496
    buffer_load_dwordx4 v25, s[20:23], s67 offen lds
    s_mov_b32 m0, 146432
    s_mov_b32 s67, 110592
    buffer_load_dwordx4 v25, s[20:23], s67 offen lds
    v_add_u32 v28, 147456, v26
    v_xor_b32 v29, 32, v28
    ds_read_b64_tr_b16 a[128:129], v28 offset:0
    ds_read_b64_tr_b16 a[130:131], v28 offset:512
    ds_read_b64_tr_b16 a[132:133], v28 offset:8192
    ds_read_b64_tr_b16 a[134:135], v28 offset:8704
    ds_read_b64_tr_b16 a[176:177], v29 offset:0
    ds_read_b64_tr_b16 a[178:179], v29 offset:512
    ds_read_b64_tr_b16 a[180:181], v29 offset:8192
    ds_read_b64_tr_b16 a[182:183], v29 offset:8704
    s_waitcnt lgkmcnt(0)
    s_barrier
    s_mov_b32 m0, 159744
    s_mov_b32 s67, 114688
    buffer_load_dwordx4 v30, s[20:23], s67 offen lds
    s_mov_b32 m0, 160768
    s_mov_b32 s67, 118784
    buffer_load_dwordx4 v30, s[20:23], s67 offen lds
    s_mov_b32 m0, 161792
    s_mov_b32 s67, 122880
    buffer_load_dwordx4 v30, s[20:23], s67 offen lds
    s_mov_b32 m0, 162816
    s_mov_b32 s67, 126976
    buffer_load_dwordx4 v30, s[20:23], s67 offen lds
    v_min_u32 v18, -2, v18
    s_cmp_lg_u32 s79, 0
    s_cbranch_scc1 R3_p0
    buffer_store_dword v18, v5, s[4:7], s27 offen
R3_p0ok:
    s_add_u32 s67, s27, 0x2000
    buffer_load_dword v15, v5, s[4:7], s27 offen sc1
    buffer_load_dword v15, v5, s[4:7], s67 offen sc1
    s_add_u32 s67, s27, 0x4000
    buffer_load_dword v15, v5, s[4:7], s67 offen sc1
    s_add_u32 s67, s27, 0x6000
    buffer_load_dword v15, v5, s[4:7], s67 offen sc1
    buffer_load_dword v15, v5, s[4:7], s32 offen sc1
    s_waitcnt vmcnt(33)
    v_xor_b32 v28, 0, v31
    v_add_u32 v28, 32768, v28
    ds_read_b64_tr_b16 v[192:193], v28 offset:0
    ds_read_b64_tr_b16 v[194:195], v28 offset:512
    ds_read_b64_tr_b16 v[196:197], v28 offset:2048
    ds_read_b64_tr_b16 v[198:199], v28 offset:2560
    v_xor_b32 v28, 64, v31
    v_add_u32 v28, 32768, v28
    ds_read_b64_tr_b16 v[216:217], v28 offset:0
    ds_read_b64_tr_b16 v[218:219], v28 offset:512
    ds_read_b64_tr_b16 v[220:221], v28 offset:2048
    ds_read_b64_tr_b16 v[222:223], v28 offset:2560
    v_xor_b32 v28, 128, v31
    v_add_u32 v28, 32768, v28
    ds_read_b64_tr_b16 v[240:241], v28 offset:0
    ds_read_b64_tr_b16 v[242:243], v28 offset:512
    ds_read_b64_tr_b16 v[244:245], v28 offset:2048
    ds_read_b64_tr_b16 v[246:247], v28 offset:2560
    v_xor_b32 v28, 192, v31
    v_add_u32 v28, 32768, v28
    ds_read_b64_tr_b16 v[96:97], v28 offset:0
    ds_read_b64_tr_b16 v[98:99], v28 offset:512
    ds_read_b64_tr_b16 v[100:101], v28 offset:2048
    ds_read_b64_tr_b16 v[102:103], v28 offset:2560
    s_waitcnt lgkmcnt(0)
    ds_write_b128 v0, v[32:35] offset:45056
    ds_write_b128 v0, v[36:39] offset:46080
    ds_write_b128 v0, v[40:43] offset:47104
    ds_write_b128 v0, v[44:47] offset:48128
    ds_write_b128 v0, v[48:51] offset:61440
    ds_write_b128 v0, v[52:55] offset:62464
    ds_write_b128 v0, v[56:59] offset:63488
    ds_write_b128 v0, v[60:63] offset:64512
    s_waitcnt lgkmcnt(0)
    s_waitcnt vmcnt(25)
    v_xor_b32 v28, 0, v31
    v_add_u32 v28, 65536, v28
    ds_read_b64_tr_b16 v[200:201], v28 offset:0
    ds_read_b64_tr_b16 v[202:203], v28 offset:512
    ds_read_b64_tr_b16 v[204:205], v28 offset:2048
    ds_read_b64_tr_b16 v[206:207], v28 offset:2560
    v_xor_b32 v28, 64, v31
    v_add_u32 v28, 65536, v28
    ds_read_b64_tr_b16 v[224:225], v28 offset:0
    ds_read_b64_tr_b16 v[226:227], v28 offset:512
    ds_read_b64_tr_b16 v[228:229], v28 offset:2048
    ds_read_b64_tr_b16 v[230:231], v28 offset:2560
    v_xor_b32 v28, 128, v31
    v_add_u32 v28, 65536, v28
    ds_read_b64_tr_b16 v[248:249], v28 offset:0
    ds_read_b64_tr_b16 v[250:251], v28 offset:512
    ds_read_b64_tr_b16 v[252:253], v28 offset:2048
    ds_read_b64_tr_b16 v[254:255], v28 offset:2560
    v_xor_b32 v28, 192, v31
    v_add_u32 v28, 65536, v28
    ds_read_b64_tr_b16 v[104:105], v28 offset:0
    ds_read_b64_tr_b16 v[106:107], v28 offset:512
    ds_read_b64_tr_b16 v[108:109], v28 offset:2048
    ds_read_b64_tr_b16 v[110:111], v28 offset:2560
    s_waitcnt lgkmcnt(0)
    ds_write_b128 v1, v[64:67] offset:12288
    ds_write_b128 v1, v[68:71] offset:13312
    ds_write_b128 v1, v[72:75] offset:14336
    ds_write_b128 v1, v[76:79] offset:15360
    ds_write_b128 v1, v[80:83] offset:28672
    ds_write_b128 v1, v[84:87] offset:29696
    ds_write_b128 v1, v[88:91] offset:30720
    ds_write_b128 v1, v[92:95] offset:31744
    s_waitcnt lgkmcnt(0)
    s_waitcnt vmcnt(14)
    v_cmp_eq_u32 vcc, 0, v16
    s_cbranch_vccnz R3_kv0
R3_kv0ok:
    s_add_u32 s33, s33, 16
    s_add_u32 s70, s31, 0x2000
    s_mov_b32 m0, s66
    v_mov_b32 v11, v17
    buffer_load_dwordx4 v0, s[4:7], s31 offen sc1 lds
    buffer_load_dwordx4 v0, s[4:7], s31 offen offset:1024 sc1 lds
    buffer_load_dwordx4 v[20:23], v0, s[4:7], s70 offen sc1
    buffer_load_dwordx4 v[24:27], v0, s[4:7], s70 offen offset:1024 sc1
    s_add_u32 s31, s31, 0x4000
    s_add_u32 s70, s31, 0x2000
    s_xor_b32 s66, s66, 0x2000
    s_xor_b32 s67, s30, 0x40000
    buffer_load_dword v15, v10, s[4:7], s67 offen sc1
    buffer_load_dword v15, v10, s[4:7], s67 offen offset:2048 sc1
    buffer_load_dword v15, v10, s[4:7], s30 offen sc1
    buffer_load_dword v15, v10, s[4:7], s30 offen offset:2048 sc1
    v_xor_b32 v28, 0, v31
    v_add_u32 v28, 98304, v28
    ds_read_b64_tr_b16 v[208:209], v28 offset:0
    ds_read_b64_tr_b16 v[210:211], v28 offset:512
    ds_read_b64_tr_b16 v[212:213], v28 offset:2048
    ds_read_b64_tr_b16 v[214:215], v28 offset:2560
    v_xor_b32 v28, 64, v31
    v_add_u32 v28, 98304, v28
    ds_read_b64_tr_b16 v[232:233], v28 offset:0
    ds_read_b64_tr_b16 v[234:235], v28 offset:512
    ds_read_b64_tr_b16 v[236:237], v28 offset:2048
    ds_read_b64_tr_b16 v[238:239], v28 offset:2560
    v_xor_b32 v28, 128, v31
    v_add_u32 v28, 98304, v28
    ds_read_b64_tr_b16 v[112:113], v28 offset:0
    ds_read_b64_tr_b16 v[114:115], v28 offset:512
    ds_read_b64_tr_b16 v[116:117], v28 offset:2048
    ds_read_b64_tr_b16 v[118:119], v28 offset:2560
    v_xor_b32 v28, 192, v31
    v_add_u32 v28, 98304, v28
    ds_read_b64_tr_b16 v[120:121], v28 offset:0
    ds_read_b64_tr_b16 v[122:123], v28 offset:512
    ds_read_b64_tr_b16 v[124:125], v28 offset:2048
    ds_read_b64_tr_b16 v[126:127], v28 offset:2560
    s_waitcnt lgkmcnt(0)
    ds_write_b128 v1, v[96:99] offset:45056
    ds_write_b128 v1, v[100:103] offset:46080
    ds_write_b128 v1, v[104:107] offset:47104
    ds_write_b128 v1, v[108:111] offset:48128
    ds_write_b128 v1, v[112:115] offset:61440
    ds_write_b128 v1, v[116:119] offset:62464
    ds_write_b128 v1, v[120:123] offset:63488
    ds_write_b128 v1, v[124:127] offset:64512
    s_waitcnt lgkmcnt(0)
    s_waitcnt vmcnt(14)
    v_xor_b32 v28, 0, v31
    v_add_u32 v28, 131072, v28
    ds_read_b64_tr_b16 v[32:33], v28 offset:0
    ds_read_b64_tr_b16 v[34:35], v28 offset:512
    ds_read_b64_tr_b16 v[36:37], v28 offset:2048
    ds_read_b64_tr_b16 v[38:39], v28 offset:2560
    v_xor_b32 v28, 64, v31
    v_add_u32 v28, 131072, v28
    ds_read_b64_tr_b16 v[40:41], v28 offset:0
    ds_read_b64_tr_b16 v[42:43], v28 offset:512
    ds_read_b64_tr_b16 v[44:45], v28 offset:2048
    ds_read_b64_tr_b16 v[46:47], v28 offset:2560
    v_xor_b32 v28, 128, v31
    v_add_u32 v28, 131072, v28
    ds_read_b64_tr_b16 v[48:49], v28 offset:0
    ds_read_b64_tr_b16 v[50:51], v28 offset:512
    ds_read_b64_tr_b16 v[52:53], v28 offset:2048
    ds_read_b64_tr_b16 v[54:55], v28 offset:2560
    v_xor_b32 v28, 192, v31
    v_add_u32 v28, 131072, v28
    ds_read_b64_tr_b16 v[56:57], v28 offset:0
    ds_read_b64_tr_b16 v[58:59], v28 offset:512
    ds_read_b64_tr_b16 v[60:61], v28 offset:2048
    ds_read_b64_tr_b16 v[62:63], v28 offset:2560
    s_waitcnt lgkmcnt(0)
    ds_write_b128 v2, v[32:35] offset:12288
    ds_write_b128 v2, v[36:39] offset:13312
    ds_write_b128 v2, v[40:43] offset:14336
    ds_write_b128 v2, v[44:47] offset:15360
    ds_write_b128 v2, v[48:51] offset:28672
    ds_write_b128 v2, v[52:55] offset:29696
    ds_write_b128 v2, v[56:59] offset:30720
    ds_write_b128 v2, v[60:63] offset:31744
    s_waitcnt lgkmcnt(0)
    v_min_u32 v18, -2, v18
    s_waitcnt vmcnt(0)
    v_cmp_ne_u32 vcc, 32, v14
    s_mov_b32 m0, 23552
    v_mov_b64 v[28:29], v[20:21]
    v_mov_b64 v[30:31], v[22:23]
    v_mov_b64 v[32:33], v[24:25]
    v_mov_b64 v[34:35], v[26:27]
    s_add_u32 s8, s29, 0x1000
    s_add_u32 s9, s29, 0x2000
    s_add_u32 s10, s29, 0x3000
    s_mov_b32 s20, 0
    s_mov_b32 s21, 0x3f803f80
    s_mov_b32 s12, s64
    s_mov_b32 s13, s64
    s_mov_b32 s14, 0xcccccccc
    s_mov_b32 s15, 0xcccccccc
    s_mov_b32 s16, 0x3f803f80
    s_mov_b32 s17, 0x3f803f80
    v_mov_b64 v[68:69], 0
    v_mov_b64 v[70:71], 0
    v_mov_b64 v[72:73], 0
    v_mov_b64 v[74:75], 0
    v_mov_b64 v[76:77], 0
    v_mov_b64 v[78:79], 0
    v_mov_b64 v[82:83], 0
    v_mov_b64 v[84:85], 0
    v_mov_b64 v[86:87], 0
    v_mov_b64 v[88:89], 0
    v_mov_b64 v[90:91], 0
    v_mov_b64 v[126:127], 0
    v_mov_b64 v[80:81], 0
    v_mov_b64 v[124:125], 0
    ds_read_b128 v[12:15], v0 offset:30976
    ds_read_b128 v[92:95], v0 offset:61440
    ds_read_b128 v[96:99], v0 offset:62464
    ds_read_b128 v[100:103], v1 offset:28672
    ds_read_b128 v[104:107], v1 offset:29696
    ds_read_b128 v[108:111], v0 offset:63488
    ds_read_b128 v[112:115], v0 offset:64512
    ds_read_b128 v[116:119], v1 offset:30720
    ds_read_b128 v[120:123], v1 offset:31744
    v_mov_b64 v[36:37], -1
    v_mov_b64 v[38:39], -1
    v_mov_b32 v19, -1
    s_waitcnt lgkmcnt(0)
    s_cmp_lg_u32 s79, 0
    s_cbranch_scc1 S3_pub2
    s_branch R3_pub2
.p2align 6
R3_loop:
    ds_read_b128 v[12:15], v0 offset:30976
    v_mov_b64_e64 v[68:69], 0
    s_xor_b32 s29, s29, 0x40000
    v_mov_b64_e64 v[70:71], 0
    s_xor_b32 s8, s8, 0x40000
    ds_read_b128 v[92:95], v0 offset:61440
    buffer_store_dwordx2 v[124:125], v4, s[4:7], s10 offen
    s_xor_b32 s9, s9, 0x40000
    s_xor_b32 s10, s10, 0x40000
    v_mov_b64 v[80:81], 0
    v_mov_b64 v[124:125], 0
    ds_read_b128 v[96:99], v0 offset:62464
    v_mov_b64_e64 v[72:73], 0
    s_add_u32 s32, s32, 0x2000
    v_mov_b64_e64 v[74:75], 0
    s_add_u32 s31, s31, 0x4000
    ds_read_b128 v[100:103], v1 offset:28672
    ds_read_b128 v[104:107], v1 offset:29696
    v_mov_b64_e64 v[76:77], 0
    s_add_u32 s70, s31, 0x2000
    v_mov_b64_e64 v[78:79], 0
    s_xor_b32 s66, s66, 0x2000
    ds_read_b128 v[108:111], v0 offset:63488
    ds_read_b128 v[112:115], v0 offset:64512
    v_mov_b64_e64 v[82:83], 0
    s_mov_b32 m0, 23552
    v_mov_b64 v[84:85], 0
    v_mov_b64 v[86:87], 0
    ds_read_b128 v[116:119], v1 offset:30720
    ds_read_b128 v[120:123], v1 offset:31744
    v_mov_b64 v[88:89], 0
    v_mov_b64 v[90:91], 0
    v_mov_b64 v[126:127], 0
    s_waitcnt lgkmcnt(0)
    s_nop 15
    s_nop 2
    buffer_load_dwordx4 v[40:43], v10, s[4:7], s30 offen sc1
    buffer_load_dwordx4 v[44:47], v10, s[4:7], s30 offen offset:2048 sc1
    s_nop 15
    s_nop 9
    buffer_load_dwordx4 v[48:51], v10, s[4:7], s30 offen sc1
    buffer_load_dwordx4 v[52:55], v10, s[4:7], s30 offen offset:2048 sc1
    s_waitcnt vmcnt(3)
    v_mfma_f32_16x16x32_bf16 v[64:67], v[12:15], v[40:43], 0
    v_bitop3_b32 v16, v40, v41, s18 bitop3:0x7e
    v_bitop3_b32 v17, v42, v43, s18 bitop3:0x7e
    s_waitcnt vmcnt(2)
    v_mfma_f32_16x16x32_bf16 v[64:67], v[12:15], v[44:47], v[64:67]
    v_bitop3_b32 v18, v44, v45, s18 bitop3:0x7e
    v_or3_b32 v16, v16, v17, v18
    v_bitop3_b32 v17, v46, v47, s18 bitop3:0x7e
    v_bitop3_b32 v16, v16, v17, 1 bitop3:0xa8
    v_cmp_ne_u32 vcc, 0, v16
    s_nop 1
    v_add_f32_dpp v64, v64, v64 row_ror:4 row_mask:0xf bank_mask:0xf
    v_add_f32_dpp v65, v65, v65 row_ror:4 row_mask:0xf bank_mask:0xf
    s_nop 0
    v_add_f32_dpp v64, v64, v64 row_ror:8 row_mask:0xf bank_mask:0xf
    v_add_f32_dpp v65, v65, v65 row_ror:8 row_mask:0xf bank_mask:0xf
    v_cvt_pk_bf16_f32 v18, v64, v65
    s_cbranch_vccnz R3_pa1
R3_pub:
    buffer_store_dword v18, v5, s[4:7], s27 offen
R3_pub2:
    buffer_load_dwordx4 v[36:39], v10, s[4:7], s28 offen sc1
    s_cmp_eq_u32 s26, 63
    s_cbranch_scc1 R3_last
    v_cmp_eq_u32 vcc, 0, v11
    v_mov_b64 v[20:21], v[28:29]
    v_mov_b64 v[22:23], v[30:31]
    v_mov_b64 v[24:25], v[32:33]
    v_mov_b64_e64 v[26:27], v[34:35]
    s_xor_b32 s19, s27, 0x4000
    s_add_u32 s27, s27, 0x2000
    s_bitset0_b32 s27, 15
    s_xor_b32 s30, s30, 0x40000
    s_mov_b32 s35, 0
    s_cbranch_vccnz R3_flag
R3_flagok:
    s_add_u32 s67, s26, 2
    s_lshr_b32 s18, s67, 1
    s_add_u32 s33, s33, 16
    s_min_u32 s33, s33, s34
    s_add_u32 s26, s26, 1
    s_nop 0
    buffer_load_dwordx4 v[36:39], v10, s[4:7], s28 offen sc1
    s_nop 15
    s_nop 2
    buffer_load_dwordx4 v[36:39], v10, s[4:7], s28 offen sc1
    s_waitcnt vmcnt(2)
    v_max3_u32 v16, v36, v37, v38
    v_max_u32 v16, v16, v39
    v_cmp_eq_u32 vcc, -1, v16
    ds_write_b128 v0, v[36:39] offset:19456
    s_cbranch_vccnz R3_pe1
R3_peok:
    v_smfmac_f32_16x16x64_bf16 v[68:71], v[36:39], v[92:99], v3
    buffer_load_dwordx4 v[52:55], v10, s[4:7], s69 offen sc1
    buffer_load_dwordx4 v10, s[4:7], s69 offen sc1 lds
    v_smfmac_f32_16x16x64_bf16 v[72:75], v[36:39], v[100:107], v3
    s_mov_b32 m0, s66
    v_smfmac_f32_16x16x64_bf16 v[76:79], v[36:39], v[108:115], v3
    s_waitcnt lgkmcnt(0)
    s_barrier
    ds_read_b128 v[40:43], v0 offset:16384
    ds_read_b128 v[44:47], v0 offset:17408
    v_smfmac_f32_16x16x64_bf16 v[80:83], v[36:39], v[116:123], v3
    ds_read_b128 v[48:51], v0 offset:18432
    v_smfmac_f32_16x16x64_bf16 v[84:87], v[36:39], a[192:199], v3
    ds_read_b128 v[92:95], v0 offset:45056
    v_smfmac_f32_16x16x64_bf16 v[88:91], v[36:39], a[200:207], v3
    ds_read_b128 v[96:99], v0 offset:46080
    s_waitcnt lgkmcnt(4)
    v_smfmac_f32_16x16x64_bf16 v[68:71], v[40:43], a[0:7], v3
    ds_read_b128 v[100:103], v0 offset:47104
    v_smfmac_f32_16x16x64_bf16 v[72:75], v[40:43], a[8:15], v3
    ds_read_b128 v[104:107], v0 offset:48128
    v_smfmac_f32_16x16x64_bf16 v[76:79], v[40:43], a[16:23], v3
    ds_read_b128 v[108:111], v1 offset:12288
    v_smfmac_f32_16x16x64_bf16 v[80:83], v[40:43], a[24:31], v3
    ds_read_b128 v[112:115], v1 offset:13312
    s_waitcnt lgkmcnt(7)
    v_smfmac_f32_16x16x64_bf16 v[68:71], v[44:47], a[32:39], v3
    ds_read_b128 v[116:119], v1 offset:14336
    v_smfmac_f32_16x16x64_bf16 v[72:75], v[44:47], a[40:47], v3
    ds_read_b128 v[120:123], v1 offset:15360
    v_smfmac_f32_16x16x64_bf16 v[76:79], v[44:47], a[48:55], v3
    v_smfmac_f32_16x16x64_bf16 v[80:83], v[44:47], a[56:63], v3
    s_waitcnt lgkmcnt(8)
    s_waitcnt lgkmcnt(6)
    v_smfmac_f32_16x16x64_bf16 v[68:71], v[48:51], v[92:99], v3
    s_waitcnt vmcnt(1)
    v_max3_u32 v16, v52, v53, v54
    v_smfmac_f32_16x16x64_bf16 v[72:75], v[48:51], a[64:71], v3
    s_waitcnt lgkmcnt(4)
    v_max_u32_e64 v16, v16, v55
    v_smfmac_f32_16x16x64_bf16 v[76:79], v[48:51], v[100:107], v3
    v_cmp_eq_u32_e64 vcc, -1, v16
    v_smfmac_f32_16x16x64_bf16 v[80:83], v[48:51], a[72:79], v3
    s_waitcnt vmcnt(0)
    s_waitcnt lgkmcnt(0)
    v_smfmac_f32_16x16x64_bf16 v[84:87], v[40:43], a[208:215], v3
    s_cbranch_vccnz R3_plr
R3_plok:
    s_barrier
    ds_read_b128 v[56:59], v0 offset:20480
    v_smfmac_f32_16x16x64_bf16 v[68:71], v[52:55], v[108:115], v3
    ds_read_b128 v[60:63], v0 offset:21504
    ds_read_b128 v[64:67], v0 offset:22528
    v_smfmac_f32_16x16x64_bf16 v[72:75], v[52:55], a[80:87], v3
    v_smfmac_f32_16x16x64_bf16 v[76:79], v[52:55], v[116:123], v3
    buffer_load_dwordx4 v0, s[4:7], s31 offen sc1 lds
    v_smfmac_f32_16x16x64_bf16 v[80:83], v[52:55], a[88:95], v3
    s_waitcnt lgkmcnt(2)
    v_smfmac_f32_16x16x64_bf16 v[68:71], v[56:59], a[96:103], v3
    buffer_load_dword v11, off, s[4:7], s33 sc1
    s_waitcnt lgkmcnt(1)
    v_smfmac_f32_16x16x64_bf16 v[68:71], v[60:63], a[104:111], v3
    s_waitcnt lgkmcnt(0)
    v_smfmac_f32_16x16x64_bf16 v[68:71], v[64:67], a[112:119], v3
    buffer_load_dwordx4 v0, s[4:7], s31 offen offset:1024 sc1 lds
    ds_read_b128 v[104:107], v9 offset:6144
    v_smfmac_f32_16x16x64_bf16 v[72:75], v[56:59], a[120:127], v3
    v_smfmac_f32_16x16x64_bf16 v[72:75], v[60:63], a[128:135], v3
    buffer_load_dwordx4 v[28:31], v0, s[4:7], s70 offen sc1
    ds_read_b128 v[108:111], v9 offset:7168
    v_add_f32 v68, v68, v70
    v_smfmac_f32_16x16x64_bf16 v[72:75], v[64:67], a[136:143], v3
    ds_read_b128 v[112:115], v9 offset:0
    v_add_f32_e64 v69, v69, v71
    v_smfmac_f32_16x16x64_bf16 v[76:79], v[56:59], a[144:151], v3
    v_cvt_pk_bf16_f32 v92, v68, v69
    v_smfmac_f32_16x16x64_bf16 v[76:79], v[60:63], a[152:159], v3
    buffer_load_dwordx4 v[32:35], v0, s[4:7], s70 offen offset:1024 sc1
    ds_read_b128 v[116:119], v9 offset:1024
    v_add_f32_e64 v72, v72, v74
    v_smfmac_f32_16x16x64_bf16 v[76:79], v[64:67], a[160:167], v3
    ds_read_b128 v[120:123], v9 offset:2048
    v_add_f32_e64 v73, v73, v75
    v_smfmac_f32_16x16x64_bf16 v[80:83], v[56:59], a[168:175], v3
    v_cvt_pk_bf16_f32 v93, v72, v73
    v_smfmac_f32_16x16x64_bf16 v[80:83], v[60:63], a[176:183], v3
    buffer_store_dword v19, v5, s[4:7], s19 offen
    ds_write_b64 v6, v[92:93] offset:27840
    v_add_f32_e64 v76, v76, v78
    v_smfmac_f32_16x16x64_bf16 v[80:83], v[64:67], a[184:191], v3
    v_add_f32_e64 v77, v77, v79
    v_smfmac_f32_16x16x64_bf16 v[88:91], v[40:43], a[216:223], v3
    s_add_u32 s28, s28, 0x2000
    s_bitset0_b32 s28, 15
    v_cvt_pk_bf16_f32 v94, v76, v77
    s_add_u32 s69, s28, 0x1000
    v_add_f32 v80, v80, v82
    v_add_f32_e64 v81, v81, v83
    v_cvt_pk_bf16_f32 v95, v80, v81
    ds_write_b64 v6, v[94:95] offset:28384
    ds_read_b64_tr_b16 v[12:13], v7 offset:27840
    ds_read_b64_tr_b16 v[14:15], v7 offset:28112
    v_smfmac_f32_16x16x64_bf16 v[84:87], v[44:47], a[224:231], v3
    ds_read_b128 v[80:83], v9 offset:4096
    v_smfmac_f32_16x16x64_bf16 v[88:91], v[44:47], a[232:239], v3
    buffer_store_dword v18, v5, s[4:7], s32 offen sc1
    v_smfmac_f32_16x16x64_bf16 v[84:87], v[48:51], a[240:247], v3
    s_waitcnt lgkmcnt(3)
    s_barrier
    ds_read_b64_tr_b16 v[92:93], v7 offset:24576
    ds_read_b64_tr_b16 v[94:95], v7 offset:24848
    v_smfmac_f32_16x16x64_bf16 v[88:91], v[48:51], a[248:255], v3
    v_smfmac_f32_16x16x64_bf16 v[84:87], v[52:55], v[128:135], v3
    ds_read_b64_tr_b16 v[96:97], v7 offset:25664
    s_waitcnt lgkmcnt(4)
    v_mfma_f32_16x16x32_bf16 v[76:79], v[12:15], v[12:15], 0
    ds_read_b64_tr_b16 v[98:99], v7 offset:25936
    ds_read_b64_tr_b16 v[100:101], v7 offset:26752
    v_mfma_f32_16x16x32_bf16 v[68:71], v[104:107], v[12:15], 0
    ds_read_b64_tr_b16 v[102:103], v7 offset:27024
    ds_read_b128 v[104:107], v9 offset:3072
    v_mfma_f32_16x16x32_bf16 v[72:75], v[108:111], v[12:15], 0
    ds_read_b128 v[108:111], v9 offset:5120
    s_waitcnt lgkmcnt(6)
    v_mfma_f32_16x16x32_bf16 v[76:79], v[92:95], v[92:95], v[76:79]
    ds_read_b128 v[36:39], v2 offset:12288
    v_mfma_f32_16x16x32_bf16 v[68:71], v[112:115], v[92:95], v[68:71]
    v_mov_b64 v[112:113], s[20:21]
    v_mov_b64 v[114:115], s[16:17]
    v_mfma_f32_16x16x32_bf16 v[72:75], v[116:119], v[92:95], v[72:75]
    s_waitcnt lgkmcnt(3)
    v_mov_b64 v[116:117], 0
    v_mov_b64_e64 v[118:119], 0
    v_mfma_f32_16x16x32_bf16 v[68:71], v[120:123], v[96:99], v[68:71]
    s_mov_b64 vcc, s[14:15]
    v_mov_b64 v[120:121], 0
    v_mov_b64_e64 v[122:123], 0
    v_mfma_f32_16x16x32_bf16 v[68:71], v[80:83], v[100:103], v[68:71]
    s_waitcnt lgkmcnt(1)
    v_mov_b64 v[80:81], 0
    v_mov_b64_e64 v[82:83], 0
    v_mfma_f32_16x16x32_bf16 v[72:75], v[104:107], v[96:99], v[72:75]
    v_xor_b32 v9, 0x2000, v9
    v_mov_b32_e64 v16, s64
    v_mfma_f32_16x16x32_bf16 v[72:75], v[108:111], v[100:103], v[72:75]
    v_max3_f32 v12, v68, v69, v70
    v_mov_b32_e64 v109, 0
    v_mfma_f32_16x16x32_bf16 v[76:79], v[96:99], v[96:99], v[76:79]
    v_max_f32 v12, v12, v71
    v_mov_b32 v110, 0
    v_mfma_f32_16x16x32_bf16 v[76:79], v[100:103], v[100:103], v[76:79]
    v_max3_f32 v12, v12, v72, v73
    v_max3_f32 v12, v12, v74, v75
    v_smfmac_f32_16x16x64_bf16 v[88:91], v[52:55], v[136:143], v3
    ds_read_b128 v[40:43], v2 offset:13312
    v_cndmask_b32_dpp v68, v72, v68, vcc quad_perm:[2,3,2,3] row_mask:0xf bank_mask:0xf
    v_cndmask_b32_dpp v69, v73, v69, vcc quad_perm:[2,3,2,3] row_mask:0xf bank_mask:0xf
    v_max3_f32 v79, v12, v76, v77
    v_max3_f32 v96, v12, v76, v77
    v_smfmac_f32_16x16x64_bf16 v[84:87], v[56:59], v[144:151], v3
    ds_read_b128 v[44:47], v2 offset:14336
    v_permlane16_swap_b32 v79, v96
    v_max_f32 v78, v79, v96
    v_max_f32_e64 v79, v79, v96
    v_smfmac_f32_16x16x64_bf16 v[88:91], v[56:59], v[152:159], v3
    ds_read_b128 v[48:51], v2 offset:15360
    v_permlane32_swap_b32 v78, v79
    v_max_f32 v78, v78, v79
    v_smfmac_f32_16x16x64_bf16 v[84:87], v[60:63], v[160:167], v3
    ds_read_b128 v[52:55], v2 offset:28672
    v_mul_f32_dpp v78, v78, v16 quad_perm:[2,3,2,3] row_mask:0xf bank_mask:0xf
    v_smfmac_f32_16x16x64_bf16 v[88:91], v[60:63], v[168:175], v3
    ds_read_b128 v[56:59], v2 offset:29696
    v_cndmask_b32_dpp v76, v77, v76, vcc quad_perm:[2,3,2,3] row_mask:0xf bank_mask:0xf
    v_smfmac_f32_16x16x64_bf16 v[84:87], v[64:67], v[176:183], v3
    ds_read_b128 v[60:63], v2 offset:30720
    v_cndmask_b32_dpp v70, v74, v70, vcc quad_perm:[2,3,2,3] row_mask:0xf bank_mask:0xf
    v_smfmac_f32_16x16x64_bf16 v[88:91], v[64:67], v[184:191], v3
    ds_read_b128 v[64:67], v2 offset:31744
    v_cndmask_b32_dpp v71, v75, v71, vcc quad_perm:[2,3,2,3] row_mask:0xf bank_mask:0xf
    v_fma_f32 v76, v76, s64, -v78
    v_exp_f32_e64 v76, v76
    v_pk_fma_f32 v[68:69], v[68:69], s[12:13], v[78:79] op_sel_hi:[1,1,0] neg_lo:[0,0,1] neg_hi:[0,0,1]
    v_pk_fma_f32 v[70:71], v[70:71], s[12:13], v[78:79] op_sel_hi:[1,1,0] neg_lo:[0,0,1] neg_hi:[0,0,1]
    v_mov_b32_dpp v77, v76 quad_perm:[0,1,0,1] row_mask:0xf bank_mask:0xf
    v_pk_add_f32 v[84:85], v[84:85], v[86:87]
    v_pk_add_f32 v[88:89], v[88:89], v[90:91]
    v_cvt_pk_bf16_f32 v108, v76, v77
    v_cvt_pk_bf16_f32 v111, v76, v77
    v_cvt_pk_bf16_f32 v16, v84, v85
    v_cvt_pk_bf16_f32 v17, v88, v89
    v_exp_f32 v68, v68
    v_exp_f32 v69, v69
    v_mfma_f32_16x16x16_bf16 v[92:95], v[16:17], v[108:109], 0
    v_cvt_pk_bf16_f32 v104, v68, v69
    v_exp_f32_e64 v70, v70
    v_mfma_f32_16x16x16_bf16 v[96:99], v[16:17], v[110:111], 0
    v_exp_f32_e64 v71, v71
    v_cvt_pk_bf16_f32 v103, v76, 0
    v_cvt_pk_bf16_f32 v105, v70, v71
    v_mov_b32_dpp v106, v104 quad_perm:[0,1,0,1] row_mask:0xf bank_mask:0xf
    s_nop 0
    v_mfma_f32_16x16x32_bf16 v[72:75], v[112:115], v[102:105], 0
    v_mov_b32_dpp v107, v105 quad_perm:[0,1,0,1] row_mask:0xf bank_mask:0xf
    s_nop 1
    v_mfma_f32_16x16x32_bf16 v[92:95], v[20:23], v[104:107], v[92:95]
    v_mfma_f32_16x16x32_bf16 v[96:99], v[24:27], v[104:107], v[96:99]
    v_add_f32_dpp v72, v72, v72 quad_perm:[2,3,0,1] row_mask:0xf bank_mask:0xf
    v_rcp_f32 v72, v72
    s_mov_b64 exec, s[14:15]
    v_mul_f32 v92, v72, v92
    v_mul_f32 v93, v72, v93
    v_mul_f32 v94, v72, v94
    v_mul_f32 v95, v72, v95
    v_cvt_pk_bf16_f32 v84, v92, v93
    v_cvt_pk_bf16_f32 v85, v94, v95
    ds_write_b64 v8, v[84:85] offset:30464
    v_pk_mul_f32 v[96:97], v[96:97], v[72:73] op_sel_hi:[1,0]
    v_pk_mul_f32 v[98:99], v[98:99], v[72:73] op_sel_hi:[1,0]
    v_cvt_pk_bf16_f32 v86, v96, v97
    v_cvt_pk_bf16_f32 v87, v98, v99
    ds_write_b64 v8, v[86:87] offset:30472
    s_mov_b64 exec, -1
    v_mov_b32_dpp v88, v84 quad_perm:[2,3,2,3] row_mask:0xf bank_mask:0xf
    v_mov_b32_dpp v89, v85 quad_perm:[2,3,2,3] row_mask:0xf bank_mask:0xf
    v_mov_b32_dpp v90, v86 quad_perm:[2,3,2,3] row_mask:0xf bank_mask:0xf
    v_mov_b32_dpp v91, v87 quad_perm:[2,3,2,3] row_mask:0xf bank_mask:0xf
    s_waitcnt lgkmcnt(2)
    s_nop 0
    v_smfmac_f32_16x16x64_bf16 v[116:119], v[88:91], v[36:43], v3
    s_waitcnt lgkmcnt(0)
    s_barrier
    ds_read_b128 v[68:71], v8 offset:28928
    ds_read_b128 v[72:75], v8 offset:29440
    ds_read_b128 v[76:79], v8 offset:29952
    v_smfmac_f32_16x16x64_bf16 v[120:123], v[88:91], v[44:51], v3
    ds_read_b128 v[36:39], v1 offset:61440
    v_smfmac_f32_16x16x64_bf16 v[80:83], v[88:91], v[52:59], v3
    ds_read_b128 v[40:43], v1 offset:62464
    v_smfmac_f32_16x16x64_bf16 v[124:127], v[88:91], v[60:67], v3
    ds_read_b128 v[44:47], v1 offset:45056
    s_waitcnt lgkmcnt(5)
    v_smfmac_f32_16x16x64_bf16 v[116:119], v[68:71], v[192:199], v3
    ds_read_b128 v[48:51], v1 offset:46080
    s_waitcnt lgkmcnt(5)
    v_smfmac_f32_16x16x64_bf16 v[116:119], v[72:75], v[200:207], v3
    ds_read_b128 v[52:55], v1 offset:47104
    s_waitcnt lgkmcnt(5)
    v_smfmac_f32_16x16x64_bf16 v[116:119], v[76:79], v[208:215], v3
    ds_read_b128 v[56:59], v1 offset:48128
    ds_read_b128 v[60:63], v1 offset:63488
    v_smfmac_f32_16x16x64_bf16 v[120:123], v[68:71], v[216:223], v3
    ds_read_b128 v[64:67], v1 offset:64512
    v_smfmac_f32_16x16x64_bf16 v[120:123], v[72:75], v[224:231], v3
    v_cvt_pk_bf16_f32 v116, v116, v117
    v_cvt_pk_bf16_f32 v117, v118, v119
    v_bfi_b32 v116, 1, s18, v116
    v_bfi_b32 v117, 1, s18, v117
    v_smfmac_f32_16x16x64_bf16 v[120:123], v[76:79], v[232:239], v3
    buffer_store_dwordx2 v[116:117], v4, s[4:7], s29 offen
    v_smfmac_f32_16x16x64_bf16 v[80:83], v[68:71], v[240:247], v3
    s_waitcnt lgkmcnt(0)
    v_smfmac_f32_16x16x64_bf16 v[80:83], v[72:75], v[248:255], v3
    v_cvt_pk_bf16_f32 v120, v120, v121
    v_cvt_pk_bf16_f32 v121, v122, v123
    v_bfi_b32 v120, 1, s18, v120
    v_bfi_b32 v121, 1, s18, v121
    v_smfmac_f32_16x16x64_bf16 v[80:83], v[76:79], v[36:43], v3
    buffer_store_dwordx2 v[120:121], v4, s[4:7], s8 offen
    v_smfmac_f32_16x16x64_bf16 v[124:127], v[68:71], v[44:51], v3
    v_smfmac_f32_16x16x64_bf16 v[124:127], v[72:75], v[52:59], v3
    v_cvt_pk_bf16_f32 v80, v80, v81
    v_cvt_pk_bf16_f32 v81, v82, v83
    v_bfi_b32 v80, 1, s18, v80
    v_bfi_b32 v81, 1, s18, v81
    v_smfmac_f32_16x16x64_bf16 v[124:127], v[76:79], v[60:67], v3
    buffer_store_dwordx2 v[80:81], v4, s[4:7], s9 offen
    s_nop 6
    v_cvt_pk_bf16_f32 v124, v124, v125
    v_cvt_pk_bf16_f32 v125, v126, v127
    v_bfi_b32 v124, 1, s18, v124
    v_bfi_b32 v125, 1, s18, v125
    s_nop 0
    s_branch R3_loop
.p2align 5
R3_pa1:
    buffer_load_dwordx4 v[40:43], v10, s[4:7], s30 offen sc1
    buffer_load_dwordx4 v[44:47], v10, s[4:7], s30 offen offset:2048 sc1
    s_waitcnt vmcnt(3)
    v_mfma_f32_16x16x32_bf16 v[64:67], v[12:15], v[48:51], 0
    v_bitop3_b32 v16, v48, v49, s18 bitop3:0x7e
    v_bitop3_b32 v17, v50, v51, s18 bitop3:0x7e
    s_waitcnt vmcnt(2)
    v_mfma_f32_16x16x32_bf16 v[64:67], v[12:15], v[52:55], v[64:67]
    v_bitop3_b32 v18, v52, v53, s18 bitop3:0x7e
    v_or3_b32 v16, v16, v17, v18
    v_bitop3_b32 v17, v54, v55, s18 bitop3:0x7e
    v_bitop3_b32 v16, v16, v17, 1 bitop3:0xa8
    v_cmp_ne_u32 vcc, 0, v16
    s_nop 1
    v_add_f32_dpp v64, v64, v64 row_ror:4 row_mask:0xf bank_mask:0xf
    v_add_f32_dpp v65, v65, v65 row_ror:4 row_mask:0xf bank_mask:0xf
    s_nop 0
    v_add_f32_dpp v64, v64, v64 row_ror:8 row_mask:0xf bank_mask:0xf
    v_add_f32_dpp v65, v65, v65 row_ror:8 row_mask:0xf bank_mask:0xf
    v_cvt_pk_bf16_f32 v18, v64, v65
    s_cbranch_vccz R3_pub
R3_par:
    buffer_load_dwordx4 v[48:51], v10, s[4:7], s30 offen sc1
    buffer_load_dwordx4 v[52:55], v10, s[4:7], s30 offen offset:2048 sc1
    s_waitcnt vmcnt(3)
    v_mfma_f32_16x16x32_bf16 v[64:67], v[12:15], v[40:43], 0
    v_bitop3_b32 v16, v40, v41, s18 bitop3:0x7e
    v_bitop3_b32 v17, v42, v43, s18 bitop3:0x7e
    s_waitcnt vmcnt(2)
    v_mfma_f32_16x16x32_bf16 v[64:67], v[12:15], v[44:47], v[64:67]
    v_bitop3_b32 v18, v44, v45, s18 bitop3:0x7e
    v_or3_b32 v16, v16, v17, v18
    v_bitop3_b32 v17, v46, v47, s18 bitop3:0x7e
    v_bitop3_b32 v16, v16, v17, 1 bitop3:0xa8
    v_cmp_ne_u32 vcc, 0, v16
    s_nop 1
    v_add_f32_dpp v64, v64, v64 row_ror:4 row_mask:0xf bank_mask:0xf
    v_add_f32_dpp v65, v65, v65 row_ror:4 row_mask:0xf bank_mask:0xf
    s_nop 0
    v_add_f32_dpp v64, v64, v64 row_ror:8 row_mask:0xf bank_mask:0xf
    v_add_f32_dpp v65, v65, v65 row_ror:8 row_mask:0xf bank_mask:0xf
    v_cvt_pk_bf16_f32 v18, v64, v65
    s_cbranch_vccz R3_pub
    buffer_load_dwordx4 v[40:43], v10, s[4:7], s30 offen sc1
    buffer_load_dwordx4 v[44:47], v10, s[4:7], s30 offen offset:2048 sc1
    s_waitcnt vmcnt(3)
    v_mfma_f32_16x16x32_bf16 v[64:67], v[12:15], v[48:51], 0
    v_bitop3_b32 v16, v48, v49, s18 bitop3:0x7e
    v_bitop3_b32 v17, v50, v51, s18 bitop3:0x7e
    s_waitcnt vmcnt(2)
    v_mfma_f32_16x16x32_bf16 v[64:67], v[12:15], v[52:55], v[64:67]
    v_bitop3_b32 v18, v52, v53, s18 bitop3:0x7e
    v_or3_b32 v16, v16, v17, v18
    v_bitop3_b32 v17, v54, v55, s18 bitop3:0x7e
    v_bitop3_b32 v16, v16, v17, 1 bitop3:0xa8
    v_cmp_ne_u32 vcc, 0, v16
    s_nop 1
    v_add_f32_dpp v64, v64, v64 row_ror:4 row_mask:0xf bank_mask:0xf
    v_add_f32_dpp v65, v65, v65 row_ror:4 row_mask:0xf bank_mask:0xf
    s_nop 0
    v_add_f32_dpp v64, v64, v64 row_ror:8 row_mask:0xf bank_mask:0xf
    v_add_f32_dpp v65, v65, v65 row_ror:8 row_mask:0xf bank_mask:0xf
    v_cvt_pk_bf16_f32 v18, v64, v65
    s_cbranch_vccz R3_pub
    s_add_u32 s35, s35, 1
    s_cmp_lt_u32 s35, 131072
    s_cbranch_scc1 R3_par
    s_branch L_END
R3_last:
    buffer_store_dword v18, v5, s[4:7], s32 offen sc1
    s_branch R_DONE
R3_flag:
    buffer_load_dword v11, off, s[4:7], s33 sc1
    s_waitcnt vmcnt(0)
    v_cmp_eq_u32 vcc, 0, v11
    s_cbranch_vccz R3_flagok
    s_add_u32 s35, s35, 1
    s_cmp_lt_u32 s35, 131072
    s_cbranch_scc1 R3_flag
    s_branch L_END
.p2align 5
R3_pe1:
    buffer_load_dwordx4 v[36:39], v10, s[4:7], s28 offen sc1
    s_waitcnt vmcnt(2)
    v_max3_u32 v16, v36, v37, v38
    v_max_u32 v16, v16, v39
    v_cmp_eq_u32 vcc, -1, v16
    ds_write_b128 v0, v[36:39] offset:19456
    s_cbranch_vccz R3_peok
    buffer_load_dwordx4 v[36:39], v10, s[4:7], s28 offen sc1
    s_waitcnt vmcnt(2)
    v_max3_u32 v16, v36, v37, v38
    v_max_u32 v16, v16, v39
    v_cmp_eq_u32 vcc, -1, v16
    ds_write_b128 v0, v[36:39] offset:19456
    s_cbranch_vccz R3_peok
R3_pe2:
    buffer_load_dwordx4 v[36:39], v10, s[4:7], s28 offen sc1
    s_add_u32 s35, s35, 1
    s_cmp_ge_u32 s35, 131072
    s_cbranch_scc1 L_END
    s_waitcnt vmcnt(2)
    v_max3_u32 v16, v36, v37, v38
    v_max_u32 v16, v16, v39
    v_cmp_eq_u32 vcc, -1, v16
    ds_write_b128 v0, v[36:39] offset:19456
    s_cbranch_vccz R3_peok
    s_branch R3_pe2
R3_plr:
    s_mov_b32 m0, 23552
    s_nop 0
    buffer_load_dwordx4 v[52:55], v10, s[4:7], s69 offen sc1
    buffer_load_dwordx4 v10, s[4:7], s69 offen sc1 lds
    s_mov_b32 m0, s66
    s_waitcnt vmcnt(0)
    v_max3_u32 v16, v52, v53, v54
    v_max_u32 v16, v16, v55
    v_cmp_eq_u32 vcc, -1, v16
    s_waitcnt lgkmcnt(0)
    s_cbranch_vccz R3_plok
    s_add_u32 s35, s35, 1
    s_cmp_lt_u32 s35, 131072
    s_cbranch_scc1 R3_plr
    s_branch L_END
R3_reg:
    s_mov_b32 s35, 0
R3_reg2:
    global_load_dword v11, v16, s[60:61] sc1
    s_waitcnt vmcnt(0)
    v_cmp_eq_u32 vcc, 0, v11
    s_cbranch_vccz R3_reg2_ok
    s_add_u32 s35, s35, 1
    s_cmp_lt_u32 s35, 131072
    s_cbranch_scc1 R3_reg2
    s_branch L_END
R3_reg2_ok:
    s_branch R3_regok
R3_md:
    v_lshlrev_b32 v12, 1, v0
    v_and_b32 v12, 0xe0, v12
    s_mov_b32 s89, 0
R3_md2:
    global_load_dword v14, v12, s[60:61] sc1
    s_waitcnt vmcnt(0)
    v_readlane_b32 s80, v14, 0
    v_readlane_b32 s81, v14, 1
    v_readlane_b32 s82, v14, 2
    v_readlane_b32 s83, v14, 3
    v_readlane_b32 s84, v14, 4
    v_readlane_b32 s85, v14, 5
    v_readlane_b32 s86, v14, 6
    v_readlane_b32 s87, v14, 7
    s_nop 3
    s_add_u32 s88, s80, s81
    s_add_u32 s88, s88, s82
    s_add_u32 s88, s88, s83
    s_add_u32 s88, s88, s84
    s_add_u32 s88, s88, s85
    s_add_u32 s88, s88, s86
    s_add_u32 s88, s88, s87
    s_cmp_ge_u32 s80, 32
    s_cbranch_scc1 R3_mdok
    s_cmp_ge_u32 s88, 256
    s_cbranch_scc1 R3_md3
    s_sleep 16
    s_add_u32 s89, s89, 1
    s_cmp_lt_u32 s89, 131072
    s_cbranch_scc1 R3_md2
    s_branch L_END
R3_md3:
    s_mov_b32 s79, 1
    s_branch R3_mdok
R3_p0:
    buffer_store_dword v18, v5, s[4:7], s27 offen sc1
    s_branch R3_p0ok
R3_kv0:
    s_mov_b32 s35, 0
R3_kv02:
    buffer_load_dword v17, off, s[4:7], s33 offset:16 sc1
    buffer_load_dword v16, off, s[4:7], s33 sc1
    s_waitcnt vmcnt(0)
    v_cmp_eq_u32 vcc, 0, v16
    s_cbranch_vccz R3_kv02_ok
    s_add_u32 s35, s35, 1
    s_cmp_lt_u32 s35, 131072
    s_cbranch_scc1 R3_kv02
    s_branch L_END
R3_kv02_ok:
    s_branch R3_kv0ok
S0_loop:
    s_waitcnt vmcnt(0)
    s_xor_b32 s9, s9, 0x40000
    s_xor_b32 s10, s10, 0x40000
    v_mov_b64 v[80:81], 0
    v_mov_b64_e64 v[124:125], 0
    ds_read_b128 v[12:15], v0 offset:30976
    v_mov_b64_e64 v[68:69], 0
    ds_read_b128 v[92:95], v0 offset:49152
    v_mov_b64_e64 v[70:71], 0
    ds_read_b128 v[96:99], v0 offset:50176
    v_mov_b64_e64 v[72:73], 0
    ds_read_b128 v[100:103], v1 offset:16384
    v_mov_b64_e64 v[74:75], 0
    ds_read_b128 v[104:107], v1 offset:17408
    v_mov_b64_e64 v[76:77], 0
    ds_read_b128 v[108:111], v0 offset:51200
    v_mov_b64_e64 v[78:79], 0
    ds_read_b128 v[112:115], v0 offset:52224
    v_mov_b64_e64 v[82:83], 0
    ds_read_b128 v[116:119], v1 offset:18432
    v_mov_b64_e64 v[84:85], 0
    ds_read_b128 v[120:123], v1 offset:19456
    v_mov_b64_e64 v[86:87], 0
    s_xor_b32 s29, s29, 0x40000
    v_mov_b64_e64 v[88:89], 0
    s_xor_b32 s8, s8, 0x40000
    v_mov_b64_e64 v[90:91], 0
    s_add_u32 s32, s32, 0x2000
    v_mov_b64_e64 v[126:127], 0
    s_add_u32 s31, s31, 0x4000
    s_add_u32 s70, s31, 0x2000
    s_xor_b32 s66, s66, 0x2000
    s_mov_b32 m0, 20480
    s_waitcnt lgkmcnt(0)
    s_nop 6
    buffer_load_dwordx4 v[40:43], v10, s[4:7], s30 offen sc1
    buffer_load_dwordx4 v[44:47], v10, s[4:7], s30 offen offset:2048 sc1
    s_waitcnt vmcnt(1)
    v_mfma_f32_16x16x32_bf16 v[64:67], v[12:15], v[40:43], 0
    v_bitop3_b32 v16, v40, v41, s18 bitop3:0x7e
    v_bitop3_b32 v17, v42, v43, s18 bitop3:0x7e
    s_waitcnt vmcnt(0)
    v_mfma_f32_16x16x32_bf16 v[64:67], v[12:15], v[44:47], v[64:67]
    v_bitop3_b32 v18, v44, v45, s18 bitop3:0x7e
    v_or3_b32 v16, v16, v17, v18
    v_bitop3_b32 v17, v46, v47, s18 bitop3:0x7e
    v_bitop3_b32 v16, v16, v17, 1 bitop3:0xa8
    v_cmp_ne_u32 vcc, 0, v16
    s_nop 1
    v_add_f32_dpp v64, v64, v64 row_ror:4 row_mask:0xf bank_mask:0xf
    v_add_f32_dpp v65, v65, v65 row_ror:4 row_mask:0xf bank_mask:0xf
    s_nop 0
    v_add_f32_dpp v64, v64, v64 row_ror:8 row_mask:0xf bank_mask:0xf
    v_add_f32_dpp v65, v65, v65 row_ror:8 row_mask:0xf bank_mask:0xf
    v_cvt_pk_bf16_f32 v18, v64, v65
    s_cbranch_vccnz S0_pa1
S0_pub:
    buffer_store_dword v18, v5, s[4:7], s27 offen sc1
S0_pub2:
    s_cmp_eq_u32 s26, 63
    s_cbranch_scc1 S0_last
    v_cmp_eq_u32 vcc, 0, v11
    v_mov_b64 v[20:21], v[28:29]
    v_mov_b64 v[22:23], v[30:31]
    v_mov_b64 v[24:25], v[32:33]
    v_mov_b64_e64 v[26:27], v[34:35]
    s_xor_b32 s19, s27, 0x4000
    s_add_u32 s27, s27, 0x2000
    s_bitset0_b32 s27, 15
    s_xor_b32 s30, s30, 0x40000
    s_mov_b32 s35, 0
    s_cbranch_vccnz S0_flag
S0_flagok:
    s_add_u32 s67, s26, 2
    s_lshr_b32 s18, s67, 1
    s_add_u32 s33, s33, 16
    s_min_u32 s33, s33, s34
    s_add_u32 s26, s26, 1
    s_nop 1
    buffer_load_dwordx4 v[36:39], v10, s[4:7], s28 offen sc1
    s_waitcnt vmcnt(0)
    v_max3_u32 v16, v36, v37, v38
    v_max_u32 v16, v16, v39
    v_cmp_eq_u32 vcc, -1, v16
    ds_write_b128 v0, v[36:39] offset:16384
    s_cbranch_vccnz S0_pe1
S0_peok:
    v_smfmac_f32_16x16x64_bf16 v[68:71], v[36:39], v[92:99], v3
    v_smfmac_f32_16x16x64_bf16 v[72:75], v[36:39], v[100:107], v3
    buffer_load_dwordx4 v[52:55], v10, s[4:7], s69 offen sc1
    buffer_load_dwordx4 v10, s[4:7], s69 offen sc1 lds
    v_smfmac_f32_16x16x64_bf16 v[76:79], v[36:39], v[108:115], v3
    s_mov_b32 m0, s66
    s_waitcnt lgkmcnt(0)
    s_barrier
    ds_read_b128 v[40:43], v0 offset:17408
    ds_read_b128 v[44:47], v0 offset:18432
    v_smfmac_f32_16x16x64_bf16 v[80:83], v[36:39], v[116:123], v3
    ds_read_b128 v[48:51], v0 offset:19456
    v_smfmac_f32_16x16x64_bf16 v[84:87], v[36:39], a[192:199], v3
    ds_read_b128 v[92:95], v0 offset:32768
    v_smfmac_f32_16x16x64_bf16 v[88:91], v[36:39], a[200:207], v3
    ds_read_b128 v[96:99], v0 offset:33792
    s_waitcnt lgkmcnt(4)
    v_smfmac_f32_16x16x64_bf16 v[68:71], v[40:43], a[0:7], v3
    ds_read_b128 v[100:103], v0 offset:34816
    v_smfmac_f32_16x16x64_bf16 v[72:75], v[40:43], a[8:15], v3
    ds_read_b128 v[104:107], v0 offset:35840
    v_smfmac_f32_16x16x64_bf16 v[76:79], v[40:43], a[16:23], v3
    ds_read_b128 v[108:111], v1 offset:0
    v_smfmac_f32_16x16x64_bf16 v[80:83], v[40:43], a[24:31], v3
    ds_read_b128 v[112:115], v1 offset:1024
    s_waitcnt lgkmcnt(7)
    v_smfmac_f32_16x16x64_bf16 v[68:71], v[44:47], a[32:39], v3
    ds_read_b128 v[116:119], v1 offset:2048
    v_smfmac_f32_16x16x64_bf16 v[72:75], v[44:47], a[40:47], v3
    ds_read_b128 v[120:123], v1 offset:3072
    v_smfmac_f32_16x16x64_bf16 v[76:79], v[44:47], a[48:55], v3
    v_smfmac_f32_16x16x64_bf16 v[80:83], v[44:47], a[56:63], v3
    s_waitcnt lgkmcnt(8)
    s_waitcnt lgkmcnt(6)
    v_smfmac_f32_16x16x64_bf16 v[68:71], v[48:51], v[92:99], v3
    s_waitcnt vmcnt(1)
    v_max3_u32 v16, v52, v53, v54
    v_smfmac_f32_16x16x64_bf16 v[72:75], v[48:51], a[64:71], v3
    s_waitcnt lgkmcnt(4)
    v_max_u32_e64 v16, v16, v55
    v_smfmac_f32_16x16x64_bf16 v[76:79], v[48:51], v[100:107], v3
    v_cmp_eq_u32_e64 vcc, -1, v16
    v_smfmac_f32_16x16x64_bf16 v[80:83], v[48:51], a[72:79], v3
    s_waitcnt vmcnt(0)
    s_waitcnt lgkmcnt(0)
    v_smfmac_f32_16x16x64_bf16 v[84:87], v[40:43], a[208:215], v3
    s_cbranch_vccnz S0_plr
S0_plok:
    s_barrier
    ds_read_b128 v[56:59], v0 offset:21504
    v_smfmac_f32_16x16x64_bf16 v[68:71], v[52:55], v[108:115], v3
    ds_read_b128 v[60:63], v0 offset:22528
    ds_read_b128 v[64:67], v0 offset:23552
    v_smfmac_f32_16x16x64_bf16 v[72:75], v[52:55], a[80:87], v3
    v_smfmac_f32_16x16x64_bf16 v[76:79], v[52:55], v[116:123], v3
    buffer_load_dwordx4 v0, s[4:7], s31 offen sc1 lds
    v_smfmac_f32_16x16x64_bf16 v[80:83], v[52:55], a[88:95], v3
    s_waitcnt lgkmcnt(2)
    v_smfmac_f32_16x16x64_bf16 v[68:71], v[56:59], a[96:103], v3
    buffer_load_dword v11, off, s[4:7], s33 sc1
    s_waitcnt lgkmcnt(1)
    v_smfmac_f32_16x16x64_bf16 v[68:71], v[60:63], a[104:111], v3
    s_waitcnt lgkmcnt(0)
    v_smfmac_f32_16x16x64_bf16 v[68:71], v[64:67], a[112:119], v3
    buffer_load_dwordx4 v0, s[4:7], s31 offen offset:1024 sc1 lds
    ds_read_b128 v[104:107], v9 offset:0
    v_smfmac_f32_16x16x64_bf16 v[72:75], v[56:59], a[120:127], v3
    v_smfmac_f32_16x16x64_bf16 v[72:75], v[60:63], a[128:135], v3
    buffer_load_dwordx4 v[28:31], v0, s[4:7], s70 offen sc1
    ds_read_b128 v[108:111], v9 offset:1024
    v_add_f32 v68, v68, v70
    v_smfmac_f32_16x16x64_bf16 v[72:75], v[64:67], a[136:143], v3
    ds_read_b128 v[112:115], v9 offset:2048
    v_add_f32_e64 v69, v69, v71
    v_smfmac_f32_16x16x64_bf16 v[76:79], v[56:59], a[144:151], v3
    v_cvt_pk_bf16_f32 v92, v68, v69
    v_smfmac_f32_16x16x64_bf16 v[76:79], v[60:63], a[152:159], v3
    buffer_load_dwordx4 v[32:35], v0, s[4:7], s70 offen offset:1024 sc1
    ds_read_b128 v[116:119], v9 offset:3072
    v_add_f32_e64 v72, v72, v74
    v_smfmac_f32_16x16x64_bf16 v[76:79], v[64:67], a[160:167], v3
    ds_read_b128 v[120:123], v9 offset:4096
    v_add_f32_e64 v73, v73, v75
    v_smfmac_f32_16x16x64_bf16 v[80:83], v[56:59], a[168:175], v3
    v_cvt_pk_bf16_f32 v93, v72, v73
    v_smfmac_f32_16x16x64_bf16 v[80:83], v[60:63], a[176:183], v3
    buffer_store_dword v19, v5, s[4:7], s19 offen sc1
    ds_write_b64 v6, v[92:93] offset:24576
    v_add_f32_e64 v76, v76, v78
    v_smfmac_f32_16x16x64_bf16 v[80:83], v[64:67], a[184:191], v3
    v_add_f32_e64 v77, v77, v79
    v_smfmac_f32_16x16x64_bf16 v[88:91], v[40:43], a[216:223], v3
    s_add_u32 s28, s28, 0x2000
    s_bitset0_b32 s28, 15
    v_cvt_pk_bf16_f32 v94, v76, v77
    s_add_u32 s69, s28, 0x1000
    v_add_f32 v80, v80, v82
    v_add_f32_e64 v81, v81, v83
    v_cvt_pk_bf16_f32 v95, v80, v81
    ds_write_b64 v6, v[94:95] offset:25120
    ds_read_b64_tr_b16 v[12:13], v7 offset:24576
    ds_read_b64_tr_b16 v[14:15], v7 offset:24848
    v_smfmac_f32_16x16x64_bf16 v[84:87], v[44:47], a[224:231], v3
    ds_read_b128 v[80:83], v9 offset:6144
    v_smfmac_f32_16x16x64_bf16 v[88:91], v[44:47], a[232:239], v3
    buffer_store_dword v18, v5, s[4:7], s32 offen sc1
    v_smfmac_f32_16x16x64_bf16 v[84:87], v[48:51], a[240:247], v3
    s_waitcnt lgkmcnt(3)
    s_barrier
    ds_read_b64_tr_b16 v[92:93], v7 offset:25664
    ds_read_b64_tr_b16 v[94:95], v7 offset:25936
    v_smfmac_f32_16x16x64_bf16 v[88:91], v[48:51], a[248:255], v3
    v_smfmac_f32_16x16x64_bf16 v[84:87], v[52:55], v[128:135], v3
    ds_read_b64_tr_b16 v[96:97], v7 offset:26752
    s_waitcnt lgkmcnt(4)
    v_mfma_f32_16x16x32_bf16 v[76:79], v[12:15], v[12:15], 0
    ds_read_b64_tr_b16 v[98:99], v7 offset:27024
    ds_read_b64_tr_b16 v[100:101], v7 offset:27840
    v_mfma_f32_16x16x32_bf16 v[68:71], v[104:107], v[12:15], 0
    ds_read_b64_tr_b16 v[102:103], v7 offset:28112
    ds_read_b128 v[104:107], v9 offset:5120
    v_mfma_f32_16x16x32_bf16 v[72:75], v[108:111], v[12:15], 0
    ds_read_b128 v[108:111], v9 offset:7168
    s_waitcnt lgkmcnt(6)
    v_mfma_f32_16x16x32_bf16 v[76:79], v[92:95], v[92:95], v[76:79]
    ds_read_b128 v[36:39], v1 offset:32768
    v_mfma_f32_16x16x32_bf16 v[68:71], v[112:115], v[92:95], v[68:71]
    v_mov_b64 v[112:113], s[20:21]
    v_mov_b64 v[114:115], s[16:17]
    v_mfma_f32_16x16x32_bf16 v[72:75], v[116:119], v[92:95], v[72:75]
    s_waitcnt lgkmcnt(3)
    v_mov_b64 v[116:117], 0
    v_mov_b64_e64 v[118:119], 0
    v_mfma_f32_16x16x32_bf16 v[68:71], v[120:123], v[96:99], v[68:71]
    s_mov_b64 vcc, s[14:15]
    v_mov_b64 v[120:121], 0
    v_mov_b64_e64 v[122:123], 0
    v_mfma_f32_16x16x32_bf16 v[68:71], v[80:83], v[100:103], v[68:71]
    s_waitcnt lgkmcnt(1)
    v_mov_b64 v[80:81], 0
    v_mov_b64_e64 v[82:83], 0
    v_mfma_f32_16x16x32_bf16 v[72:75], v[104:107], v[96:99], v[72:75]
    v_xor_b32 v9, 0x2000, v9
    v_mov_b32_e64 v16, s64
    v_mfma_f32_16x16x32_bf16 v[72:75], v[108:111], v[100:103], v[72:75]
    v_max3_f32 v12, v68, v69, v70
    v_mov_b32_e64 v109, 0
    v_mfma_f32_16x16x32_bf16 v[76:79], v[96:99], v[96:99], v[76:79]
    v_max_f32 v12, v12, v71
    v_mov_b32 v110, 0
    v_mfma_f32_16x16x32_bf16 v[76:79], v[100:103], v[100:103], v[76:79]
    v_max3_f32 v12, v12, v72, v73
    v_max3_f32 v12, v12, v74, v75
    v_smfmac_f32_16x16x64_bf16 v[88:91], v[52:55], v[136:143], v3
    ds_read_b128 v[40:43], v1 offset:33792
    v_cndmask_b32_dpp v68, v72, v68, vcc quad_perm:[2,3,2,3] row_mask:0xf bank_mask:0xf
    v_cndmask_b32_dpp v69, v73, v69, vcc quad_perm:[2,3,2,3] row_mask:0xf bank_mask:0xf
    v_max3_f32 v79, v12, v76, v77
    v_max3_f32 v96, v12, v76, v77
    v_smfmac_f32_16x16x64_bf16 v[84:87], v[56:59], v[144:151], v3
    ds_read_b128 v[44:47], v1 offset:34816
    v_permlane16_swap_b32 v79, v96
    v_max_f32 v78, v79, v96
    v_max_f32_e64 v79, v79, v96
    v_smfmac_f32_16x16x64_bf16 v[88:91], v[56:59], v[152:159], v3
    ds_read_b128 v[48:51], v1 offset:35840
    v_permlane32_swap_b32 v78, v79
    v_max_f32 v78, v78, v79
    v_smfmac_f32_16x16x64_bf16 v[84:87], v[60:63], v[160:167], v3
    ds_read_b128 v[52:55], v1 offset:49152
    v_mul_f32_dpp v78, v78, v16 quad_perm:[2,3,2,3] row_mask:0xf bank_mask:0xf
    v_smfmac_f32_16x16x64_bf16 v[88:91], v[60:63], v[168:175], v3
    ds_read_b128 v[56:59], v1 offset:50176
    v_cndmask_b32_dpp v76, v77, v76, vcc quad_perm:[2,3,2,3] row_mask:0xf bank_mask:0xf
    v_smfmac_f32_16x16x64_bf16 v[84:87], v[64:67], v[176:183], v3
    ds_read_b128 v[60:63], v1 offset:51200
    v_cndmask_b32_dpp v70, v74, v70, vcc quad_perm:[2,3,2,3] row_mask:0xf bank_mask:0xf
    v_smfmac_f32_16x16x64_bf16 v[88:91], v[64:67], v[184:191], v3
    ds_read_b128 v[64:67], v1 offset:52224
    v_cndmask_b32_dpp v71, v75, v71, vcc quad_perm:[2,3,2,3] row_mask:0xf bank_mask:0xf
    v_fma_f32 v76, v76, s64, -v78
    v_exp_f32_e64 v76, v76
    v_pk_fma_f32 v[68:69], v[68:69], s[12:13], v[78:79] op_sel_hi:[1,1,0] neg_lo:[0,0,1] neg_hi:[0,0,1]
    v_pk_fma_f32 v[70:71], v[70:71], s[12:13], v[78:79] op_sel_hi:[1,1,0] neg_lo:[0,0,1] neg_hi:[0,0,1]
    v_mov_b32_dpp v77, v76 quad_perm:[0,1,0,1] row_mask:0xf bank_mask:0xf
    v_pk_add_f32 v[84:85], v[84:85], v[86:87]
    v_pk_add_f32 v[88:89], v[88:89], v[90:91]
    v_cvt_pk_bf16_f32 v108, v76, v77
    v_cvt_pk_bf16_f32 v111, v76, v77
    v_cvt_pk_bf16_f32 v16, v84, v85
    v_cvt_pk_bf16_f32 v17, v88, v89
    v_exp_f32 v68, v68
    v_exp_f32 v69, v69
    v_mfma_f32_16x16x16_bf16 v[92:95], v[16:17], v[108:109], 0
    v_cvt_pk_bf16_f32 v104, v68, v69
    v_exp_f32_e64 v70, v70
    v_mfma_f32_16x16x16_bf16 v[96:99], v[16:17], v[110:111], 0
    v_exp_f32_e64 v71, v71
    v_cvt_pk_bf16_f32 v103, v76, 0
    v_cvt_pk_bf16_f32 v105, v70, v71
    v_mov_b32_dpp v106, v104 quad_perm:[0,1,0,1] row_mask:0xf bank_mask:0xf
    s_nop 0
    v_mfma_f32_16x16x32_bf16 v[72:75], v[112:115], v[102:105], 0
    v_mov_b32_dpp v107, v105 quad_perm:[0,1,0,1] row_mask:0xf bank_mask:0xf
    s_nop 1
    v_mfma_f32_16x16x32_bf16 v[92:95], v[20:23], v[104:107], v[92:95]
    v_mfma_f32_16x16x32_bf16 v[96:99], v[24:27], v[104:107], v[96:99]
    v_add_f32_dpp v72, v72, v72 quad_perm:[2,3,0,1] row_mask:0xf bank_mask:0xf
    v_rcp_f32 v72, v72
    s_mov_b64 exec, s[14:15]
    v_mul_f32 v92, v72, v92
    v_mul_f32 v93, v72, v93
    v_mul_f32 v94, v72, v94
    v_mul_f32 v95, v72, v95
    v_cvt_pk_bf16_f32 v84, v92, v93
    v_cvt_pk_bf16_f32 v85, v94, v95
    ds_write_b64 v8, v[84:85] offset:28928
    v_pk_mul_f32 v[96:97], v[96:97], v[72:73] op_sel_hi:[1,0]
    v_pk_mul_f32 v[98:99], v[98:99], v[72:73] op_sel_hi:[1,0]
    v_cvt_pk_bf16_f32 v86, v96, v97
    v_cvt_pk_bf16_f32 v87, v98, v99
    ds_write_b64 v8, v[86:87] offset:28936
    s_mov_b64 exec, -1
    v_mov_b32_dpp v88, v84 quad_perm:[2,3,2,3] row_mask:0xf bank_mask:0xf
    v_mov_b32_dpp v89, v85 quad_perm:[2,3,2,3] row_mask:0xf bank_mask:0xf
    v_mov_b32_dpp v90, v86 quad_perm:[2,3,2,3] row_mask:0xf bank_mask:0xf
    v_mov_b32_dpp v91, v87 quad_perm:[2,3,2,3] row_mask:0xf bank_mask:0xf
    s_waitcnt lgkmcnt(2)
    s_nop 0
    v_smfmac_f32_16x16x64_bf16 v[116:119], v[88:91], v[36:43], v3
    s_waitcnt lgkmcnt(0)
    s_barrier
    ds_read_b128 v[68:71], v8 offset:29440
    ds_read_b128 v[72:75], v8 offset:29952
    ds_read_b128 v[76:79], v8 offset:30464
    v_smfmac_f32_16x16x64_bf16 v[120:123], v[88:91], v[44:51], v3
    ds_read_b128 v[36:39], v2 offset:16384
    v_smfmac_f32_16x16x64_bf16 v[80:83], v[88:91], v[52:59], v3
    ds_read_b128 v[40:43], v2 offset:17408
    v_smfmac_f32_16x16x64_bf16 v[124:127], v[88:91], v[60:67], v3
    ds_read_b128 v[44:47], v2 offset:0
    s_waitcnt lgkmcnt(5)
    v_smfmac_f32_16x16x64_bf16 v[116:119], v[68:71], v[192:199], v3
    ds_read_b128 v[48:51], v2 offset:1024
    s_waitcnt lgkmcnt(5)
    v_smfmac_f32_16x16x64_bf16 v[116:119], v[72:75], v[200:207], v3
    ds_read_b128 v[52:55], v2 offset:2048
    s_waitcnt lgkmcnt(5)
    v_smfmac_f32_16x16x64_bf16 v[116:119], v[76:79], v[208:215], v3
    ds_read_b128 v[56:59], v2 offset:3072
    ds_read_b128 v[60:63], v2 offset:18432
    v_smfmac_f32_16x16x64_bf16 v[120:123], v[68:71], v[216:223], v3
    ds_read_b128 v[64:67], v2 offset:19456
    v_smfmac_f32_16x16x64_bf16 v[120:123], v[72:75], v[224:231], v3
    v_cvt_pk_bf16_f32 v116, v116, v117
    v_cvt_pk_bf16_f32 v117, v118, v119
    v_bfi_b32 v116, 1, s18, v116
    v_bfi_b32 v117, 1, s18, v117
    v_smfmac_f32_16x16x64_bf16 v[120:123], v[76:79], v[232:239], v3
    buffer_store_dwordx2 v[116:117], v4, s[4:7], s29 offen sc1
    v_smfmac_f32_16x16x64_bf16 v[80:83], v[68:71], v[240:247], v3
    s_waitcnt lgkmcnt(0)
    v_smfmac_f32_16x16x64_bf16 v[80:83], v[72:75], v[248:255], v3
    v_cvt_pk_bf16_f32 v120, v120, v121
    v_cvt_pk_bf16_f32 v121, v122, v123
    v_bfi_b32 v120, 1, s18, v120
    v_bfi_b32 v121, 1, s18, v121
    v_smfmac_f32_16x16x64_bf16 v[80:83], v[76:79], v[36:43], v3
    buffer_store_dwordx2 v[120:121], v4, s[4:7], s8 offen sc1
    v_smfmac_f32_16x16x64_bf16 v[124:127], v[68:71], v[44:51], v3
    v_smfmac_f32_16x16x64_bf16 v[124:127], v[72:75], v[52:59], v3
    v_cvt_pk_bf16_f32 v80, v80, v81
    v_cvt_pk_bf16_f32 v81, v82, v83
    v_bfi_b32 v80, 1, s18, v80
    v_bfi_b32 v81, 1, s18, v81
    v_smfmac_f32_16x16x64_bf16 v[124:127], v[76:79], v[60:67], v3
    buffer_store_dwordx2 v[80:81], v4, s[4:7], s9 offen sc1
    s_nop 6
    v_cvt_pk_bf16_f32 v124, v124, v125
    v_cvt_pk_bf16_f32 v125, v126, v127
    v_bfi_b32 v124, 1, s18, v124
    v_bfi_b32 v125, 1, s18, v125
    buffer_store_dwordx2 v[124:125], v4, s[4:7], s10 offen sc1
    s_branch S0_loop
S0_pa1:
S0_par:
    buffer_load_dwordx4 v[40:43], v10, s[4:7], s30 offen sc1
    buffer_load_dwordx4 v[44:47], v10, s[4:7], s30 offen offset:2048 sc1
    s_waitcnt vmcnt(1)
    v_mfma_f32_16x16x32_bf16 v[64:67], v[12:15], v[40:43], 0
    v_bitop3_b32 v16, v40, v41, s18 bitop3:0x7e
    v_bitop3_b32 v17, v42, v43, s18 bitop3:0x7e
    s_waitcnt vmcnt(0)
    v_mfma_f32_16x16x32_bf16 v[64:67], v[12:15], v[44:47], v[64:67]
    v_bitop3_b32 v18, v44, v45, s18 bitop3:0x7e
    v_or3_b32 v16, v16, v17, v18
    v_bitop3_b32 v17, v46, v47, s18 bitop3:0x7e
    v_bitop3_b32 v16, v16, v17, 1 bitop3:0xa8
    v_cmp_ne_u32 vcc, 0, v16
    s_nop 1
    v_add_f32_dpp v64, v64, v64 row_ror:4 row_mask:0xf bank_mask:0xf
    v_add_f32_dpp v65, v65, v65 row_ror:4 row_mask:0xf bank_mask:0xf
    s_nop 0
    v_add_f32_dpp v64, v64, v64 row_ror:8 row_mask:0xf bank_mask:0xf
    v_add_f32_dpp v65, v65, v65 row_ror:8 row_mask:0xf bank_mask:0xf
    v_cvt_pk_bf16_f32 v18, v64, v65
    s_cbranch_vccz S0_pub
    s_add_u32 s35, s35, 1
    s_cmp_lt_u32 s35, 131072
    s_cbranch_scc1 S0_par
    s_branch L_END
S0_last:
    buffer_store_dword v18, v5, s[4:7], s32 offen sc1
    s_branch R_DONE
S0_flag:
    buffer_load_dword v11, off, s[4:7], s33 sc1
    s_waitcnt vmcnt(0)
    v_cmp_eq_u32 vcc, 0, v11
    s_cbranch_vccz S0_flagok
    s_add_u32 s35, s35, 1
    s_cmp_lt_u32 s35, 131072
    s_cbranch_scc1 S0_flag
    s_branch L_END
S0_pe1:
S0_pe2:
    buffer_load_dwordx4 v[36:39], v10, s[4:7], s28 offen sc1
    s_add_u32 s35, s35, 1
    s_cmp_ge_u32 s35, 131072
    s_cbranch_scc1 L_END
    s_waitcnt vmcnt(0)
    v_max3_u32 v16, v36, v37, v38
    v_max_u32 v16, v16, v39
    v_cmp_eq_u32 vcc, -1, v16
    ds_write_b128 v0, v[36:39] offset:16384
    s_cbranch_vccz S0_peok
    s_branch S0_pe2
S0_plr:
    s_mov_b32 m0, 20480
    s_nop 0
    buffer_load_dwordx4 v[52:55], v10, s[4:7], s69 offen sc1
    buffer_load_dwordx4 v10, s[4:7], s69 offen sc1 lds
    s_mov_b32 m0, s66
    s_waitcnt vmcnt(0)
    v_max3_u32 v16, v52, v53, v54
    v_max_u32 v16, v16, v55
    v_cmp_eq_u32 vcc, -1, v16
    s_waitcnt lgkmcnt(0)
    s_cbranch_vccz S0_plok
    s_add_u32 s35, s35, 1
    s_cmp_lt_u32 s35, 131072
    s_cbranch_scc1 S0_plr
    s_branch L_END
S1_loop:
    s_waitcnt vmcnt(0)
    s_xor_b32 s9, s9, 0x40000
    s_xor_b32 s10, s10, 0x40000
    v_mov_b64 v[80:81], 0
    v_mov_b64_e64 v[124:125], 0
    ds_read_b128 v[12:15], v0 offset:30976
    v_mov_b64_e64 v[68:69], 0
    ds_read_b128 v[92:95], v0 offset:53248
    v_mov_b64_e64 v[70:71], 0
    ds_read_b128 v[96:99], v0 offset:54272
    v_mov_b64_e64 v[72:73], 0
    ds_read_b128 v[100:103], v1 offset:20480
    v_mov_b64_e64 v[74:75], 0
    ds_read_b128 v[104:107], v1 offset:21504
    v_mov_b64_e64 v[76:77], 0
    ds_read_b128 v[108:111], v0 offset:55296
    v_mov_b64_e64 v[78:79], 0
    ds_read_b128 v[112:115], v0 offset:56320
    v_mov_b64_e64 v[82:83], 0
    ds_read_b128 v[116:119], v1 offset:22528
    v_mov_b64_e64 v[84:85], 0
    ds_read_b128 v[120:123], v1 offset:23552
    v_mov_b64_e64 v[86:87], 0
    s_xor_b32 s29, s29, 0x40000
    v_mov_b64_e64 v[88:89], 0
    s_xor_b32 s8, s8, 0x40000
    v_mov_b64_e64 v[90:91], 0
    s_add_u32 s32, s32, 0x2000
    v_mov_b64_e64 v[126:127], 0
    s_add_u32 s31, s31, 0x4000
    s_add_u32 s70, s31, 0x2000
    s_xor_b32 s66, s66, 0x2000
    s_mov_b32 m0, 21504
    s_waitcnt lgkmcnt(0)
    s_nop 6
    buffer_load_dwordx4 v[40:43], v10, s[4:7], s30 offen sc1
    buffer_load_dwordx4 v[44:47], v10, s[4:7], s30 offen offset:2048 sc1
    s_waitcnt vmcnt(1)
    v_mfma_f32_16x16x32_bf16 v[64:67], v[12:15], v[40:43], 0
    v_bitop3_b32 v16, v40, v41, s18 bitop3:0x7e
    v_bitop3_b32 v17, v42, v43, s18 bitop3:0x7e
    s_waitcnt vmcnt(0)
    v_mfma_f32_16x16x32_bf16 v[64:67], v[12:15], v[44:47], v[64:67]
    v_bitop3_b32 v18, v44, v45, s18 bitop3:0x7e
    v_or3_b32 v16, v16, v17, v18
    v_bitop3_b32 v17, v46, v47, s18 bitop3:0x7e
    v_bitop3_b32 v16, v16, v17, 1 bitop3:0xa8
    v_cmp_ne_u32 vcc, 0, v16
    s_nop 1
    v_add_f32_dpp v64, v64, v64 row_ror:4 row_mask:0xf bank_mask:0xf
    v_add_f32_dpp v65, v65, v65 row_ror:4 row_mask:0xf bank_mask:0xf
    s_nop 0
    v_add_f32_dpp v64, v64, v64 row_ror:8 row_mask:0xf bank_mask:0xf
    v_add_f32_dpp v65, v65, v65 row_ror:8 row_mask:0xf bank_mask:0xf
    v_cvt_pk_bf16_f32 v18, v64, v65
    s_cbranch_vccnz S1_pa1
S1_pub:
    buffer_store_dword v18, v5, s[4:7], s27 offen sc1
S1_pub2:
    s_cmp_eq_u32 s26, 63
    s_cbranch_scc1 S1_last
    v_cmp_eq_u32 vcc, 0, v11
    v_mov_b64 v[20:21], v[28:29]
    v_mov_b64 v[22:23], v[30:31]
    v_mov_b64 v[24:25], v[32:33]
    v_mov_b64_e64 v[26:27], v[34:35]
    s_xor_b32 s19, s27, 0x4000
    s_add_u32 s27, s27, 0x2000
    s_bitset0_b32 s27, 15
    s_xor_b32 s30, s30, 0x40000
    s_mov_b32 s35, 0
    s_cbranch_vccnz S1_flag
S1_flagok:
    s_add_u32 s67, s26, 2
    s_lshr_b32 s18, s67, 1
    s_add_u32 s33, s33, 16
    s_min_u32 s33, s33, s34
    s_add_u32 s26, s26, 1
    s_nop 1
    buffer_load_dwordx4 v[36:39], v10, s[4:7], s28 offen sc1
    s_waitcnt vmcnt(0)
    v_max3_u32 v16, v36, v37, v38
    v_max_u32 v16, v16, v39
    v_cmp_eq_u32 vcc, -1, v16
    ds_write_b128 v0, v[36:39] offset:17408
    s_cbranch_vccnz S1_pe1
S1_peok:
    v_smfmac_f32_16x16x64_bf16 v[68:71], v[36:39], v[92:99], v3
    buffer_load_dwordx4 v[52:55], v10, s[4:7], s69 offen sc1
    buffer_load_dwordx4 v10, s[4:7], s69 offen sc1 lds
    v_smfmac_f32_16x16x64_bf16 v[72:75], v[36:39], v[100:107], v3
    s_mov_b32 m0, s66
    v_smfmac_f32_16x16x64_bf16 v[76:79], v[36:39], v[108:115], v3
    s_waitcnt lgkmcnt(0)
    s_barrier
    ds_read_b128 v[40:43], v0 offset:18432
    ds_read_b128 v[44:47], v0 offset:19456
    v_smfmac_f32_16x16x64_bf16 v[80:83], v[36:39], v[116:123], v3
    ds_read_b128 v[48:51], v0 offset:16384
    v_smfmac_f32_16x16x64_bf16 v[84:87], v[36:39], a[192:199], v3
    ds_read_b128 v[92:95], v0 offset:36864
    v_smfmac_f32_16x16x64_bf16 v[88:91], v[36:39], a[200:207], v3
    ds_read_b128 v[96:99], v0 offset:37888
    s_waitcnt lgkmcnt(4)
    v_smfmac_f32_16x16x64_bf16 v[68:71], v[40:43], a[0:7], v3
    ds_read_b128 v[100:103], v0 offset:38912
    v_smfmac_f32_16x16x64_bf16 v[72:75], v[40:43], a[8:15], v3
    ds_read_b128 v[104:107], v0 offset:39936
    v_smfmac_f32_16x16x64_bf16 v[76:79], v[40:43], a[16:23], v3
    ds_read_b128 v[108:111], v1 offset:4096
    v_smfmac_f32_16x16x64_bf16 v[80:83], v[40:43], a[24:31], v3
    ds_read_b128 v[112:115], v1 offset:5120
    s_waitcnt lgkmcnt(7)
    v_smfmac_f32_16x16x64_bf16 v[68:71], v[44:47], a[32:39], v3
    ds_read_b128 v[116:119], v1 offset:6144
    v_smfmac_f32_16x16x64_bf16 v[72:75], v[44:47], a[40:47], v3
    ds_read_b128 v[120:123], v1 offset:7168
    v_smfmac_f32_16x16x64_bf16 v[76:79], v[44:47], a[48:55], v3
    v_smfmac_f32_16x16x64_bf16 v[80:83], v[44:47], a[56:63], v3
    s_waitcnt lgkmcnt(8)
    s_waitcnt lgkmcnt(6)
    v_smfmac_f32_16x16x64_bf16 v[68:71], v[48:51], v[92:99], v3
    s_waitcnt vmcnt(1)
    v_max3_u32 v16, v52, v53, v54
    v_smfmac_f32_16x16x64_bf16 v[72:75], v[48:51], a[64:71], v3
    s_waitcnt lgkmcnt(4)
    v_max_u32_e64 v16, v16, v55
    v_smfmac_f32_16x16x64_bf16 v[76:79], v[48:51], v[100:107], v3
    v_cmp_eq_u32_e64 vcc, -1, v16
    v_smfmac_f32_16x16x64_bf16 v[80:83], v[48:51], a[72:79], v3
    s_waitcnt vmcnt(0)
    s_waitcnt lgkmcnt(0)
    v_smfmac_f32_16x16x64_bf16 v[84:87], v[40:43], a[208:215], v3
    s_cbranch_vccnz S1_plr
S1_plok:
    s_barrier
    ds_read_b128 v[56:59], v0 offset:22528
    v_smfmac_f32_16x16x64_bf16 v[68:71], v[52:55], v[108:115], v3
    ds_read_b128 v[60:63], v0 offset:23552
    ds_read_b128 v[64:67], v0 offset:20480
    v_smfmac_f32_16x16x64_bf16 v[72:75], v[52:55], a[80:87], v3
    buffer_load_dwordx4 v0, s[4:7], s31 offen sc1 lds
    v_smfmac_f32_16x16x64_bf16 v[76:79], v[52:55], v[116:123], v3
    v_smfmac_f32_16x16x64_bf16 v[80:83], v[52:55], a[88:95], v3
    buffer_load_dword v11, off, s[4:7], s33 sc1
    s_waitcnt lgkmcnt(2)
    v_smfmac_f32_16x16x64_bf16 v[68:71], v[56:59], a[96:103], v3
    s_waitcnt lgkmcnt(1)
    v_smfmac_f32_16x16x64_bf16 v[68:71], v[60:63], a[104:111], v3
    buffer_load_dwordx4 v0, s[4:7], s31 offen offset:1024 sc1 lds
    s_waitcnt lgkmcnt(0)
    v_smfmac_f32_16x16x64_bf16 v[68:71], v[64:67], a[112:119], v3
    ds_read_b128 v[104:107], v9 offset:2048
    v_smfmac_f32_16x16x64_bf16 v[72:75], v[56:59], a[120:127], v3
    buffer_load_dwordx4 v[28:31], v0, s[4:7], s70 offen sc1
    v_smfmac_f32_16x16x64_bf16 v[72:75], v[60:63], a[128:135], v3
    ds_read_b128 v[108:111], v9 offset:3072
    v_add_f32 v68, v68, v70
    v_smfmac_f32_16x16x64_bf16 v[72:75], v[64:67], a[136:143], v3
    ds_read_b128 v[112:115], v9 offset:4096
    v_add_f32_e64 v69, v69, v71
    v_smfmac_f32_16x16x64_bf16 v[76:79], v[56:59], a[144:151], v3
    buffer_load_dwordx4 v[32:35], v0, s[4:7], s70 offen offset:1024 sc1
    v_cvt_pk_bf16_f32 v92, v68, v69
    v_smfmac_f32_16x16x64_bf16 v[76:79], v[60:63], a[152:159], v3
    ds_read_b128 v[116:119], v9 offset:5120
    v_add_f32_e64 v72, v72, v74
    v_smfmac_f32_16x16x64_bf16 v[76:79], v[64:67], a[160:167], v3
    ds_read_b128 v[120:123], v9 offset:6144
    v_add_f32_e64 v73, v73, v75
    v_smfmac_f32_16x16x64_bf16 v[80:83], v[56:59], a[168:175], v3
    buffer_store_dword v19, v5, s[4:7], s19 offen sc1
    v_cvt_pk_bf16_f32 v93, v72, v73
    v_smfmac_f32_16x16x64_bf16 v[80:83], v[60:63], a[176:183], v3
    ds_write_b64 v6, v[92:93] offset:25664
    v_add_f32_e64 v76, v76, v78
    v_smfmac_f32_16x16x64_bf16 v[80:83], v[64:67], a[184:191], v3
    v_add_f32_e64 v77, v77, v79
    v_smfmac_f32_16x16x64_bf16 v[88:91], v[40:43], a[216:223], v3
    s_add_u32 s28, s28, 0x2000
    s_bitset0_b32 s28, 15
    v_cvt_pk_bf16_f32 v94, v76, v77
    s_add_u32 s69, s28, 0x1000
    v_add_f32 v80, v80, v82
    v_add_f32_e64 v81, v81, v83
    v_cvt_pk_bf16_f32 v95, v80, v81
    ds_write_b64 v6, v[94:95] offset:26208
    ds_read_b64_tr_b16 v[12:13], v7 offset:25664
    ds_read_b64_tr_b16 v[14:15], v7 offset:25936
    v_smfmac_f32_16x16x64_bf16 v[84:87], v[44:47], a[224:231], v3
    buffer_store_dword v18, v5, s[4:7], s32 offen sc1
    ds_read_b128 v[80:83], v9 offset:0
    v_smfmac_f32_16x16x64_bf16 v[88:91], v[44:47], a[232:239], v3
    v_smfmac_f32_16x16x64_bf16 v[84:87], v[48:51], a[240:247], v3
    s_waitcnt lgkmcnt(3)
    s_barrier
    ds_read_b64_tr_b16 v[92:93], v7 offset:26752
    ds_read_b64_tr_b16 v[94:95], v7 offset:27024
    v_smfmac_f32_16x16x64_bf16 v[88:91], v[48:51], a[248:255], v3
    v_smfmac_f32_16x16x64_bf16 v[84:87], v[52:55], v[128:135], v3
    ds_read_b64_tr_b16 v[96:97], v7 offset:27840
    s_waitcnt lgkmcnt(4)
    v_mfma_f32_16x16x32_bf16 v[76:79], v[12:15], v[12:15], 0
    ds_read_b64_tr_b16 v[98:99], v7 offset:28112
    ds_read_b64_tr_b16 v[100:101], v7 offset:24576
    v_mfma_f32_16x16x32_bf16 v[68:71], v[104:107], v[12:15], 0
    ds_read_b64_tr_b16 v[102:103], v7 offset:24848
    ds_read_b128 v[104:107], v9 offset:7168
    v_mfma_f32_16x16x32_bf16 v[72:75], v[108:111], v[12:15], 0
    ds_read_b128 v[108:111], v9 offset:1024
    s_waitcnt lgkmcnt(6)
    v_mfma_f32_16x16x32_bf16 v[76:79], v[92:95], v[92:95], v[76:79]
    ds_read_b128 v[36:39], v1 offset:53248
    v_mfma_f32_16x16x32_bf16 v[68:71], v[112:115], v[92:95], v[68:71]
    v_mov_b64 v[112:113], s[20:21]
    v_mov_b64 v[114:115], s[16:17]
    v_mfma_f32_16x16x32_bf16 v[72:75], v[116:119], v[92:95], v[72:75]
    s_waitcnt lgkmcnt(3)
    v_mov_b64 v[116:117], 0
    v_mov_b64_e64 v[118:119], 0
    v_mfma_f32_16x16x32_bf16 v[68:71], v[120:123], v[96:99], v[68:71]
    s_mov_b64 vcc, s[14:15]
    v_mov_b64 v[120:121], 0
    v_mov_b64_e64 v[122:123], 0
    v_mfma_f32_16x16x32_bf16 v[68:71], v[80:83], v[100:103], v[68:71]
    s_waitcnt lgkmcnt(1)
    v_mov_b64 v[80:81], 0
    v_mov_b64_e64 v[82:83], 0
    v_mfma_f32_16x16x32_bf16 v[72:75], v[104:107], v[96:99], v[72:75]
    v_xor_b32 v9, 0x2000, v9
    v_mov_b32_e64 v16, s64
    v_mfma_f32_16x16x32_bf16 v[72:75], v[108:111], v[100:103], v[72:75]
    v_max3_f32 v12, v68, v69, v70
    v_mov_b32_e64 v109, 0
    v_mfma_f32_16x16x32_bf16 v[76:79], v[96:99], v[96:99], v[76:79]
    v_max_f32 v12, v12, v71
    v_mov_b32 v110, 0
    v_mfma_f32_16x16x32_bf16 v[76:79], v[100:103], v[100:103], v[76:79]
    v_max3_f32 v12, v12, v72, v73
    v_max3_f32 v12, v12, v74, v75
    v_smfmac_f32_16x16x64_bf16 v[88:91], v[52:55], v[136:143], v3
    ds_read_b128 v[40:43], v1 offset:54272
    v_cndmask_b32_dpp v68, v72, v68, vcc quad_perm:[2,3,2,3] row_mask:0xf bank_mask:0xf
    v_cndmask_b32_dpp v69, v73, v69, vcc quad_perm:[2,3,2,3] row_mask:0xf bank_mask:0xf
    v_max3_f32 v79, v12, v76, v77
    v_max3_f32 v96, v12, v76, v77
    v_smfmac_f32_16x16x64_bf16 v[84:87], v[56:59], v[144:151], v3
    ds_read_b128 v[44:47], v1 offset:55296
    v_permlane16_swap_b32 v79, v96
    v_max_f32 v78, v79, v96
    v_max_f32_e64 v79, v79, v96
    v_smfmac_f32_16x16x64_bf16 v[88:91], v[56:59], v[152:159], v3
    ds_read_b128 v[48:51], v1 offset:56320
    v_permlane32_swap_b32 v78, v79
    v_max_f32 v78, v78, v79
    v_smfmac_f32_16x16x64_bf16 v[84:87], v[60:63], v[160:167], v3
    ds_read_b128 v[52:55], v2 offset:4096
    v_mul_f32_dpp v78, v78, v16 quad_perm:[2,3,2,3] row_mask:0xf bank_mask:0xf
    v_smfmac_f32_16x16x64_bf16 v[88:91], v[60:63], v[168:175], v3
    ds_read_b128 v[56:59], v2 offset:5120
    v_cndmask_b32_dpp v76, v77, v76, vcc quad_perm:[2,3,2,3] row_mask:0xf bank_mask:0xf
    v_smfmac_f32_16x16x64_bf16 v[84:87], v[64:67], v[176:183], v3
    ds_read_b128 v[60:63], v2 offset:6144
    v_cndmask_b32_dpp v70, v74, v70, vcc quad_perm:[2,3,2,3] row_mask:0xf bank_mask:0xf
    v_smfmac_f32_16x16x64_bf16 v[88:91], v[64:67], v[184:191], v3
    ds_read_b128 v[64:67], v2 offset:7168
    v_cndmask_b32_dpp v71, v75, v71, vcc quad_perm:[2,3,2,3] row_mask:0xf bank_mask:0xf
    v_fma_f32 v76, v76, s64, -v78
    v_exp_f32_e64 v76, v76
    v_pk_fma_f32 v[68:69], v[68:69], s[12:13], v[78:79] op_sel_hi:[1,1,0] neg_lo:[0,0,1] neg_hi:[0,0,1]
    v_pk_fma_f32 v[70:71], v[70:71], s[12:13], v[78:79] op_sel_hi:[1,1,0] neg_lo:[0,0,1] neg_hi:[0,0,1]
    v_mov_b32_dpp v77, v76 quad_perm:[0,1,0,1] row_mask:0xf bank_mask:0xf
    v_pk_add_f32 v[84:85], v[84:85], v[86:87]
    v_pk_add_f32 v[88:89], v[88:89], v[90:91]
    v_cvt_pk_bf16_f32 v108, v76, v77
    v_cvt_pk_bf16_f32 v111, v76, v77
    v_cvt_pk_bf16_f32 v16, v84, v85
    v_cvt_pk_bf16_f32 v17, v88, v89
    v_exp_f32 v68, v68
    v_exp_f32 v69, v69
    v_mfma_f32_16x16x16_bf16 v[92:95], v[16:17], v[108:109], 0
    v_cvt_pk_bf16_f32 v104, v68, v69
    v_exp_f32_e64 v70, v70
    v_mfma_f32_16x16x16_bf16 v[96:99], v[16:17], v[110:111], 0
    v_exp_f32_e64 v71, v71
    v_cvt_pk_bf16_f32 v103, v76, 0
    v_cvt_pk_bf16_f32 v105, v70, v71
    v_mov_b32_dpp v106, v104 quad_perm:[0,1,0,1] row_mask:0xf bank_mask:0xf
    s_nop 0
    v_mfma_f32_16x16x32_bf16 v[72:75], v[112:115], v[102:105], 0
    v_mov_b32_dpp v107, v105 quad_perm:[0,1,0,1] row_mask:0xf bank_mask:0xf
    s_nop 1
    v_mfma_f32_16x16x32_bf16 v[92:95], v[20:23], v[104:107], v[92:95]
    v_mfma_f32_16x16x32_bf16 v[96:99], v[24:27], v[104:107], v[96:99]
    v_add_f32_dpp v72, v72, v72 quad_perm:[2,3,0,1] row_mask:0xf bank_mask:0xf
    v_rcp_f32 v72, v72
    s_mov_b64 exec, s[14:15]
    v_mul_f32 v92, v72, v92
    v_mul_f32 v93, v72, v93
    v_mul_f32 v94, v72, v94
    v_mul_f32 v95, v72, v95
    v_cvt_pk_bf16_f32 v84, v92, v93
    v_cvt_pk_bf16_f32 v85, v94, v95
    ds_write_b64 v8, v[84:85] offset:29440
    v_pk_mul_f32 v[96:97], v[96:97], v[72:73] op_sel_hi:[1,0]
    v_pk_mul_f32 v[98:99], v[98:99], v[72:73] op_sel_hi:[1,0]
    v_cvt_pk_bf16_f32 v86, v96, v97
    v_cvt_pk_bf16_f32 v87, v98, v99
    ds_write_b64 v8, v[86:87] offset:29448
    s_mov_b64 exec, -1
    v_mov_b32_dpp v88, v84 quad_perm:[2,3,2,3] row_mask:0xf bank_mask:0xf
    v_mov_b32_dpp v89, v85 quad_perm:[2,3,2,3] row_mask:0xf bank_mask:0xf
    v_mov_b32_dpp v90, v86 quad_perm:[2,3,2,3] row_mask:0xf bank_mask:0xf
    v_mov_b32_dpp v91, v87 quad_perm:[2,3,2,3] row_mask:0xf bank_mask:0xf
    s_waitcnt lgkmcnt(2)
    s_nop 0
    v_smfmac_f32_16x16x64_bf16 v[116:119], v[88:91], v[36:43], v3
    s_waitcnt lgkmcnt(0)
    s_barrier
    ds_read_b128 v[68:71], v8 offset:29952
    ds_read_b128 v[72:75], v8 offset:30464
    ds_read_b128 v[76:79], v8 offset:28928
    v_smfmac_f32_16x16x64_bf16 v[120:123], v[88:91], v[44:51], v3
    ds_read_b128 v[36:39], v1 offset:36864
    v_smfmac_f32_16x16x64_bf16 v[80:83], v[88:91], v[52:59], v3
    ds_read_b128 v[40:43], v1 offset:37888
    v_smfmac_f32_16x16x64_bf16 v[124:127], v[88:91], v[60:67], v3
    ds_read_b128 v[44:47], v2 offset:20480
    s_waitcnt lgkmcnt(5)
    v_smfmac_f32_16x16x64_bf16 v[116:119], v[68:71], v[192:199], v3
    ds_read_b128 v[48:51], v2 offset:21504
    s_waitcnt lgkmcnt(5)
    v_smfmac_f32_16x16x64_bf16 v[116:119], v[72:75], v[200:207], v3
    ds_read_b128 v[52:55], v2 offset:22528
    s_waitcnt lgkmcnt(5)
    v_smfmac_f32_16x16x64_bf16 v[116:119], v[76:79], v[208:215], v3
    ds_read_b128 v[56:59], v2 offset:23552
    ds_read_b128 v[60:63], v1 offset:38912
    v_smfmac_f32_16x16x64_bf16 v[120:123], v[68:71], v[216:223], v3
    ds_read_b128 v[64:67], v1 offset:39936
    v_smfmac_f32_16x16x64_bf16 v[120:123], v[72:75], v[224:231], v3
    v_cvt_pk_bf16_f32 v116, v116, v117
    v_cvt_pk_bf16_f32 v117, v118, v119
    v_bfi_b32 v116, 1, s18, v116
    v_bfi_b32 v117, 1, s18, v117
    v_smfmac_f32_16x16x64_bf16 v[120:123], v[76:79], v[232:239], v3
    buffer_store_dwordx2 v[116:117], v4, s[4:7], s29 offen sc1
    v_smfmac_f32_16x16x64_bf16 v[80:83], v[68:71], v[240:247], v3
    s_waitcnt lgkmcnt(0)
    v_smfmac_f32_16x16x64_bf16 v[80:83], v[72:75], v[248:255], v3
    v_cvt_pk_bf16_f32 v120, v120, v121
    v_cvt_pk_bf16_f32 v121, v122, v123
    v_bfi_b32 v120, 1, s18, v120
    v_bfi_b32 v121, 1, s18, v121
    v_smfmac_f32_16x16x64_bf16 v[80:83], v[76:79], v[36:43], v3
    buffer_store_dwordx2 v[120:121], v4, s[4:7], s8 offen sc1
    v_smfmac_f32_16x16x64_bf16 v[124:127], v[68:71], v[44:51], v3
    v_smfmac_f32_16x16x64_bf16 v[124:127], v[72:75], v[52:59], v3
    v_cvt_pk_bf16_f32 v80, v80, v81
    v_cvt_pk_bf16_f32 v81, v82, v83
    v_bfi_b32 v80, 1, s18, v80
    v_bfi_b32 v81, 1, s18, v81
    v_smfmac_f32_16x16x64_bf16 v[124:127], v[76:79], v[60:67], v3
    buffer_store_dwordx2 v[80:81], v4, s[4:7], s9 offen sc1
    s_nop 6
    v_cvt_pk_bf16_f32 v124, v124, v125
    v_cvt_pk_bf16_f32 v125, v126, v127
    v_bfi_b32 v124, 1, s18, v124
    v_bfi_b32 v125, 1, s18, v125
    buffer_store_dwordx2 v[124:125], v4, s[4:7], s10 offen sc1
    s_branch S1_loop
S1_pa1:
S1_par:
    buffer_load_dwordx4 v[40:43], v10, s[4:7], s30 offen sc1
    buffer_load_dwordx4 v[44:47], v10, s[4:7], s30 offen offset:2048 sc1
    s_waitcnt vmcnt(1)
    v_mfma_f32_16x16x32_bf16 v[64:67], v[12:15], v[40:43], 0
    v_bitop3_b32 v16, v40, v41, s18 bitop3:0x7e
    v_bitop3_b32 v17, v42, v43, s18 bitop3:0x7e
    s_waitcnt vmcnt(0)
    v_mfma_f32_16x16x32_bf16 v[64:67], v[12:15], v[44:47], v[64:67]
    v_bitop3_b32 v18, v44, v45, s18 bitop3:0x7e
    v_or3_b32 v16, v16, v17, v18
    v_bitop3_b32 v17, v46, v47, s18 bitop3:0x7e
    v_bitop3_b32 v16, v16, v17, 1 bitop3:0xa8
    v_cmp_ne_u32 vcc, 0, v16
    s_nop 1
    v_add_f32_dpp v64, v64, v64 row_ror:4 row_mask:0xf bank_mask:0xf
    v_add_f32_dpp v65, v65, v65 row_ror:4 row_mask:0xf bank_mask:0xf
    s_nop 0
    v_add_f32_dpp v64, v64, v64 row_ror:8 row_mask:0xf bank_mask:0xf
    v_add_f32_dpp v65, v65, v65 row_ror:8 row_mask:0xf bank_mask:0xf
    v_cvt_pk_bf16_f32 v18, v64, v65
    s_cbranch_vccz S1_pub
    s_add_u32 s35, s35, 1
    s_cmp_lt_u32 s35, 131072
    s_cbranch_scc1 S1_par
    s_branch L_END
S1_last:
    buffer_store_dword v18, v5, s[4:7], s32 offen sc1
    s_branch R_DONE
S1_flag:
    buffer_load_dword v11, off, s[4:7], s33 sc1
    s_waitcnt vmcnt(0)
    v_cmp_eq_u32 vcc, 0, v11
    s_cbranch_vccz S1_flagok
    s_add_u32 s35, s35, 1
    s_cmp_lt_u32 s35, 131072
    s_cbranch_scc1 S1_flag
    s_branch L_END
S1_pe1:
S1_pe2:
    buffer_load_dwordx4 v[36:39], v10, s[4:7], s28 offen sc1
    s_add_u32 s35, s35, 1
    s_cmp_ge_u32 s35, 131072
    s_cbranch_scc1 L_END
    s_waitcnt vmcnt(0)
    v_max3_u32 v16, v36, v37, v38
    v_max_u32 v16, v16, v39
    v_cmp_eq_u32 vcc, -1, v16
    ds_write_b128 v0, v[36:39] offset:17408
    s_cbranch_vccz S1_peok
    s_branch S1_pe2
S1_plr:
    s_mov_b32 m0, 21504
    s_nop 0
    buffer_load_dwordx4 v[52:55], v10, s[4:7], s69 offen sc1
    buffer_load_dwordx4 v10, s[4:7], s69 offen sc1 lds
    s_mov_b32 m0, s66
    s_waitcnt vmcnt(0)
    v_max3_u32 v16, v52, v53, v54
    v_max_u32 v16, v16, v55
    v_cmp_eq_u32 vcc, -1, v16
    s_waitcnt lgkmcnt(0)
    s_cbranch_vccz S1_plok
    s_add_u32 s35, s35, 1
    s_cmp_lt_u32 s35, 131072
    s_cbranch_scc1 S1_plr
    s_branch L_END
S2_loop:
    s_waitcnt vmcnt(0)
    s_xor_b32 s9, s9, 0x40000
    s_xor_b32 s10, s10, 0x40000
    v_mov_b64 v[80:81], 0
    v_mov_b64_e64 v[124:125], 0
    ds_read_b128 v[12:15], v0 offset:30976
    v_mov_b64_e64 v[68:69], 0
    ds_read_b128 v[92:95], v0 offset:40960
    v_mov_b64_e64 v[70:71], 0
    ds_read_b128 v[96:99], v0 offset:41984
    v_mov_b64_e64 v[72:73], 0
    ds_read_b128 v[100:103], v1 offset:24576
    v_mov_b64_e64 v[74:75], 0
    ds_read_b128 v[104:107], v1 offset:25600
    v_mov_b64_e64 v[76:77], 0
    ds_read_b128 v[108:111], v0 offset:43008
    v_mov_b64_e64 v[78:79], 0
    ds_read_b128 v[112:115], v0 offset:44032
    v_mov_b64_e64 v[82:83], 0
    ds_read_b128 v[116:119], v1 offset:26624
    v_mov_b64_e64 v[84:85], 0
    ds_read_b128 v[120:123], v1 offset:27648
    v_mov_b64_e64 v[86:87], 0
    s_xor_b32 s29, s29, 0x40000
    v_mov_b64_e64 v[88:89], 0
    s_xor_b32 s8, s8, 0x40000
    v_mov_b64_e64 v[90:91], 0
    s_add_u32 s32, s32, 0x2000
    v_mov_b64_e64 v[126:127], 0
    s_add_u32 s31, s31, 0x4000
    s_add_u32 s70, s31, 0x2000
    s_xor_b32 s66, s66, 0x2000
    s_mov_b32 m0, 22528
    s_waitcnt lgkmcnt(0)
    s_nop 6
    buffer_load_dwordx4 v[40:43], v10, s[4:7], s30 offen sc1
    buffer_load_dwordx4 v[44:47], v10, s[4:7], s30 offen offset:2048 sc1
    s_waitcnt vmcnt(1)
    v_mfma_f32_16x16x32_bf16 v[64:67], v[12:15], v[40:43], 0
    v_bitop3_b32 v16, v40, v41, s18 bitop3:0x7e
    v_bitop3_b32 v17, v42, v43, s18 bitop3:0x7e
    s_waitcnt vmcnt(0)
    v_mfma_f32_16x16x32_bf16 v[64:67], v[12:15], v[44:47], v[64:67]
    v_bitop3_b32 v18, v44, v45, s18 bitop3:0x7e
    v_or3_b32 v16, v16, v17, v18
    v_bitop3_b32 v17, v46, v47, s18 bitop3:0x7e
    v_bitop3_b32 v16, v16, v17, 1 bitop3:0xa8
    v_cmp_ne_u32 vcc, 0, v16
    s_nop 1
    v_add_f32_dpp v64, v64, v64 row_ror:4 row_mask:0xf bank_mask:0xf
    v_add_f32_dpp v65, v65, v65 row_ror:4 row_mask:0xf bank_mask:0xf
    s_nop 0
    v_add_f32_dpp v64, v64, v64 row_ror:8 row_mask:0xf bank_mask:0xf
    v_add_f32_dpp v65, v65, v65 row_ror:8 row_mask:0xf bank_mask:0xf
    v_cvt_pk_bf16_f32 v18, v64, v65
    s_cbranch_vccnz S2_pa1
S2_pub:
    buffer_store_dword v18, v5, s[4:7], s27 offen sc1
S2_pub2:
    s_cmp_eq_u32 s26, 63
    s_cbranch_scc1 S2_last
    v_cmp_eq_u32 vcc, 0, v11
    v_mov_b64 v[20:21], v[28:29]
    v_mov_b64 v[22:23], v[30:31]
    v_mov_b64 v[24:25], v[32:33]
    v_mov_b64_e64 v[26:27], v[34:35]
    s_xor_b32 s19, s27, 0x4000
    s_add_u32 s27, s27, 0x2000
    s_bitset0_b32 s27, 15
    s_xor_b32 s30, s30, 0x40000
    s_mov_b32 s35, 0
    s_cbranch_vccnz S2_flag
S2_flagok:
    s_add_u32 s67, s26, 2
    s_lshr_b32 s18, s67, 1
    s_add_u32 s33, s33, 16
    s_min_u32 s33, s33, s34
    s_add_u32 s26, s26, 1
    s_nop 1
    buffer_load_dwordx4 v[36:39], v10, s[4:7], s28 offen sc1
    s_waitcnt vmcnt(0)
    v_max3_u32 v16, v36, v37, v38
    v_max_u32 v16, v16, v39
    v_cmp_eq_u32 vcc, -1, v16
    ds_write_b128 v0, v[36:39] offset:18432
    s_cbranch_vccnz S2_pe1
S2_peok:
    v_smfmac_f32_16x16x64_bf16 v[68:71], v[36:39], v[92:99], v3
    buffer_load_dwordx4 v[52:55], v10, s[4:7], s69 offen sc1
    buffer_load_dwordx4 v10, s[4:7], s69 offen sc1 lds
    v_smfmac_f32_16x16x64_bf16 v[72:75], v[36:39], v[100:107], v3
    s_mov_b32 m0, s66
    v_smfmac_f32_16x16x64_bf16 v[76:79], v[36:39], v[108:115], v3
    s_waitcnt lgkmcnt(0)
    s_barrier
    ds_read_b128 v[40:43], v0 offset:19456
    ds_read_b128 v[44:47], v0 offset:16384
    v_smfmac_f32_16x16x64_bf16 v[80:83], v[36:39], v[116:123], v3
    ds_read_b128 v[48:51], v0 offset:17408
    v_smfmac_f32_16x16x64_bf16 v[84:87], v[36:39], a[192:199], v3
    ds_read_b128 v[92:95], v0 offset:57344
    v_smfmac_f32_16x16x64_bf16 v[88:91], v[36:39], a[200:207], v3
    ds_read_b128 v[96:99], v0 offset:58368
    s_waitcnt lgkmcnt(4)
    v_smfmac_f32_16x16x64_bf16 v[68:71], v[40:43], a[0:7], v3
    ds_read_b128 v[100:103], v0 offset:59392
    v_smfmac_f32_16x16x64_bf16 v[72:75], v[40:43], a[8:15], v3
    ds_read_b128 v[104:107], v0 offset:60416
    v_smfmac_f32_16x16x64_bf16 v[76:79], v[40:43], a[16:23], v3
    ds_read_b128 v[108:111], v1 offset:8192
    v_smfmac_f32_16x16x64_bf16 v[80:83], v[40:43], a[24:31], v3
    ds_read_b128 v[112:115], v1 offset:9216
    s_waitcnt lgkmcnt(7)
    v_smfmac_f32_16x16x64_bf16 v[68:71], v[44:47], a[32:39], v3
    ds_read_b128 v[116:119], v1 offset:10240
    v_smfmac_f32_16x16x64_bf16 v[72:75], v[44:47], a[40:47], v3
    ds_read_b128 v[120:123], v1 offset:11264
    v_smfmac_f32_16x16x64_bf16 v[76:79], v[44:47], a[48:55], v3
    v_smfmac_f32_16x16x64_bf16 v[80:83], v[44:47], a[56:63], v3
    s_waitcnt lgkmcnt(8)
    s_waitcnt lgkmcnt(6)
    v_smfmac_f32_16x16x64_bf16 v[68:71], v[48:51], v[92:99], v3
    s_waitcnt vmcnt(1)
    v_max3_u32 v16, v52, v53, v54
    v_smfmac_f32_16x16x64_bf16 v[72:75], v[48:51], a[64:71], v3
    s_waitcnt lgkmcnt(4)
    v_max_u32_e64 v16, v16, v55
    v_smfmac_f32_16x16x64_bf16 v[76:79], v[48:51], v[100:107], v3
    v_cmp_eq_u32_e64 vcc, -1, v16
    v_smfmac_f32_16x16x64_bf16 v[80:83], v[48:51], a[72:79], v3
    s_waitcnt vmcnt(0)
    s_waitcnt lgkmcnt(0)
    v_smfmac_f32_16x16x64_bf16 v[84:87], v[40:43], a[208:215], v3
    s_cbranch_vccnz S2_plr
S2_plok:
    s_barrier
    ds_read_b128 v[56:59], v0 offset:23552
    v_smfmac_f32_16x16x64_bf16 v[68:71], v[52:55], v[108:115], v3
    ds_read_b128 v[60:63], v0 offset:20480
    ds_read_b128 v[64:67], v0 offset:21504
    v_smfmac_f32_16x16x64_bf16 v[72:75], v[52:55], a[80:87], v3
    buffer_load_dwordx4 v0, s[4:7], s31 offen sc1 lds
    v_smfmac_f32_16x16x64_bf16 v[76:79], v[52:55], v[116:123], v3
    v_smfmac_f32_16x16x64_bf16 v[80:83], v[52:55], a[88:95], v3
    buffer_load_dword v11, off, s[4:7], s33 sc1
    s_waitcnt lgkmcnt(2)
    v_smfmac_f32_16x16x64_bf16 v[68:71], v[56:59], a[96:103], v3
    s_waitcnt lgkmcnt(1)
    v_smfmac_f32_16x16x64_bf16 v[68:71], v[60:63], a[104:111], v3
    buffer_load_dwordx4 v0, s[4:7], s31 offen offset:1024 sc1 lds
    s_waitcnt lgkmcnt(0)
    v_smfmac_f32_16x16x64_bf16 v[68:71], v[64:67], a[112:119], v3
    ds_read_b128 v[104:107], v9 offset:4096
    v_smfmac_f32_16x16x64_bf16 v[72:75], v[56:59], a[120:127], v3
    buffer_load_dwordx4 v[28:31], v0, s[4:7], s70 offen sc1
    v_smfmac_f32_16x16x64_bf16 v[72:75], v[60:63], a[128:135], v3
    ds_read_b128 v[108:111], v9 offset:5120
    v_add_f32 v68, v68, v70
    v_smfmac_f32_16x16x64_bf16 v[72:75], v[64:67], a[136:143], v3
    ds_read_b128 v[112:115], v9 offset:6144
    v_add_f32_e64 v69, v69, v71
    v_smfmac_f32_16x16x64_bf16 v[76:79], v[56:59], a[144:151], v3
    buffer_load_dwordx4 v[32:35], v0, s[4:7], s70 offen offset:1024 sc1
    v_cvt_pk_bf16_f32 v92, v68, v69
    v_smfmac_f32_16x16x64_bf16 v[76:79], v[60:63], a[152:159], v3
    ds_read_b128 v[116:119], v9 offset:7168
    v_add_f32_e64 v72, v72, v74
    v_smfmac_f32_16x16x64_bf16 v[76:79], v[64:67], a[160:167], v3
    ds_read_b128 v[120:123], v9 offset:0
    v_add_f32_e64 v73, v73, v75
    v_smfmac_f32_16x16x64_bf16 v[80:83], v[56:59], a[168:175], v3
    buffer_store_dword v19, v5, s[4:7], s19 offen sc1
    v_cvt_pk_bf16_f32 v93, v72, v73
    v_smfmac_f32_16x16x64_bf16 v[80:83], v[60:63], a[176:183], v3
    ds_write_b64 v6, v[92:93] offset:26752
    v_add_f32_e64 v76, v76, v78
    v_smfmac_f32_16x16x64_bf16 v[80:83], v[64:67], a[184:191], v3
    v_add_f32_e64 v77, v77, v79
    v_smfmac_f32_16x16x64_bf16 v[88:91], v[40:43], a[216:223], v3
    s_add_u32 s28, s28, 0x2000
    s_bitset0_b32 s28, 15
    v_cvt_pk_bf16_f32 v94, v76, v77
    s_add_u32 s69, s28, 0x1000
    v_add_f32 v80, v80, v82
    v_add_f32_e64 v81, v81, v83
    v_cvt_pk_bf16_f32 v95, v80, v81
    ds_write_b64 v6, v[94:95] offset:27296
    ds_read_b64_tr_b16 v[12:13], v7 offset:26752
    ds_read_b64_tr_b16 v[14:15], v7 offset:27024
    v_smfmac_f32_16x16x64_bf16 v[84:87], v[44:47], a[224:231], v3
    buffer_store_dword v18, v5, s[4:7], s32 offen sc1
    ds_read_b128 v[80:83], v9 offset:2048
    v_smfmac_f32_16x16x64_bf16 v[88:91], v[44:47], a[232:239], v3
    v_smfmac_f32_16x16x64_bf16 v[84:87], v[48:51], a[240:247], v3
    s_waitcnt lgkmcnt(3)
    s_barrier
    ds_read_b64_tr_b16 v[92:93], v7 offset:27840
    ds_read_b64_tr_b16 v[94:95], v7 offset:28112
    v_smfmac_f32_16x16x64_bf16 v[88:91], v[48:51], a[248:255], v3
    v_smfmac_f32_16x16x64_bf16 v[84:87], v[52:55], v[128:135], v3
    ds_read_b64_tr_b16 v[96:97], v7 offset:24576
    s_waitcnt lgkmcnt(4)
    v_mfma_f32_16x16x32_bf16 v[76:79], v[12:15], v[12:15], 0
    ds_read_b64_tr_b16 v[98:99], v7 offset:24848
    ds_read_b64_tr_b16 v[100:101], v7 offset:25664
    v_mfma_f32_16x16x32_bf16 v[68:71], v[104:107], v[12:15], 0
    ds_read_b64_tr_b16 v[102:103], v7 offset:25936
    ds_read_b128 v[104:107], v9 offset:1024
    v_mfma_f32_16x16x32_bf16 v[72:75], v[108:111], v[12:15], 0
    ds_read_b128 v[108:111], v9 offset:3072
    s_waitcnt lgkmcnt(6)
    v_mfma_f32_16x16x32_bf16 v[76:79], v[92:95], v[92:95], v[76:79]
    ds_read_b128 v[36:39], v1 offset:59392
    v_mfma_f32_16x16x32_bf16 v[68:71], v[112:115], v[92:95], v[68:71]
    v_mov_b64 v[112:113], s[20:21]
    v_mov_b64 v[114:115], s[16:17]
    v_mfma_f32_16x16x32_bf16 v[72:75], v[116:119], v[92:95], v[72:75]
    s_waitcnt lgkmcnt(3)
    v_mov_b64 v[116:117], 0
    v_mov_b64_e64 v[118:119], 0
    v_mfma_f32_16x16x32_bf16 v[68:71], v[120:123], v[96:99], v[68:71]
    s_mov_b64 vcc, s[14:15]
    v_mov_b64 v[120:121], 0
    v_mov_b64_e64 v[122:123], 0
    v_mfma_f32_16x16x32_bf16 v[68:71], v[80:83], v[100:103], v[68:71]
    s_waitcnt lgkmcnt(1)
    v_mov_b64 v[80:81], 0
    v_mov_b64_e64 v[82:83], 0
    v_mfma_f32_16x16x32_bf16 v[72:75], v[104:107], v[96:99], v[72:75]
    v_xor_b32 v9, 0x2000, v9
    v_mov_b32_e64 v16, s64
    v_mfma_f32_16x16x32_bf16 v[72:75], v[108:111], v[100:103], v[72:75]
    v_max3_f32 v12, v68, v69, v70
    v_mov_b32_e64 v109, 0
    v_mfma_f32_16x16x32_bf16 v[76:79], v[96:99], v[96:99], v[76:79]
    v_max_f32 v12, v12, v71
    v_mov_b32 v110, 0
    v_mfma_f32_16x16x32_bf16 v[76:79], v[100:103], v[100:103], v[76:79]
    v_max3_f32 v12, v12, v72, v73
    v_max3_f32 v12, v12, v74, v75
    v_smfmac_f32_16x16x64_bf16 v[88:91], v[52:55], v[136:143], v3
    ds_read_b128 v[40:43], v1 offset:60416
    v_cndmask_b32_dpp v68, v72, v68, vcc quad_perm:[2,3,2,3] row_mask:0xf bank_mask:0xf
    v_cndmask_b32_dpp v69, v73, v69, vcc quad_perm:[2,3,2,3] row_mask:0xf bank_mask:0xf
    v_max3_f32 v79, v12, v76, v77
    v_max3_f32 v96, v12, v76, v77
    v_smfmac_f32_16x16x64_bf16 v[84:87], v[56:59], v[144:151], v3
    ds_read_b128 v[44:47], v2 offset:8192
    v_permlane16_swap_b32 v79, v96
    v_max_f32 v78, v79, v96
    v_max_f32_e64 v79, v79, v96
    v_smfmac_f32_16x16x64_bf16 v[88:91], v[56:59], v[152:159], v3
    ds_read_b128 v[48:51], v2 offset:9216
    v_permlane32_swap_b32 v78, v79
    v_max_f32 v78, v78, v79
    v_smfmac_f32_16x16x64_bf16 v[84:87], v[60:63], v[160:167], v3
    ds_read_b128 v[52:55], v2 offset:10240
    v_mul_f32_dpp v78, v78, v16 quad_perm:[2,3,2,3] row_mask:0xf bank_mask:0xf
    v_smfmac_f32_16x16x64_bf16 v[88:91], v[60:63], v[168:175], v3
    ds_read_b128 v[56:59], v2 offset:11264
    v_cndmask_b32_dpp v76, v77, v76, vcc quad_perm:[2,3,2,3] row_mask:0xf bank_mask:0xf
    v_smfmac_f32_16x16x64_bf16 v[84:87], v[64:67], v[176:183], v3
    ds_read_b128 v[60:63], v2 offset:24576
    v_cndmask_b32_dpp v70, v74, v70, vcc quad_perm:[2,3,2,3] row_mask:0xf bank_mask:0xf
    v_smfmac_f32_16x16x64_bf16 v[88:91], v[64:67], v[184:191], v3
    ds_read_b128 v[64:67], v2 offset:25600
    v_cndmask_b32_dpp v71, v75, v71, vcc quad_perm:[2,3,2,3] row_mask:0xf bank_mask:0xf
    v_fma_f32 v76, v76, s64, -v78
    v_exp_f32_e64 v76, v76
    v_pk_fma_f32 v[68:69], v[68:69], s[12:13], v[78:79] op_sel_hi:[1,1,0] neg_lo:[0,0,1] neg_hi:[0,0,1]
    v_pk_fma_f32 v[70:71], v[70:71], s[12:13], v[78:79] op_sel_hi:[1,1,0] neg_lo:[0,0,1] neg_hi:[0,0,1]
    v_mov_b32_dpp v77, v76 quad_perm:[0,1,0,1] row_mask:0xf bank_mask:0xf
    v_pk_add_f32 v[84:85], v[84:85], v[86:87]
    v_pk_add_f32 v[88:89], v[88:89], v[90:91]
    v_cvt_pk_bf16_f32 v108, v76, v77
    v_cvt_pk_bf16_f32 v111, v76, v77
    v_cvt_pk_bf16_f32 v16, v84, v85
    v_cvt_pk_bf16_f32 v17, v88, v89
    v_exp_f32 v68, v68
    v_exp_f32 v69, v69
    v_mfma_f32_16x16x16_bf16 v[92:95], v[16:17], v[108:109], 0
    v_cvt_pk_bf16_f32 v104, v68, v69
    v_exp_f32_e64 v70, v70
    v_mfma_f32_16x16x16_bf16 v[96:99], v[16:17], v[110:111], 0
    v_exp_f32_e64 v71, v71
    v_cvt_pk_bf16_f32 v103, v76, 0
    v_cvt_pk_bf16_f32 v105, v70, v71
    v_mov_b32_dpp v106, v104 quad_perm:[0,1,0,1] row_mask:0xf bank_mask:0xf
    s_nop 0
    v_mfma_f32_16x16x32_bf16 v[72:75], v[112:115], v[102:105], 0
    v_mov_b32_dpp v107, v105 quad_perm:[0,1,0,1] row_mask:0xf bank_mask:0xf
    s_nop 1
    v_mfma_f32_16x16x32_bf16 v[92:95], v[20:23], v[104:107], v[92:95]
    v_mfma_f32_16x16x32_bf16 v[96:99], v[24:27], v[104:107], v[96:99]
    v_add_f32_dpp v72, v72, v72 quad_perm:[2,3,0,1] row_mask:0xf bank_mask:0xf
    v_rcp_f32 v72, v72
    s_mov_b64 exec, s[14:15]
    v_mul_f32 v92, v72, v92
    v_mul_f32 v93, v72, v93
    v_mul_f32 v94, v72, v94
    v_mul_f32 v95, v72, v95
    v_cvt_pk_bf16_f32 v84, v92, v93
    v_cvt_pk_bf16_f32 v85, v94, v95
    ds_write_b64 v8, v[84:85] offset:29952
    v_pk_mul_f32 v[96:97], v[96:97], v[72:73] op_sel_hi:[1,0]
    v_pk_mul_f32 v[98:99], v[98:99], v[72:73] op_sel_hi:[1,0]
    v_cvt_pk_bf16_f32 v86, v96, v97
    v_cvt_pk_bf16_f32 v87, v98, v99
    ds_write_b64 v8, v[86:87] offset:29960
    s_mov_b64 exec, -1
    v_mov_b32_dpp v88, v84 quad_perm:[2,3,2,3] row_mask:0xf bank_mask:0xf
    v_mov_b32_dpp v89, v85 quad_perm:[2,3,2,3] row_mask:0xf bank_mask:0xf
    v_mov_b32_dpp v90, v86 quad_perm:[2,3,2,3] row_mask:0xf bank_mask:0xf
    v_mov_b32_dpp v91, v87 quad_perm:[2,3,2,3] row_mask:0xf bank_mask:0xf
    s_waitcnt lgkmcnt(2)
    s_nop 0
    v_smfmac_f32_16x16x64_bf16 v[116:119], v[88:91], v[36:43], v3
    s_waitcnt lgkmcnt(0)
    s_barrier
    ds_read_b128 v[68:71], v8 offset:30464
    ds_read_b128 v[72:75], v8 offset:28928
    ds_read_b128 v[76:79], v8 offset:29440
    v_smfmac_f32_16x16x64_bf16 v[120:123], v[88:91], v[44:51], v3
    ds_read_b128 v[36:39], v1 offset:43008
    v_smfmac_f32_16x16x64_bf16 v[80:83], v[88:91], v[52:59], v3
    ds_read_b128 v[40:43], v1 offset:44032
    v_smfmac_f32_16x16x64_bf16 v[124:127], v[88:91], v[60:67], v3
    ds_read_b128 v[44:47], v2 offset:26624
    s_waitcnt lgkmcnt(5)
    v_smfmac_f32_16x16x64_bf16 v[116:119], v[68:71], v[192:199], v3
    ds_read_b128 v[48:51], v2 offset:27648
    s_waitcnt lgkmcnt(5)
    v_smfmac_f32_16x16x64_bf16 v[116:119], v[72:75], v[200:207], v3
    ds_read_b128 v[52:55], v1 offset:40960
    s_waitcnt lgkmcnt(5)
    v_smfmac_f32_16x16x64_bf16 v[116:119], v[76:79], v[208:215], v3
    ds_read_b128 v[56:59], v1 offset:41984
    ds_read_b128 v[60:63], v1 offset:57344
    v_smfmac_f32_16x16x64_bf16 v[120:123], v[68:71], v[216:223], v3
    ds_read_b128 v[64:67], v1 offset:58368
    v_smfmac_f32_16x16x64_bf16 v[120:123], v[72:75], v[224:231], v3
    v_cvt_pk_bf16_f32 v116, v116, v117
    v_cvt_pk_bf16_f32 v117, v118, v119
    v_bfi_b32 v116, 1, s18, v116
    v_bfi_b32 v117, 1, s18, v117
    v_smfmac_f32_16x16x64_bf16 v[120:123], v[76:79], v[232:239], v3
    buffer_store_dwordx2 v[116:117], v4, s[4:7], s29 offen sc1
    v_smfmac_f32_16x16x64_bf16 v[80:83], v[68:71], v[240:247], v3
    s_waitcnt lgkmcnt(0)
    v_smfmac_f32_16x16x64_bf16 v[80:83], v[72:75], v[248:255], v3
    v_cvt_pk_bf16_f32 v120, v120, v121
    v_cvt_pk_bf16_f32 v121, v122, v123
    v_bfi_b32 v120, 1, s18, v120
    v_bfi_b32 v121, 1, s18, v121
    v_smfmac_f32_16x16x64_bf16 v[80:83], v[76:79], v[36:43], v3
    buffer_store_dwordx2 v[120:121], v4, s[4:7], s8 offen sc1
    v_smfmac_f32_16x16x64_bf16 v[124:127], v[68:71], v[44:51], v3
    v_smfmac_f32_16x16x64_bf16 v[124:127], v[72:75], v[52:59], v3
    v_cvt_pk_bf16_f32 v80, v80, v81
    v_cvt_pk_bf16_f32 v81, v82, v83
    v_bfi_b32 v80, 1, s18, v80
    v_bfi_b32 v81, 1, s18, v81
    v_smfmac_f32_16x16x64_bf16 v[124:127], v[76:79], v[60:67], v3
    buffer_store_dwordx2 v[80:81], v4, s[4:7], s9 offen sc1
    s_nop 6
    v_cvt_pk_bf16_f32 v124, v124, v125
    v_cvt_pk_bf16_f32 v125, v126, v127
    v_bfi_b32 v124, 1, s18, v124
    v_bfi_b32 v125, 1, s18, v125
    buffer_store_dwordx2 v[124:125], v4, s[4:7], s10 offen sc1
    s_branch S2_loop
S2_pa1:
S2_par:
    buffer_load_dwordx4 v[40:43], v10, s[4:7], s30 offen sc1
    buffer_load_dwordx4 v[44:47], v10, s[4:7], s30 offen offset:2048 sc1
    s_waitcnt vmcnt(1)
    v_mfma_f32_16x16x32_bf16 v[64:67], v[12:15], v[40:43], 0
    v_bitop3_b32 v16, v40, v41, s18 bitop3:0x7e
    v_bitop3_b32 v17, v42, v43, s18 bitop3:0x7e
    s_waitcnt vmcnt(0)
    v_mfma_f32_16x16x32_bf16 v[64:67], v[12:15], v[44:47], v[64:67]
    v_bitop3_b32 v18, v44, v45, s18 bitop3:0x7e
    v_or3_b32 v16, v16, v17, v18
    v_bitop3_b32 v17, v46, v47, s18 bitop3:0x7e
    v_bitop3_b32 v16, v16, v17, 1 bitop3:0xa8
    v_cmp_ne_u32 vcc, 0, v16
    s_nop 1
    v_add_f32_dpp v64, v64, v64 row_ror:4 row_mask:0xf bank_mask:0xf
    v_add_f32_dpp v65, v65, v65 row_ror:4 row_mask:0xf bank_mask:0xf
    s_nop 0
    v_add_f32_dpp v64, v64, v64 row_ror:8 row_mask:0xf bank_mask:0xf
    v_add_f32_dpp v65, v65, v65 row_ror:8 row_mask:0xf bank_mask:0xf
    v_cvt_pk_bf16_f32 v18, v64, v65
    s_cbranch_vccz S2_pub
    s_add_u32 s35, s35, 1
    s_cmp_lt_u32 s35, 131072
    s_cbranch_scc1 S2_par
    s_branch L_END
S2_last:
    buffer_store_dword v18, v5, s[4:7], s32 offen sc1
    s_branch R_DONE
S2_flag:
    buffer_load_dword v11, off, s[4:7], s33 sc1
    s_waitcnt vmcnt(0)
    v_cmp_eq_u32 vcc, 0, v11
    s_cbranch_vccz S2_flagok
    s_add_u32 s35, s35, 1
    s_cmp_lt_u32 s35, 131072
    s_cbranch_scc1 S2_flag
    s_branch L_END
S2_pe1:
S2_pe2:
    buffer_load_dwordx4 v[36:39], v10, s[4:7], s28 offen sc1
    s_add_u32 s35, s35, 1
    s_cmp_ge_u32 s35, 131072
    s_cbranch_scc1 L_END
    s_waitcnt vmcnt(0)
    v_max3_u32 v16, v36, v37, v38
    v_max_u32 v16, v16, v39
    v_cmp_eq_u32 vcc, -1, v16
    ds_write_b128 v0, v[36:39] offset:18432
    s_cbranch_vccz S2_peok
    s_branch S2_pe2
S2_plr:
    s_mov_b32 m0, 22528
    s_nop 0
    buffer_load_dwordx4 v[52:55], v10, s[4:7], s69 offen sc1
    buffer_load_dwordx4 v10, s[4:7], s69 offen sc1 lds
    s_mov_b32 m0, s66
    s_waitcnt vmcnt(0)
    v_max3_u32 v16, v52, v53, v54
    v_max_u32 v16, v16, v55
    v_cmp_eq_u32 vcc, -1, v16
    s_waitcnt lgkmcnt(0)
    s_cbranch_vccz S2_plok
    s_add_u32 s35, s35, 1
    s_cmp_lt_u32 s35, 131072
    s_cbranch_scc1 S2_plr
    s_branch L_END
S3_loop:
    s_waitcnt vmcnt(0)
    s_xor_b32 s9, s9, 0x40000
    s_xor_b32 s10, s10, 0x40000
    v_mov_b64 v[80:81], 0
    v_mov_b64_e64 v[124:125], 0
    ds_read_b128 v[12:15], v0 offset:30976
    v_mov_b64_e64 v[68:69], 0
    ds_read_b128 v[92:95], v0 offset:61440
    v_mov_b64_e64 v[70:71], 0
    ds_read_b128 v[96:99], v0 offset:62464
    v_mov_b64_e64 v[72:73], 0
    ds_read_b128 v[100:103], v1 offset:28672
    v_mov_b64_e64 v[74:75], 0
    ds_read_b128 v[104:107], v1 offset:29696
    v_mov_b64_e64 v[76:77], 0
    ds_read_b128 v[108:111], v0 offset:63488
    v_mov_b64_e64 v[78:79], 0
    ds_read_b128 v[112:115], v0 offset:64512
    v_mov_b64_e64 v[82:83], 0
    ds_read_b128 v[116:119], v1 offset:30720
    v_mov_b64_e64 v[84:85], 0
    ds_read_b128 v[120:123], v1 offset:31744
    v_mov_b64_e64 v[86:87], 0
    s_xor_b32 s29, s29, 0x40000
    v_mov_b64_e64 v[88:89], 0
    s_xor_b32 s8, s8, 0x40000
    v_mov_b64_e64 v[90:91], 0
    s_add_u32 s32, s32, 0x2000
    v_mov_b64_e64 v[126:127], 0
    s_add_u32 s31, s31, 0x4000
    s_add_u32 s70, s31, 0x2000
    s_xor_b32 s66, s66, 0x2000
    s_mov_b32 m0, 23552
    s_waitcnt lgkmcnt(0)
    s_nop 6
    buffer_load_dwordx4 v[40:43], v10, s[4:7], s30 offen sc1
    buffer_load_dwordx4 v[44:47], v10, s[4:7], s30 offen offset:2048 sc1
    s_waitcnt vmcnt(1)
    v_mfma_f32_16x16x32_bf16 v[64:67], v[12:15], v[40:43], 0
    v_bitop3_b32 v16, v40, v41, s18 bitop3:0x7e
    v_bitop3_b32 v17, v42, v43, s18 bitop3:0x7e
    s_waitcnt vmcnt(0)
    v_mfma_f32_16x16x32_bf16 v[64:67], v[12:15], v[44:47], v[64:67]
    v_bitop3_b32 v18, v44, v45, s18 bitop3:0x7e
    v_or3_b32 v16, v16, v17, v18
    v_bitop3_b32 v17, v46, v47, s18 bitop3:0x7e
    v_bitop3_b32 v16, v16, v17, 1 bitop3:0xa8
    v_cmp_ne_u32 vcc, 0, v16
    s_nop 1
    v_add_f32_dpp v64, v64, v64 row_ror:4 row_mask:0xf bank_mask:0xf
    v_add_f32_dpp v65, v65, v65 row_ror:4 row_mask:0xf bank_mask:0xf
    s_nop 0
    v_add_f32_dpp v64, v64, v64 row_ror:8 row_mask:0xf bank_mask:0xf
    v_add_f32_dpp v65, v65, v65 row_ror:8 row_mask:0xf bank_mask:0xf
    v_cvt_pk_bf16_f32 v18, v64, v65
    s_cbranch_vccnz S3_pa1
S3_pub:
    buffer_store_dword v18, v5, s[4:7], s27 offen sc1
S3_pub2:
    s_cmp_eq_u32 s26, 63
    s_cbranch_scc1 S3_last
    v_cmp_eq_u32 vcc, 0, v11
    v_mov_b64 v[20:21], v[28:29]
    v_mov_b64 v[22:23], v[30:31]
    v_mov_b64 v[24:25], v[32:33]
    v_mov_b64_e64 v[26:27], v[34:35]
    s_xor_b32 s19, s27, 0x4000
    s_add_u32 s27, s27, 0x2000
    s_bitset0_b32 s27, 15
    s_xor_b32 s30, s30, 0x40000
    s_mov_b32 s35, 0
    s_cbranch_vccnz S3_flag
S3_flagok:
    s_add_u32 s67, s26, 2
    s_lshr_b32 s18, s67, 1
    s_add_u32 s33, s33, 16
    s_min_u32 s33, s33, s34
    s_add_u32 s26, s26, 1
    s_nop 1
    buffer_load_dwordx4 v[36:39], v10, s[4:7], s28 offen sc1
    s_waitcnt vmcnt(0)
    v_max3_u32 v16, v36, v37, v38
    v_max_u32 v16, v16, v39
    v_cmp_eq_u32 vcc, -1, v16
    ds_write_b128 v0, v[36:39] offset:19456
    s_cbranch_vccnz S3_pe1
S3_peok:
    v_smfmac_f32_16x16x64_bf16 v[68:71], v[36:39], v[92:99], v3
    buffer_load_dwordx4 v[52:55], v10, s[4:7], s69 offen sc1
    buffer_load_dwordx4 v10, s[4:7], s69 offen sc1 lds
    v_smfmac_f32_16x16x64_bf16 v[72:75], v[36:39], v[100:107], v3
    s_mov_b32 m0, s66
    v_smfmac_f32_16x16x64_bf16 v[76:79], v[36:39], v[108:115], v3
    s_waitcnt lgkmcnt(0)
    s_barrier
    ds_read_b128 v[40:43], v0 offset:16384
    ds_read_b128 v[44:47], v0 offset:17408
    v_smfmac_f32_16x16x64_bf16 v[80:83], v[36:39], v[116:123], v3
    ds_read_b128 v[48:51], v0 offset:18432
    v_smfmac_f32_16x16x64_bf16 v[84:87], v[36:39], a[192:199], v3
    ds_read_b128 v[92:95], v0 offset:45056
    v_smfmac_f32_16x16x64_bf16 v[88:91], v[36:39], a[200:207], v3
    ds_read_b128 v[96:99], v0 offset:46080
    s_waitcnt lgkmcnt(4)
    v_smfmac_f32_16x16x64_bf16 v[68:71], v[40:43], a[0:7], v3
    ds_read_b128 v[100:103], v0 offset:47104
    v_smfmac_f32_16x16x64_bf16 v[72:75], v[40:43], a[8:15], v3
    ds_read_b128 v[104:107], v0 offset:48128
    v_smfmac_f32_16x16x64_bf16 v[76:79], v[40:43], a[16:23], v3
    ds_read_b128 v[108:111], v1 offset:12288
    v_smfmac_f32_16x16x64_bf16 v[80:83], v[40:43], a[24:31], v3
    ds_read_b128 v[112:115], v1 offset:13312
    s_waitcnt lgkmcnt(7)
    v_smfmac_f32_16x16x64_bf16 v[68:71], v[44:47], a[32:39], v3
    ds_read_b128 v[116:119], v1 offset:14336
    v_smfmac_f32_16x16x64_bf16 v[72:75], v[44:47], a[40:47], v3
    ds_read_b128 v[120:123], v1 offset:15360
    v_smfmac_f32_16x16x64_bf16 v[76:79], v[44:47], a[48:55], v3
    v_smfmac_f32_16x16x64_bf16 v[80:83], v[44:47], a[56:63], v3
    s_waitcnt lgkmcnt(8)
    s_waitcnt lgkmcnt(6)
    v_smfmac_f32_16x16x64_bf16 v[68:71], v[48:51], v[92:99], v3
    s_waitcnt vmcnt(1)
    v_max3_u32 v16, v52, v53, v54
    v_smfmac_f32_16x16x64_bf16 v[72:75], v[48:51], a[64:71], v3
    s_waitcnt lgkmcnt(4)
    v_max_u32_e64 v16, v16, v55
    v_smfmac_f32_16x16x64_bf16 v[76:79], v[48:51], v[100:107], v3
    v_cmp_eq_u32_e64 vcc, -1, v16
    v_smfmac_f32_16x16x64_bf16 v[80:83], v[48:51], a[72:79], v3
    s_waitcnt vmcnt(0)
    s_waitcnt lgkmcnt(0)
    v_smfmac_f32_16x16x64_bf16 v[84:87], v[40:43], a[208:215], v3
    s_cbranch_vccnz S3_plr
S3_plok:
    s_barrier
    ds_read_b128 v[56:59], v0 offset:20480
    v_smfmac_f32_16x16x64_bf16 v[68:71], v[52:55], v[108:115], v3
    ds_read_b128 v[60:63], v0 offset:21504
    ds_read_b128 v[64:67], v0 offset:22528
    v_smfmac_f32_16x16x64_bf16 v[72:75], v[52:55], a[80:87], v3
    v_smfmac_f32_16x16x64_bf16 v[76:79], v[52:55], v[116:123], v3
    buffer_load_dwordx4 v0, s[4:7], s31 offen sc1 lds
    v_smfmac_f32_16x16x64_bf16 v[80:83], v[52:55], a[88:95], v3
    s_waitcnt lgkmcnt(2)
    v_smfmac_f32_16x16x64_bf16 v[68:71], v[56:59], a[96:103], v3
    buffer_load_dword v11, off, s[4:7], s33 sc1
    s_waitcnt lgkmcnt(1)
    v_smfmac_f32_16x16x64_bf16 v[68:71], v[60:63], a[104:111], v3
    s_waitcnt lgkmcnt(0)
    v_smfmac_f32_16x16x64_bf16 v[68:71], v[64:67], a[112:119], v3
    buffer_load_dwordx4 v0, s[4:7], s31 offen offset:1024 sc1 lds
    ds_read_b128 v[104:107], v9 offset:6144
    v_smfmac_f32_16x16x64_bf16 v[72:75], v[56:59], a[120:127], v3
    v_smfmac_f32_16x16x64_bf16 v[72:75], v[60:63], a[128:135], v3
    buffer_load_dwordx4 v[28:31], v0, s[4:7], s70 offen sc1
    ds_read_b128 v[108:111], v9 offset:7168
    v_add_f32 v68, v68, v70
    v_smfmac_f32_16x16x64_bf16 v[72:75], v[64:67], a[136:143], v3
    ds_read_b128 v[112:115], v9 offset:0
    v_add_f32_e64 v69, v69, v71
    v_smfmac_f32_16x16x64_bf16 v[76:79], v[56:59], a[144:151], v3
    v_cvt_pk_bf16_f32 v92, v68, v69
    v_smfmac_f32_16x16x64_bf16 v[76:79], v[60:63], a[152:159], v3
    buffer_load_dwordx4 v[32:35], v0, s[4:7], s70 offen offset:1024 sc1
    ds_read_b128 v[116:119], v9 offset:1024
    v_add_f32_e64 v72, v72, v74
    v_smfmac_f32_16x16x64_bf16 v[76:79], v[64:67], a[160:167], v3
    ds_read_b128 v[120:123], v9 offset:2048
    v_add_f32_e64 v73, v73, v75
    v_smfmac_f32_16x16x64_bf16 v[80:83], v[56:59], a[168:175], v3
    v_cvt_pk_bf16_f32 v93, v72, v73
    v_smfmac_f32_16x16x64_bf16 v[80:83], v[60:63], a[176:183], v3
    buffer_store_dword v19, v5, s[4:7], s19 offen sc1
    ds_write_b64 v6, v[92:93] offset:27840
    v_add_f32_e64 v76, v76, v78
    v_smfmac_f32_16x16x64_bf16 v[80:83], v[64:67], a[184:191], v3
    v_add_f32_e64 v77, v77, v79
    v_smfmac_f32_16x16x64_bf16 v[88:91], v[40:43], a[216:223], v3
    s_add_u32 s28, s28, 0x2000
    s_bitset0_b32 s28, 15
    v_cvt_pk_bf16_f32 v94, v76, v77
    s_add_u32 s69, s28, 0x1000
    v_add_f32 v80, v80, v82
    v_add_f32_e64 v81, v81, v83
    v_cvt_pk_bf16_f32 v95, v80, v81
    ds_write_b64 v6, v[94:95] offset:28384
    ds_read_b64_tr_b16 v[12:13], v7 offset:27840
    ds_read_b64_tr_b16 v[14:15], v7 offset:28112
    v_smfmac_f32_16x16x64_bf16 v[84:87], v[44:47], a[224:231], v3
    ds_read_b128 v[80:83], v9 offset:4096
    v_smfmac_f32_16x16x64_bf16 v[88:91], v[44:47], a[232:239], v3
    buffer_store_dword v18, v5, s[4:7], s32 offen sc1
    v_smfmac_f32_16x16x64_bf16 v[84:87], v[48:51], a[240:247], v3
    s_waitcnt lgkmcnt(3)
    s_barrier
    ds_read_b64_tr_b16 v[92:93], v7 offset:24576
    ds_read_b64_tr_b16 v[94:95], v7 offset:24848
    v_smfmac_f32_16x16x64_bf16 v[88:91], v[48:51], a[248:255], v3
    v_smfmac_f32_16x16x64_bf16 v[84:87], v[52:55], v[128:135], v3
    ds_read_b64_tr_b16 v[96:97], v7 offset:25664
    s_waitcnt lgkmcnt(4)
    v_mfma_f32_16x16x32_bf16 v[76:79], v[12:15], v[12:15], 0
    ds_read_b64_tr_b16 v[98:99], v7 offset:25936
    ds_read_b64_tr_b16 v[100:101], v7 offset:26752
    v_mfma_f32_16x16x32_bf16 v[68:71], v[104:107], v[12:15], 0
    ds_read_b64_tr_b16 v[102:103], v7 offset:27024
    ds_read_b128 v[104:107], v9 offset:3072
    v_mfma_f32_16x16x32_bf16 v[72:75], v[108:111], v[12:15], 0
    ds_read_b128 v[108:111], v9 offset:5120
    s_waitcnt lgkmcnt(6)
    v_mfma_f32_16x16x32_bf16 v[76:79], v[92:95], v[92:95], v[76:79]
    ds_read_b128 v[36:39], v2 offset:12288
    v_mfma_f32_16x16x32_bf16 v[68:71], v[112:115], v[92:95], v[68:71]
    v_mov_b64 v[112:113], s[20:21]
    v_mov_b64 v[114:115], s[16:17]
    v_mfma_f32_16x16x32_bf16 v[72:75], v[116:119], v[92:95], v[72:75]
    s_waitcnt lgkmcnt(3)
    v_mov_b64 v[116:117], 0
    v_mov_b64_e64 v[118:119], 0
    v_mfma_f32_16x16x32_bf16 v[68:71], v[120:123], v[96:99], v[68:71]
    s_mov_b64 vcc, s[14:15]
    v_mov_b64 v[120:121], 0
    v_mov_b64_e64 v[122:123], 0
    v_mfma_f32_16x16x32_bf16 v[68:71], v[80:83], v[100:103], v[68:71]
    s_waitcnt lgkmcnt(1)
    v_mov_b64 v[80:81], 0
    v_mov_b64_e64 v[82:83], 0
    v_mfma_f32_16x16x32_bf16 v[72:75], v[104:107], v[96:99], v[72:75]
    v_xor_b32 v9, 0x2000, v9
    v_mov_b32_e64 v16, s64
    v_mfma_f32_16x16x32_bf16 v[72:75], v[108:111], v[100:103], v[72:75]
    v_max3_f32 v12, v68, v69, v70
    v_mov_b32_e64 v109, 0
    v_mfma_f32_16x16x32_bf16 v[76:79], v[96:99], v[96:99], v[76:79]
    v_max_f32 v12, v12, v71
    v_mov_b32 v110, 0
    v_mfma_f32_16x16x32_bf16 v[76:79], v[100:103], v[100:103], v[76:79]
    v_max3_f32 v12, v12, v72, v73
    v_max3_f32 v12, v12, v74, v75
    v_smfmac_f32_16x16x64_bf16 v[88:91], v[52:55], v[136:143], v3
    ds_read_b128 v[40:43], v2 offset:13312
    v_cndmask_b32_dpp v68, v72, v68, vcc quad_perm:[2,3,2,3] row_mask:0xf bank_mask:0xf
    v_cndmask_b32_dpp v69, v73, v69, vcc quad_perm:[2,3,2,3] row_mask:0xf bank_mask:0xf
    v_max3_f32 v79, v12, v76, v77
    v_max3_f32 v96, v12, v76, v77
    v_smfmac_f32_16x16x64_bf16 v[84:87], v[56:59], v[144:151], v3
    ds_read_b128 v[44:47], v2 offset:14336
    v_permlane16_swap_b32 v79, v96
    v_max_f32 v78, v79, v96
    v_max_f32_e64 v79, v79, v96
    v_smfmac_f32_16x16x64_bf16 v[88:91], v[56:59], v[152:159], v3
    ds_read_b128 v[48:51], v2 offset:15360
    v_permlane32_swap_b32 v78, v79
    v_max_f32 v78, v78, v79
    v_smfmac_f32_16x16x64_bf16 v[84:87], v[60:63], v[160:167], v3
    ds_read_b128 v[52:55], v2 offset:28672
    v_mul_f32_dpp v78, v78, v16 quad_perm:[2,3,2,3] row_mask:0xf bank_mask:0xf
    v_smfmac_f32_16x16x64_bf16 v[88:91], v[60:63], v[168:175], v3
    ds_read_b128 v[56:59], v2 offset:29696
    v_cndmask_b32_dpp v76, v77, v76, vcc quad_perm:[2,3,2,3] row_mask:0xf bank_mask:0xf
    v_smfmac_f32_16x16x64_bf16 v[84:87], v[64:67], v[176:183], v3
    ds_read_b128 v[60:63], v2 offset:30720
    v_cndmask_b32_dpp v70, v74, v70, vcc quad_perm:[2,3,2,3] row_mask:0xf bank_mask:0xf
    v_smfmac_f32_16x16x64_bf16 v[88:91], v[64:67], v[184:191], v3
    ds_read_b128 v[64:67], v2 offset:31744
    v_cndmask_b32_dpp v71, v75, v71, vcc quad_perm:[2,3,2,3] row_mask:0xf bank_mask:0xf
    v_fma_f32 v76, v76, s64, -v78
    v_exp_f32_e64 v76, v76
    v_pk_fma_f32 v[68:69], v[68:69], s[12:13], v[78:79] op_sel_hi:[1,1,0] neg_lo:[0,0,1] neg_hi:[0,0,1]
    v_pk_fma_f32 v[70:71], v[70:71], s[12:13], v[78:79] op_sel_hi:[1,1,0] neg_lo:[0,0,1] neg_hi:[0,0,1]
    v_mov_b32_dpp v77, v76 quad_perm:[0,1,0,1] row_mask:0xf bank_mask:0xf
    v_pk_add_f32 v[84:85], v[84:85], v[86:87]
    v_pk_add_f32 v[88:89], v[88:89], v[90:91]
    v_cvt_pk_bf16_f32 v108, v76, v77
    v_cvt_pk_bf16_f32 v111, v76, v77
    v_cvt_pk_bf16_f32 v16, v84, v85
    v_cvt_pk_bf16_f32 v17, v88, v89
    v_exp_f32 v68, v68
    v_exp_f32 v69, v69
    v_mfma_f32_16x16x16_bf16 v[92:95], v[16:17], v[108:109], 0
    v_cvt_pk_bf16_f32 v104, v68, v69
    v_exp_f32_e64 v70, v70
    v_mfma_f32_16x16x16_bf16 v[96:99], v[16:17], v[110:111], 0
    v_exp_f32_e64 v71, v71
    v_cvt_pk_bf16_f32 v103, v76, 0
    v_cvt_pk_bf16_f32 v105, v70, v71
    v_mov_b32_dpp v106, v104 quad_perm:[0,1,0,1] row_mask:0xf bank_mask:0xf
    s_nop 0
    v_mfma_f32_16x16x32_bf16 v[72:75], v[112:115], v[102:105], 0
    v_mov_b32_dpp v107, v105 quad_perm:[0,1,0,1] row_mask:0xf bank_mask:0xf
    s_nop 1
    v_mfma_f32_16x16x32_bf16 v[92:95], v[20:23], v[104:107], v[92:95]
    v_mfma_f32_16x16x32_bf16 v[96:99], v[24:27], v[104:107], v[96:99]
    v_add_f32_dpp v72, v72, v72 quad_perm:[2,3,0,1] row_mask:0xf bank_mask:0xf
    v_rcp_f32 v72, v72
    s_mov_b64 exec, s[14:15]
    v_mul_f32 v92, v72, v92
    v_mul_f32 v93, v72, v93
    v_mul_f32 v94, v72, v94
    v_mul_f32 v95, v72, v95
    v_cvt_pk_bf16_f32 v84, v92, v93
    v_cvt_pk_bf16_f32 v85, v94, v95
    ds_write_b64 v8, v[84:85] offset:30464
    v_pk_mul_f32 v[96:97], v[96:97], v[72:73] op_sel_hi:[1,0]
    v_pk_mul_f32 v[98:99], v[98:99], v[72:73] op_sel_hi:[1,0]
    v_cvt_pk_bf16_f32 v86, v96, v97
    v_cvt_pk_bf16_f32 v87, v98, v99
    ds_write_b64 v8, v[86:87] offset:30472
    s_mov_b64 exec, -1
    v_mov_b32_dpp v88, v84 quad_perm:[2,3,2,3] row_mask:0xf bank_mask:0xf
    v_mov_b32_dpp v89, v85 quad_perm:[2,3,2,3] row_mask:0xf bank_mask:0xf
    v_mov_b32_dpp v90, v86 quad_perm:[2,3,2,3] row_mask:0xf bank_mask:0xf
    v_mov_b32_dpp v91, v87 quad_perm:[2,3,2,3] row_mask:0xf bank_mask:0xf
    s_waitcnt lgkmcnt(2)
    s_nop 0
    v_smfmac_f32_16x16x64_bf16 v[116:119], v[88:91], v[36:43], v3
    s_waitcnt lgkmcnt(0)
    s_barrier
    ds_read_b128 v[68:71], v8 offset:28928
    ds_read_b128 v[72:75], v8 offset:29440
    ds_read_b128 v[76:79], v8 offset:29952
    v_smfmac_f32_16x16x64_bf16 v[120:123], v[88:91], v[44:51], v3
    ds_read_b128 v[36:39], v1 offset:61440
    v_smfmac_f32_16x16x64_bf16 v[80:83], v[88:91], v[52:59], v3
    ds_read_b128 v[40:43], v1 offset:62464
    v_smfmac_f32_16x16x64_bf16 v[124:127], v[88:91], v[60:67], v3
    ds_read_b128 v[44:47], v1 offset:45056
    s_waitcnt lgkmcnt(5)
    v_smfmac_f32_16x16x64_bf16 v[116:119], v[68:71], v[192:199], v3
    ds_read_b128 v[48:51], v1 offset:46080
    s_waitcnt lgkmcnt(5)
    v_smfmac_f32_16x16x64_bf16 v[116:119], v[72:75], v[200:207], v3
    ds_read_b128 v[52:55], v1 offset:47104
    s_waitcnt lgkmcnt(5)
    v_smfmac_f32_16x16x64_bf16 v[116:119], v[76:79], v[208:215], v3
    ds_read_b128 v[56:59], v1 offset:48128
    ds_read_b128 v[60:63], v1 offset:63488
    v_smfmac_f32_16x16x64_bf16 v[120:123], v[68:71], v[216:223], v3
    ds_read_b128 v[64:67], v1 offset:64512
    v_smfmac_f32_16x16x64_bf16 v[120:123], v[72:75], v[224:231], v3
    v_cvt_pk_bf16_f32 v116, v116, v117
    v_cvt_pk_bf16_f32 v117, v118, v119
    v_bfi_b32 v116, 1, s18, v116
    v_bfi_b32 v117, 1, s18, v117
    v_smfmac_f32_16x16x64_bf16 v[120:123], v[76:79], v[232:239], v3
    buffer_store_dwordx2 v[116:117], v4, s[4:7], s29 offen sc1
    v_smfmac_f32_16x16x64_bf16 v[80:83], v[68:71], v[240:247], v3
    s_waitcnt lgkmcnt(0)
    v_smfmac_f32_16x16x64_bf16 v[80:83], v[72:75], v[248:255], v3
    v_cvt_pk_bf16_f32 v120, v120, v121
    v_cvt_pk_bf16_f32 v121, v122, v123
    v_bfi_b32 v120, 1, s18, v120
    v_bfi_b32 v121, 1, s18, v121
    v_smfmac_f32_16x16x64_bf16 v[80:83], v[76:79], v[36:43], v3
    buffer_store_dwordx2 v[120:121], v4, s[4:7], s8 offen sc1
    v_smfmac_f32_16x16x64_bf16 v[124:127], v[68:71], v[44:51], v3
    v_smfmac_f32_16x16x64_bf16 v[124:127], v[72:75], v[52:59], v3
    v_cvt_pk_bf16_f32 v80, v80, v81
    v_cvt_pk_bf16_f32 v81, v82, v83
    v_bfi_b32 v80, 1, s18, v80
    v_bfi_b32 v81, 1, s18, v81
    v_smfmac_f32_16x16x64_bf16 v[124:127], v[76:79], v[60:67], v3
    buffer_store_dwordx2 v[80:81], v4, s[4:7], s9 offen sc1
    s_nop 6
    v_cvt_pk_bf16_f32 v124, v124, v125
    v_cvt_pk_bf16_f32 v125, v126, v127
    v_bfi_b32 v124, 1, s18, v124
    v_bfi_b32 v125, 1, s18, v125
    buffer_store_dwordx2 v[124:125], v4, s[4:7], s10 offen sc1
    s_branch S3_loop
S3_pa1:
S3_par:
    buffer_load_dwordx4 v[40:43], v10, s[4:7], s30 offen sc1
    buffer_load_dwordx4 v[44:47], v10, s[4:7], s30 offen offset:2048 sc1
    s_waitcnt vmcnt(1)
    v_mfma_f32_16x16x32_bf16 v[64:67], v[12:15], v[40:43], 0
    v_bitop3_b32 v16, v40, v41, s18 bitop3:0x7e
    v_bitop3_b32 v17, v42, v43, s18 bitop3:0x7e
    s_waitcnt vmcnt(0)
    v_mfma_f32_16x16x32_bf16 v[64:67], v[12:15], v[44:47], v[64:67]
    v_bitop3_b32 v18, v44, v45, s18 bitop3:0x7e
    v_or3_b32 v16, v16, v17, v18
    v_bitop3_b32 v17, v46, v47, s18 bitop3:0x7e
    v_bitop3_b32 v16, v16, v17, 1 bitop3:0xa8
    v_cmp_ne_u32 vcc, 0, v16
    s_nop 1
    v_add_f32_dpp v64, v64, v64 row_ror:4 row_mask:0xf bank_mask:0xf
    v_add_f32_dpp v65, v65, v65 row_ror:4 row_mask:0xf bank_mask:0xf
    s_nop 0
    v_add_f32_dpp v64, v64, v64 row_ror:8 row_mask:0xf bank_mask:0xf
    v_add_f32_dpp v65, v65, v65 row_ror:8 row_mask:0xf bank_mask:0xf
    v_cvt_pk_bf16_f32 v18, v64, v65
    s_cbranch_vccz S3_pub
    s_add_u32 s35, s35, 1
    s_cmp_lt_u32 s35, 131072
    s_cbranch_scc1 S3_par
    s_branch L_END
S3_last:
    buffer_store_dword v18, v5, s[4:7], s32 offen sc1
    s_branch R_DONE
S3_flag:
    buffer_load_dword v11, off, s[4:7], s33 sc1
    s_waitcnt vmcnt(0)
    v_cmp_eq_u32 vcc, 0, v11
    s_cbranch_vccz S3_flagok
    s_add_u32 s35, s35, 1
    s_cmp_lt_u32 s35, 131072
    s_cbranch_scc1 S3_flag
    s_branch L_END
S3_pe1:
S3_pe2:
    buffer_load_dwordx4 v[36:39], v10, s[4:7], s28 offen sc1
    s_add_u32 s35, s35, 1
    s_cmp_ge_u32 s35, 131072
    s_cbranch_scc1 L_END
    s_waitcnt vmcnt(0)
    v_max3_u32 v16, v36, v37, v38
    v_max_u32 v16, v16, v39
    v_cmp_eq_u32 vcc, -1, v16
    ds_write_b128 v0, v[36:39] offset:19456
    s_cbranch_vccz S3_peok
    s_branch S3_pe2
S3_plr:
    s_mov_b32 m0, 23552
    s_nop 0
    buffer_load_dwordx4 v[52:55], v10, s[4:7], s69 offen sc1
    buffer_load_dwordx4 v10, s[4:7], s69 offen sc1 lds
    s_mov_b32 m0, s66
    s_waitcnt vmcnt(0)
    v_max3_u32 v16, v52, v53, v54
    v_max_u32 v16, v16, v55
    v_cmp_eq_u32 vcc, -1, v16
    s_waitcnt lgkmcnt(0)
    s_cbranch_vccz S3_plok
    s_add_u32 s35, s35, 1
    s_cmp_lt_u32 s35, 131072
    s_cbranch_scc1 S3_plr
    s_branch L_END
R_DONE:
    s_branch L_END
L_OVER:
    v_lshlrev_b32 v2, 5, v0
    v_and_b32 v2, 0xe0, v2
    s_mov_b32 s89, 0
L_OVER1:
    global_load_dword v3, v2, s[60:61] sc1
    s_waitcnt vmcnt(0)
    v_readlane_b32 s80, v3, 0
    v_readlane_b32 s81, v3, 1
    v_readlane_b32 s82, v3, 2
    v_readlane_b32 s83, v3, 3
    v_readlane_b32 s84, v3, 4
    v_readlane_b32 s85, v3, 5
    v_readlane_b32 s86, v3, 6
    v_readlane_b32 s87, v3, 7
    s_nop 3
    s_add_u32 s88, s80, s81
    s_add_u32 s88, s88, s82
    s_add_u32 s88, s88, s83
    s_add_u32 s88, s88, s84
    s_add_u32 s88, s88, s85
    s_add_u32 s88, s88, s86
    s_add_u32 s88, s88, s87
    s_cmp_ge_u32 s88, 256
    s_cbranch_scc1 L_OVER2
    s_sleep 16
    s_add_u32 s89, s89, 1
    s_cmp_lt_u32 s89, 131072
    s_cbranch_scc1 L_OVER1
    s_branch L_END
L_OVER2:
    s_sub_u32 s88, s24, 32
    s_max_u32 s89, s80, 32
    s_sub_u32 s89, s89, 32
    s_cmp_gt_u32 s3, 0
    s_cselect_b32 s89, s89, 0
    s_add_u32 s88, s88, s89
    s_max_u32 s89, s81, 32
    s_sub_u32 s89, s89, 32
    s_cmp_gt_u32 s3, 1
    s_cselect_b32 s89, s89, 0
    s_add_u32 s88, s88, s89
    s_max_u32 s89, s82, 32
    s_sub_u32 s89, s89, 32
    s_cmp_gt_u32 s3, 2
    s_cselect_b32 s89, s89, 0
    s_add_u32 s88, s88, s89
    s_max_u32 s89, s83, 32
    s_sub_u32 s89, s89, 32
    s_cmp_gt_u32 s3, 3
    s_cselect_b32 s89, s89, 0
    s_add_u32 s88, s88, s89
    s_max_u32 s89, s84, 32
    s_sub_u32 s89, s89, 32
    s_cmp_gt_u32 s3, 4
    s_cselect_b32 s89, s89, 0
    s_add_u32 s88, s88, s89
    s_max_u32 s89, s85, 32
    s_sub_u32 s89, s89, 32
    s_cmp_gt_u32 s3, 5
    s_cselect_b32 s89, s89, 0
    s_add_u32 s88, s88, s89
    s_max_u32 s89, s86, 32
    s_sub_u32 s89, s89, 32
    s_cmp_gt_u32 s3, 6
    s_cselect_b32 s89, s89, 0
    s_add_u32 s88, s88, s89
    s_min_u32 s89, s80, 32
    s_add_u32 s24, s89, s88
    s_mov_b32 s3, 0
    s_cmp_lt_u32 s24, 32
    s_cbranch_scc1 L_ROLE
    s_sub_u32 s88, s24, 32
    s_min_u32 s89, s81, 32
    s_add_u32 s24, s89, s88
    s_mov_b32 s3, 1
    s_cmp_lt_u32 s24, 32
    s_cbranch_scc1 L_ROLE
    s_sub_u32 s88, s24, 32
    s_min_u32 s89, s82, 32
    s_add_u32 s24, s89, s88
    s_mov_b32 s3, 2
    s_cmp_lt_u32 s24, 32
    s_cbranch_scc1 L_ROLE
    s_sub_u32 s88, s24, 32
    s_min_u32 s89, s83, 32
    s_add_u32 s24, s89, s88
    s_mov_b32 s3, 3
    s_cmp_lt_u32 s24, 32
    s_cbranch_scc1 L_ROLE
    s_sub_u32 s88, s24, 32
    s_min_u32 s89, s84, 32
    s_add_u32 s24, s89, s88
    s_mov_b32 s3, 4
    s_cmp_lt_u32 s24, 32
    s_cbranch_scc1 L_ROLE
    s_sub_u32 s88, s24, 32
    s_min_u32 s89, s85, 32
    s_add_u32 s24, s89, s88
    s_mov_b32 s3, 5
    s_cmp_lt_u32 s24, 32
    s_cbranch_scc1 L_ROLE
    s_sub_u32 s88, s24, 32
    s_min_u32 s89, s86, 32
    s_add_u32 s24, s89, s88
    s_mov_b32 s3, 6
    s_cmp_lt_u32 s24, 32
    s_cbranch_scc1 L_ROLE
    s_sub_u32 s88, s24, 32
    s_min_u32 s89, s87, 32
    s_add_u32 s24, s89, s88
    s_mov_b32 s3, 7
    s_cmp_lt_u32 s24, 32
    s_cbranch_scc1 L_ROLE
    s_sub_u32 s88, s24, 32
    s_branch L_END
L_END:
L_LAST:
    s_endpgm
.section .rodata,"a"
.p2align 6
.amdhsa_kernel parallel_sum__memory_aug_recurrent_mem_tr__glu_gated_swiglu__prompt_kernel
  .amdhsa_next_free_vgpr 512
  .amdhsa_next_free_sgpr 102
  .amdhsa_accum_offset 256
  .amdhsa_group_segment_fixed_size 0
  .amdhsa_kernarg_size 112
  .amdhsa_user_sgpr_count 2
  .amdhsa_user_sgpr_kernarg_segment_ptr 1
  .amdhsa_system_sgpr_workgroup_id_x 1
.end_amdhsa_kernel
```
